```python
import torch

def _softmax(x, axis=-1):
    return torch.softmax(x, dim=axis)
def _gelu(x):
    return torch.nn.functional.gelu(x, approximate="tanh")
def _silu(x):
    return torch.nn.functional.silu(x)
def _sigmoid(x):
    return torch.sigmoid(x)
def _layernorm(x, axis=-1, eps=1e-5):
    m = x.mean(dim=axis, keepdim=True)
    v = x.var(dim=axis, keepdim=True, unbiased=False)
    return (x - m) / torch.sqrt(v + eps)
def _scatter_add(tgt, idx, src, axis=0):
    return tgt.clone().index_add_(axis, idx, src)
def _segment_sum(src, seg, n):
    out = torch.zeros((n,) + src.shape[1:], dtype=src.dtype)
    return out.index_add_(0, seg, src)
def _pad(x, pw):
    flat = tuple(v for pair in reversed(pw) for v in pair)
    return torch.nn.functional.pad(x, flat)

kernel_name = 'interleave_layers__ssm_conv_h3__swiglu_ffn__prompt'

def setup_inputs():

    _w = (lambda a: (lambda t: t.to(torch.bfloat16) if t.is_floating_point() else t)(torch.as_tensor(a)))
    def _A_setup():
        B, S, D = 1, 2048, 640
        ks = 4
        return {
            "q": _w((lambda *s: torch.randn(*s, dtype=torch.bfloat16) * 0.05)(B, S, D)),
            "k": _w((lambda *s: torch.randn(*s, dtype=torch.bfloat16) * 1.6)(B, S, D)),
            "v": _w((lambda *s: torch.randn(*s, dtype=torch.bfloat16) * 1.6)(B, S, D)),
            "shift_k": _w((lambda *s: torch.randn(*s, dtype=torch.bfloat16) * 1.6)(D, ks) * 0.5),
            "ssm_k": _w((lambda *s: torch.randn(*s, dtype=torch.bfloat16) * 1.6)(D, S) * (1.0 / S ** 0.5)),
            "ssm_D": _w((lambda *s: torch.randn(*s, dtype=torch.bfloat16) * 1.6)(D)),
        }
    _A_in = _A_setup()

    def _B_setup():
        B, S, D, F = 1, 2048, 640, 1728
        return {
            "x": _w((lambda *s: torch.randn(*s, dtype=torch.bfloat16) * 0.05)(B, S, D)),
            "w_gate": _w((lambda *s: torch.randn(*s, dtype=torch.bfloat16) * 0.2)(D, F)),
            "w_up": _w((lambda *s: torch.randn(*s, dtype=torch.bfloat16) * 0.2)(D, F)),
            "w_down": _w((lambda *s: torch.randn(*s, dtype=torch.bfloat16) * 0.2)(F, D)),
        }
    _B_in = _B_setup()

    return {
        "A_q": _A_in["q"],
        "A_k": _A_in["k"],
        "A_v": _A_in["v"],
        "A_shift_k": _A_in["shift_k"],
        "A_ssm_k": _A_in["ssm_k"],
        "A_ssm_D": _A_in["ssm_D"],
        "B_x": _B_in["x"],
        "B_w_gate": _B_in["w_gate"],
        "B_w_up": _B_in["w_up"],
        "B_w_down": _B_in["w_down"],
    }

def reference(A_q, A_k, A_v, A_shift_k, A_ssm_k, A_ssm_D, B_x, B_w_gate, B_w_up, B_w_down):
    def _A_ref(q, k, v, shift_k, ssm_k, ssm_D):
        B, S, D = q.shape
        ks = shift_k.shape[-1]
        k_pad = _pad(k, ((0, 0), (ks - 1, 0), (0, 0)))
        k_shift = torch.zeros_like(k)
        for t in range(ks):
            k_shift = k_shift + k_pad[:, t:t + S, :] * shift_k[:, ks - 1 - t][None, None, :]
        kv = k_shift * v
        L = 2 * S
        kv_pad = _pad(kv, ((0, 0), (0, S), (0, 0)))
        kf_pad = _pad(ssm_k, ((0, 0), (0, S)))
        kv_f = (lambda x, axes=(-2,-1): torch.fft.rfft2(x.float(), dim=axes))(kv_pad[:, None, :, :], axes=(1, 2))
        kf_f = (lambda x, axes=(-2,-1): torch.fft.rfft2(x.float(), dim=axes))(kf_pad[:, None, :], axes=(1, 2))
        kf_f = (lambda x, *d: x.permute(*d))(kf_f, 1, 2, 0)
        y_f = kv_f * kf_f[None, :, :, :]
        y = (lambda x, s, axes=(-2,-1): torch.fft.irfft2(x, s=s, dim=axes).to(torch.bfloat16))(y_f, (1, L), axes=(1, 2))[:, 0, :S, :]
        y = y + kv * ssm_D[None, None, :]
        return q * y

    def _B_ref(x, w_gate, w_up, w_down):
        g = _silu(x @ w_gate)
        u = x @ w_up
        return (g * u) @ w_down

    x = A_q
    x = x + _A_ref(_layernorm(x, axis=-1), A_k, A_v, A_shift_k, A_ssm_k, A_ssm_D)
    x = x + _B_ref(_layernorm(x, axis=-1), B_w_gate, B_w_up, B_w_down)
    x = x + _A_ref(_layernorm(x, axis=-1), A_k, A_v, A_shift_k, A_ssm_k, A_ssm_D)
    x = x + _B_ref(_layernorm(x, axis=-1), B_w_gate, B_w_up, B_w_down)
    return x
```

```asm
; @launch grid=(256,1,1) block=(256,1,1) lds=163840
.amdgcn_target "amdgcn-amd-amdhsa--gfx950"
.text
.globl interleave_layers__ssm_conv_h3__swiglu_ffn__prompt_kernel
.p2align 8
.type interleave_layers__ssm_conv_h3__swiglu_ffn__prompt_kernel,@function
interleave_layers__ssm_conv_h3__swiglu_ffn__prompt_kernel:
s_cmp_ge_u32 s2, 248
s_cbranch_scc1 Lend
s_load_dwordx16 s[64:79], s[0:1], 0
s_load_dwordx8 s[80:87], s[0:1], 64
s_load_dwordx2 s[88:89], s[0:1], 96
v_lshrrev_b32 v2, 6, v0
v_and_b32 v1, 63, v0
s_and_b32 s21, s2, 7
v_readfirstlane_b32 s3, v2
s_lshr_b32 s22, s2, 3
s_lshr_b32 s23, s21, 1
s_and_b32 s24, s21, 1
s_cmp_ge_u32 s22, 21
s_cbranch_scc1 Lrole_g2
s_mul_i32 s37, s21, 21
s_add_u32 s37, s37, s22
s_cmp_ge_u32 s37, 160
s_cbranch_scc1 Lg1_noconv
s_lshl_b32 s38, s37, 2
s_add_u32 s38, s38, s3
s_mul_i32 s26, s22, 37
s_lshr_b32 s26, s26, 8
s_mul_i32 s26, s26, 7
s_sub_u32 s26, s22, s26
s_mul_i32 s27, s24, 7
s_add_u32 s26, s26, s27
s_lshl_b32 s26, s26, 8
s_mul_i32 s46, s3, 27648
s_lshl_b32 s47, s3, 11
v_lshrrev_b32 v20, 4, v1
v_bfe_u32 v21, v1, 1, 3
v_xor_b32 v21, v20, v21
v_lshlrev_b32 v21, 5, v21
v_mul_u32_u24 v20, 3456, v20
v_add_u32 v20, s26, v20
v_and_b32 v14, 1, v1
v_lshl_add_u32 v20, v14, 4, v20
v_add_u32 v14, v21, v20
v_xor_b32 v21, 128, v21
v_add_u32 v15, v21, v20
s_lshl_b32 s27, s3, 1
s_add_u32 s27, s27, 0
v_lshrrev_b32 v20, 4, v1
v_bfe_u32 v21, v1, 2, 2
v_lshlrev_b32 v6, 8, v21
v_lshl_add_u32 v6, v20, 10, v6
v_and_b32 v20, 1, v20
v_lshl_add_u32 v21, v20, 2, v21
v_xor_b32 v21, s27, v21
v_lshl_add_u32 v6, v21, 5, v6
v_and_b32 v20, 3, v1
v_lshl_add_u32 v6, v20, 3, v6
s_lshl_b32 s27, s3, 1
s_add_u32 s27, s27, 1
v_lshrrev_b32 v20, 4, v1
v_bfe_u32 v21, v1, 2, 2
v_lshlrev_b32 v7, 8, v21
v_lshl_add_u32 v7, v20, 10, v7
v_and_b32 v20, 1, v20
v_lshl_add_u32 v21, v20, 2, v21
v_xor_b32 v21, s27, v21
v_lshl_add_u32 v7, v21, 5, v7
v_and_b32 v20, 3, v1
v_lshl_add_u32 v7, v20, 3, v7
s_and_b32 s28, s37, 15
s_lshl_b32 s28, s28, 7
s_lshr_b32 s29, s37, 4
s_lshl_b32 s29, s29, 6
s_and_b32 s27, s3, 1
s_lshl_b32 s27, s27, 6
s_add_u32 s28, s28, s27
s_lshr_b32 s27, s3, 1
s_lshl_b32 s27, s27, 5
s_add_u32 s29, s29, s27
v_and_b32 v2, 7, v1
v_lshrrev_b32 v3, 3, v1
v_lshlrev_b32 v8, 3, v2
v_add_u32 v8, s28, v8
v_lshlrev_b32 v9, 2, v3
v_add_u32 v9, s29, v9
v_mul_u32_u24 v10, 1280, v8
v_lshl_add_u32 v10, v9, 1, v10
v_subrev_u32 v11, 3840, v10
v_cmp_eq_u32 vcc, 0, v8
v_mov_b32 v12, 0x80000000
s_nop 0
v_cndmask_b32 v11, v11, v12, vcc
v_lshlrev_b32 v12, 3, v9
v_lshlrev_b32 v13, 12, v9
v_lshl_add_u32 v13, v8, 1, v13
v_lshlrev_b32 v5, 4, v1
v_subrev_u32 v2, 32, v5
v_add_u32 v3, 992, v5
v_mov_b32 v4, 0
s_mov_b32 s30, 3840
s_mov_b32 s31, 7680
s_lshl_b32 s39, s38, 12
s_lshl_b32 s40, s38, 1
s_waitcnt lgkmcnt(0)
s_mov_b32 s4, s88
s_mov_b32 s5, s89
s_mov_b32 s6, 0x10000000
s_mov_b32 s7, 0x20000
s_mov_b32 s26, 0x1f80000
v_mov_b32 v63, 0
buffer_load_dword v62, v63, s[4:7], s26 offen sc1
s_mov_b32 s8, s66
s_mov_b32 s9, s67
s_mov_b32 s10, 0x280000
s_mov_b32 s11, 0x20000
s_mov_b32 s12, s68
s_mov_b32 s13, s69
s_mov_b32 s14, 0x280000
s_mov_b32 s15, 0x20000
s_mov_b32 s16, s70
s_mov_b32 s17, s71
s_mov_b32 s18, 0x1400
s_mov_b32 s19, 0x20000
buffer_load_dwordx2 v[16:17], v11, s[8:11], 0 offen offset:0
buffer_load_dwordx2 v[18:19], v11, s[8:11], 0 offen offset:1280
buffer_load_dwordx2 v[20:21], v11, s[8:11], 0 offen offset:2560
buffer_load_dwordx2 v[22:23], v10, s[8:11], 0 offen offset:0
buffer_load_dwordx2 v[38:39], v10, s[12:15], 0 offen offset:0
buffer_load_dwordx2 v[24:25], v10, s[8:11], 0 offen offset:1280
buffer_load_dwordx2 v[40:41], v10, s[12:15], 0 offen offset:1280
buffer_load_dwordx2 v[26:27], v10, s[8:11], 0 offen offset:2560
buffer_load_dwordx2 v[42:43], v10, s[12:15], 0 offen offset:2560
buffer_load_dwordx2 v[28:29], v10, s[8:11], s30 offen offset:0
buffer_load_dwordx2 v[44:45], v10, s[12:15], s30 offen offset:0
buffer_load_dwordx2 v[30:31], v10, s[8:11], s30 offen offset:1280
buffer_load_dwordx2 v[46:47], v10, s[12:15], s30 offen offset:1280
buffer_load_dwordx2 v[32:33], v10, s[8:11], s30 offen offset:2560
buffer_load_dwordx2 v[48:49], v10, s[12:15], s30 offen offset:2560
buffer_load_dwordx2 v[34:35], v10, s[8:11], s31 offen offset:0
buffer_load_dwordx2 v[50:51], v10, s[12:15], s31 offen offset:0
buffer_load_dwordx2 v[36:37], v10, s[8:11], s31 offen offset:1280
buffer_load_dwordx2 v[52:53], v10, s[12:15], s31 offen offset:1280
buffer_load_dwordx4 v[54:57], v12, s[16:19], 0 offen
buffer_load_dwordx4 v[58:61], v12, s[16:19], 0 offen offset:16
s_mov_b32 s8, s78
s_mov_b32 s9, s79
s_mov_b32 s10, 0x21c000
s_mov_b32 s11, 0x20000
s_mov_b32 s12, s80
s_mov_b32 s13, s81
s_mov_b32 s14, 0x21c000
s_mov_b32 s15, 0x20000
s_add_u32 m0, s47, 0
s_add_u32 s29, s46, 0
buffer_load_dwordx4 v14, s[8:11], s29 offen lds
s_add_u32 m0, s47, 1024
s_add_u32 s29, s46, 13824
buffer_load_dwordx4 v15, s[8:11], s29 offen lds
s_add_u32 m0, s47, 8192
s_add_u32 s29, s46, 0
buffer_load_dwordx4 v14, s[12:15], s29 offen lds
s_add_u32 m0, s47, 9216
s_add_u32 s29, s46, 13824
buffer_load_dwordx4 v15, s[12:15], s29 offen lds
s_add_u32 m0, s47, 16384
s_add_u32 s29, s46, 110592
buffer_load_dwordx4 v14, s[8:11], s29 offen lds
s_add_u32 m0, s47, 17408
s_add_u32 s29, s46, 124416
buffer_load_dwordx4 v15, s[8:11], s29 offen lds
s_add_u32 m0, s47, 24576
s_add_u32 s29, s46, 110592
buffer_load_dwordx4 v14, s[12:15], s29 offen lds
s_add_u32 m0, s47, 25600
s_add_u32 s29, s46, 124416
buffer_load_dwordx4 v15, s[12:15], s29 offen lds
s_mov_b32 s32, 0x0
s_mov_b32 s33, 0x1000
s_mov_b32 s34, 0x2000
s_mov_b32 s35, 0x3000
s_mov_b32 s36, 0xffff0000
s_waitcnt vmcnt(28)
v_lshlrev_b32 v64, 16, v16
s_waitcnt vmcnt(27)
v_lshlrev_b32 v65, 16, v18
s_waitcnt vmcnt(26)
v_lshlrev_b32 v66, 16, v20
s_waitcnt vmcnt(25)
v_lshlrev_b32 v67, 16, v22
s_waitcnt vmcnt(23)
v_lshlrev_b32 v68, 16, v24
s_waitcnt vmcnt(21)
v_lshlrev_b32 v69, 16, v26
s_waitcnt vmcnt(19)
v_lshlrev_b32 v70, 16, v28
s_waitcnt vmcnt(17)
v_lshlrev_b32 v71, 16, v30
s_waitcnt vmcnt(15)
v_lshlrev_b32 v72, 16, v32
s_waitcnt vmcnt(13)
v_lshlrev_b32 v73, 16, v34
s_waitcnt vmcnt(11)
v_lshlrev_b32 v74, 16, v36
v_lshlrev_b32 v76, 16, v38
v_lshlrev_b32 v77, 16, v40
v_lshlrev_b32 v78, 16, v42
v_lshlrev_b32 v79, 16, v44
v_lshlrev_b32 v80, 16, v46
v_lshlrev_b32 v81, 16, v48
v_lshlrev_b32 v82, 16, v50
s_waitcnt vmcnt(10)
v_lshlrev_b32 v83, 16, v52
s_waitcnt vmcnt(9)
v_lshlrev_b32 v84, 16, v54
v_and_b32 v85, s36, v54
v_lshlrev_b32 v86, 16, v55
v_and_b32 v87, s36, v55
v_mul_f32 v88, v67, v84
v_mul_f32 v89, v68, v84
v_mul_f32 v90, v69, v84
v_mul_f32 v91, v70, v84
v_mul_f32 v92, v71, v84
v_mul_f32 v93, v72, v84
v_mul_f32 v94, v73, v84
v_mul_f32 v95, v74, v84
v_fmac_f32 v88, v66, v85
v_fmac_f32 v89, v67, v85
v_fmac_f32 v90, v68, v85
v_fmac_f32 v91, v69, v85
v_fmac_f32 v92, v70, v85
v_fmac_f32 v93, v71, v85
v_fmac_f32 v94, v72, v85
v_fmac_f32 v95, v73, v85
v_fmac_f32 v88, v65, v86
v_fmac_f32 v89, v66, v86
v_fmac_f32 v90, v67, v86
v_fmac_f32 v91, v68, v86
v_fmac_f32 v92, v69, v86
v_fmac_f32 v93, v70, v86
v_fmac_f32 v94, v71, v86
v_fmac_f32 v95, v72, v86
v_fmac_f32 v88, v64, v87
v_fmac_f32 v89, v65, v87
v_fmac_f32 v90, v66, v87
v_fmac_f32 v91, v67, v87
v_fmac_f32 v92, v68, v87
v_fmac_f32 v93, v69, v87
v_fmac_f32 v94, v70, v87
v_fmac_f32 v95, v71, v87
v_mul_f32 v88, v88, v76
v_mul_f32 v89, v89, v77
v_mul_f32 v90, v90, v78
v_mul_f32 v91, v91, v79
v_mul_f32 v92, v92, v80
v_mul_f32 v93, v93, v81
v_mul_f32 v94, v94, v82
v_mul_f32 v95, v95, v83
v_cvt_pk_bf16_f32 v96, v95, v94
v_cvt_pk_bf16_f32 v97, v93, v92
v_cvt_pk_bf16_f32 v98, v91, v90
v_cvt_pk_bf16_f32 v99, v89, v88
buffer_store_dwordx4 v[96:99], v13, s[4:7], s32 offen sc1
v_and_b32 v64, s36, v16
v_and_b32 v65, s36, v18
v_and_b32 v66, s36, v20
v_and_b32 v67, s36, v22
v_and_b32 v68, s36, v24
v_and_b32 v69, s36, v26
v_and_b32 v70, s36, v28
v_and_b32 v71, s36, v30
v_and_b32 v72, s36, v32
v_and_b32 v73, s36, v34
v_and_b32 v74, s36, v36
v_and_b32 v76, s36, v38
v_and_b32 v77, s36, v40
v_and_b32 v78, s36, v42
v_and_b32 v79, s36, v44
v_and_b32 v80, s36, v46
v_and_b32 v81, s36, v48
v_and_b32 v82, s36, v50
v_and_b32 v83, s36, v52
v_lshlrev_b32 v84, 16, v56
v_and_b32 v85, s36, v56
v_lshlrev_b32 v86, 16, v57
v_and_b32 v87, s36, v57
v_mul_f32 v88, v67, v84
v_mul_f32 v89, v68, v84
v_mul_f32 v90, v69, v84
v_mul_f32 v91, v70, v84
v_mul_f32 v92, v71, v84
v_mul_f32 v93, v72, v84
v_mul_f32 v94, v73, v84
v_mul_f32 v95, v74, v84
v_fmac_f32 v88, v66, v85
v_fmac_f32 v89, v67, v85
v_fmac_f32 v90, v68, v85
v_fmac_f32 v91, v69, v85
v_fmac_f32 v92, v70, v85
v_fmac_f32 v93, v71, v85
v_fmac_f32 v94, v72, v85
v_fmac_f32 v95, v73, v85
v_fmac_f32 v88, v65, v86
v_fmac_f32 v89, v66, v86
v_fmac_f32 v90, v67, v86
v_fmac_f32 v91, v68, v86
v_fmac_f32 v92, v69, v86
v_fmac_f32 v93, v70, v86
v_fmac_f32 v94, v71, v86
v_fmac_f32 v95, v72, v86
v_fmac_f32 v88, v64, v87
v_fmac_f32 v89, v65, v87
v_fmac_f32 v90, v66, v87
v_fmac_f32 v91, v67, v87
v_fmac_f32 v92, v68, v87
v_fmac_f32 v93, v69, v87
v_fmac_f32 v94, v70, v87
v_fmac_f32 v95, v71, v87
v_mul_f32 v88, v88, v76
v_mul_f32 v89, v89, v77
v_mul_f32 v90, v90, v78
v_mul_f32 v91, v91, v79
v_mul_f32 v92, v92, v80
v_mul_f32 v93, v93, v81
v_mul_f32 v94, v94, v82
v_mul_f32 v95, v95, v83
v_cvt_pk_bf16_f32 v100, v95, v94
v_cvt_pk_bf16_f32 v101, v93, v92
v_cvt_pk_bf16_f32 v102, v91, v90
v_cvt_pk_bf16_f32 v103, v89, v88
buffer_store_dwordx4 v[100:103], v13, s[4:7], s33 offen sc1
v_lshlrev_b32 v64, 16, v17
v_lshlrev_b32 v65, 16, v19
v_lshlrev_b32 v66, 16, v21
v_lshlrev_b32 v67, 16, v23
v_lshlrev_b32 v68, 16, v25
v_lshlrev_b32 v69, 16, v27
v_lshlrev_b32 v70, 16, v29
v_lshlrev_b32 v71, 16, v31
v_lshlrev_b32 v72, 16, v33
v_lshlrev_b32 v73, 16, v35
v_lshlrev_b32 v74, 16, v37
v_lshlrev_b32 v76, 16, v39
v_lshlrev_b32 v77, 16, v41
v_lshlrev_b32 v78, 16, v43
v_lshlrev_b32 v79, 16, v45
v_lshlrev_b32 v80, 16, v47
v_lshlrev_b32 v81, 16, v49
v_lshlrev_b32 v82, 16, v51
v_lshlrev_b32 v83, 16, v53
s_waitcnt vmcnt(10)
v_lshlrev_b32 v84, 16, v58
v_and_b32 v85, s36, v58
v_lshlrev_b32 v86, 16, v59
v_and_b32 v87, s36, v59
v_mul_f32 v88, v67, v84
v_mul_f32 v89, v68, v84
v_mul_f32 v90, v69, v84
v_mul_f32 v91, v70, v84
v_mul_f32 v92, v71, v84
v_mul_f32 v93, v72, v84
v_mul_f32 v94, v73, v84
v_mul_f32 v95, v74, v84
v_fmac_f32 v88, v66, v85
v_fmac_f32 v89, v67, v85
v_fmac_f32 v90, v68, v85
v_fmac_f32 v91, v69, v85
v_fmac_f32 v92, v70, v85
v_fmac_f32 v93, v71, v85
v_fmac_f32 v94, v72, v85
v_fmac_f32 v95, v73, v85
v_fmac_f32 v88, v65, v86
v_fmac_f32 v89, v66, v86
v_fmac_f32 v90, v67, v86
v_fmac_f32 v91, v68, v86
v_fmac_f32 v92, v69, v86
v_fmac_f32 v93, v70, v86
v_fmac_f32 v94, v71, v86
v_fmac_f32 v95, v72, v86
v_fmac_f32 v88, v64, v87
v_fmac_f32 v89, v65, v87
v_fmac_f32 v90, v66, v87
v_fmac_f32 v91, v67, v87
v_fmac_f32 v92, v68, v87
v_fmac_f32 v93, v69, v87
v_fmac_f32 v94, v70, v87
v_fmac_f32 v95, v71, v87
v_mul_f32 v88, v88, v76
v_mul_f32 v89, v89, v77
v_mul_f32 v90, v90, v78
v_mul_f32 v91, v91, v79
v_mul_f32 v92, v92, v80
v_mul_f32 v93, v93, v81
v_mul_f32 v94, v94, v82
v_mul_f32 v95, v95, v83
v_cvt_pk_bf16_f32 v104, v95, v94
v_cvt_pk_bf16_f32 v105, v93, v92
v_cvt_pk_bf16_f32 v106, v91, v90
v_cvt_pk_bf16_f32 v107, v89, v88
buffer_store_dwordx4 v[104:107], v13, s[4:7], s34 offen sc1
v_and_b32 v64, s36, v17
v_and_b32 v65, s36, v19
v_and_b32 v66, s36, v21
v_and_b32 v67, s36, v23
v_and_b32 v68, s36, v25
v_and_b32 v69, s36, v27
v_and_b32 v70, s36, v29
v_and_b32 v71, s36, v31
v_and_b32 v72, s36, v33
v_and_b32 v73, s36, v35
v_and_b32 v74, s36, v37
v_and_b32 v76, s36, v39
v_and_b32 v77, s36, v41
v_and_b32 v78, s36, v43
v_and_b32 v79, s36, v45
v_and_b32 v80, s36, v47
v_and_b32 v81, s36, v49
v_and_b32 v82, s36, v51
v_and_b32 v83, s36, v53
v_lshlrev_b32 v84, 16, v60
v_and_b32 v85, s36, v60
v_lshlrev_b32 v86, 16, v61
v_and_b32 v87, s36, v61
v_mul_f32 v88, v67, v84
v_mul_f32 v89, v68, v84
v_mul_f32 v90, v69, v84
v_mul_f32 v91, v70, v84
v_mul_f32 v92, v71, v84
v_mul_f32 v93, v72, v84
v_mul_f32 v94, v73, v84
v_mul_f32 v95, v74, v84
v_fmac_f32 v88, v66, v85
v_fmac_f32 v89, v67, v85
v_fmac_f32 v90, v68, v85
v_fmac_f32 v91, v69, v85
v_fmac_f32 v92, v70, v85
v_fmac_f32 v93, v71, v85
v_fmac_f32 v94, v72, v85
v_fmac_f32 v95, v73, v85
v_fmac_f32 v88, v65, v86
v_fmac_f32 v89, v66, v86
v_fmac_f32 v90, v67, v86
v_fmac_f32 v91, v68, v86
v_fmac_f32 v92, v69, v86
v_fmac_f32 v93, v70, v86
v_fmac_f32 v94, v71, v86
v_fmac_f32 v95, v72, v86
v_fmac_f32 v88, v64, v87
v_fmac_f32 v89, v65, v87
v_fmac_f32 v90, v66, v87
v_fmac_f32 v91, v67, v87
v_fmac_f32 v92, v68, v87
v_fmac_f32 v93, v69, v87
v_fmac_f32 v94, v70, v87
v_fmac_f32 v95, v71, v87
v_mul_f32 v88, v88, v76
v_mul_f32 v89, v89, v77
v_mul_f32 v90, v90, v78
v_mul_f32 v91, v91, v79
v_mul_f32 v92, v92, v80
v_mul_f32 v93, v93, v81
v_mul_f32 v94, v94, v82
v_mul_f32 v95, v95, v83
v_cvt_pk_bf16_f32 v108, v95, v94
v_cvt_pk_bf16_f32 v109, v93, v92
v_cvt_pk_bf16_f32 v110, v91, v90
v_cvt_pk_bf16_f32 v111, v89, v88
buffer_store_dwordx4 v[108:111], v13, s[4:7], s35 offen sc1
s_mov_b32 s8, s72
s_mov_b32 s9, s73
s_mov_b32 s10, 0x280000
s_mov_b32 s11, 0x20000
s_mov_b32 s12, s74
s_mov_b32 s13, s75
s_mov_b32 s14, 0x500
s_mov_b32 s15, 0x20000
buffer_load_dwordx4 v[112:115], v2, s[8:11], s39 offen
buffer_load_dwordx4 v[132:135], v2, s[8:11], s39 offen offset:4
buffer_load_dwordx4 v[152:155], v2, s[8:11], s39 offen offset:8
s_add_u32 s41, s39, 0
buffer_load_dwordx4 v[116:119], v3, s[8:11], s41 offen
buffer_load_dwordx4 v[136:139], v3, s[8:11], s41 offen offset:4
buffer_load_dwordx4 v[156:159], v3, s[8:11], s41 offen offset:8
s_add_u32 s42, s39, 1024
buffer_load_dwordx4 v[120:123], v3, s[8:11], s42 offen
buffer_load_dwordx4 v[140:143], v3, s[8:11], s42 offen offset:4
buffer_load_dwordx4 v[160:163], v3, s[8:11], s42 offen offset:8
s_add_u32 s43, s39, 2048
buffer_load_dwordx4 v[124:127], v3, s[8:11], s43 offen
buffer_load_dwordx4 v[144:147], v3, s[8:11], s43 offen offset:4
buffer_load_dwordx4 v[164:167], v3, s[8:11], s43 offen offset:8
s_add_u32 s44, s39, 3072
buffer_load_dwordx4 v[128:131], v3, s[8:11], s44 offen
buffer_load_dwordx4 v[148:151], v3, s[8:11], s44 offen offset:4
buffer_load_dwordx4 v[168:171], v3, s[8:11], s44 offen offset:8
buffer_load_dwordx2 v[172:173], v4, s[8:11], s39 offen
buffer_load_ushort v174, v4, s[12:15], s40 offen
s_mov_b32 s8, s78
s_mov_b32 s9, s79
s_mov_b32 s10, 0x21c000
s_mov_b32 s11, 0x20000
s_mov_b32 s12, s80
s_mov_b32 s13, s81
s_mov_b32 s14, 0x21c000
s_mov_b32 s15, 0x20000
s_add_u32 m0, s47, 98304
s_add_u32 s29, s46, 221184
buffer_load_dwordx4 v14, s[8:11], s29 offen lds
s_add_u32 m0, s47, 99328
s_add_u32 s29, s46, 235008
buffer_load_dwordx4 v15, s[8:11], s29 offen lds
s_add_u32 m0, s47, 106496
s_add_u32 s29, s46, 221184
buffer_load_dwordx4 v14, s[12:15], s29 offen lds
s_add_u32 m0, s47, 107520
s_add_u32 s29, s46, 235008
buffer_load_dwordx4 v15, s[12:15], s29 offen lds
s_add_u32 m0, s47, 114688
s_add_u32 s29, s46, 331776
buffer_load_dwordx4 v14, s[8:11], s29 offen lds
s_add_u32 m0, s47, 115712
s_add_u32 s29, s46, 345600
buffer_load_dwordx4 v15, s[8:11], s29 offen lds
s_add_u32 m0, s47, 122880
s_add_u32 s29, s46, 331776
buffer_load_dwordx4 v14, s[12:15], s29 offen lds
s_add_u32 m0, s47, 123904
s_add_u32 s29, s46, 345600
buffer_load_dwordx4 v15, s[12:15], s29 offen lds
s_add_u32 m0, s47, 131072
s_add_u32 s29, s46, 442368
buffer_load_dwordx4 v14, s[8:11], s29 offen lds
s_add_u32 m0, s47, 132096
s_add_u32 s29, s46, 456192
buffer_load_dwordx4 v15, s[8:11], s29 offen lds
s_add_u32 m0, s47, 139264
s_add_u32 s29, s46, 442368
buffer_load_dwordx4 v14, s[12:15], s29 offen lds
s_add_u32 m0, s47, 140288
s_add_u32 s29, s46, 456192
buffer_load_dwordx4 v15, s[12:15], s29 offen lds
s_add_u32 m0, s47, 147456
s_add_u32 s29, s46, 552960
buffer_load_dwordx4 v14, s[8:11], s29 offen lds
s_add_u32 m0, s47, 148480
s_add_u32 s29, s46, 566784
buffer_load_dwordx4 v15, s[8:11], s29 offen lds
s_add_u32 m0, s47, 155648
s_add_u32 s29, s46, 552960
buffer_load_dwordx4 v14, s[12:15], s29 offen lds
s_add_u32 m0, s47, 156672
s_add_u32 s29, s46, 566784
buffer_load_dwordx4 v15, s[12:15], s29 offen lds
v_readfirstlane_b32 s20, v62
s_add_u32 s20, s20, 1
v_cmp_eq_u32 vcc, 1, v1
s_waitcnt vmcnt(17)
s_nop 0
v_cndmask_b32 v135, v135, v172, vcc
v_cndmask_b32 v154, v154, v172, vcc
v_cndmask_b32 v155, v155, v173, vcc
v_alignbit_b32 v64, v132, v112, 16
v_alignbit_b32 v84, v152, v132, 16
v_alignbit_b32 v65, v133, v113, 16
v_alignbit_b32 v85, v153, v133, 16
v_alignbit_b32 v66, v134, v114, 16
v_alignbit_b32 v86, v154, v134, 16
v_alignbit_b32 v67, v135, v115, 16
v_alignbit_b32 v87, v155, v135, 16
v_alignbit_b32 v68, v136, v116, 16
v_alignbit_b32 v88, v156, v136, 16
v_alignbit_b32 v69, v137, v117, 16
v_alignbit_b32 v89, v157, v137, 16
v_alignbit_b32 v70, v138, v118, 16
v_alignbit_b32 v90, v158, v138, 16
v_alignbit_b32 v71, v139, v119, 16
v_alignbit_b32 v91, v159, v139, 16
v_alignbit_b32 v72, v140, v120, 16
v_alignbit_b32 v92, v160, v140, 16
v_alignbit_b32 v73, v141, v121, 16
v_alignbit_b32 v93, v161, v141, 16
v_alignbit_b32 v74, v142, v122, 16
v_alignbit_b32 v94, v162, v142, 16
v_alignbit_b32 v75, v143, v123, 16
v_alignbit_b32 v95, v163, v143, 16
v_alignbit_b32 v76, v144, v124, 16
v_alignbit_b32 v96, v164, v144, 16
v_alignbit_b32 v77, v145, v125, 16
v_alignbit_b32 v97, v165, v145, 16
v_alignbit_b32 v78, v146, v126, 16
v_alignbit_b32 v98, v166, v146, 16
v_alignbit_b32 v79, v147, v127, 16
v_alignbit_b32 v99, v167, v147, 16
v_alignbit_b32 v80, v148, v128, 16
v_alignbit_b32 v100, v168, v148, 16
v_alignbit_b32 v81, v149, v129, 16
v_alignbit_b32 v101, v169, v149, 16
v_alignbit_b32 v82, v150, v130, 16
v_alignbit_b32 v102, v170, v150, 16
v_alignbit_b32 v83, v151, v131, 16
v_alignbit_b32 v103, v171, v151, 16
s_mul_i32 s45, s3, 21248
v_add_u32 v8, s45, v5
s_waitcnt vmcnt(16)
v_lshlrev_b32 v12, 16, v174
v_add_u32 v2, 0x10000, v6
v_add_u32 v3, 0x10000, v7
v_lshlrev_b32 v9, 3, v1
v_add_u32 v9, s45, v9
v_mov_b32 v10, 0
v_mov_b32 v11, 0
s_waitcnt vmcnt(33)
s_barrier
s_cmp_lg_u32 s3, 0
s_cbranch_scc1 LnoflagP_1
s_lshl_b32 s26, s37, 4
    s_add_u32 s26, s26, 0x1f00000
    v_mov_b32 v16, s20
    s_mov_b64 exec, 1
    s_nop 1
    buffer_store_dword v16, v4, s[4:7], s26 offen sc1
    s_mov_b64 exec, -1
LnoflagP_1:
ds_read_b64_tr_b16 a[0:1], v6 offset:0
ds_read_b64_tr_b16 a[2:3], v6 offset:4096
ds_read_b64_tr_b16 a[4:5], v7 offset:0
ds_read_b64_tr_b16 a[6:7], v7 offset:4096
ds_read_b64_tr_b16 a[8:9], v6 offset:8192
ds_read_b64_tr_b16 a[10:11], v6 offset:12288
ds_read_b64_tr_b16 a[12:13], v7 offset:8192
ds_read_b64_tr_b16 a[14:15], v7 offset:12288
ds_read_b64_tr_b16 a[16:17], v6 offset:16384
ds_read_b64_tr_b16 a[18:19], v6 offset:20480
ds_read_b64_tr_b16 a[20:21], v7 offset:16384
ds_read_b64_tr_b16 a[22:23], v7 offset:20480
ds_read_b64_tr_b16 a[24:25], v6 offset:24576
ds_read_b64_tr_b16 a[26:27], v6 offset:28672
ds_read_b64_tr_b16 a[28:29], v7 offset:24576
ds_read_b64_tr_b16 a[30:31], v7 offset:28672
v_add_u32 v6, 98304, v6
v_add_u32 v7, 98304, v7
s_waitcnt lgkmcnt(0)
s_barrier
ds_write_b128 v8, v[64:67] offset:0
ds_write_b128 v8, v[132:135] offset:4160
ds_write_b128 v8, v[84:87] offset:8320
ds_write_b128 v8, v[152:155] offset:12480
ds_write_b128 v8, v[68:71] offset:1024
ds_write_b128 v8, v[136:139] offset:5184
ds_write_b128 v8, v[88:91] offset:9344
ds_write_b128 v8, v[156:159] offset:13504
ds_write_b128 v8, v[72:75] offset:2048
ds_write_b128 v8, v[140:143] offset:6208
ds_write_b128 v8, v[92:95] offset:10368
ds_write_b128 v8, v[160:163] offset:14528
ds_write_b128 v8, v[76:79] offset:3072
ds_write_b128 v8, v[144:147] offset:7232
ds_write_b128 v8, v[96:99] offset:11392
ds_write_b128 v8, v[164:167] offset:15552
s_mov_b64 exec, 15
ds_write_b128 v8, v[80:83] offset:4096
ds_write_b128 v8, v[148:151] offset:8256
ds_write_b128 v8, v[100:103] offset:12416
ds_write_b128 v8, v[168:171] offset:16576
s_mov_b64 exec, -1
ds_write_b64 v9, v[10:11] offset:16640
v_and_b32 v16, 15, v1
v_lshrrev_b32 v17, 4, v1
v_and_b32 v18, 3, v16
v_mul_u32_u24 v18, 4160, v18
v_and_b32 v19, 12, v16
v_lshl_add_u32 v18, v19, 1, v18
v_lshl_add_u32 v18, v17, 4, v18
v_add_u32 v18, s45, v18
v_lshlrev_b32 v20, 1, v16
v_sub_u32 v20, v20, v17
v_lshlrev_b32 v20, 4, v20
s_add_u32 s26, s45, 16720
v_add_u32 v20, s26, v20
v_lshrrev_b32 v21, 1, v17
v_lshl_add_u32 v21, v16, 1, v21
v_lshlrev_b32 v21, 4, v21
v_and_b32 v26, 1, v17
v_sub_u32 v26, 1, v26
v_lshl_add_u32 v21, v26, 3, v21
s_add_u32 s26, s45, 17152
v_add_u32 v21, s26, v21
s_lshl_b32 s26, s3, 1
s_add_u32 s26, s26, 84992
v_lshlrev_b32 v26, 7, v16
v_add_u32 v26, s26, v26
v_lshl_add_u32 v27, v17, 2, v16
v_add_u32 v28, 0, v27
v_and_b32 v28, 15, v28
v_lshl_add_u32 v22, v28, 3, v26
v_add_u32 v28, 1, v27
v_and_b32 v28, 15, v28
v_lshl_add_u32 v23, v28, 3, v26
v_add_u32 v28, 2, v27
v_and_b32 v28, 15, v28
v_lshl_add_u32 v24, v28, 3, v26
v_add_u32 v28, 3, v27
v_and_b32 v28, 15, v28
v_lshl_add_u32 v25, v28, 3, v26
v_lshrrev_b32 v26, 3, v0
v_and_b32 v27, 7, v0
v_and_b32 v28, 15, v26
v_lshl_add_u32 v28, v27, 1, v28
v_and_b32 v29, 15, v28
v_add_u32 v28, 1, v28
v_and_b32 v28, 15, v28
v_lshlrev_b32 v30, 7, v26
v_add_u32 v30, 84992, v30
v_lshl_add_u32 v29, v29, 3, v30
v_lshl_add_u32 v28, v28, 3, v30
v_mul_u32_u24 v30, 20480, v26
v_lshl_add_u32 v30, v27, 4, v30
v_cmp_eq_u32 vcc, 0, v0
v_mov_b32 v31, 0x40000000
v_mov_b32 v2, 0
v_cndmask_b32 v31, v31, v2, vcc
v_mov_b32 v3, s20
s_and_b32 s26, s37, 0xfff0
s_lshl_b32 s26, s26, 4
s_add_u32 s26, s26, 0x1f00000
v_and_b32 v2, 15, v1
v_lshlrev_b32 v2, 4, v2
s_mov_b32 s90, 40000
Lpoll_2:
buffer_load_dword v4, v2, s[4:7], s26 offen sc1
s_waitcnt vmcnt(0)
v_cmp_ne_u32 vcc, s20, v4
s_cmp_eq_u64 vcc, 0
s_cbranch_scc1 Lpok_3

s_sub_u32 s90, s90, 1
s_cmp_lg_u32 s90, 0
s_cbranch_scc1 Lpoll_2
s_mov_b32 s8, s86
s_mov_b32 s9, s87
s_mov_b32 s10, 0x100
s_mov_b32 s11, 0x20000
v_mov_b32 v2, 0x1
v_mov_b32 v3, 0x4
s_nop 1
buffer_store_dword v2, v3, s[8:11], 0 offen
s_waitcnt vmcnt(0)
s_endpgm
Lpok_3:
s_waitcnt vmcnt(0)
s_add_u32 s26, s45, 17152
s_mov_b32 m0, s26
s_lshl_b32 s27, s38, 12
s_add_u32 s27, s27, 0x0
buffer_load_dwordx4 v5, s[4:7], s27 offen offset:0 sc1 lds
buffer_load_dwordx4 v5, s[4:7], s27 offen offset:1024 sc1 lds
buffer_load_dwordx4 v5, s[4:7], s27 offen offset:2048 sc1 lds
buffer_load_dwordx4 v5, s[4:7], s27 offen offset:3072 sc1 lds
s_barrier
ds_read_b64_tr_b16 a[32:33], v6 offset:0
ds_read_b64_tr_b16 a[34:35], v6 offset:4096
ds_read_b64_tr_b16 a[36:37], v7 offset:0
ds_read_b64_tr_b16 a[38:39], v7 offset:4096
ds_read_b64_tr_b16 a[40:41], v6 offset:8192
ds_read_b64_tr_b16 a[42:43], v6 offset:12288
ds_read_b64_tr_b16 a[44:45], v7 offset:8192
ds_read_b64_tr_b16 a[46:47], v7 offset:12288
ds_read_b64_tr_b16 a[48:49], v6 offset:16384
ds_read_b64_tr_b16 a[50:51], v6 offset:20480
ds_read_b64_tr_b16 a[52:53], v7 offset:16384
ds_read_b64_tr_b16 a[54:55], v7 offset:20480
ds_read_b64_tr_b16 a[56:57], v6 offset:24576
ds_read_b64_tr_b16 a[58:59], v6 offset:28672
ds_read_b64_tr_b16 a[60:61], v7 offset:24576
ds_read_b64_tr_b16 a[62:63], v7 offset:28672
ds_read_b64_tr_b16 a[64:65], v6 offset:32768
ds_read_b64_tr_b16 a[66:67], v6 offset:36864
ds_read_b64_tr_b16 a[68:69], v7 offset:32768
ds_read_b64_tr_b16 a[70:71], v7 offset:36864
ds_read_b64_tr_b16 a[72:73], v6 offset:40960
ds_read_b64_tr_b16 a[74:75], v6 offset:45056
ds_read_b64_tr_b16 a[76:77], v7 offset:40960
ds_read_b64_tr_b16 a[78:79], v7 offset:45056
ds_read_b64_tr_b16 a[80:81], v6 offset:49152
ds_read_b64_tr_b16 a[82:83], v6 offset:53248
ds_read_b64_tr_b16 a[84:85], v7 offset:49152
ds_read_b64_tr_b16 a[86:87], v7 offset:53248
ds_read_b64_tr_b16 a[88:89], v6 offset:57344
ds_read_b64_tr_b16 a[90:91], v6 offset:61440
ds_read_b64_tr_b16 a[92:93], v7 offset:57344
ds_read_b64_tr_b16 a[94:95], v7 offset:61440
s_waitcnt lgkmcnt(0)
s_barrier
s_add_u32 m0, s47, 98304
s_add_u32 s29, s46, 663552
buffer_load_dwordx4 v14, s[8:11], s29 offen lds
s_add_u32 m0, s47, 99328
s_add_u32 s29, s46, 677376
buffer_load_dwordx4 v15, s[8:11], s29 offen lds
s_add_u32 m0, s47, 106496
s_add_u32 s29, s46, 663552
buffer_load_dwordx4 v14, s[12:15], s29 offen lds
s_add_u32 m0, s47, 107520
s_add_u32 s29, s46, 677376
buffer_load_dwordx4 v15, s[12:15], s29 offen lds
s_add_u32 m0, s47, 114688
s_add_u32 s29, s46, 774144
buffer_load_dwordx4 v14, s[8:11], s29 offen lds
s_add_u32 m0, s47, 115712
s_add_u32 s29, s46, 787968
buffer_load_dwordx4 v15, s[8:11], s29 offen lds
s_add_u32 m0, s47, 122880
s_add_u32 s29, s46, 774144
buffer_load_dwordx4 v14, s[12:15], s29 offen lds
s_add_u32 m0, s47, 123904
s_add_u32 s29, s46, 787968
buffer_load_dwordx4 v15, s[12:15], s29 offen lds
s_add_u32 m0, s47, 131072
s_add_u32 s29, s46, 884736
buffer_load_dwordx4 v14, s[8:11], s29 offen lds
s_add_u32 m0, s47, 132096
s_add_u32 s29, s46, 898560
buffer_load_dwordx4 v15, s[8:11], s29 offen lds
s_add_u32 m0, s47, 139264
s_add_u32 s29, s46, 884736
buffer_load_dwordx4 v14, s[12:15], s29 offen lds
s_add_u32 m0, s47, 140288
s_add_u32 s29, s46, 898560
buffer_load_dwordx4 v15, s[12:15], s29 offen lds
s_add_u32 m0, s47, 147456
s_add_u32 s29, s46, 995328
buffer_load_dwordx4 v14, s[8:11], s29 offen lds
s_add_u32 m0, s47, 148480
s_add_u32 s29, s46, 1009152
buffer_load_dwordx4 v15, s[8:11], s29 offen lds
s_add_u32 m0, s47, 155648
s_add_u32 s29, s46, 995328
buffer_load_dwordx4 v14, s[12:15], s29 offen lds
s_add_u32 m0, s47, 156672
s_add_u32 s29, s46, 1009152
buffer_load_dwordx4 v15, s[12:15], s29 offen lds
s_mul_i32 s26, s22, 37
s_lshr_b32 s26, s26, 8
s_mul_i32 s27, s26, 7
s_sub_u32 s27, s22, s27
s_mul_i32 s28, s24, 7
s_add_u32 s27, s27, s28
s_lshl_b32 s27, s27, 8
s_lshl_b32 s26, s26, 2
s_add_u32 s26, s26, s3
s_lshl_b32 s26, s26, 5
s_add_u32 s26, s26, 320
s_mul_i32 s26, s26, 3456
s_add_u32 s26, s26, s27
v_lshrrev_b32 v253, 1, v1
v_mul_u32_u24 v253, 3456, v253
v_and_b32 v254, 1, v1
v_lshl_add_u32 v253, v254, 7, v253
v_add_u32 v253, s26, v253
buffer_load_dword v254, v253, s[8:11], 0 offen
buffer_load_dword v255, v253, s[12:15], 0 offen
s_waitcnt vmcnt(18)
ds_read_b64 v[64:65], v18 offset:0
ds_read_b64 v[66:67], v18 offset:8
ds_read_b128 v[128:131], v20 offset:448
ds_read_b64 v[68:69], v18 offset:512
ds_read_b64 v[70:71], v18 offset:520
ds_read_b128 v[132:135], v20 offset:960
ds_read_b64 v[72:73], v18 offset:1024
ds_read_b64 v[74:75], v18 offset:1032
ds_read_b128 v[136:139], v20 offset:1472
ds_read_b64 v[76:77], v18 offset:1536
ds_read_b64 v[78:79], v18 offset:1544
ds_read_b128 v[140:143], v20 offset:1984
s_waitcnt lgkmcnt(9)
v_mfma_f32_16x16x32_bf16 v[32:35], v[64:67], v[128:131], 0
ds_read_b64 v[96:97], v18 offset:64
ds_read_b64 v[98:99], v18 offset:72
s_waitcnt lgkmcnt(8)
v_mfma_f32_16x16x32_bf16 v[36:39], v[64:67], v[132:135], 0
ds_read_b128 v[160:163], v20 offset:384
v_mfma_f32_16x16x32_bf16 v[36:39], v[68:71], v[128:131], v[36:39]
ds_read_b64 v[100:101], v18 offset:576
v_mfma_f32_16x16x32_bf16 v[40:43], v[68:71], v[132:135], 0
ds_read_b64 v[102:103], v18 offset:584
s_waitcnt lgkmcnt(8)
v_mfma_f32_16x16x32_bf16 v[40:43], v[64:67], v[136:139], v[40:43]
ds_read_b128 v[164:167], v20 offset:896
v_mfma_f32_16x16x32_bf16 v[44:47], v[68:71], v[136:139], 0
ds_read_b64 v[104:105], v18 offset:1088
ds_read_b64 v[106:107], v18 offset:1096
v_mfma_f32_16x16x32_bf16 v[40:43], v[72:75], v[128:131], v[40:43]
ds_read_b128 v[168:171], v20 offset:1408
v_mfma_f32_16x16x32_bf16 v[44:47], v[72:75], v[132:135], v[44:47]
ds_read_b64 v[108:109], v18 offset:1600
s_waitcnt lgkmcnt(10)
v_mfma_f32_16x16x32_bf16 v[44:47], v[64:67], v[140:143], v[44:47]
ds_read_b64 v[110:111], v18 offset:1608
v_mfma_f32_16x16x32_bf16 v[44:47], v[76:79], v[128:131], v[44:47]
ds_read_b128 v[172:175], v20 offset:1920
s_waitcnt lgkmcnt(9)
v_mfma_f32_16x16x32_bf16 v[32:35], v[96:99], v[160:163], v[32:35]
ds_read_b64 v[64:65], v18 offset:128
ds_read_b64 v[66:67], v18 offset:136
s_waitcnt lgkmcnt(8)
v_mfma_f32_16x16x32_bf16 v[36:39], v[96:99], v[164:167], v[36:39]
ds_read_b128 v[128:131], v20 offset:320
v_mfma_f32_16x16x32_bf16 v[36:39], v[100:103], v[160:163], v[36:39]
ds_read_b64 v[68:69], v18 offset:640
v_mfma_f32_16x16x32_bf16 v[40:43], v[100:103], v[164:167], v[40:43]
ds_read_b64 v[70:71], v18 offset:648
s_waitcnt lgkmcnt(8)
v_mfma_f32_16x16x32_bf16 v[40:43], v[96:99], v[168:171], v[40:43]
ds_read_b128 v[132:135], v20 offset:832
v_mfma_f32_16x16x32_bf16 v[44:47], v[100:103], v[168:171], v[44:47]
ds_read_b64 v[72:73], v18 offset:1152
ds_read_b64 v[74:75], v18 offset:1160
v_mfma_f32_16x16x32_bf16 v[40:43], v[104:107], v[160:163], v[40:43]
ds_read_b128 v[136:139], v20 offset:1344
v_mfma_f32_16x16x32_bf16 v[44:47], v[104:107], v[164:167], v[44:47]
ds_read_b64 v[76:77], v18 offset:1664
s_waitcnt lgkmcnt(10)
v_mfma_f32_16x16x32_bf16 v[44:47], v[96:99], v[172:175], v[44:47]
ds_read_b64 v[78:79], v18 offset:1672
v_mfma_f32_16x16x32_bf16 v[44:47], v[108:111], v[160:163], v[44:47]
ds_read_b128 v[140:143], v20 offset:1856
s_waitcnt lgkmcnt(9)
v_mfma_f32_16x16x32_bf16 v[32:35], v[64:67], v[128:131], v[32:35]
ds_read_b64 v[96:97], v18 offset:192
ds_read_b64 v[98:99], v18 offset:200
s_waitcnt lgkmcnt(8)
v_mfma_f32_16x16x32_bf16 v[36:39], v[64:67], v[132:135], v[36:39]
ds_read_b128 v[160:163], v20 offset:256
v_mfma_f32_16x16x32_bf16 v[36:39], v[68:71], v[128:131], v[36:39]
ds_read_b64 v[100:101], v18 offset:704
v_mfma_f32_16x16x32_bf16 v[40:43], v[68:71], v[132:135], v[40:43]
ds_read_b64 v[102:103], v18 offset:712
s_waitcnt lgkmcnt(8)
v_mfma_f32_16x16x32_bf16 v[40:43], v[64:67], v[136:139], v[40:43]
ds_read_b128 v[164:167], v20 offset:768
v_mfma_f32_16x16x32_bf16 v[44:47], v[68:71], v[136:139], v[44:47]
ds_read_b64 v[104:105], v18 offset:1216
ds_read_b64 v[106:107], v18 offset:1224
v_mfma_f32_16x16x32_bf16 v[40:43], v[72:75], v[128:131], v[40:43]
ds_read_b128 v[168:171], v20 offset:1280
v_mfma_f32_16x16x32_bf16 v[44:47], v[72:75], v[132:135], v[44:47]
ds_read_b64 v[108:109], v18 offset:1728
s_waitcnt lgkmcnt(10)
v_mfma_f32_16x16x32_bf16 v[44:47], v[64:67], v[140:143], v[44:47]
ds_read_b64 v[110:111], v18 offset:1736
v_mfma_f32_16x16x32_bf16 v[44:47], v[76:79], v[128:131], v[44:47]
ds_read_b128 v[172:175], v20 offset:1792
s_waitcnt lgkmcnt(9)
v_mfma_f32_16x16x32_bf16 v[32:35], v[96:99], v[160:163], v[32:35]
ds_read_b64 v[64:65], v18 offset:256
ds_read_b64 v[66:67], v18 offset:264
s_waitcnt lgkmcnt(8)
v_mfma_f32_16x16x32_bf16 v[36:39], v[96:99], v[164:167], v[36:39]
ds_read_b128 v[128:131], v20 offset:192
v_mfma_f32_16x16x32_bf16 v[36:39], v[100:103], v[160:163], v[36:39]
ds_read_b64 v[68:69], v18 offset:768
v_mfma_f32_16x16x32_bf16 v[40:43], v[100:103], v[164:167], v[40:43]
ds_read_b64 v[70:71], v18 offset:776
s_waitcnt lgkmcnt(8)
v_mfma_f32_16x16x32_bf16 v[40:43], v[96:99], v[168:171], v[40:43]
ds_read_b128 v[132:135], v20 offset:704
v_mfma_f32_16x16x32_bf16 v[44:47], v[100:103], v[168:171], v[44:47]
ds_read_b64 v[72:73], v18 offset:1280
ds_read_b64 v[74:75], v18 offset:1288
v_mfma_f32_16x16x32_bf16 v[40:43], v[104:107], v[160:163], v[40:43]
ds_read_b128 v[136:139], v20 offset:1216
v_mfma_f32_16x16x32_bf16 v[44:47], v[104:107], v[164:167], v[44:47]
ds_read_b64 v[76:77], v18 offset:1792
s_waitcnt lgkmcnt(10)
v_mfma_f32_16x16x32_bf16 v[44:47], v[96:99], v[172:175], v[44:47]
ds_read_b64 v[78:79], v18 offset:1800
v_mfma_f32_16x16x32_bf16 v[44:47], v[108:111], v[160:163], v[44:47]
ds_read_b128 v[140:143], v20 offset:1728
s_waitcnt lgkmcnt(9)
v_mfma_f32_16x16x32_bf16 v[32:35], v[64:67], v[128:131], v[32:35]
ds_read_b64 v[96:97], v18 offset:320
ds_read_b64 v[98:99], v18 offset:328
s_waitcnt lgkmcnt(8)
v_mfma_f32_16x16x32_bf16 v[36:39], v[64:67], v[132:135], v[36:39]
ds_read_b128 v[160:163], v20 offset:128
v_mfma_f32_16x16x32_bf16 v[36:39], v[68:71], v[128:131], v[36:39]
ds_read_b64 v[100:101], v18 offset:832
v_mfma_f32_16x16x32_bf16 v[40:43], v[68:71], v[132:135], v[40:43]
ds_read_b64 v[102:103], v18 offset:840
s_waitcnt lgkmcnt(8)
v_mfma_f32_16x16x32_bf16 v[40:43], v[64:67], v[136:139], v[40:43]
ds_read_b128 v[164:167], v20 offset:640
v_mfma_f32_16x16x32_bf16 v[44:47], v[68:71], v[136:139], v[44:47]
ds_read_b64 v[104:105], v18 offset:1344
ds_read_b64 v[106:107], v18 offset:1352
v_mfma_f32_16x16x32_bf16 v[40:43], v[72:75], v[128:131], v[40:43]
ds_read_b128 v[168:171], v20 offset:1152
v_mfma_f32_16x16x32_bf16 v[44:47], v[72:75], v[132:135], v[44:47]
ds_read_b64 v[108:109], v18 offset:1856
s_waitcnt lgkmcnt(10)
v_mfma_f32_16x16x32_bf16 v[44:47], v[64:67], v[140:143], v[44:47]
ds_read_b64 v[110:111], v18 offset:1864
v_mfma_f32_16x16x32_bf16 v[44:47], v[76:79], v[128:131], v[44:47]
ds_read_b128 v[172:175], v20 offset:1664
s_waitcnt lgkmcnt(9)
v_mfma_f32_16x16x32_bf16 v[32:35], v[96:99], v[160:163], v[32:35]
ds_read_b64 v[64:65], v18 offset:384
ds_read_b64 v[66:67], v18 offset:392
s_waitcnt lgkmcnt(8)
v_mfma_f32_16x16x32_bf16 v[36:39], v[96:99], v[164:167], v[36:39]
ds_read_b128 v[128:131], v20 offset:64
v_mfma_f32_16x16x32_bf16 v[36:39], v[100:103], v[160:163], v[36:39]
ds_read_b64 v[68:69], v18 offset:896
v_mfma_f32_16x16x32_bf16 v[40:43], v[100:103], v[164:167], v[40:43]
ds_read_b64 v[70:71], v18 offset:904
s_waitcnt lgkmcnt(8)
v_mfma_f32_16x16x32_bf16 v[40:43], v[96:99], v[168:171], v[40:43]
ds_read_b128 v[132:135], v20 offset:576
v_mfma_f32_16x16x32_bf16 v[44:47], v[100:103], v[168:171], v[44:47]
ds_read_b64 v[72:73], v18 offset:1408
ds_read_b64 v[74:75], v18 offset:1416
v_mfma_f32_16x16x32_bf16 v[40:43], v[104:107], v[160:163], v[40:43]
ds_read_b128 v[136:139], v20 offset:1088
v_mfma_f32_16x16x32_bf16 v[44:47], v[104:107], v[164:167], v[44:47]
ds_read_b64 v[76:77], v18 offset:1920
s_waitcnt lgkmcnt(10)
v_mfma_f32_16x16x32_bf16 v[44:47], v[96:99], v[172:175], v[44:47]
ds_read_b64 v[78:79], v18 offset:1928
v_mfma_f32_16x16x32_bf16 v[44:47], v[108:111], v[160:163], v[44:47]
ds_read_b128 v[140:143], v20 offset:1600
s_waitcnt lgkmcnt(9)
v_mfma_f32_16x16x32_bf16 v[32:35], v[64:67], v[128:131], v[32:35]
ds_read_b64 v[96:97], v18 offset:448
ds_read_b64 v[98:99], v18 offset:456
s_waitcnt lgkmcnt(8)
v_mfma_f32_16x16x32_bf16 v[36:39], v[64:67], v[132:135], v[36:39]
ds_read_b128 v[160:163], v20 offset:0
v_mfma_f32_16x16x32_bf16 v[36:39], v[68:71], v[128:131], v[36:39]
ds_read_b64 v[100:101], v18 offset:960
v_mfma_f32_16x16x32_bf16 v[40:43], v[68:71], v[132:135], v[40:43]
ds_read_b64 v[102:103], v18 offset:968
s_waitcnt lgkmcnt(8)
v_mfma_f32_16x16x32_bf16 v[40:43], v[64:67], v[136:139], v[40:43]
ds_read_b128 v[164:167], v20 offset:512
v_mfma_f32_16x16x32_bf16 v[44:47], v[68:71], v[136:139], v[44:47]
ds_read_b64 v[104:105], v18 offset:1472
ds_read_b64 v[106:107], v18 offset:1480
v_mfma_f32_16x16x32_bf16 v[40:43], v[72:75], v[128:131], v[40:43]
ds_read_b128 v[168:171], v20 offset:1024
v_mfma_f32_16x16x32_bf16 v[44:47], v[72:75], v[132:135], v[44:47]
ds_read_b64 v[108:109], v18 offset:1984
s_waitcnt lgkmcnt(10)
v_mfma_f32_16x16x32_bf16 v[44:47], v[64:67], v[140:143], v[44:47]
ds_read_b64 v[110:111], v18 offset:1992
v_mfma_f32_16x16x32_bf16 v[44:47], v[76:79], v[128:131], v[44:47]
ds_read_b128 v[172:175], v20 offset:1536
s_waitcnt lgkmcnt(9)
v_mfma_f32_16x16x32_bf16 v[32:35], v[96:99], v[160:163], v[32:35]
s_waitcnt lgkmcnt(6)
v_mfma_f32_16x16x32_bf16 v[36:39], v[96:99], v[164:167], v[36:39]
v_mfma_f32_16x16x32_bf16 v[36:39], v[100:103], v[160:163], v[36:39]
v_mfma_f32_16x16x32_bf16 v[40:43], v[100:103], v[164:167], v[40:43]
s_waitcnt lgkmcnt(3)
v_mfma_f32_16x16x32_bf16 v[40:43], v[96:99], v[168:171], v[40:43]
v_mfma_f32_16x16x32_bf16 v[44:47], v[100:103], v[168:171], v[44:47]
v_mfma_f32_16x16x32_bf16 v[40:43], v[104:107], v[160:163], v[40:43]
v_mfma_f32_16x16x32_bf16 v[44:47], v[104:107], v[164:167], v[44:47]
s_waitcnt lgkmcnt(0)
v_mfma_f32_16x16x32_bf16 v[44:47], v[96:99], v[172:175], v[44:47]
v_mfma_f32_16x16x32_bf16 v[44:47], v[108:111], v[160:163], v[44:47]
ds_read_b64 v[64:65], v21 offset:0
ds_read_b64 v[66:67], v21 offset:512
ds_read_b64 v[68:69], v21 offset:1024
ds_read_b64 v[70:71], v21 offset:1536
s_waitcnt lgkmcnt(3)
v_and_b32 v80, 0xffff0000, v65
v_lshlrev_b32 v81, 16, v65
v_and_b32 v82, 0xffff0000, v64
v_lshlrev_b32 v83, 16, v64
v_fma_f32 v80, v80, v12, v32
v_fma_f32 v81, v81, v12, v33
v_fma_f32 v82, v82, v12, v34
v_fma_f32 v83, v83, v12, v35
v_cvt_pk_bf16_f32 v84, v80, v81
v_cvt_pk_bf16_f32 v85, v82, v83
ds_write_b16 v22, v84 offset:0
ds_write_b16_d16_hi v23, v84 offset:0
ds_write_b16 v24, v85 offset:0
ds_write_b16_d16_hi v25, v85 offset:0
s_waitcnt lgkmcnt(6)
v_and_b32 v88, 0xffff0000, v67
v_lshlrev_b32 v89, 16, v67
v_and_b32 v90, 0xffff0000, v66
v_lshlrev_b32 v91, 16, v66
v_fma_f32 v88, v88, v12, v36
v_fma_f32 v89, v89, v12, v37
v_fma_f32 v90, v90, v12, v38
v_fma_f32 v91, v91, v12, v39
v_cvt_pk_bf16_f32 v92, v88, v89
v_cvt_pk_bf16_f32 v93, v90, v91
ds_write_b16 v22, v92 offset:2048
ds_write_b16_d16_hi v23, v92 offset:2048
ds_write_b16 v24, v93 offset:2048
ds_write_b16_d16_hi v25, v93 offset:2048
s_waitcnt lgkmcnt(9)
v_and_b32 v96, 0xffff0000, v69
v_lshlrev_b32 v97, 16, v69
v_and_b32 v98, 0xffff0000, v68
v_lshlrev_b32 v99, 16, v68
v_fma_f32 v96, v96, v12, v40
v_fma_f32 v97, v97, v12, v41
v_fma_f32 v98, v98, v12, v42
v_fma_f32 v99, v99, v12, v43
v_cvt_pk_bf16_f32 v100, v96, v97
v_cvt_pk_bf16_f32 v101, v98, v99
ds_write_b16 v22, v100 offset:4096
ds_write_b16_d16_hi v23, v100 offset:4096
ds_write_b16 v24, v101 offset:4096
ds_write_b16_d16_hi v25, v101 offset:4096
s_waitcnt lgkmcnt(12)
v_and_b32 v104, 0xffff0000, v71
v_lshlrev_b32 v105, 16, v71
v_and_b32 v106, 0xffff0000, v70
v_lshlrev_b32 v107, 16, v70
v_fma_f32 v104, v104, v12, v44
v_fma_f32 v105, v105, v12, v45
v_fma_f32 v106, v106, v12, v46
v_fma_f32 v107, v107, v12, v47
v_cvt_pk_bf16_f32 v108, v104, v105
v_cvt_pk_bf16_f32 v109, v106, v107
ds_write_b16 v22, v108 offset:6144
ds_write_b16_d16_hi v23, v108 offset:6144
ds_write_b16 v24, v109 offset:6144
ds_write_b16_d16_hi v25, v109 offset:6144
s_waitcnt vmcnt(2)
s_waitcnt lgkmcnt(0)
s_barrier
ds_read_b64 v[112:113], v29 offset:0
ds_read_b64 v[114:115], v28 offset:0
ds_read_b64 v[116:117], v29 offset:4096
ds_read_b64 v[118:119], v28 offset:4096
s_lshl_b32 s26, s37, 7
s_add_u32 s26, s26, 0x300000
s_waitcnt lgkmcnt(2)
buffer_store_dwordx4 v[112:115], v30, s[4:7], s26 offen sc1
s_lshl_b32 s26, s37, 7
s_add_u32 s26, s26, 0x3a0000
s_waitcnt lgkmcnt(0)
buffer_store_dwordx4 v[116:119], v30, s[4:7], s26 offen sc1
ds_read_b64 v[64:65], v18 offset:0
ds_read_b64 v[66:67], v18 offset:8
ds_read_b128 v[128:131], v20 offset:448
ds_read_b64 v[68:69], v18 offset:512
ds_read_b64 v[70:71], v18 offset:520
ds_read_b128 v[132:135], v20 offset:960
ds_read_b64 v[72:73], v18 offset:1024
ds_read_b64 v[74:75], v18 offset:1032
ds_read_b128 v[136:139], v20 offset:1472
ds_read_b64 v[76:77], v18 offset:1536
ds_read_b64 v[78:79], v18 offset:1544
ds_read_b128 v[140:143], v20 offset:1984
ds_read_b64 v[80:81], v18 offset:2048
ds_read_b64 v[82:83], v18 offset:2056
ds_read_b128 v[144:147], v20 offset:2496
ds_read_b64 v[84:85], v18 offset:2560
ds_read_b64 v[86:87], v18 offset:2568
ds_read_b128 v[148:151], v20 offset:3008
ds_read_b64 v[88:89], v18 offset:3072
ds_read_b64 v[90:91], v18 offset:3080
ds_read_b128 v[152:155], v20 offset:3520
ds_read_b64 v[92:93], v18 offset:3584
ds_read_b64 v[94:95], v18 offset:3592
ds_read_b128 v[156:159], v20 offset:4032
s_waitcnt lgkmcnt(15)
v_mfma_f32_16x16x32_bf16 v[48:51], v[72:75], v[136:139], 0
ds_read_b64_tr_b16 a[96:97], v6 offset:0
ds_read_b64 v[96:97], v18 offset:64
s_waitcnt lgkmcnt(14)
v_mfma_f32_16x16x32_bf16 v[48:51], v[68:71], v[140:143], v[48:51]
ds_read_b64 v[98:99], v18 offset:72
v_mfma_f32_16x16x32_bf16 v[52:55], v[72:75], v[140:143], 0
ds_read_b64_tr_b16 a[98:99], v6 offset:4096
ds_read_b128 v[160:163], v20 offset:384
v_mfma_f32_16x16x32_bf16 v[48:51], v[76:79], v[132:135], v[48:51]
ds_read_b64 v[100:101], v18 offset:576
v_mfma_f32_16x16x32_bf16 v[52:55], v[76:79], v[136:139], v[52:55]
ds_read_b64_tr_b16 a[100:101], v7 offset:0
ds_read_b64 v[102:103], v18 offset:584
v_mfma_f32_16x16x32_bf16 v[56:59], v[76:79], v[140:143], 0
ds_read_b128 v[164:167], v20 offset:896
s_waitcnt lgkmcnt(15)
v_mfma_f32_16x16x32_bf16 v[48:51], v[64:67], v[144:147], v[48:51]
ds_read_b64 v[104:105], v18 offset:1088
v_mfma_f32_16x16x32_bf16 v[52:55], v[68:71], v[144:147], v[52:55]
ds_read_b64_tr_b16 a[102:103], v7 offset:4096
ds_read_b64 v[106:107], v18 offset:1096
v_mfma_f32_16x16x32_bf16 v[56:59], v[72:75], v[144:147], v[56:59]
ds_read_b128 v[168:171], v20 offset:1408
v_mfma_f32_16x16x32_bf16 v[60:63], v[76:79], v[144:147], 0
ds_read_b64_tr_b16 a[104:105], v6 offset:8192
ds_read_b64 v[108:109], v18 offset:1600
v_mfma_f32_16x16x32_bf16 v[48:51], v[80:83], v[128:131], v[48:51]
ds_read_b64 v[110:111], v18 offset:1608
v_mfma_f32_16x16x32_bf16 v[52:55], v[80:83], v[132:135], v[52:55]
ds_read_b64_tr_b16 a[106:107], v6 offset:12288
ds_read_b128 v[172:175], v20 offset:1920
v_mfma_f32_16x16x32_bf16 v[56:59], v[80:83], v[136:139], v[56:59]
v_mfma_f32_16x16x32_bf16 v[60:63], v[80:83], v[140:143], v[60:63]
ds_read_b64 v[112:113], v18 offset:2112
v_mfma_f32_16x16x32_bf16 v[52:55], v[64:67], v[148:151], v[52:55]
ds_read_b64_tr_b16 a[108:109], v7 offset:8192
ds_read_b64 v[114:115], v18 offset:2120
v_mfma_f32_16x16x32_bf16 v[56:59], v[68:71], v[148:151], v[56:59]
ds_read_b128 v[176:179], v20 offset:2432
v_mfma_f32_16x16x32_bf16 v[60:63], v[72:75], v[148:151], v[60:63]
ds_read_b64_tr_b16 a[110:111], v7 offset:12288
ds_read_b64 v[116:117], v18 offset:2624
v_mfma_f32_16x16x32_bf16 v[52:55], v[84:87], v[128:131], v[52:55]
ds_read_b64 v[118:119], v18 offset:2632
v_mfma_f32_16x16x32_bf16 v[56:59], v[84:87], v[132:135], v[56:59]
ds_read_b64_tr_b16 a[112:113], v6 offset:16384
ds_read_b128 v[180:183], v20 offset:2944
v_mfma_f32_16x16x32_bf16 v[60:63], v[84:87], v[136:139], v[60:63]
ds_read_b64 v[120:121], v18 offset:3136
s_waitcnt lgkmcnt(15)
v_mfma_f32_16x16x32_bf16 v[56:59], v[64:67], v[152:155], v[56:59]
ds_read_b64 v[122:123], v18 offset:3144
v_mfma_f32_16x16x32_bf16 v[60:63], v[68:71], v[152:155], v[60:63]
ds_read_b64_tr_b16 a[114:115], v6 offset:20480
ds_read_b128 v[184:187], v20 offset:3456
v_mfma_f32_16x16x32_bf16 v[56:59], v[88:91], v[128:131], v[56:59]
ds_read_b64 v[124:125], v18 offset:3648
v_mfma_f32_16x16x32_bf16 v[60:63], v[88:91], v[132:135], v[60:63]
ds_read_b64_tr_b16 a[116:117], v7 offset:16384
ds_read_b64 v[126:127], v18 offset:3656
v_mfma_f32_16x16x32_bf16 v[60:63], v[64:67], v[156:159], v[60:63]
ds_read_b128 v[188:191], v20 offset:3968
v_mfma_f32_16x16x32_bf16 v[60:63], v[92:95], v[128:131], v[60:63]
v_mfma_f32_16x16x32_bf16 v[48:51], v[104:107], v[168:171], v[48:51]
ds_read_b64_tr_b16 a[118:119], v7 offset:20480
ds_read_b64 v[64:65], v18 offset:128
s_waitcnt lgkmcnt(15)
v_mfma_f32_16x16x32_bf16 v[48:51], v[100:103], v[172:175], v[48:51]
ds_read_b64 v[66:67], v18 offset:136
v_mfma_f32_16x16x32_bf16 v[52:55], v[104:107], v[172:175], v[52:55]
ds_read_b64_tr_b16 a[120:121], v6 offset:24576
ds_read_b128 v[128:131], v20 offset:320
v_mfma_f32_16x16x32_bf16 v[48:51], v[108:111], v[164:167], v[48:51]
ds_read_b64 v[68:69], v18 offset:640
v_mfma_f32_16x16x32_bf16 v[52:55], v[108:111], v[168:171], v[52:55]
ds_read_b64_tr_b16 a[122:123], v6 offset:28672
ds_read_b64 v[70:71], v18 offset:648
v_mfma_f32_16x16x32_bf16 v[56:59], v[108:111], v[172:175], v[56:59]
ds_read_b128 v[132:135], v20 offset:832
v_mfma_f32_16x16x32_bf16 v[48:51], v[96:99], v[176:179], v[48:51]
ds_read_b64 v[72:73], v18 offset:1152
v_mfma_f32_16x16x32_bf16 v[52:55], v[100:103], v[176:179], v[52:55]
ds_read_b64_tr_b16 a[124:125], v7 offset:24576
ds_read_b64 v[74:75], v18 offset:1160
v_mfma_f32_16x16x32_bf16 v[56:59], v[104:107], v[176:179], v[56:59]
ds_read_b128 v[136:139], v20 offset:1344
v_mfma_f32_16x16x32_bf16 v[60:63], v[108:111], v[176:179], v[60:63]
ds_read_b64_tr_b16 a[126:127], v7 offset:28672
ds_read_b64 v[76:77], v18 offset:1664
v_mfma_f32_16x16x32_bf16 v[48:51], v[112:115], v[160:163], v[48:51]
ds_read_b64 v[78:79], v18 offset:1672
v_mfma_f32_16x16x32_bf16 v[52:55], v[112:115], v[164:167], v[52:55]
ds_read_b64_tr_b16 a[128:129], v6 offset:32768
ds_read_b128 v[140:143], v20 offset:1856
v_mfma_f32_16x16x32_bf16 v[56:59], v[112:115], v[168:171], v[56:59]
v_mfma_f32_16x16x32_bf16 v[60:63], v[112:115], v[172:175], v[60:63]
ds_read_b64 v[80:81], v18 offset:2176
s_waitcnt lgkmcnt(15)
v_mfma_f32_16x16x32_bf16 v[52:55], v[96:99], v[180:183], v[52:55]
ds_read_b64_tr_b16 a[130:131], v6 offset:36864
ds_read_b64 v[82:83], v18 offset:2184
v_mfma_f32_16x16x32_bf16 v[56:59], v[100:103], v[180:183], v[56:59]
ds_read_b128 v[144:147], v20 offset:2368
v_mfma_f32_16x16x32_bf16 v[60:63], v[104:107], v[180:183], v[60:63]
ds_read_b64_tr_b16 a[132:133], v7 offset:32768
ds_read_b64 v[84:85], v18 offset:2688
v_mfma_f32_16x16x32_bf16 v[52:55], v[116:119], v[160:163], v[52:55]
ds_read_b64 v[86:87], v18 offset:2696
v_mfma_f32_16x16x32_bf16 v[56:59], v[116:119], v[164:167], v[56:59]
ds_read_b64_tr_b16 a[134:135], v7 offset:36864
ds_read_b128 v[148:151], v20 offset:2880
v_mfma_f32_16x16x32_bf16 v[60:63], v[116:119], v[168:171], v[60:63]
ds_read_b64 v[88:89], v18 offset:3200
v_mfma_f32_16x16x32_bf16 v[56:59], v[96:99], v[184:187], v[56:59]
ds_read_b64 v[90:91], v18 offset:3208
v_mfma_f32_16x16x32_bf16 v[60:63], v[100:103], v[184:187], v[60:63]
ds_read_b64_tr_b16 a[136:137], v6 offset:40960
ds_read_b128 v[152:155], v20 offset:3392
v_mfma_f32_16x16x32_bf16 v[56:59], v[120:123], v[160:163], v[56:59]
ds_read_b64 v[92:93], v18 offset:3712
v_mfma_f32_16x16x32_bf16 v[60:63], v[120:123], v[164:167], v[60:63]
ds_read_b64_tr_b16 a[138:139], v6 offset:45056
ds_read_b64 v[94:95], v18 offset:3720
v_mfma_f32_16x16x32_bf16 v[60:63], v[96:99], v[188:191], v[60:63]
ds_read_b128 v[156:159], v20 offset:3904
v_mfma_f32_16x16x32_bf16 v[60:63], v[124:127], v[160:163], v[60:63]
s_waitcnt lgkmcnt(15)
v_mfma_f32_16x16x32_bf16 v[48:51], v[72:75], v[136:139], v[48:51]
ds_read_b64_tr_b16 a[140:141], v7 offset:40960
ds_read_b64 v[96:97], v18 offset:192
v_mfma_f32_16x16x32_bf16 v[48:51], v[68:71], v[140:143], v[48:51]
ds_read_b64 v[98:99], v18 offset:200
v_mfma_f32_16x16x32_bf16 v[52:55], v[72:75], v[140:143], v[52:55]
ds_read_b64_tr_b16 a[142:143], v7 offset:45056
ds_read_b128 v[160:163], v20 offset:256
v_mfma_f32_16x16x32_bf16 v[48:51], v[76:79], v[132:135], v[48:51]
ds_read_b64 v[100:101], v18 offset:704
v_mfma_f32_16x16x32_bf16 v[52:55], v[76:79], v[136:139], v[52:55]
ds_read_b64 v[102:103], v18 offset:712
v_mfma_f32_16x16x32_bf16 v[56:59], v[76:79], v[140:143], v[56:59]
ds_read_b64_tr_b16 a[144:145], v6 offset:49152
ds_read_b128 v[164:167], v20 offset:768
s_waitcnt lgkmcnt(15)
v_mfma_f32_16x16x32_bf16 v[48:51], v[64:67], v[144:147], v[48:51]
ds_read_b64 v[104:105], v18 offset:1216
v_mfma_f32_16x16x32_bf16 v[52:55], v[68:71], v[144:147], v[52:55]
ds_read_b64_tr_b16 a[146:147], v6 offset:53248
ds_read_b64 v[106:107], v18 offset:1224
v_mfma_f32_16x16x32_bf16 v[56:59], v[72:75], v[144:147], v[56:59]
ds_read_b128 v[168:171], v20 offset:1280
v_mfma_f32_16x16x32_bf16 v[60:63], v[76:79], v[144:147], v[60:63]
ds_read_b64 v[108:109], v18 offset:1728
v_mfma_f32_16x16x32_bf16 v[48:51], v[80:83], v[128:131], v[48:51]
ds_read_b64_tr_b16 a[148:149], v7 offset:49152
ds_read_b64 v[110:111], v18 offset:1736
v_mfma_f32_16x16x32_bf16 v[52:55], v[80:83], v[132:135], v[52:55]
ds_read_b128 v[172:175], v20 offset:1792
v_mfma_f32_16x16x32_bf16 v[56:59], v[80:83], v[136:139], v[56:59]
v_mfma_f32_16x16x32_bf16 v[60:63], v[80:83], v[140:143], v[60:63]
ds_read_b64_tr_b16 a[150:151], v7 offset:53248
ds_read_b64 v[112:113], v18 offset:2240
v_mfma_f32_16x16x32_bf16 v[52:55], v[64:67], v[148:151], v[52:55]
ds_read_b64 v[114:115], v18 offset:2248
v_mfma_f32_16x16x32_bf16 v[56:59], v[68:71], v[148:151], v[56:59]
ds_read_b64_tr_b16 a[152:153], v6 offset:57344
ds_read_b128 v[176:179], v20 offset:2304
v_mfma_f32_16x16x32_bf16 v[60:63], v[72:75], v[148:151], v[60:63]
ds_read_b64 v[116:117], v18 offset:2752
v_mfma_f32_16x16x32_bf16 v[52:55], v[84:87], v[128:131], v[52:55]
ds_read_b64 v[118:119], v18 offset:2760
v_mfma_f32_16x16x32_bf16 v[56:59], v[84:87], v[132:135], v[56:59]
ds_read_b64_tr_b16 a[154:155], v6 offset:61440
ds_read_b128 v[180:183], v20 offset:2816
v_mfma_f32_16x16x32_bf16 v[60:63], v[84:87], v[136:139], v[60:63]
ds_read_b64 v[120:121], v18 offset:3264
s_waitcnt lgkmcnt(15)
v_mfma_f32_16x16x32_bf16 v[56:59], v[64:67], v[152:155], v[56:59]
ds_read_b64_tr_b16 a[156:157], v7 offset:57344
ds_read_b64 v[122:123], v18 offset:3272
v_mfma_f32_16x16x32_bf16 v[60:63], v[68:71], v[152:155], v[60:63]
ds_read_b128 v[184:187], v20 offset:3328
v_mfma_f32_16x16x32_bf16 v[56:59], v[88:91], v[128:131], v[56:59]
ds_read_b64 v[124:125], v18 offset:3776
v_mfma_f32_16x16x32_bf16 v[60:63], v[88:91], v[132:135], v[60:63]
ds_read_b64_tr_b16 a[158:159], v7 offset:61440
ds_read_b64 v[126:127], v18 offset:3784
v_mfma_f32_16x16x32_bf16 v[60:63], v[64:67], v[156:159], v[60:63]
ds_read_b128 v[188:191], v20 offset:3840
v_mfma_f32_16x16x32_bf16 v[60:63], v[92:95], v[128:131], v[60:63]
s_waitcnt lgkmcnt(2)
s_waitcnt vmcnt(0)
s_barrier
v_mfma_f32_16x16x32_bf16 v[48:51], v[104:107], v[168:171], v[48:51]
s_lshl_b32 s26, s37, 4
s_add_u32 s26, s26, 0x1f02000
buffer_store_dword v3, v31, s[4:7], s26 offen sc1
ds_read_b64 v[64:65], v18 offset:256
v_mfma_f32_16x16x32_bf16 v[48:51], v[100:103], v[172:175], v[48:51]
ds_read_b64 v[66:67], v18 offset:264
v_mfma_f32_16x16x32_bf16 v[52:55], v[104:107], v[172:175], v[52:55]
s_add_u32 m0, s47, 98304
s_add_u32 s29, s46, 1105920
buffer_load_dwordx4 v14, s[8:11], s29 offen lds
ds_read_b128 v[128:131], v20 offset:192
v_mfma_f32_16x16x32_bf16 v[48:51], v[108:111], v[164:167], v[48:51]
ds_read_b64 v[68:69], v18 offset:768
v_mfma_f32_16x16x32_bf16 v[52:55], v[108:111], v[168:171], v[52:55]
ds_read_b64 v[70:71], v18 offset:776
v_mfma_f32_16x16x32_bf16 v[56:59], v[108:111], v[172:175], v[56:59]
s_add_u32 m0, s47, 99328
s_add_u32 s29, s46, 1119744
buffer_load_dwordx4 v15, s[8:11], s29 offen lds
ds_read_b128 v[132:135], v20 offset:704
v_mfma_f32_16x16x32_bf16 v[48:51], v[96:99], v[176:179], v[48:51]
ds_read_b64 v[72:73], v18 offset:1280
v_mfma_f32_16x16x32_bf16 v[52:55], v[100:103], v[176:179], v[52:55]
ds_read_b64 v[74:75], v18 offset:1288
v_mfma_f32_16x16x32_bf16 v[56:59], v[104:107], v[176:179], v[56:59]
s_add_u32 m0, s47, 106496
s_add_u32 s29, s46, 1105920
buffer_load_dwordx4 v14, s[12:15], s29 offen lds
ds_read_b128 v[136:139], v20 offset:1216
v_mfma_f32_16x16x32_bf16 v[60:63], v[108:111], v[176:179], v[60:63]
ds_read_b64 v[76:77], v18 offset:1792
v_mfma_f32_16x16x32_bf16 v[48:51], v[112:115], v[160:163], v[48:51]
ds_read_b64 v[78:79], v18 offset:1800
v_mfma_f32_16x16x32_bf16 v[52:55], v[112:115], v[164:167], v[52:55]
s_add_u32 m0, s47, 107520
s_add_u32 s29, s46, 1119744
buffer_load_dwordx4 v15, s[12:15], s29 offen lds
ds_read_b128 v[140:143], v20 offset:1728
v_mfma_f32_16x16x32_bf16 v[56:59], v[112:115], v[168:171], v[56:59]
v_mfma_f32_16x16x32_bf16 v[60:63], v[112:115], v[172:175], v[60:63]
ds_read_b64 v[80:81], v18 offset:2304
v_mfma_f32_16x16x32_bf16 v[52:55], v[96:99], v[180:183], v[52:55]
s_add_u32 m0, s47, 114688
s_add_u32 s29, s46, 1216512
buffer_load_dwordx4 v14, s[8:11], s29 offen lds
ds_read_b64 v[82:83], v18 offset:2312
v_mfma_f32_16x16x32_bf16 v[56:59], v[100:103], v[180:183], v[56:59]
ds_read_b128 v[144:147], v20 offset:2240
v_mfma_f32_16x16x32_bf16 v[60:63], v[104:107], v[180:183], v[60:63]
ds_read_b64 v[84:85], v18 offset:2816
v_mfma_f32_16x16x32_bf16 v[52:55], v[116:119], v[160:163], v[52:55]
s_add_u32 m0, s47, 115712
s_add_u32 s29, s46, 1230336
buffer_load_dwordx4 v15, s[8:11], s29 offen lds
ds_read_b64 v[86:87], v18 offset:2824
v_mfma_f32_16x16x32_bf16 v[56:59], v[116:119], v[164:167], v[56:59]
ds_read_b128 v[148:151], v20 offset:2752
v_mfma_f32_16x16x32_bf16 v[60:63], v[116:119], v[168:171], v[60:63]
ds_read_b64 v[88:89], v18 offset:3328
v_mfma_f32_16x16x32_bf16 v[56:59], v[96:99], v[184:187], v[56:59]
s_add_u32 m0, s47, 122880
s_add_u32 s29, s46, 1216512
buffer_load_dwordx4 v14, s[12:15], s29 offen lds
ds_read_b64 v[90:91], v18 offset:3336
v_mfma_f32_16x16x32_bf16 v[60:63], v[100:103], v[184:187], v[60:63]
ds_read_b128 v[152:155], v20 offset:3264
v_mfma_f32_16x16x32_bf16 v[56:59], v[120:123], v[160:163], v[56:59]
ds_read_b64 v[92:93], v18 offset:3840
v_mfma_f32_16x16x32_bf16 v[60:63], v[120:123], v[164:167], v[60:63]
s_add_u32 m0, s47, 123904
s_add_u32 s29, s46, 1230336
buffer_load_dwordx4 v15, s[12:15], s29 offen lds
ds_read_b64 v[94:95], v18 offset:3848
s_waitcnt lgkmcnt(15)
v_mfma_f32_16x16x32_bf16 v[60:63], v[96:99], v[188:191], v[60:63]
ds_read_b128 v[156:159], v20 offset:3776
v_mfma_f32_16x16x32_bf16 v[60:63], v[124:127], v[160:163], v[60:63]
s_waitcnt lgkmcnt(15)
v_mfma_f32_16x16x32_bf16 v[48:51], v[72:75], v[136:139], v[48:51]
s_add_u32 m0, s47, 131072
s_add_u32 s29, s46, 1327104
buffer_load_dwordx4 v14, s[8:11], s29 offen lds
ds_read_b64 v[96:97], v18 offset:320
s_waitcnt lgkmcnt(13)
v_mfma_f32_16x16x32_bf16 v[48:51], v[68:71], v[140:143], v[48:51]
ds_read_b64 v[98:99], v18 offset:328
v_mfma_f32_16x16x32_bf16 v[52:55], v[72:75], v[140:143], v[52:55]
s_add_u32 m0, s47, 132096
s_add_u32 s29, s46, 1340928
buffer_load_dwordx4 v15, s[8:11], s29 offen lds
ds_read_b128 v[160:163], v20 offset:128
v_mfma_f32_16x16x32_bf16 v[48:51], v[76:79], v[132:135], v[48:51]
ds_read_b64 v[100:101], v18 offset:832
v_mfma_f32_16x16x32_bf16 v[52:55], v[76:79], v[136:139], v[52:55]
ds_read_b64 v[102:103], v18 offset:840
v_mfma_f32_16x16x32_bf16 v[56:59], v[76:79], v[140:143], v[56:59]
s_add_u32 m0, s47, 139264
s_add_u32 s29, s46, 1327104
buffer_load_dwordx4 v14, s[12:15], s29 offen lds
ds_read_b128 v[164:167], v20 offset:640
s_waitcnt lgkmcnt(15)
v_mfma_f32_16x16x32_bf16 v[48:51], v[64:67], v[144:147], v[48:51]
ds_read_b64 v[104:105], v18 offset:1344
v_mfma_f32_16x16x32_bf16 v[52:55], v[68:71], v[144:147], v[52:55]
ds_read_b64 v[106:107], v18 offset:1352
v_mfma_f32_16x16x32_bf16 v[56:59], v[72:75], v[144:147], v[56:59]
s_add_u32 m0, s47, 140288
s_add_u32 s29, s46, 1340928
buffer_load_dwordx4 v15, s[12:15], s29 offen lds
ds_read_b128 v[168:171], v20 offset:1152
v_mfma_f32_16x16x32_bf16 v[60:63], v[76:79], v[144:147], v[60:63]
ds_read_b64 v[108:109], v18 offset:1856
v_mfma_f32_16x16x32_bf16 v[48:51], v[80:83], v[128:131], v[48:51]
ds_read_b64 v[110:111], v18 offset:1864
v_mfma_f32_16x16x32_bf16 v[52:55], v[80:83], v[132:135], v[52:55]
s_add_u32 m0, s47, 147456
s_add_u32 s29, s46, 1437696
buffer_load_dwordx4 v14, s[8:11], s29 offen lds
ds_read_b128 v[172:175], v20 offset:1664
v_mfma_f32_16x16x32_bf16 v[56:59], v[80:83], v[136:139], v[56:59]
v_mfma_f32_16x16x32_bf16 v[60:63], v[80:83], v[140:143], v[60:63]
ds_read_b64 v[112:113], v18 offset:2368
s_waitcnt lgkmcnt(15)
v_mfma_f32_16x16x32_bf16 v[52:55], v[64:67], v[148:151], v[52:55]
s_add_u32 m0, s47, 148480
s_add_u32 s29, s46, 1451520
buffer_load_dwordx4 v15, s[8:11], s29 offen lds
ds_read_b64 v[114:115], v18 offset:2376
v_mfma_f32_16x16x32_bf16 v[56:59], v[68:71], v[148:151], v[56:59]
ds_read_b128 v[176:179], v20 offset:2176
v_mfma_f32_16x16x32_bf16 v[60:63], v[72:75], v[148:151], v[60:63]
ds_read_b64 v[116:117], v18 offset:2880
v_mfma_f32_16x16x32_bf16 v[52:55], v[84:87], v[128:131], v[52:55]
s_add_u32 m0, s47, 155648
s_add_u32 s29, s46, 1437696
buffer_load_dwordx4 v14, s[12:15], s29 offen lds
ds_read_b64 v[118:119], v18 offset:2888
v_mfma_f32_16x16x32_bf16 v[56:59], v[84:87], v[132:135], v[56:59]
ds_read_b128 v[180:183], v20 offset:2688
v_mfma_f32_16x16x32_bf16 v[60:63], v[84:87], v[136:139], v[60:63]
ds_read_b64 v[120:121], v18 offset:3392
v_mfma_f32_16x16x32_bf16 v[56:59], v[64:67], v[152:155], v[56:59]
s_add_u32 m0, s47, 156672
s_add_u32 s29, s46, 1451520
buffer_load_dwordx4 v15, s[12:15], s29 offen lds
ds_read_b64 v[122:123], v18 offset:3400
v_mfma_f32_16x16x32_bf16 v[60:63], v[68:71], v[152:155], v[60:63]
ds_read_b128 v[184:187], v20 offset:3200
v_mfma_f32_16x16x32_bf16 v[56:59], v[88:91], v[128:131], v[56:59]
ds_read_b64 v[124:125], v18 offset:3904
v_mfma_f32_16x16x32_bf16 v[60:63], v[88:91], v[132:135], v[60:63]
ds_read_b64 v[126:127], v18 offset:3912
s_waitcnt lgkmcnt(15)
v_mfma_f32_16x16x32_bf16 v[60:63], v[64:67], v[156:159], v[60:63]
ds_read_b128 v[188:191], v20 offset:3712
v_mfma_f32_16x16x32_bf16 v[60:63], v[92:95], v[128:131], v[60:63]
s_waitcnt lgkmcnt(15)
v_mfma_f32_16x16x32_bf16 v[48:51], v[104:107], v[168:171], v[48:51]
ds_read_b64 v[64:65], v18 offset:384
s_waitcnt lgkmcnt(13)
v_mfma_f32_16x16x32_bf16 v[48:51], v[100:103], v[172:175], v[48:51]
ds_read_b64 v[66:67], v18 offset:392
v_mfma_f32_16x16x32_bf16 v[52:55], v[104:107], v[172:175], v[52:55]
ds_read_b128 v[128:131], v20 offset:64
v_mfma_f32_16x16x32_bf16 v[48:51], v[108:111], v[164:167], v[48:51]
ds_read_b64 v[68:69], v18 offset:896
v_mfma_f32_16x16x32_bf16 v[52:55], v[108:111], v[168:171], v[52:55]
ds_read_b64 v[70:71], v18 offset:904
v_mfma_f32_16x16x32_bf16 v[56:59], v[108:111], v[172:175], v[56:59]
ds_read_b128 v[132:135], v20 offset:576
s_waitcnt lgkmcnt(15)
v_mfma_f32_16x16x32_bf16 v[48:51], v[96:99], v[176:179], v[48:51]
ds_read_b64 v[72:73], v18 offset:1408
v_mfma_f32_16x16x32_bf16 v[52:55], v[100:103], v[176:179], v[52:55]
ds_read_b64 v[74:75], v18 offset:1416
v_mfma_f32_16x16x32_bf16 v[56:59], v[104:107], v[176:179], v[56:59]
ds_read_b128 v[136:139], v20 offset:1088
v_mfma_f32_16x16x32_bf16 v[60:63], v[108:111], v[176:179], v[60:63]
ds_read_b64 v[76:77], v18 offset:1920
v_mfma_f32_16x16x32_bf16 v[48:51], v[112:115], v[160:163], v[48:51]
ds_read_b64 v[78:79], v18 offset:1928
v_mfma_f32_16x16x32_bf16 v[52:55], v[112:115], v[164:167], v[52:55]
ds_read_b128 v[140:143], v20 offset:1600
v_mfma_f32_16x16x32_bf16 v[56:59], v[112:115], v[168:171], v[56:59]
v_mfma_f32_16x16x32_bf16 v[60:63], v[112:115], v[172:175], v[60:63]
ds_read_b64 v[80:81], v18 offset:2432
s_waitcnt lgkmcnt(15)
v_mfma_f32_16x16x32_bf16 v[52:55], v[96:99], v[180:183], v[52:55]
ds_read_b64 v[82:83], v18 offset:2440
v_mfma_f32_16x16x32_bf16 v[56:59], v[100:103], v[180:183], v[56:59]
ds_read_b128 v[144:147], v20 offset:2112
v_mfma_f32_16x16x32_bf16 v[60:63], v[104:107], v[180:183], v[60:63]
ds_read_b64 v[84:85], v18 offset:2944
v_mfma_f32_16x16x32_bf16 v[52:55], v[116:119], v[160:163], v[52:55]
ds_read_b64 v[86:87], v18 offset:2952
v_mfma_f32_16x16x32_bf16 v[56:59], v[116:119], v[164:167], v[56:59]
ds_read_b128 v[148:151], v20 offset:2624
v_mfma_f32_16x16x32_bf16 v[60:63], v[116:119], v[168:171], v[60:63]
ds_read_b64 v[88:89], v18 offset:3456
v_mfma_f32_16x16x32_bf16 v[56:59], v[96:99], v[184:187], v[56:59]
ds_read_b64 v[90:91], v18 offset:3464
v_mfma_f32_16x16x32_bf16 v[60:63], v[100:103], v[184:187], v[60:63]
ds_read_b128 v[152:155], v20 offset:3136
v_mfma_f32_16x16x32_bf16 v[56:59], v[120:123], v[160:163], v[56:59]
ds_read_b64 v[92:93], v18 offset:3968
v_mfma_f32_16x16x32_bf16 v[60:63], v[120:123], v[164:167], v[60:63]
ds_read_b64 v[94:95], v18 offset:3976
s_waitcnt lgkmcnt(15)
v_mfma_f32_16x16x32_bf16 v[60:63], v[96:99], v[188:191], v[60:63]
ds_read_b128 v[156:159], v20 offset:3648
v_mfma_f32_16x16x32_bf16 v[60:63], v[124:127], v[160:163], v[60:63]
s_waitcnt lgkmcnt(15)
v_mfma_f32_16x16x32_bf16 v[48:51], v[72:75], v[136:139], v[48:51]
ds_read_b64 v[96:97], v18 offset:448
s_waitcnt lgkmcnt(13)
v_mfma_f32_16x16x32_bf16 v[48:51], v[68:71], v[140:143], v[48:51]
ds_read_b64 v[98:99], v18 offset:456
v_mfma_f32_16x16x32_bf16 v[52:55], v[72:75], v[140:143], v[52:55]
ds_read_b128 v[160:163], v20 offset:0
v_mfma_f32_16x16x32_bf16 v[48:51], v[76:79], v[132:135], v[48:51]
ds_read_b64 v[100:101], v18 offset:960
v_mfma_f32_16x16x32_bf16 v[52:55], v[76:79], v[136:139], v[52:55]
ds_read_b64 v[102:103], v18 offset:968
v_mfma_f32_16x16x32_bf16 v[56:59], v[76:79], v[140:143], v[56:59]
ds_read_b128 v[164:167], v20 offset:512
s_waitcnt lgkmcnt(15)
v_mfma_f32_16x16x32_bf16 v[48:51], v[64:67], v[144:147], v[48:51]
ds_read_b64 v[104:105], v18 offset:1472
v_mfma_f32_16x16x32_bf16 v[52:55], v[68:71], v[144:147], v[52:55]
ds_read_b64 v[106:107], v18 offset:1480
v_mfma_f32_16x16x32_bf16 v[56:59], v[72:75], v[144:147], v[56:59]
ds_read_b128 v[168:171], v20 offset:1024
v_mfma_f32_16x16x32_bf16 v[60:63], v[76:79], v[144:147], v[60:63]
ds_read_b64 v[108:109], v18 offset:1984
v_mfma_f32_16x16x32_bf16 v[48:51], v[80:83], v[128:131], v[48:51]
ds_read_b64 v[110:111], v18 offset:1992
v_mfma_f32_16x16x32_bf16 v[52:55], v[80:83], v[132:135], v[52:55]
ds_read_b128 v[172:175], v20 offset:1536
v_mfma_f32_16x16x32_bf16 v[56:59], v[80:83], v[136:139], v[56:59]
v_mfma_f32_16x16x32_bf16 v[60:63], v[80:83], v[140:143], v[60:63]
ds_read_b64 v[112:113], v18 offset:2496
s_waitcnt lgkmcnt(15)
v_mfma_f32_16x16x32_bf16 v[52:55], v[64:67], v[148:151], v[52:55]
ds_read_b64 v[114:115], v18 offset:2504
v_mfma_f32_16x16x32_bf16 v[56:59], v[68:71], v[148:151], v[56:59]
ds_read_b128 v[176:179], v20 offset:2048
v_mfma_f32_16x16x32_bf16 v[60:63], v[72:75], v[148:151], v[60:63]
ds_read_b64 v[116:117], v18 offset:3008
v_mfma_f32_16x16x32_bf16 v[52:55], v[84:87], v[128:131], v[52:55]
ds_read_b64 v[118:119], v18 offset:3016
v_mfma_f32_16x16x32_bf16 v[56:59], v[84:87], v[132:135], v[56:59]
ds_read_b128 v[180:183], v20 offset:2560
v_mfma_f32_16x16x32_bf16 v[60:63], v[84:87], v[136:139], v[60:63]
ds_read_b64 v[120:121], v18 offset:3520
v_mfma_f32_16x16x32_bf16 v[56:59], v[64:67], v[152:155], v[56:59]
ds_read_b64 v[122:123], v18 offset:3528
v_mfma_f32_16x16x32_bf16 v[60:63], v[68:71], v[152:155], v[60:63]
ds_read_b128 v[184:187], v20 offset:3072
v_mfma_f32_16x16x32_bf16 v[56:59], v[88:91], v[128:131], v[56:59]
ds_read_b64 v[124:125], v18 offset:4032
v_mfma_f32_16x16x32_bf16 v[60:63], v[88:91], v[132:135], v[60:63]
ds_read_b64 v[126:127], v18 offset:4040
s_waitcnt lgkmcnt(15)
v_mfma_f32_16x16x32_bf16 v[60:63], v[64:67], v[156:159], v[60:63]
ds_read_b128 v[188:191], v20 offset:3584
v_mfma_f32_16x16x32_bf16 v[60:63], v[92:95], v[128:131], v[60:63]
s_waitcnt lgkmcnt(15)
v_mfma_f32_16x16x32_bf16 v[48:51], v[104:107], v[168:171], v[48:51]
s_waitcnt lgkmcnt(12)
v_mfma_f32_16x16x32_bf16 v[48:51], v[100:103], v[172:175], v[48:51]
v_mfma_f32_16x16x32_bf16 v[52:55], v[104:107], v[172:175], v[52:55]
v_mfma_f32_16x16x32_bf16 v[48:51], v[108:111], v[164:167], v[48:51]
v_mfma_f32_16x16x32_bf16 v[52:55], v[108:111], v[168:171], v[52:55]
v_mfma_f32_16x16x32_bf16 v[56:59], v[108:111], v[172:175], v[56:59]
s_waitcnt lgkmcnt(9)
v_mfma_f32_16x16x32_bf16 v[48:51], v[96:99], v[176:179], v[48:51]
v_mfma_f32_16x16x32_bf16 v[52:55], v[100:103], v[176:179], v[52:55]
v_mfma_f32_16x16x32_bf16 v[56:59], v[104:107], v[176:179], v[56:59]
v_mfma_f32_16x16x32_bf16 v[60:63], v[108:111], v[176:179], v[60:63]
v_mfma_f32_16x16x32_bf16 v[48:51], v[112:115], v[160:163], v[48:51]
v_mfma_f32_16x16x32_bf16 v[52:55], v[112:115], v[164:167], v[52:55]
v_mfma_f32_16x16x32_bf16 v[56:59], v[112:115], v[168:171], v[56:59]
v_mfma_f32_16x16x32_bf16 v[60:63], v[112:115], v[172:175], v[60:63]
s_waitcnt lgkmcnt(6)
v_mfma_f32_16x16x32_bf16 v[52:55], v[96:99], v[180:183], v[52:55]
v_mfma_f32_16x16x32_bf16 v[56:59], v[100:103], v[180:183], v[56:59]
v_mfma_f32_16x16x32_bf16 v[60:63], v[104:107], v[180:183], v[60:63]
v_mfma_f32_16x16x32_bf16 v[52:55], v[116:119], v[160:163], v[52:55]
v_mfma_f32_16x16x32_bf16 v[56:59], v[116:119], v[164:167], v[56:59]
v_mfma_f32_16x16x32_bf16 v[60:63], v[116:119], v[168:171], v[60:63]
s_waitcnt lgkmcnt(3)
v_mfma_f32_16x16x32_bf16 v[56:59], v[96:99], v[184:187], v[56:59]
v_mfma_f32_16x16x32_bf16 v[60:63], v[100:103], v[184:187], v[60:63]
v_mfma_f32_16x16x32_bf16 v[56:59], v[120:123], v[160:163], v[56:59]
v_mfma_f32_16x16x32_bf16 v[60:63], v[120:123], v[164:167], v[60:63]
s_waitcnt lgkmcnt(0)
v_mfma_f32_16x16x32_bf16 v[60:63], v[96:99], v[188:191], v[60:63]
v_mfma_f32_16x16x32_bf16 v[60:63], v[124:127], v[160:163], v[60:63]
ds_read_b64 v[64:65], v21 offset:2048
ds_read_b64 v[66:67], v21 offset:2560
ds_read_b64 v[68:69], v21 offset:3072
ds_read_b64 v[70:71], v21 offset:3584
s_waitcnt lgkmcnt(3)
v_and_b32 v80, 0xffff0000, v65
v_lshlrev_b32 v81, 16, v65
v_and_b32 v82, 0xffff0000, v64
v_lshlrev_b32 v83, 16, v64
v_fma_f32 v80, v80, v12, v48
v_fma_f32 v81, v81, v12, v49
v_fma_f32 v82, v82, v12, v50
v_fma_f32 v83, v83, v12, v51
v_cvt_pk_bf16_f32 v84, v80, v81
v_cvt_pk_bf16_f32 v85, v82, v83
ds_write_b16 v22, v84 offset:0
ds_write_b16_d16_hi v23, v84 offset:0
ds_write_b16 v24, v85 offset:0
ds_write_b16_d16_hi v25, v85 offset:0
s_waitcnt lgkmcnt(6)
v_and_b32 v88, 0xffff0000, v67
v_lshlrev_b32 v89, 16, v67
v_and_b32 v90, 0xffff0000, v66
v_lshlrev_b32 v91, 16, v66
v_fma_f32 v88, v88, v12, v52
v_fma_f32 v89, v89, v12, v53
v_fma_f32 v90, v90, v12, v54
v_fma_f32 v91, v91, v12, v55
v_cvt_pk_bf16_f32 v92, v88, v89
v_cvt_pk_bf16_f32 v93, v90, v91
ds_write_b16 v22, v92 offset:2048
ds_write_b16_d16_hi v23, v92 offset:2048
ds_write_b16 v24, v93 offset:2048
ds_write_b16_d16_hi v25, v93 offset:2048
s_waitcnt lgkmcnt(9)
v_and_b32 v96, 0xffff0000, v69
v_lshlrev_b32 v97, 16, v69
v_and_b32 v98, 0xffff0000, v68
v_lshlrev_b32 v99, 16, v68
v_fma_f32 v96, v96, v12, v56
v_fma_f32 v97, v97, v12, v57
v_fma_f32 v98, v98, v12, v58
v_fma_f32 v99, v99, v12, v59
v_cvt_pk_bf16_f32 v100, v96, v97
v_cvt_pk_bf16_f32 v101, v98, v99
ds_write_b16 v22, v100 offset:4096
ds_write_b16_d16_hi v23, v100 offset:4096
ds_write_b16 v24, v101 offset:4096
ds_write_b16_d16_hi v25, v101 offset:4096
s_waitcnt lgkmcnt(12)
v_and_b32 v104, 0xffff0000, v71
v_lshlrev_b32 v105, 16, v71
v_and_b32 v106, 0xffff0000, v70
v_lshlrev_b32 v107, 16, v70
v_fma_f32 v104, v104, v12, v60
v_fma_f32 v105, v105, v12, v61
v_fma_f32 v106, v106, v12, v62
v_fma_f32 v107, v107, v12, v63
v_cvt_pk_bf16_f32 v108, v104, v105
v_cvt_pk_bf16_f32 v109, v106, v107
ds_write_b16 v22, v108 offset:6144
ds_write_b16_d16_hi v23, v108 offset:6144
ds_write_b16 v24, v109 offset:6144
ds_write_b16_d16_hi v25, v109 offset:6144
s_waitcnt vmcnt(0)
s_waitcnt lgkmcnt(0)
s_barrier
ds_read_b64 v[112:113], v29 offset:0
ds_read_b64 v[114:115], v28 offset:0
ds_read_b64 v[116:117], v29 offset:4096
ds_read_b64 v[118:119], v28 offset:4096
s_lshl_b32 s26, s37, 7
s_add_u32 s26, s26, 0x440000
s_waitcnt lgkmcnt(2)
buffer_store_dwordx4 v[112:115], v30, s[4:7], s26 offen sc1
s_lshl_b32 s26, s37, 7
s_add_u32 s26, s26, 0x4e0000
s_waitcnt lgkmcnt(0)
buffer_store_dwordx4 v[116:119], v30, s[4:7], s26 offen sc1
s_lshl_b32 s91, s37, 4
s_add_u32 s91, s91, 0x1f02a00
v_subrev_u32 v120, 98304, v6
v_subrev_u32 v121, 98304, v7
v_add_u32 v122, 0x10000, v120
v_add_u32 v123, 0x10000, v121
s_add_u32 m0, s47, 0
s_add_u32 s29, s46, 1548288
buffer_load_dwordx4 v14, s[8:11], s29 offen lds
s_add_u32 m0, s47, 1024
s_add_u32 s29, s46, 1562112
buffer_load_dwordx4 v15, s[8:11], s29 offen lds
s_add_u32 m0, s47, 8192
s_add_u32 s29, s46, 1548288
buffer_load_dwordx4 v14, s[12:15], s29 offen lds
s_add_u32 m0, s47, 9216
s_add_u32 s29, s46, 1562112
buffer_load_dwordx4 v15, s[12:15], s29 offen lds
ds_read_b64_tr_b16 a[160:161], v6 offset:0
ds_read_b64_tr_b16 a[162:163], v6 offset:4096
ds_read_b64_tr_b16 a[164:165], v7 offset:0
ds_read_b64_tr_b16 a[166:167], v7 offset:4096
ds_read_b64_tr_b16 a[168:169], v6 offset:8192
ds_read_b64_tr_b16 a[170:171], v6 offset:12288
ds_read_b64_tr_b16 a[172:173], v7 offset:8192
ds_read_b64_tr_b16 a[174:175], v7 offset:12288
s_add_u32 m0, s47, 16384
s_add_u32 s29, s46, 1658880
buffer_load_dwordx4 v14, s[8:11], s29 offen lds
s_add_u32 m0, s47, 17408
s_add_u32 s29, s46, 1672704
buffer_load_dwordx4 v15, s[8:11], s29 offen lds
s_add_u32 m0, s47, 24576
s_add_u32 s29, s46, 1658880
buffer_load_dwordx4 v14, s[12:15], s29 offen lds
s_add_u32 m0, s47, 25600
s_add_u32 s29, s46, 1672704
buffer_load_dwordx4 v15, s[12:15], s29 offen lds
ds_read_b64_tr_b16 a[176:177], v6 offset:16384
ds_read_b64_tr_b16 a[178:179], v6 offset:20480
ds_read_b64_tr_b16 a[180:181], v7 offset:16384
ds_read_b64_tr_b16 a[182:183], v7 offset:20480
ds_read_b64_tr_b16 a[184:185], v6 offset:24576
ds_read_b64_tr_b16 a[186:187], v6 offset:28672
ds_read_b64_tr_b16 a[188:189], v7 offset:24576
ds_read_b64_tr_b16 a[190:191], v7 offset:28672
ds_read_b64_tr_b16 a[192:193], v6 offset:32768
ds_read_b64_tr_b16 a[194:195], v6 offset:36864
ds_read_b64_tr_b16 a[196:197], v7 offset:32768
ds_read_b64_tr_b16 a[198:199], v7 offset:36864
ds_read_b64_tr_b16 a[200:201], v6 offset:40960
ds_read_b64_tr_b16 a[202:203], v6 offset:45056
ds_read_b64_tr_b16 a[204:205], v7 offset:40960
ds_read_b64_tr_b16 a[206:207], v7 offset:45056
ds_read_b64_tr_b16 a[208:209], v6 offset:49152
ds_read_b64_tr_b16 a[210:211], v6 offset:53248
ds_read_b64_tr_b16 a[212:213], v7 offset:49152
ds_read_b64_tr_b16 a[214:215], v7 offset:53248
ds_read_b64_tr_b16 a[216:217], v6 offset:57344
ds_read_b64_tr_b16 a[218:219], v6 offset:61440
ds_read_b64_tr_b16 a[220:221], v7 offset:57344
ds_read_b64_tr_b16 a[222:223], v7 offset:61440
s_mul_i32 s26, s22, 37
s_lshr_b32 s37, s26, 8
s_mul_i32 s26, s37, 7
s_sub_u32 s38, s22, s26
s_mul_i32 s26, s24, 7
s_add_u32 s38, s38, s26
s_lshl_b32 s39, s38, 2
s_add_u32 s39, s39, s3
s_cmp_eq_u32 s37, 2
s_cselect_b32 s40, 10, 11
s_lshl_b32 s41, s37, 2
s_add_u32 s41, s41, s23
v_lshlrev_b32 v2, 4, v1
v_and_b32 v20, 15, v1
v_lshrrev_b32 v21, 4, v1
v_mul_u32_u24 v3, 1280, v21
v_lshl_add_u32 v3, v20, 4, v3
s_cmp_lt_u32 s39, 54
s_cselect_b32 s26, 0, 0x40000000
v_add_u32 v4, s26, v2
v_mov_b32 v22, 0x40000000
v_mov_b32 v23, s26
v_cmp_eq_u32 vcc, 0, v1
v_mov_b32 v181, s20
s_nop 0
v_cndmask_b32 v5, v22, v23, vcc
v_add_u32 v185, 98304, v2
s_mul_i32 s31, s3, 5120
s_mov_b32 s36, 0
s_mul_i32 s26, s3, 1280
v_lshlrev_b32 v182, 4, v20
v_add_u32 v182, s26, v182
v_lshl_add_u32 v3, v21, 8, v182
v_add_u32 v182, 1024, v182
v_lshlrev_b32 v184, 3, v20
v_add_u32 v184, 159744, v184
s_lshl_b32 s26, s3, 7
v_lshrrev_b32 v22, 1, v21
v_lshl_add_u32 v183, v22, 2, v184
v_add_u32 v183, s26, v183
v_lshl_add_u32 v184, v21, 7, v184
s_lshl_b32 s27, s36, 7
s_add_u32 s27, s27, s41
s_mul_i32 s42, s27, 5120
s_add_u32 s42, s42, 0x1d00000
s_mul_i32 s43, s27, 20480
s_add_u32 s43, s43, s31
s_add_u32 s43, s43, 0x600000
v_mov_b32 v8, 0x3f803f80
v_mov_b32 v9, 0x3f803f80
v_mov_b32 v10, 0x3f803f80
v_mov_b32 v11, 0x3f803f80
s_nop 1
v_mfma_f32_16x16x32_bf16 v[72:75], a[0:3], v[8:11], 0
v_mfma_f32_16x16x32_bf16 v[76:79], a[4:7], v[8:11], 0
v_mfma_f32_16x16x32_bf16 v[80:83], a[8:11], v[8:11], 0
v_mfma_f32_16x16x32_bf16 v[84:87], a[12:15], v[8:11], 0
v_mfma_f32_16x16x32_bf16 v[72:75], a[16:19], v[8:11], v[72:75]
v_mfma_f32_16x16x32_bf16 v[76:79], a[20:23], v[8:11], v[76:79]
v_mfma_f32_16x16x32_bf16 v[80:83], a[24:27], v[8:11], v[80:83]
v_mfma_f32_16x16x32_bf16 v[84:87], a[28:31], v[8:11], v[84:87]
v_mfma_f32_16x16x32_bf16 v[72:75], a[32:35], v[8:11], v[72:75]
v_mfma_f32_16x16x32_bf16 v[76:79], a[36:39], v[8:11], v[76:79]
v_mfma_f32_16x16x32_bf16 v[80:83], a[40:43], v[8:11], v[80:83]
v_mfma_f32_16x16x32_bf16 v[84:87], a[44:47], v[8:11], v[84:87]
v_mfma_f32_16x16x32_bf16 v[72:75], a[48:51], v[8:11], v[72:75]
v_mfma_f32_16x16x32_bf16 v[76:79], a[52:55], v[8:11], v[76:79]
v_mfma_f32_16x16x32_bf16 v[80:83], a[56:59], v[8:11], v[80:83]
v_mfma_f32_16x16x32_bf16 v[84:87], a[60:63], v[8:11], v[84:87]
v_mfma_f32_16x16x32_bf16 v[72:75], a[64:67], v[8:11], v[72:75]
v_mfma_f32_16x16x32_bf16 v[76:79], a[68:71], v[8:11], v[76:79]
v_mfma_f32_16x16x32_bf16 v[80:83], a[72:75], v[8:11], v[80:83]
v_mfma_f32_16x16x32_bf16 v[84:87], a[76:79], v[8:11], v[84:87]
v_mfma_f32_16x16x32_bf16 v[72:75], a[80:83], v[8:11], v[72:75]
v_mfma_f32_16x16x32_bf16 v[76:79], a[84:87], v[8:11], v[76:79]
v_mfma_f32_16x16x32_bf16 v[80:83], a[88:91], v[8:11], v[80:83]
v_mfma_f32_16x16x32_bf16 v[84:87], a[92:95], v[8:11], v[84:87]
v_mfma_f32_16x16x32_bf16 v[72:75], a[96:99], v[8:11], v[72:75]
v_mfma_f32_16x16x32_bf16 v[76:79], a[100:103], v[8:11], v[76:79]
v_mfma_f32_16x16x32_bf16 v[80:83], a[104:107], v[8:11], v[80:83]
v_mfma_f32_16x16x32_bf16 v[84:87], a[108:111], v[8:11], v[84:87]
v_mfma_f32_16x16x32_bf16 v[72:75], a[112:115], v[8:11], v[72:75]
v_mfma_f32_16x16x32_bf16 v[76:79], a[116:119], v[8:11], v[76:79]
v_mfma_f32_16x16x32_bf16 v[80:83], a[120:123], v[8:11], v[80:83]
v_mfma_f32_16x16x32_bf16 v[84:87], a[124:127], v[8:11], v[84:87]
v_mfma_f32_16x16x32_bf16 v[72:75], a[128:131], v[8:11], v[72:75]
v_mfma_f32_16x16x32_bf16 v[76:79], a[132:135], v[8:11], v[76:79]
v_mfma_f32_16x16x32_bf16 v[80:83], a[136:139], v[8:11], v[80:83]
v_mfma_f32_16x16x32_bf16 v[84:87], a[140:143], v[8:11], v[84:87]
v_mfma_f32_16x16x32_bf16 v[72:75], a[144:147], v[8:11], v[72:75]
v_mfma_f32_16x16x32_bf16 v[76:79], a[148:151], v[8:11], v[76:79]
v_mfma_f32_16x16x32_bf16 v[80:83], a[152:155], v[8:11], v[80:83]
v_mfma_f32_16x16x32_bf16 v[84:87], a[156:159], v[8:11], v[84:87]
s_waitcnt vmcnt(8) lgkmcnt(0)
s_barrier
buffer_store_dword v181, v31, s[4:7], s91 offen sc1
s_add_u32 m0, s47, 32768
s_add_u32 s29, s46, 1769472
buffer_load_dwordx4 v14, s[8:11], s29 offen lds
s_add_u32 m0, s47, 33792
s_add_u32 s29, s46, 1783296
buffer_load_dwordx4 v15, s[8:11], s29 offen lds
s_add_u32 m0, s47, 40960
s_add_u32 s29, s46, 1769472
buffer_load_dwordx4 v14, s[12:15], s29 offen lds
s_add_u32 m0, s47, 41984
s_add_u32 s29, s46, 1783296
buffer_load_dwordx4 v15, s[12:15], s29 offen lds
s_add_u32 m0, s47, 49152
s_add_u32 s29, s46, 1880064
buffer_load_dwordx4 v14, s[8:11], s29 offen lds
s_add_u32 m0, s47, 50176
s_add_u32 s29, s46, 1893888
buffer_load_dwordx4 v15, s[8:11], s29 offen lds
s_add_u32 m0, s47, 57344
s_add_u32 s29, s46, 1880064
buffer_load_dwordx4 v14, s[12:15], s29 offen lds
s_add_u32 m0, s47, 58368
s_add_u32 s29, s46, 1893888
buffer_load_dwordx4 v15, s[12:15], s29 offen lds
s_add_u32 m0, s47, 65536
s_add_u32 s29, s46, 1990656
buffer_load_dwordx4 v14, s[8:11], s29 offen lds
s_add_u32 m0, s47, 66560
s_add_u32 s29, s46, 2004480
buffer_load_dwordx4 v15, s[8:11], s29 offen lds
s_add_u32 m0, s47, 73728
s_add_u32 s29, s46, 1990656
buffer_load_dwordx4 v14, s[12:15], s29 offen lds
s_add_u32 m0, s47, 74752
s_add_u32 s29, s46, 2004480
buffer_load_dwordx4 v15, s[12:15], s29 offen lds
s_add_u32 m0, s47, 81920
s_add_u32 s29, s46, 2101248
buffer_load_dwordx4 v14, s[8:11], s29 offen lds
s_add_u32 m0, s47, 82944
s_add_u32 s29, s46, 2115072
buffer_load_dwordx4 v15, s[8:11], s29 offen lds
s_add_u32 m0, s47, 90112
s_add_u32 s29, s46, 2101248
buffer_load_dwordx4 v14, s[12:15], s29 offen lds
s_add_u32 m0, s47, 91136
s_add_u32 s29, s46, 2115072
buffer_load_dwordx4 v15, s[12:15], s29 offen lds
buffer_load_dwordx3 v[100:102], v3, s[4:7], s42 offen sc1
buffer_load_dwordx3 v[104:106], v182, s[4:7], s42 offen sc1
s_add_u32 s92, s42, 61440
buffer_load_dwordx3 v[128:130], v3, s[4:7], s92 offen sc1
buffer_load_dwordx3 v[132:134], v182, s[4:7], s92 offen sc1
s_waitcnt lgkmcnt(15)
v_mfma_f32_16x16x32_bf16 v[72:75], a[160:163], v[8:11], v[72:75]
v_mfma_f32_16x16x32_bf16 v[76:79], a[164:167], v[8:11], v[76:79]
v_mfma_f32_16x16x32_bf16 v[80:83], a[168:171], v[8:11], v[80:83]
v_mfma_f32_16x16x32_bf16 v[84:87], a[172:175], v[8:11], v[84:87]
v_mfma_f32_16x16x32_bf16 v[72:75], a[176:179], v[8:11], v[72:75]
v_mfma_f32_16x16x32_bf16 v[76:79], a[180:183], v[8:11], v[76:79]
v_mfma_f32_16x16x32_bf16 v[80:83], a[184:187], v[8:11], v[80:83]
v_mfma_f32_16x16x32_bf16 v[84:87], a[188:191], v[8:11], v[84:87]
s_waitcnt lgkmcnt(14)
v_mfma_f32_16x16x32_bf16 v[72:75], a[192:195], v[8:11], v[72:75]
s_waitcnt lgkmcnt(12)
v_mfma_f32_16x16x32_bf16 v[76:79], a[196:199], v[8:11], v[76:79]
s_waitcnt lgkmcnt(10)
v_mfma_f32_16x16x32_bf16 v[80:83], a[200:203], v[8:11], v[80:83]
s_waitcnt lgkmcnt(8)
v_mfma_f32_16x16x32_bf16 v[84:87], a[204:207], v[8:11], v[84:87]
s_waitcnt lgkmcnt(6)
v_mfma_f32_16x16x32_bf16 v[72:75], a[208:211], v[8:11], v[72:75]
s_waitcnt lgkmcnt(4)
v_mfma_f32_16x16x32_bf16 v[76:79], a[212:215], v[8:11], v[76:79]
s_waitcnt lgkmcnt(2)
v_mfma_f32_16x16x32_bf16 v[80:83], a[216:219], v[8:11], v[80:83]
s_waitcnt lgkmcnt(0)
v_mfma_f32_16x16x32_bf16 v[84:87], a[220:223], v[8:11], v[84:87]
s_mov_b32 s8, s88
s_mov_b32 s9, s89
s_mov_b32 s10, 0x10000000
s_mov_b32 s11, 0x20000
s_lshl_b32 s26, s36, 7
s_add_u32 s26, s26, s41
s_mul_i32 s46, s26, 55296
s_lshl_b32 s27, s39, 10
s_add_u32 s46, s46, s27
s_add_u32 s46, s46, 0xc00000
s_lshl_b32 s47, s26, 10
s_lshl_b32 s27, s39, 4
s_add_u32 s47, s47, s27
s_add_u32 s47, s47, 0x1f10000
s_mov_b32 s45, 0x40000000
s_mov_b32 s32, 0x40000000
s_mov_b32 s33, 0x40000000
s_sub_u32 s44, s40, 2
s_mov_b32 s34, s40
s_waitcnt vmcnt(3)
v_cmp_ne_u32 vcc, s20, v102
s_waitcnt vmcnt(2)
v_cmp_ne_u32 s[28:29], s20, v106
s_or_b64 vcc, vcc, s[28:29]
s_mov_b64 s[92:93], vcc
s_waitcnt vmcnt(1)
v_cmp_ne_u32 vcc, s20, v130
s_waitcnt vmcnt(0)
v_cmp_ne_u32 s[28:29], s20, v134
s_or_b64 vcc, vcc, s[28:29]
s_or_b64 vcc, vcc, s[92:93]
s_cmp_eq_u64 vcc, 0
s_cbranch_scc1 Lhok_5
s_mov_b32 s90, 40000
Lpg_6:
buffer_load_dwordx3 v[100:102], v3, s[4:7], s42 offen sc1
buffer_load_dwordx3 v[104:106], v182, s[4:7], s42 offen sc1
s_waitcnt vmcnt(0)
v_cmp_ne_u32 vcc, s20, v102
v_cmp_ne_u32 s[28:29], s20, v106
s_nop 0
s_or_b64 vcc, vcc, s[28:29]
s_cmp_eq_u64 vcc, 0
s_cbranch_scc1 Lpgok_7
s_sub_u32 s90, s90, 1
s_cmp_lg_u32 s90, 0
s_cbranch_scc1 Lpg_6
s_mov_b32 s8, s86
s_mov_b32 s9, s87
s_mov_b32 s10, 0x100
s_mov_b32 s11, 0x20000
v_mov_b32 v2, 0x4
v_mov_b32 v3, 0x10
s_nop 1
buffer_store_dword v2, v3, s[8:11], 0 offen
s_waitcnt vmcnt(0)
s_endpgm
Lpgok_7:
s_waitcnt vmcnt(0)
s_add_u32 s92, s42, 61440
s_mov_b32 s90, 40000
Lpg_8:
buffer_load_dwordx3 v[128:130], v3, s[4:7], s92 offen sc1
buffer_load_dwordx3 v[132:134], v182, s[4:7], s92 offen sc1
s_waitcnt vmcnt(0)
v_cmp_ne_u32 vcc, s20, v130
v_cmp_ne_u32 s[28:29], s20, v134
s_nop 0
s_or_b64 vcc, vcc, s[28:29]
s_cmp_eq_u64 vcc, 0
s_cbranch_scc1 Lpgok_9
s_sub_u32 s90, s90, 1
s_cmp_lg_u32 s90, 0
s_cbranch_scc1 Lpg_8
s_mov_b32 s8, s86
s_mov_b32 s9, s87
s_mov_b32 s10, 0x100
s_mov_b32 s11, 0x20000
v_mov_b32 v2, 0x4
v_mov_b32 v3, 0x10
s_nop 1
buffer_store_dword v2, v3, s[8:11], 0 offen
s_waitcnt vmcnt(0)
s_endpgm
Lpgok_9:
s_waitcnt vmcnt(0)
Lhok_5:
s_nop 1
v_fmac_f32 v100, 0x3e800000, v104
v_fmac_f32 v101, 0x3e800000, v105
s_nop 1
v_permlane32_swap_b32 v100, v101
v_add_f32 v100, v100, v101
v_mov_b32 v6, v100
s_nop 1
v_permlane16_swap_b32 v100, v6
v_add_f32 v100, v100, v6
ds_write_b32 v183, v100 offset:0
v_fmac_f32 v128, 0x3e800000, v132
v_fmac_f32 v129, 0x3e800000, v133
s_nop 1
v_permlane32_swap_b32 v128, v129
v_add_f32 v128, v128, v129
v_mov_b32 v6, v128
s_nop 1
v_permlane16_swap_b32 v128, v6
v_add_f32 v128, v128, v6
ds_write_b32 v183, v128 offset:512
s_add_u32 m0, s31, 98304
s_add_u32 s35, s43, 4096
buffer_load_dwordx4 v2, s[4:7], s43 offen offset:0 sc1 lds
buffer_load_dwordx4 v2, s[4:7], s43 offen offset:1024 sc1 lds
buffer_load_dwordx4 v2, s[4:7], s43 offen offset:2048 sc1 lds
buffer_load_dwordx4 v2, s[4:7], s43 offen offset:3072 sc1 lds
s_add_u32 m0, s31, 102400
s_nop 0
buffer_load_dwordx4 v2, s[4:7], s35 offen sc1 lds
s_add_u32 s43, s43, 245760
s_add_u32 m0, s31, 118784
s_add_u32 s35, s43, 4096
buffer_load_dwordx4 v2, s[4:7], s43 offen offset:0 sc1 lds
buffer_load_dwordx4 v2, s[4:7], s43 offen offset:1024 sc1 lds
buffer_load_dwordx4 v2, s[4:7], s43 offen offset:2048 sc1 lds
buffer_load_dwordx4 v2, s[4:7], s43 offen offset:3072 sc1 lds
s_add_u32 m0, s31, 122880
s_nop 0
buffer_load_dwordx4 v2, s[4:7], s35 offen sc1 lds
s_add_u32 s43, s43, 245760
s_add_u32 s42, s42, 122880
s_waitcnt vmcnt(14)
s_barrier
ds_read_b64_tr_b16 a[224:225], v120 offset:0
ds_read_b64_tr_b16 a[226:227], v120 offset:4096
ds_read_b64_tr_b16 a[228:229], v121 offset:0
ds_read_b64_tr_b16 a[230:231], v121 offset:4096
ds_read_b64_tr_b16 a[232:233], v120 offset:8192
ds_read_b64_tr_b16 a[234:235], v120 offset:12288
ds_read_b64_tr_b16 a[236:237], v121 offset:8192
ds_read_b64_tr_b16 a[238:239], v121 offset:12288
ds_read_b64_tr_b16 a[240:241], v120 offset:16384
ds_read_b64_tr_b16 a[242:243], v120 offset:20480
ds_read_b64_tr_b16 a[244:245], v121 offset:16384
ds_read_b64_tr_b16 a[246:247], v121 offset:20480
ds_read_b64_tr_b16 a[248:249], v120 offset:24576
ds_read_b64_tr_b16 a[250:251], v120 offset:28672
ds_read_b64_tr_b16 a[252:253], v121 offset:24576
ds_read_b64_tr_b16 a[254:255], v121 offset:28672
ds_read_b64_tr_b16 v[192:193], v120 offset:32768
ds_read_b64_tr_b16 v[194:195], v120 offset:36864
ds_read_b64_tr_b16 v[196:197], v121 offset:32768
ds_read_b64_tr_b16 v[198:199], v121 offset:36864
ds_read_b64_tr_b16 v[200:201], v120 offset:40960
ds_read_b64_tr_b16 v[202:203], v120 offset:45056
ds_read_b64_tr_b16 v[204:205], v121 offset:40960
ds_read_b64_tr_b16 v[206:207], v121 offset:45056
ds_read_b64_tr_b16 v[208:209], v120 offset:49152
ds_read_b64_tr_b16 v[210:211], v120 offset:53248
ds_read_b64_tr_b16 v[212:213], v121 offset:49152
ds_read_b64_tr_b16 v[214:215], v121 offset:53248
ds_read_b64_tr_b16 v[216:217], v120 offset:57344
ds_read_b64_tr_b16 v[218:219], v120 offset:61440
ds_read_b64_tr_b16 v[220:221], v121 offset:57344
ds_read_b64_tr_b16 v[222:223], v121 offset:61440
ds_read_b64_tr_b16 v[224:225], v122 offset:0
ds_read_b64_tr_b16 v[226:227], v122 offset:4096
ds_read_b64_tr_b16 v[228:229], v123 offset:0
ds_read_b64_tr_b16 v[230:231], v123 offset:4096
ds_read_b64_tr_b16 v[232:233], v122 offset:8192
ds_read_b64_tr_b16 v[234:235], v122 offset:12288
ds_read_b64_tr_b16 v[236:237], v123 offset:8192
ds_read_b64_tr_b16 v[238:239], v123 offset:12288
ds_read_b64_tr_b16 v[240:241], v122 offset:16384
ds_read_b64_tr_b16 v[242:243], v122 offset:20480
ds_read_b64_tr_b16 v[244:245], v123 offset:16384
ds_read_b64_tr_b16 v[246:247], v123 offset:20480
ds_read_b64_tr_b16 v[248:249], v122 offset:24576
ds_read_b64_tr_b16 v[250:251], v122 offset:28672
ds_read_b64_tr_b16 v[252:253], v123 offset:24576
ds_read_b64_tr_b16 v[254:255], v123 offset:28672
s_waitcnt lgkmcnt(15)
v_mfma_f32_16x16x32_bf16 v[72:75], a[224:227], v[8:11], v[72:75]
v_mfma_f32_16x16x32_bf16 v[76:79], a[228:231], v[8:11], v[76:79]
v_mfma_f32_16x16x32_bf16 v[80:83], a[232:235], v[8:11], v[80:83]
v_mfma_f32_16x16x32_bf16 v[84:87], a[236:239], v[8:11], v[84:87]
v_mfma_f32_16x16x32_bf16 v[72:75], a[240:243], v[8:11], v[72:75]
v_mfma_f32_16x16x32_bf16 v[76:79], a[244:247], v[8:11], v[76:79]
v_mfma_f32_16x16x32_bf16 v[80:83], a[248:251], v[8:11], v[80:83]
v_mfma_f32_16x16x32_bf16 v[84:87], a[252:255], v[8:11], v[84:87]
v_mfma_f32_16x16x32_bf16 v[72:75], v[192:195], v[8:11], v[72:75]
v_mfma_f32_16x16x32_bf16 v[76:79], v[196:199], v[8:11], v[76:79]
v_mfma_f32_16x16x32_bf16 v[80:83], v[200:203], v[8:11], v[80:83]
v_mfma_f32_16x16x32_bf16 v[84:87], v[204:207], v[8:11], v[84:87]
v_mfma_f32_16x16x32_bf16 v[72:75], v[208:211], v[8:11], v[72:75]
v_mfma_f32_16x16x32_bf16 v[76:79], v[212:215], v[8:11], v[76:79]
v_mfma_f32_16x16x32_bf16 v[80:83], v[216:219], v[8:11], v[80:83]
v_mfma_f32_16x16x32_bf16 v[84:87], v[220:223], v[8:11], v[84:87]
s_waitcnt lgkmcnt(14)
v_mfma_f32_16x16x32_bf16 v[72:75], v[224:227], v[8:11], v[72:75]
s_waitcnt lgkmcnt(12)
v_mfma_f32_16x16x32_bf16 v[76:79], v[228:231], v[8:11], v[76:79]
s_waitcnt lgkmcnt(10)
v_mfma_f32_16x16x32_bf16 v[80:83], v[232:235], v[8:11], v[80:83]
s_waitcnt lgkmcnt(8)
v_mfma_f32_16x16x32_bf16 v[84:87], v[236:239], v[8:11], v[84:87]
s_waitcnt lgkmcnt(6)
v_mfma_f32_16x16x32_bf16 v[72:75], v[240:243], v[8:11], v[72:75]
s_waitcnt lgkmcnt(4)
v_mfma_f32_16x16x32_bf16 v[76:79], v[244:247], v[8:11], v[76:79]
s_waitcnt lgkmcnt(2)
v_mfma_f32_16x16x32_bf16 v[80:83], v[248:251], v[8:11], v[80:83]
s_waitcnt lgkmcnt(0)
v_mfma_f32_16x16x32_bf16 v[84:87], v[252:255], v[8:11], v[84:87]
s_waitcnt vmcnt(0) lgkmcnt(0)
s_barrier
s_nop 7
s_branch Lg1_enter
Lg1_noconv:
s_waitcnt lgkmcnt(0)
s_mov_b32 s4, s88
s_mov_b32 s5, s89
s_mov_b32 s6, 0x10000000
s_mov_b32 s7, 0x20000
s_mov_b32 s26, 0x1f80000
v_mov_b32 v63, 0
buffer_load_dword v62, v63, s[4:7], s26 offen sc1
s_mul_i32 s26, s22, 37
s_lshr_b32 s37, s26, 8
s_mul_i32 s26, s37, 7
s_sub_u32 s38, s22, s26
s_mul_i32 s26, s24, 7
s_add_u32 s38, s38, s26
s_lshl_b32 s39, s38, 2
s_add_u32 s39, s39, s3
s_cmp_eq_u32 s37, 2
s_cselect_b32 s40, 10, 11
s_lshl_b32 s41, s37, 2
s_add_u32 s41, s41, s23
s_mov_b32 s8, s78
s_mov_b32 s9, s79
s_mov_b32 s10, 0x21c000
s_mov_b32 s11, 0x20000
s_mov_b32 s12, s80
s_mov_b32 s13, s81
s_mov_b32 s14, 0x21c000
s_mov_b32 s15, 0x20000
s_lshl_b32 s26, s38, 8
v_lshrrev_b32 v20, 4, v1
v_bfe_u32 v21, v1, 1, 3
v_xor_b32 v21, v20, v21
v_lshlrev_b32 v21, 5, v21
v_mul_u32_u24 v20, 3456, v20
v_add_u32 v20, s26, v20
v_and_b32 v24, 1, v1
v_lshl_add_u32 v20, v24, 4, v20
v_add_u32 v24, v21, v20
v_xor_b32 v21, 128, v21
v_add_u32 v25, v21, v20
s_lshl_b32 s27, s3, 1
s_add_u32 s27, s27, 0
v_lshrrev_b32 v20, 4, v1
v_bfe_u32 v21, v1, 2, 2
v_lshlrev_b32 v26, 8, v21
v_lshl_add_u32 v26, v20, 10, v26
v_and_b32 v20, 1, v20
v_lshl_add_u32 v21, v20, 2, v21
v_xor_b32 v21, s27, v21
v_lshl_add_u32 v26, v21, 5, v26
v_and_b32 v20, 3, v1
v_lshl_add_u32 v26, v20, 3, v26
v_add_u32 v28, 0x10000, v26
s_lshl_b32 s27, s3, 1
s_add_u32 s27, s27, 1
v_lshrrev_b32 v20, 4, v1
v_bfe_u32 v21, v1, 2, 2
v_lshlrev_b32 v27, 8, v21
v_lshl_add_u32 v27, v20, 10, v27
v_and_b32 v20, 1, v20
v_lshl_add_u32 v21, v20, 2, v21
v_xor_b32 v21, s27, v21
v_lshl_add_u32 v27, v21, 5, v27
v_and_b32 v20, 3, v1
v_lshl_add_u32 v27, v20, 3, v27
v_add_u32 v29, 0x10000, v27
s_mul_i32 s30, s3, 27648
s_lshl_b32 s31, s3, 11
s_add_u32 m0, s31, 0
s_add_u32 s35, s30, 0
buffer_load_dwordx4 v24, s[8:11], s35 offen lds
s_add_u32 m0, s31, 1024
s_add_u32 s35, s30, 13824
buffer_load_dwordx4 v25, s[8:11], s35 offen lds
s_add_u32 m0, s31, 8192
s_add_u32 s35, s30, 0
buffer_load_dwordx4 v24, s[12:15], s35 offen lds
s_add_u32 m0, s31, 9216
s_add_u32 s35, s30, 13824
buffer_load_dwordx4 v25, s[12:15], s35 offen lds
s_add_u32 m0, s31, 16384
s_add_u32 s35, s30, 110592
buffer_load_dwordx4 v24, s[8:11], s35 offen lds
s_add_u32 m0, s31, 17408
s_add_u32 s35, s30, 124416
buffer_load_dwordx4 v25, s[8:11], s35 offen lds
s_add_u32 m0, s31, 24576
s_add_u32 s35, s30, 110592
buffer_load_dwordx4 v24, s[12:15], s35 offen lds
s_add_u32 m0, s31, 25600
s_add_u32 s35, s30, 124416
buffer_load_dwordx4 v25, s[12:15], s35 offen lds
s_add_u32 m0, s31, 32768
s_add_u32 s35, s30, 221184
buffer_load_dwordx4 v24, s[8:11], s35 offen lds
s_add_u32 m0, s31, 33792
s_add_u32 s35, s30, 235008
buffer_load_dwordx4 v25, s[8:11], s35 offen lds
s_add_u32 m0, s31, 40960
s_add_u32 s35, s30, 221184
buffer_load_dwordx4 v24, s[12:15], s35 offen lds
s_add_u32 m0, s31, 41984
s_add_u32 s35, s30, 235008
buffer_load_dwordx4 v25, s[12:15], s35 offen lds
s_add_u32 m0, s31, 49152
s_add_u32 s35, s30, 331776
buffer_load_dwordx4 v24, s[8:11], s35 offen lds
s_add_u32 m0, s31, 50176
s_add_u32 s35, s30, 345600
buffer_load_dwordx4 v25, s[8:11], s35 offen lds
s_add_u32 m0, s31, 57344
s_add_u32 s35, s30, 331776
buffer_load_dwordx4 v24, s[12:15], s35 offen lds
s_add_u32 m0, s31, 58368
s_add_u32 s35, s30, 345600
buffer_load_dwordx4 v25, s[12:15], s35 offen lds
s_add_u32 m0, s31, 65536
s_add_u32 s35, s30, 442368
buffer_load_dwordx4 v24, s[8:11], s35 offen lds
s_add_u32 m0, s31, 66560
s_add_u32 s35, s30, 456192
buffer_load_dwordx4 v25, s[8:11], s35 offen lds
s_add_u32 m0, s31, 73728
s_add_u32 s35, s30, 442368
buffer_load_dwordx4 v24, s[12:15], s35 offen lds
s_add_u32 m0, s31, 74752
s_add_u32 s35, s30, 456192
buffer_load_dwordx4 v25, s[12:15], s35 offen lds
s_add_u32 m0, s31, 81920
s_add_u32 s35, s30, 552960
buffer_load_dwordx4 v24, s[8:11], s35 offen lds
s_add_u32 m0, s31, 82944
s_add_u32 s35, s30, 566784
buffer_load_dwordx4 v25, s[8:11], s35 offen lds
s_add_u32 m0, s31, 90112
s_add_u32 s35, s30, 552960
buffer_load_dwordx4 v24, s[12:15], s35 offen lds
s_add_u32 m0, s31, 91136
s_add_u32 s35, s30, 566784
buffer_load_dwordx4 v25, s[12:15], s35 offen lds
s_add_u32 m0, s31, 98304
s_add_u32 s35, s30, 663552
buffer_load_dwordx4 v24, s[8:11], s35 offen lds
s_add_u32 m0, s31, 99328
s_add_u32 s35, s30, 677376
buffer_load_dwordx4 v25, s[8:11], s35 offen lds
s_add_u32 m0, s31, 106496
s_add_u32 s35, s30, 663552
buffer_load_dwordx4 v24, s[12:15], s35 offen lds
s_add_u32 m0, s31, 107520
s_add_u32 s35, s30, 677376
buffer_load_dwordx4 v25, s[12:15], s35 offen lds
s_waitcnt vmcnt(24) lgkmcnt(0)
s_barrier
s_add_u32 m0, s31, 114688
s_add_u32 s35, s30, 774144
buffer_load_dwordx4 v24, s[8:11], s35 offen lds
s_add_u32 m0, s31, 115712
s_add_u32 s35, s30, 787968
buffer_load_dwordx4 v25, s[8:11], s35 offen lds
s_add_u32 m0, s31, 122880
s_add_u32 s35, s30, 774144
buffer_load_dwordx4 v24, s[12:15], s35 offen lds
s_add_u32 m0, s31, 123904
s_add_u32 s35, s30, 787968
buffer_load_dwordx4 v25, s[12:15], s35 offen lds
ds_read_b64_tr_b16 a[0:1], v26 offset:0
ds_read_b64_tr_b16 a[2:3], v26 offset:4096
ds_read_b64_tr_b16 a[4:5], v27 offset:0
ds_read_b64_tr_b16 a[6:7], v27 offset:4096
ds_read_b64_tr_b16 a[8:9], v26 offset:8192
ds_read_b64_tr_b16 a[10:11], v26 offset:12288
ds_read_b64_tr_b16 a[12:13], v27 offset:8192
ds_read_b64_tr_b16 a[14:15], v27 offset:12288
s_waitcnt vmcnt(24) lgkmcnt(0)
s_barrier
s_add_u32 m0, s31, 0
s_add_u32 s35, s30, 884736
buffer_load_dwordx4 v24, s[8:11], s35 offen lds
s_add_u32 m0, s31, 1024
s_add_u32 s35, s30, 898560
buffer_load_dwordx4 v25, s[8:11], s35 offen lds
s_add_u32 m0, s31, 8192
s_add_u32 s35, s30, 884736
buffer_load_dwordx4 v24, s[12:15], s35 offen lds
s_add_u32 m0, s31, 9216
s_add_u32 s35, s30, 898560
buffer_load_dwordx4 v25, s[12:15], s35 offen lds
ds_read_b64_tr_b16 a[16:17], v26 offset:16384
ds_read_b64_tr_b16 a[18:19], v26 offset:20480
ds_read_b64_tr_b16 a[20:21], v27 offset:16384
ds_read_b64_tr_b16 a[22:23], v27 offset:20480
ds_read_b64_tr_b16 a[24:25], v26 offset:24576
ds_read_b64_tr_b16 a[26:27], v26 offset:28672
ds_read_b64_tr_b16 a[28:29], v27 offset:24576
ds_read_b64_tr_b16 a[30:31], v27 offset:28672
s_waitcnt vmcnt(24) lgkmcnt(0)
s_barrier
s_add_u32 m0, s31, 16384
s_add_u32 s35, s30, 995328
buffer_load_dwordx4 v24, s[8:11], s35 offen lds
s_add_u32 m0, s31, 17408
s_add_u32 s35, s30, 1009152
buffer_load_dwordx4 v25, s[8:11], s35 offen lds
s_add_u32 m0, s31, 24576
s_add_u32 s35, s30, 995328
buffer_load_dwordx4 v24, s[12:15], s35 offen lds
s_add_u32 m0, s31, 25600
s_add_u32 s35, s30, 1009152
buffer_load_dwordx4 v25, s[12:15], s35 offen lds
ds_read_b64_tr_b16 a[32:33], v26 offset:32768
ds_read_b64_tr_b16 a[34:35], v26 offset:36864
ds_read_b64_tr_b16 a[36:37], v27 offset:32768
ds_read_b64_tr_b16 a[38:39], v27 offset:36864
ds_read_b64_tr_b16 a[40:41], v26 offset:40960
ds_read_b64_tr_b16 a[42:43], v26 offset:45056
ds_read_b64_tr_b16 a[44:45], v27 offset:40960
ds_read_b64_tr_b16 a[46:47], v27 offset:45056
s_waitcnt vmcnt(24) lgkmcnt(0)
s_barrier
s_add_u32 m0, s31, 32768
s_add_u32 s35, s30, 1105920
buffer_load_dwordx4 v24, s[8:11], s35 offen lds
s_add_u32 m0, s31, 33792
s_add_u32 s35, s30, 1119744
buffer_load_dwordx4 v25, s[8:11], s35 offen lds
s_add_u32 m0, s31, 40960
s_add_u32 s35, s30, 1105920
buffer_load_dwordx4 v24, s[12:15], s35 offen lds
s_add_u32 m0, s31, 41984
s_add_u32 s35, s30, 1119744
buffer_load_dwordx4 v25, s[12:15], s35 offen lds
ds_read_b64_tr_b16 a[48:49], v26 offset:49152
ds_read_b64_tr_b16 a[50:51], v26 offset:53248
ds_read_b64_tr_b16 a[52:53], v27 offset:49152
ds_read_b64_tr_b16 a[54:55], v27 offset:53248
ds_read_b64_tr_b16 a[56:57], v26 offset:57344
ds_read_b64_tr_b16 a[58:59], v26 offset:61440
ds_read_b64_tr_b16 a[60:61], v27 offset:57344
ds_read_b64_tr_b16 a[62:63], v27 offset:61440
s_waitcnt vmcnt(24) lgkmcnt(0)
s_barrier
s_add_u32 m0, s31, 49152
s_add_u32 s35, s30, 1216512
buffer_load_dwordx4 v24, s[8:11], s35 offen lds
s_add_u32 m0, s31, 50176
s_add_u32 s35, s30, 1230336
buffer_load_dwordx4 v25, s[8:11], s35 offen lds
s_add_u32 m0, s31, 57344
s_add_u32 s35, s30, 1216512
buffer_load_dwordx4 v24, s[12:15], s35 offen lds
s_add_u32 m0, s31, 58368
s_add_u32 s35, s30, 1230336
buffer_load_dwordx4 v25, s[12:15], s35 offen lds
ds_read_b64_tr_b16 a[64:65], v28 offset:0
ds_read_b64_tr_b16 a[66:67], v28 offset:4096
ds_read_b64_tr_b16 a[68:69], v29 offset:0
ds_read_b64_tr_b16 a[70:71], v29 offset:4096
ds_read_b64_tr_b16 a[72:73], v28 offset:8192
ds_read_b64_tr_b16 a[74:75], v28 offset:12288
ds_read_b64_tr_b16 a[76:77], v29 offset:8192
ds_read_b64_tr_b16 a[78:79], v29 offset:12288
s_waitcnt vmcnt(24) lgkmcnt(0)
s_barrier
s_add_u32 m0, s31, 65536
s_add_u32 s35, s30, 1327104
buffer_load_dwordx4 v24, s[8:11], s35 offen lds
s_add_u32 m0, s31, 66560
s_add_u32 s35, s30, 1340928
buffer_load_dwordx4 v25, s[8:11], s35 offen lds
s_add_u32 m0, s31, 73728
s_add_u32 s35, s30, 1327104
buffer_load_dwordx4 v24, s[12:15], s35 offen lds
s_add_u32 m0, s31, 74752
s_add_u32 s35, s30, 1340928
buffer_load_dwordx4 v25, s[12:15], s35 offen lds
ds_read_b64_tr_b16 a[80:81], v28 offset:16384
ds_read_b64_tr_b16 a[82:83], v28 offset:20480
ds_read_b64_tr_b16 a[84:85], v29 offset:16384
ds_read_b64_tr_b16 a[86:87], v29 offset:20480
ds_read_b64_tr_b16 a[88:89], v28 offset:24576
ds_read_b64_tr_b16 a[90:91], v28 offset:28672
ds_read_b64_tr_b16 a[92:93], v29 offset:24576
ds_read_b64_tr_b16 a[94:95], v29 offset:28672
s_waitcnt vmcnt(24) lgkmcnt(0)
s_barrier
s_add_u32 m0, s31, 81920
s_add_u32 s35, s30, 1437696
buffer_load_dwordx4 v24, s[8:11], s35 offen lds
s_add_u32 m0, s31, 82944
s_add_u32 s35, s30, 1451520
buffer_load_dwordx4 v25, s[8:11], s35 offen lds
s_add_u32 m0, s31, 90112
s_add_u32 s35, s30, 1437696
buffer_load_dwordx4 v24, s[12:15], s35 offen lds
s_add_u32 m0, s31, 91136
s_add_u32 s35, s30, 1451520
buffer_load_dwordx4 v25, s[12:15], s35 offen lds
ds_read_b64_tr_b16 a[96:97], v28 offset:32768
ds_read_b64_tr_b16 a[98:99], v28 offset:36864
ds_read_b64_tr_b16 a[100:101], v29 offset:32768
ds_read_b64_tr_b16 a[102:103], v29 offset:36864
ds_read_b64_tr_b16 a[104:105], v28 offset:40960
ds_read_b64_tr_b16 a[106:107], v28 offset:45056
ds_read_b64_tr_b16 a[108:109], v29 offset:40960
ds_read_b64_tr_b16 a[110:111], v29 offset:45056
s_waitcnt vmcnt(24) lgkmcnt(0)
s_barrier
s_add_u32 m0, s31, 98304
s_add_u32 s35, s30, 1548288
buffer_load_dwordx4 v24, s[8:11], s35 offen lds
s_add_u32 m0, s31, 99328
s_add_u32 s35, s30, 1562112
buffer_load_dwordx4 v25, s[8:11], s35 offen lds
s_add_u32 m0, s31, 106496
s_add_u32 s35, s30, 1548288
buffer_load_dwordx4 v24, s[12:15], s35 offen lds
s_add_u32 m0, s31, 107520
s_add_u32 s35, s30, 1562112
buffer_load_dwordx4 v25, s[12:15], s35 offen lds
ds_read_b64_tr_b16 a[112:113], v28 offset:49152
ds_read_b64_tr_b16 a[114:115], v28 offset:53248
ds_read_b64_tr_b16 a[116:117], v29 offset:49152
ds_read_b64_tr_b16 a[118:119], v29 offset:53248
ds_read_b64_tr_b16 a[120:121], v28 offset:57344
ds_read_b64_tr_b16 a[122:123], v28 offset:61440
ds_read_b64_tr_b16 a[124:125], v29 offset:57344
ds_read_b64_tr_b16 a[126:127], v29 offset:61440
s_waitcnt vmcnt(24) lgkmcnt(0)
s_barrier
s_add_u32 m0, s31, 114688
s_add_u32 s35, s30, 1658880
buffer_load_dwordx4 v24, s[8:11], s35 offen lds
s_add_u32 m0, s31, 115712
s_add_u32 s35, s30, 1672704
buffer_load_dwordx4 v25, s[8:11], s35 offen lds
s_add_u32 m0, s31, 122880
s_add_u32 s35, s30, 1658880
buffer_load_dwordx4 v24, s[12:15], s35 offen lds
s_add_u32 m0, s31, 123904
s_add_u32 s35, s30, 1672704
buffer_load_dwordx4 v25, s[12:15], s35 offen lds
ds_read_b64_tr_b16 a[128:129], v26 offset:0
ds_read_b64_tr_b16 a[130:131], v26 offset:4096
ds_read_b64_tr_b16 a[132:133], v27 offset:0
ds_read_b64_tr_b16 a[134:135], v27 offset:4096
ds_read_b64_tr_b16 a[136:137], v26 offset:8192
ds_read_b64_tr_b16 a[138:139], v26 offset:12288
ds_read_b64_tr_b16 a[140:141], v27 offset:8192
ds_read_b64_tr_b16 a[142:143], v27 offset:12288
s_waitcnt vmcnt(24) lgkmcnt(0)
s_barrier
s_add_u32 m0, s31, 0
s_add_u32 s35, s30, 1769472
buffer_load_dwordx4 v24, s[8:11], s35 offen lds
s_add_u32 m0, s31, 1024
s_add_u32 s35, s30, 1783296
buffer_load_dwordx4 v25, s[8:11], s35 offen lds
s_add_u32 m0, s31, 8192
s_add_u32 s35, s30, 1769472
buffer_load_dwordx4 v24, s[12:15], s35 offen lds
s_add_u32 m0, s31, 9216
s_add_u32 s35, s30, 1783296
buffer_load_dwordx4 v25, s[12:15], s35 offen lds
ds_read_b64_tr_b16 a[144:145], v26 offset:16384
ds_read_b64_tr_b16 a[146:147], v26 offset:20480
ds_read_b64_tr_b16 a[148:149], v27 offset:16384
ds_read_b64_tr_b16 a[150:151], v27 offset:20480
ds_read_b64_tr_b16 a[152:153], v26 offset:24576
ds_read_b64_tr_b16 a[154:155], v26 offset:28672
ds_read_b64_tr_b16 a[156:157], v27 offset:24576
ds_read_b64_tr_b16 a[158:159], v27 offset:28672
s_waitcnt vmcnt(24) lgkmcnt(0)
s_barrier
s_add_u32 m0, s31, 16384
s_add_u32 s35, s30, 1880064
buffer_load_dwordx4 v24, s[8:11], s35 offen lds
s_add_u32 m0, s31, 17408
s_add_u32 s35, s30, 1893888
buffer_load_dwordx4 v25, s[8:11], s35 offen lds
s_add_u32 m0, s31, 24576
s_add_u32 s35, s30, 1880064
buffer_load_dwordx4 v24, s[12:15], s35 offen lds
s_add_u32 m0, s31, 25600
s_add_u32 s35, s30, 1893888
buffer_load_dwordx4 v25, s[12:15], s35 offen lds
ds_read_b64_tr_b16 a[160:161], v26 offset:32768
ds_read_b64_tr_b16 a[162:163], v26 offset:36864
ds_read_b64_tr_b16 a[164:165], v27 offset:32768
ds_read_b64_tr_b16 a[166:167], v27 offset:36864
ds_read_b64_tr_b16 a[168:169], v26 offset:40960
ds_read_b64_tr_b16 a[170:171], v26 offset:45056
ds_read_b64_tr_b16 a[172:173], v27 offset:40960
ds_read_b64_tr_b16 a[174:175], v27 offset:45056
s_waitcnt vmcnt(24) lgkmcnt(0)
s_barrier
s_add_u32 m0, s31, 32768
s_add_u32 s35, s30, 1990656
buffer_load_dwordx4 v24, s[8:11], s35 offen lds
s_add_u32 m0, s31, 33792
s_add_u32 s35, s30, 2004480
buffer_load_dwordx4 v25, s[8:11], s35 offen lds
s_add_u32 m0, s31, 40960
s_add_u32 s35, s30, 1990656
buffer_load_dwordx4 v24, s[12:15], s35 offen lds
s_add_u32 m0, s31, 41984
s_add_u32 s35, s30, 2004480
buffer_load_dwordx4 v25, s[12:15], s35 offen lds
ds_read_b64_tr_b16 a[176:177], v26 offset:49152
ds_read_b64_tr_b16 a[178:179], v26 offset:53248
ds_read_b64_tr_b16 a[180:181], v27 offset:49152
ds_read_b64_tr_b16 a[182:183], v27 offset:53248
ds_read_b64_tr_b16 a[184:185], v26 offset:57344
ds_read_b64_tr_b16 a[186:187], v26 offset:61440
ds_read_b64_tr_b16 a[188:189], v27 offset:57344
ds_read_b64_tr_b16 a[190:191], v27 offset:61440
s_waitcnt vmcnt(24) lgkmcnt(0)
s_barrier
s_add_u32 m0, s31, 49152
s_add_u32 s35, s30, 2101248
buffer_load_dwordx4 v24, s[8:11], s35 offen lds
s_add_u32 m0, s31, 50176
s_add_u32 s35, s30, 2115072
buffer_load_dwordx4 v25, s[8:11], s35 offen lds
s_add_u32 m0, s31, 57344
s_add_u32 s35, s30, 2101248
buffer_load_dwordx4 v24, s[12:15], s35 offen lds
s_add_u32 m0, s31, 58368
s_add_u32 s35, s30, 2115072
buffer_load_dwordx4 v25, s[12:15], s35 offen lds
ds_read_b64_tr_b16 a[192:193], v28 offset:0
ds_read_b64_tr_b16 a[194:195], v28 offset:4096
ds_read_b64_tr_b16 a[196:197], v29 offset:0
ds_read_b64_tr_b16 a[198:199], v29 offset:4096
ds_read_b64_tr_b16 a[200:201], v28 offset:8192
ds_read_b64_tr_b16 a[202:203], v28 offset:12288
ds_read_b64_tr_b16 a[204:205], v29 offset:8192
ds_read_b64_tr_b16 a[206:207], v29 offset:12288
s_waitcnt vmcnt(24) lgkmcnt(0)
s_barrier
ds_read_b64_tr_b16 a[208:209], v28 offset:16384
ds_read_b64_tr_b16 a[210:211], v28 offset:20480
ds_read_b64_tr_b16 a[212:213], v29 offset:16384
ds_read_b64_tr_b16 a[214:215], v29 offset:20480
ds_read_b64_tr_b16 a[216:217], v28 offset:24576
ds_read_b64_tr_b16 a[218:219], v28 offset:28672
ds_read_b64_tr_b16 a[220:221], v29 offset:24576
ds_read_b64_tr_b16 a[222:223], v29 offset:28672
s_waitcnt vmcnt(20) lgkmcnt(0)
s_barrier
ds_read_b64_tr_b16 a[224:225], v28 offset:32768
ds_read_b64_tr_b16 a[226:227], v28 offset:36864
ds_read_b64_tr_b16 a[228:229], v29 offset:32768
ds_read_b64_tr_b16 a[230:231], v29 offset:36864
ds_read_b64_tr_b16 a[232:233], v28 offset:40960
ds_read_b64_tr_b16 a[234:235], v28 offset:45056
ds_read_b64_tr_b16 a[236:237], v29 offset:40960
ds_read_b64_tr_b16 a[238:239], v29 offset:45056
s_waitcnt vmcnt(16) lgkmcnt(0)
s_barrier
ds_read_b64_tr_b16 a[240:241], v28 offset:49152
ds_read_b64_tr_b16 a[242:243], v28 offset:53248
ds_read_b64_tr_b16 a[244:245], v29 offset:49152
ds_read_b64_tr_b16 a[246:247], v29 offset:53248
ds_read_b64_tr_b16 a[248:249], v28 offset:57344
ds_read_b64_tr_b16 a[250:251], v28 offset:61440
ds_read_b64_tr_b16 a[252:253], v29 offset:57344
ds_read_b64_tr_b16 a[254:255], v29 offset:61440
s_waitcnt vmcnt(12) lgkmcnt(0)
s_barrier
ds_read_b64_tr_b16 v[192:193], v26 offset:0
ds_read_b64_tr_b16 v[194:195], v26 offset:4096
ds_read_b64_tr_b16 v[196:197], v27 offset:0
ds_read_b64_tr_b16 v[198:199], v27 offset:4096
ds_read_b64_tr_b16 v[200:201], v26 offset:8192
ds_read_b64_tr_b16 v[202:203], v26 offset:12288
ds_read_b64_tr_b16 v[204:205], v27 offset:8192
ds_read_b64_tr_b16 v[206:207], v27 offset:12288
s_waitcnt vmcnt(8) lgkmcnt(0)
s_barrier
ds_read_b64_tr_b16 v[208:209], v26 offset:16384
ds_read_b64_tr_b16 v[210:211], v26 offset:20480
ds_read_b64_tr_b16 v[212:213], v27 offset:16384
ds_read_b64_tr_b16 v[214:215], v27 offset:20480
ds_read_b64_tr_b16 v[216:217], v26 offset:24576
ds_read_b64_tr_b16 v[218:219], v26 offset:28672
ds_read_b64_tr_b16 v[220:221], v27 offset:24576
ds_read_b64_tr_b16 v[222:223], v27 offset:28672
s_waitcnt vmcnt(4) lgkmcnt(0)
s_barrier
ds_read_b64_tr_b16 v[224:225], v26 offset:32768
ds_read_b64_tr_b16 v[226:227], v26 offset:36864
ds_read_b64_tr_b16 v[228:229], v27 offset:32768
ds_read_b64_tr_b16 v[230:231], v27 offset:36864
ds_read_b64_tr_b16 v[232:233], v26 offset:40960
ds_read_b64_tr_b16 v[234:235], v26 offset:45056
ds_read_b64_tr_b16 v[236:237], v27 offset:40960
ds_read_b64_tr_b16 v[238:239], v27 offset:45056
s_waitcnt vmcnt(0) lgkmcnt(0)
s_barrier
ds_read_b64_tr_b16 v[240:241], v26 offset:49152
ds_read_b64_tr_b16 v[242:243], v26 offset:53248
ds_read_b64_tr_b16 v[244:245], v27 offset:49152
ds_read_b64_tr_b16 v[246:247], v27 offset:53248
ds_read_b64_tr_b16 v[248:249], v26 offset:57344
ds_read_b64_tr_b16 v[250:251], v26 offset:61440
ds_read_b64_tr_b16 v[252:253], v27 offset:57344
ds_read_b64_tr_b16 v[254:255], v27 offset:61440
s_waitcnt lgkmcnt(0)
s_barrier
v_mov_b32 v8, 0x3f803f80
v_mov_b32 v9, 0x3f803f80
v_mov_b32 v10, 0x3f803f80
v_mov_b32 v11, 0x3f803f80
s_nop 1
v_mfma_f32_16x16x32_bf16 v[72:75], a[0:3], v[8:11], 0
v_mfma_f32_16x16x32_bf16 v[76:79], a[4:7], v[8:11], 0
v_mfma_f32_16x16x32_bf16 v[80:83], a[8:11], v[8:11], 0
v_mfma_f32_16x16x32_bf16 v[84:87], a[12:15], v[8:11], 0
v_mfma_f32_16x16x32_bf16 v[72:75], a[16:19], v[8:11], v[72:75]
v_mfma_f32_16x16x32_bf16 v[76:79], a[20:23], v[8:11], v[76:79]
v_mfma_f32_16x16x32_bf16 v[80:83], a[24:27], v[8:11], v[80:83]
v_mfma_f32_16x16x32_bf16 v[84:87], a[28:31], v[8:11], v[84:87]
v_mfma_f32_16x16x32_bf16 v[72:75], a[32:35], v[8:11], v[72:75]
v_mfma_f32_16x16x32_bf16 v[76:79], a[36:39], v[8:11], v[76:79]
v_mfma_f32_16x16x32_bf16 v[80:83], a[40:43], v[8:11], v[80:83]
v_mfma_f32_16x16x32_bf16 v[84:87], a[44:47], v[8:11], v[84:87]
v_mfma_f32_16x16x32_bf16 v[72:75], a[48:51], v[8:11], v[72:75]
v_mfma_f32_16x16x32_bf16 v[76:79], a[52:55], v[8:11], v[76:79]
v_mfma_f32_16x16x32_bf16 v[80:83], a[56:59], v[8:11], v[80:83]
v_mfma_f32_16x16x32_bf16 v[84:87], a[60:63], v[8:11], v[84:87]
v_mfma_f32_16x16x32_bf16 v[72:75], a[64:67], v[8:11], v[72:75]
v_mfma_f32_16x16x32_bf16 v[76:79], a[68:71], v[8:11], v[76:79]
v_mfma_f32_16x16x32_bf16 v[80:83], a[72:75], v[8:11], v[80:83]
v_mfma_f32_16x16x32_bf16 v[84:87], a[76:79], v[8:11], v[84:87]
v_mfma_f32_16x16x32_bf16 v[72:75], a[80:83], v[8:11], v[72:75]
v_mfma_f32_16x16x32_bf16 v[76:79], a[84:87], v[8:11], v[76:79]
v_mfma_f32_16x16x32_bf16 v[80:83], a[88:91], v[8:11], v[80:83]
v_mfma_f32_16x16x32_bf16 v[84:87], a[92:95], v[8:11], v[84:87]
v_mfma_f32_16x16x32_bf16 v[72:75], a[96:99], v[8:11], v[72:75]
v_mfma_f32_16x16x32_bf16 v[76:79], a[100:103], v[8:11], v[76:79]
v_mfma_f32_16x16x32_bf16 v[80:83], a[104:107], v[8:11], v[80:83]
v_mfma_f32_16x16x32_bf16 v[84:87], a[108:111], v[8:11], v[84:87]
v_mfma_f32_16x16x32_bf16 v[72:75], a[112:115], v[8:11], v[72:75]
v_mfma_f32_16x16x32_bf16 v[76:79], a[116:119], v[8:11], v[76:79]
v_mfma_f32_16x16x32_bf16 v[80:83], a[120:123], v[8:11], v[80:83]
v_mfma_f32_16x16x32_bf16 v[84:87], a[124:127], v[8:11], v[84:87]
v_mfma_f32_16x16x32_bf16 v[72:75], a[128:131], v[8:11], v[72:75]
v_mfma_f32_16x16x32_bf16 v[76:79], a[132:135], v[8:11], v[76:79]
v_mfma_f32_16x16x32_bf16 v[80:83], a[136:139], v[8:11], v[80:83]
v_mfma_f32_16x16x32_bf16 v[84:87], a[140:143], v[8:11], v[84:87]
v_mfma_f32_16x16x32_bf16 v[72:75], a[144:147], v[8:11], v[72:75]
v_mfma_f32_16x16x32_bf16 v[76:79], a[148:151], v[8:11], v[76:79]
v_mfma_f32_16x16x32_bf16 v[80:83], a[152:155], v[8:11], v[80:83]
v_mfma_f32_16x16x32_bf16 v[84:87], a[156:159], v[8:11], v[84:87]
v_mfma_f32_16x16x32_bf16 v[72:75], a[160:163], v[8:11], v[72:75]
v_mfma_f32_16x16x32_bf16 v[76:79], a[164:167], v[8:11], v[76:79]
v_mfma_f32_16x16x32_bf16 v[80:83], a[168:171], v[8:11], v[80:83]
v_mfma_f32_16x16x32_bf16 v[84:87], a[172:175], v[8:11], v[84:87]
v_mfma_f32_16x16x32_bf16 v[72:75], a[176:179], v[8:11], v[72:75]
v_mfma_f32_16x16x32_bf16 v[76:79], a[180:183], v[8:11], v[76:79]
v_mfma_f32_16x16x32_bf16 v[80:83], a[184:187], v[8:11], v[80:83]
v_mfma_f32_16x16x32_bf16 v[84:87], a[188:191], v[8:11], v[84:87]
v_mfma_f32_16x16x32_bf16 v[72:75], a[192:195], v[8:11], v[72:75]
v_mfma_f32_16x16x32_bf16 v[76:79], a[196:199], v[8:11], v[76:79]
v_mfma_f32_16x16x32_bf16 v[80:83], a[200:203], v[8:11], v[80:83]
v_mfma_f32_16x16x32_bf16 v[84:87], a[204:207], v[8:11], v[84:87]
v_mfma_f32_16x16x32_bf16 v[72:75], a[208:211], v[8:11], v[72:75]
v_mfma_f32_16x16x32_bf16 v[76:79], a[212:215], v[8:11], v[76:79]
v_mfma_f32_16x16x32_bf16 v[80:83], a[216:219], v[8:11], v[80:83]
v_mfma_f32_16x16x32_bf16 v[84:87], a[220:223], v[8:11], v[84:87]
v_mfma_f32_16x16x32_bf16 v[72:75], a[224:227], v[8:11], v[72:75]
v_mfma_f32_16x16x32_bf16 v[76:79], a[228:231], v[8:11], v[76:79]
v_mfma_f32_16x16x32_bf16 v[80:83], a[232:235], v[8:11], v[80:83]
v_mfma_f32_16x16x32_bf16 v[84:87], a[236:239], v[8:11], v[84:87]
v_mfma_f32_16x16x32_bf16 v[72:75], a[240:243], v[8:11], v[72:75]
v_mfma_f32_16x16x32_bf16 v[76:79], a[244:247], v[8:11], v[76:79]
v_mfma_f32_16x16x32_bf16 v[80:83], a[248:251], v[8:11], v[80:83]
v_mfma_f32_16x16x32_bf16 v[84:87], a[252:255], v[8:11], v[84:87]
v_mfma_f32_16x16x32_bf16 v[72:75], v[192:195], v[8:11], v[72:75]
v_mfma_f32_16x16x32_bf16 v[76:79], v[196:199], v[8:11], v[76:79]
v_mfma_f32_16x16x32_bf16 v[80:83], v[200:203], v[8:11], v[80:83]
v_mfma_f32_16x16x32_bf16 v[84:87], v[204:207], v[8:11], v[84:87]
v_mfma_f32_16x16x32_bf16 v[72:75], v[208:211], v[8:11], v[72:75]
v_mfma_f32_16x16x32_bf16 v[76:79], v[212:215], v[8:11], v[76:79]
v_mfma_f32_16x16x32_bf16 v[80:83], v[216:219], v[8:11], v[80:83]
v_mfma_f32_16x16x32_bf16 v[84:87], v[220:223], v[8:11], v[84:87]
v_mfma_f32_16x16x32_bf16 v[72:75], v[224:227], v[8:11], v[72:75]
v_mfma_f32_16x16x32_bf16 v[76:79], v[228:231], v[8:11], v[76:79]
v_mfma_f32_16x16x32_bf16 v[80:83], v[232:235], v[8:11], v[80:83]
v_mfma_f32_16x16x32_bf16 v[84:87], v[236:239], v[8:11], v[84:87]
v_mfma_f32_16x16x32_bf16 v[72:75], v[240:243], v[8:11], v[72:75]
v_mfma_f32_16x16x32_bf16 v[76:79], v[244:247], v[8:11], v[76:79]
v_mfma_f32_16x16x32_bf16 v[80:83], v[248:251], v[8:11], v[80:83]
v_mfma_f32_16x16x32_bf16 v[84:87], v[252:255], v[8:11], v[84:87]
v_readfirstlane_b32 s20, v62
s_add_u32 s20, s20, 1
s_nop 7
Lg1_common:
s_barrier
s_mul_i32 s26, s22, 37
s_lshr_b32 s37, s26, 8
s_mul_i32 s26, s37, 7
s_sub_u32 s38, s22, s26
s_mul_i32 s26, s24, 7
s_add_u32 s38, s38, s26
s_lshl_b32 s39, s38, 2
s_add_u32 s39, s39, s3
s_cmp_eq_u32 s37, 2
s_cselect_b32 s40, 10, 11
s_lshl_b32 s41, s37, 2
s_add_u32 s41, s41, s23
v_lshlrev_b32 v2, 4, v1
v_and_b32 v20, 15, v1
v_lshrrev_b32 v21, 4, v1
v_mul_u32_u24 v3, 1280, v21
v_lshl_add_u32 v3, v20, 4, v3
s_cmp_lt_u32 s39, 54
s_cselect_b32 s26, 0, 0x40000000
v_add_u32 v4, s26, v2
v_mov_b32 v22, 0x40000000
v_mov_b32 v23, s26
v_cmp_eq_u32 vcc, 0, v1
v_mov_b32 v181, s20
s_nop 0
v_cndmask_b32 v5, v22, v23, vcc
v_add_u32 v185, 98304, v2
s_mul_i32 s31, s3, 5120
s_mov_b32 s36, 0
s_mul_i32 s26, s3, 1280
v_lshlrev_b32 v182, 4, v20
v_add_u32 v182, s26, v182
v_lshl_add_u32 v3, v21, 8, v182
v_add_u32 v182, 1024, v182
v_lshlrev_b32 v184, 3, v20
v_add_u32 v184, 159744, v184
s_lshl_b32 s26, s3, 7
v_lshrrev_b32 v22, 1, v21
v_lshl_add_u32 v183, v22, 2, v184
v_add_u32 v183, s26, v183
v_lshl_add_u32 v184, v21, 7, v184
s_mov_b32 s8, s88
s_mov_b32 s9, s89
s_mov_b32 s10, 0x10000000
s_mov_b32 s11, 0x20000
Lg1_layer:
s_lshl_b32 s27, s36, 7
s_add_u32 s27, s27, s41
s_mul_i32 s42, s27, 5120
s_add_u32 s42, s42, 0x1d00000
s_mul_i32 s43, s27, 20480
s_add_u32 s43, s43, s31
s_add_u32 s43, s43, 0x600000
s_lshl_b32 s26, s36, 7
s_add_u32 s26, s26, s41
s_mul_i32 s46, s26, 55296
s_lshl_b32 s27, s39, 10
s_add_u32 s46, s46, s27
s_add_u32 s46, s46, 0xc00000
s_lshl_b32 s47, s26, 10
s_lshl_b32 s27, s39, 4
s_add_u32 s47, s47, s27
s_add_u32 s47, s47, 0x1f10000
s_mov_b32 s45, 0x40000000
s_mov_b32 s32, 0x40000000
s_mov_b32 s33, 0x40000000
s_sub_u32 s44, s40, 2
s_mov_b32 s34, s40
s_mov_b32 s90, 40000
Lpg_10:
buffer_load_dwordx3 v[100:102], v3, s[4:7], s42 offen sc1
buffer_load_dwordx3 v[104:106], v182, s[4:7], s42 offen sc1
s_waitcnt vmcnt(0)
v_cmp_ne_u32 vcc, s20, v102
v_cmp_ne_u32 s[28:29], s20, v106
s_nop 0
s_or_b64 vcc, vcc, s[28:29]
s_cmp_eq_u64 vcc, 0
s_cbranch_scc1 Lpgok_11
s_sub_u32 s90, s90, 1
s_cmp_lg_u32 s90, 0
s_cbranch_scc1 Lpg_10
s_mov_b32 s8, s86
s_mov_b32 s9, s87
s_mov_b32 s10, 0x100
s_mov_b32 s11, 0x20000
v_mov_b32 v2, 0x4
v_mov_b32 v3, 0x10
s_nop 1
buffer_store_dword v2, v3, s[8:11], 0 offen
s_waitcnt vmcnt(0)
s_endpgm
Lpgok_11:
s_waitcnt vmcnt(0)
v_fmac_f32 v100, 0x3e800000, v104
v_fmac_f32 v101, 0x3e800000, v105
s_nop 1
v_permlane32_swap_b32 v100, v101
v_add_f32 v100, v100, v101
v_mov_b32 v6, v100
s_nop 1
v_permlane16_swap_b32 v100, v6
v_add_f32 v100, v100, v6
ds_write_b32 v183, v100 offset:0
s_add_u32 s42, s42, 61440
s_add_u32 m0, s31, 98304
s_add_u32 s35, s43, 4096
buffer_load_dwordx4 v2, s[4:7], s43 offen offset:0 sc1 lds
buffer_load_dwordx4 v2, s[4:7], s43 offen offset:1024 sc1 lds
buffer_load_dwordx4 v2, s[4:7], s43 offen offset:2048 sc1 lds
buffer_load_dwordx4 v2, s[4:7], s43 offen offset:3072 sc1 lds
s_add_u32 m0, s31, 102400
s_nop 0
buffer_load_dwordx4 v2, s[4:7], s35 offen sc1 lds
s_add_u32 s43, s43, 245760
s_mov_b32 s90, 40000
Lpg_12:
buffer_load_dwordx3 v[100:102], v3, s[4:7], s42 offen sc1
buffer_load_dwordx3 v[104:106], v182, s[4:7], s42 offen sc1
s_waitcnt vmcnt(0)
v_cmp_ne_u32 vcc, s20, v102
v_cmp_ne_u32 s[28:29], s20, v106
s_nop 0
s_or_b64 vcc, vcc, s[28:29]
s_cmp_eq_u64 vcc, 0
s_cbranch_scc1 Lpgok_13
s_sub_u32 s90, s90, 1
s_cmp_lg_u32 s90, 0
s_cbranch_scc1 Lpg_12
s_mov_b32 s8, s86
s_mov_b32 s9, s87
s_mov_b32 s10, 0x100
s_mov_b32 s11, 0x20000
v_mov_b32 v2, 0x4
v_mov_b32 v3, 0x10
s_nop 1
buffer_store_dword v2, v3, s[8:11], 0 offen
s_waitcnt vmcnt(0)
s_endpgm
Lpgok_13:
s_waitcnt vmcnt(0)
v_fmac_f32 v100, 0x3e800000, v104
v_fmac_f32 v101, 0x3e800000, v105
s_nop 1
v_permlane32_swap_b32 v100, v101
v_add_f32 v100, v100, v101
v_mov_b32 v6, v100
s_nop 1
v_permlane16_swap_b32 v100, v6
v_add_f32 v100, v100, v6
ds_write_b32 v183, v100 offset:512
s_add_u32 s42, s42, 61440
s_add_u32 m0, s31, 118784
s_add_u32 s35, s43, 4096
buffer_load_dwordx4 v2, s[4:7], s43 offen offset:0 sc1 lds
buffer_load_dwordx4 v2, s[4:7], s43 offen offset:1024 sc1 lds
buffer_load_dwordx4 v2, s[4:7], s43 offen offset:2048 sc1 lds
buffer_load_dwordx4 v2, s[4:7], s43 offen offset:3072 sc1 lds
s_add_u32 m0, s31, 122880
s_nop 0
buffer_load_dwordx4 v2, s[4:7], s35 offen sc1 lds
s_add_u32 s43, s43, 245760
s_waitcnt lgkmcnt(0)
s_barrier
Lg1_enter:
ds_read_b128 v[8:11], v185 offset:0
ds_read_b128 v[12:15], v185 offset:1024
ds_read_b128 v[16:19], v185 offset:2048
ds_read_b128 v[20:23], v185 offset:3072
ds_read_b128 v[156:159], v185 offset:4096
ds_read_b128 v[160:163], v185 offset:5120
ds_read_b128 v[164:167], v185 offset:6144
ds_read_b128 v[168:171], v185 offset:7168
ds_read_b128 v[172:175], v185 offset:8192
ds_read_b128 v[176:179], v185 offset:9216
Lg1_loop:
s_waitcnt lgkmcnt(6)
v_mfma_f32_16x16x32_bf16 v[24:27], a[0:3], v[8:11], 0
buffer_load_dwordx3 v[100:102], v3, s[4:7], s42 offen sc1
v_fma_f32 v120, v96, v72, v56
v_fma_f32 v128, v96, v80, v64
v_fma_f32 v121, v96, v73, v57
v_mfma_f32_16x16x32_bf16 v[28:31], a[4:7], v[8:11], 0
buffer_load_dwordx3 v[104:106], v182, s[4:7], s42 offen sc1
v_fma_f32 v129, v96, v81, v65
v_fma_f32 v122, v96, v74, v58
v_fma_f32 v130, v96, v82, v66
v_mfma_f32_16x16x32_bf16 v[32:35], a[8:11], v[8:11], 0
v_fma_f32 v123, v96, v75, v59
v_fma_f32 v131, v96, v83, v67
v_fma_f32 v124, v96, v76, v60
v_fma_f32 v132, v96, v84, v68
v_fma_f32 v125, v96, v77, v61
v_mfma_f32_16x16x32_bf16 v[36:39], a[12:15], v[8:11], 0
ds_read_b128 v[8:11], v185 offset:10240
v_fma_f32 v133, v96, v85, v69
v_mfma_f32_16x16x32_bf16 v[24:27], a[16:19], v[12:15], v[24:27]
s_waitcnt vmcnt(7)
buffer_store_dword v181, v5, s[4:7], s33 offen sc1
v_fma_f32 v126, v96, v78, v62
v_fma_f32 v134, v96, v86, v70
v_mfma_f32_16x16x32_bf16 v[28:31], a[20:23], v[12:15], v[28:31]
v_fma_f32 v127, v96, v79, v63
v_fma_f32 v135, v96, v87, v71
v_mul_f32 v136, v120, v97
v_mul_f32 v137, v121, v97
v_mul_f32 v138, v122, v97
v_mfma_f32_16x16x32_bf16 v[32:35], a[24:27], v[12:15], v[32:35]
v_mul_f32 v139, v123, v97
v_mul_f32 v140, v124, v97
v_mul_f32 v141, v125, v97
v_mul_f32 v142, v126, v97
v_mul_f32 v143, v127, v97
v_mfma_f32_16x16x32_bf16 v[36:39], a[28:31], v[12:15], v[36:39]
ds_read_b128 v[12:15], v185 offset:11264
v_exp_f32 v136, v136
v_mfma_f32_16x16x32_bf16 v[24:27], a[32:35], v[16:19], v[24:27]
v_exp_f32 v137, v137
v_mfma_f32_16x16x32_bf16 v[28:31], a[36:39], v[16:19], v[28:31]
v_exp_f32 v138, v138
v_mfma_f32_16x16x32_bf16 v[32:35], a[40:43], v[16:19], v[32:35]
v_exp_f32 v139, v139
v_mfma_f32_16x16x32_bf16 v[36:39], a[44:47], v[16:19], v[36:39]
ds_read_b128 v[16:19], v185 offset:12288
v_exp_f32 v140, v140
v_mfma_f32_16x16x32_bf16 v[24:27], a[48:51], v[20:23], v[24:27]
v_exp_f32 v141, v141
v_mfma_f32_16x16x32_bf16 v[28:31], a[52:55], v[20:23], v[28:31]
v_exp_f32 v142, v142
v_mfma_f32_16x16x32_bf16 v[32:35], a[56:59], v[20:23], v[32:35]
v_exp_f32 v143, v143
v_mfma_f32_16x16x32_bf16 v[36:39], a[60:63], v[20:23], v[36:39]
ds_read_b128 v[20:23], v185 offset:13312
v_mul_f32 v120, v120, v128
v_mul_f32 v121, v121, v129
v_mul_f32 v122, v122, v130
s_waitcnt lgkmcnt(6)
v_mfma_f32_16x16x32_bf16 v[24:27], a[64:67], v[156:159], v[24:27]
v_mul_f32 v123, v123, v131
v_mul_f32 v124, v124, v132
v_mul_f32 v125, v125, v133
v_mul_f32 v126, v126, v134
v_mul_f32 v127, v127, v135
v_mfma_f32_16x16x32_bf16 v[28:31], a[68:71], v[156:159], v[28:31]
v_fma_f32 v136, v136, v98, v98
v_fma_f32 v137, v137, v98, v98
v_fma_f32 v138, v138, v98, v98
v_fma_f32 v139, v139, v98, v98
v_fma_f32 v140, v140, v98, v98
v_mfma_f32_16x16x32_bf16 v[32:35], a[72:75], v[156:159], v[32:35]
v_fma_f32 v141, v141, v98, v98
v_fma_f32 v142, v142, v98, v98
v_fma_f32 v143, v143, v98, v98
v_mfma_f32_16x16x32_bf16 v[36:39], a[76:79], v[156:159], v[36:39]
ds_read_b128 v[156:159], v185 offset:14336
v_rcp_f32 v136, v136
v_mfma_f32_16x16x32_bf16 v[24:27], a[80:83], v[160:163], v[24:27]
v_rcp_f32 v137, v137
v_mfma_f32_16x16x32_bf16 v[28:31], a[84:87], v[160:163], v[28:31]
v_rcp_f32 v138, v138
v_mfma_f32_16x16x32_bf16 v[32:35], a[88:91], v[160:163], v[32:35]
v_rcp_f32 v139, v139
v_mfma_f32_16x16x32_bf16 v[36:39], a[92:95], v[160:163], v[36:39]
ds_read_b128 v[160:163], v185 offset:15360
v_rcp_f32 v140, v140
v_mfma_f32_16x16x32_bf16 v[24:27], a[96:99], v[164:167], v[24:27]
v_rcp_f32 v141, v141
v_mfma_f32_16x16x32_bf16 v[28:31], a[100:103], v[164:167], v[28:31]
v_rcp_f32 v142, v142
v_mfma_f32_16x16x32_bf16 v[32:35], a[104:107], v[164:167], v[32:35]
v_rcp_f32 v143, v143
v_mfma_f32_16x16x32_bf16 v[36:39], a[108:111], v[164:167], v[36:39]
ds_read_b128 v[164:167], v185 offset:16384
v_mul_f32 v120, v120, v136
v_mfma_f32_16x16x32_bf16 v[24:27], a[112:115], v[168:171], v[24:27]
v_mul_f32 v121, v121, v137
v_mul_f32 v122, v122, v138
v_mfma_f32_16x16x32_bf16 v[28:31], a[116:119], v[168:171], v[28:31]
v_mul_f32 v123, v123, v139
v_mul_f32 v124, v124, v140
v_mfma_f32_16x16x32_bf16 v[32:35], a[120:123], v[168:171], v[32:35]
v_mul_f32 v125, v125, v141
v_mul_f32 v126, v126, v142
v_mfma_f32_16x16x32_bf16 v[36:39], a[124:127], v[168:171], v[36:39]
ds_read_b128 v[168:171], v185 offset:17408
s_waitcnt lgkmcnt(6)
v_mfma_f32_16x16x32_bf16 v[24:27], a[128:131], v[172:175], v[24:27]
v_mul_f32 v127, v127, v143
v_cvt_pk_bf16_f32 v152, v120, v121
v_mfma_f32_16x16x32_bf16 v[28:31], a[132:135], v[172:175], v[28:31]
v_cvt_pk_bf16_f32 v153, v122, v123
v_cvt_pk_bf16_f32 v154, v124, v125
v_mfma_f32_16x16x32_bf16 v[32:35], a[136:139], v[172:175], v[32:35]
v_cvt_pk_bf16_f32 v155, v126, v127
v_mfma_f32_16x16x32_bf16 v[36:39], a[140:143], v[172:175], v[36:39]
ds_read_b128 v[172:175], v185 offset:18432
v_mfma_f32_16x16x32_bf16 v[24:27], a[144:147], v[176:179], v[24:27]
buffer_store_dwordx4 v[152:155], v4, s[4:7], s45 offen sc1
v_mfma_f32_16x16x32_bf16 v[28:31], a[148:151], v[176:179], v[28:31]
s_mov_b32 s45, s46
s_add_u32 s46, s46, 663552
s_mov_b32 s33, s32
v_mfma_f32_16x16x32_bf16 v[32:35], a[152:155], v[176:179], v[32:35]
s_mov_b32 s32, s47
s_add_u32 s47, s47, 12288
ds_read_b64 v[108:109], v184 offset:0
v_mfma_f32_16x16x32_bf16 v[36:39], a[156:159], v[176:179], v[36:39]
ds_read_b128 v[176:179], v185 offset:19456
s_waitcnt lgkmcnt(1)
v_permlane32_swap_b32 v108, v109
v_mfma_f32_16x16x32_bf16 v[24:27], a[160:163], v[8:11], v[24:27]
v_add_f32 v108, v108, v109
v_mov_b32 v7, v108
v_mfma_f32_16x16x32_bf16 v[28:31], a[164:167], v[8:11], v[28:31]
v_permlane16_swap_b32 v108, v7
v_mfma_f32_16x16x32_bf16 v[32:35], a[168:171], v[8:11], v[32:35]
v_add_f32 v108, v108, v7
v_mov_b32 v109, v108
v_mfma_f32_16x16x32_bf16 v[36:39], a[172:175], v[8:11], v[36:39]
v_permlane32_swap_b32 v108, v109
v_mfma_f32_16x16x32_bf16 v[24:27], a[176:179], v[12:15], v[24:27]
v_mul_f32 v110, 0x3acccccd, v108
v_mul_f32 v111, 0x3acccccd, v109
v_mfma_f32_16x16x32_bf16 v[28:31], a[180:183], v[12:15], v[28:31]
v_fma_f32 v111, -v110, v110, v111
v_add_f32 v90, 0x3727c5ac, v111
v_mfma_f32_16x16x32_bf16 v[32:35], a[184:187], v[12:15], v[32:35]
v_rsq_f32 v112, v90
v_mfma_f32_16x16x32_bf16 v[36:39], a[188:191], v[12:15], v[36:39]
v_sub_f32 v88, 0, v110
v_mfma_f32_16x16x32_bf16 v[24:27], a[192:195], v[16:19], v[24:27]
v_mul_f32 v89, 0xbfb8aa3b, v112
s_waitcnt vmcnt(2)
v_mfma_f32_16x16x32_bf16 v[28:31], a[196:199], v[16:19], v[28:31]
v_cmp_ne_u32 vcc, s20, v102
v_cmp_ne_u32 s[28:29], s20, v106
v_mfma_f32_16x16x32_bf16 v[32:35], a[200:203], v[16:19], v[32:35]
s_or_b64 vcc, vcc, s[28:29]
s_cmp_eq_u64 vcc, 0
s_cselect_b32 s10, 0x10000000, 0
s_cselect_b32 s25, 0, s44
s_cmp_gt_i32 s44, 0
s_cselect_b32 s10, s10, 0
v_mfma_f32_16x16x32_bf16 v[36:39], a[204:207], v[16:19], v[36:39]
v_fmac_f32 v100, 0x3e800000, v104
v_fmac_f32 v101, 0x3e800000, v105
v_mfma_f32_16x16x32_bf16 v[24:27], a[208:211], v[20:23], v[24:27]
v_permlane32_swap_b32 v100, v101
v_mfma_f32_16x16x32_bf16 v[28:31], a[212:215], v[20:23], v[28:31]
v_add_f32 v100, v100, v101
v_mov_b32 v6, v100
v_mfma_f32_16x16x32_bf16 v[32:35], a[216:219], v[20:23], v[32:35]
v_permlane16_swap_b32 v100, v6
v_mfma_f32_16x16x32_bf16 v[36:39], a[220:223], v[20:23], v[36:39]
v_add_f32 v100, v100, v6
v_mfma_f32_16x16x32_bf16 v[24:27], a[224:227], v[156:159], v[24:27]
ds_write_b32 v183, v100 offset:1024
s_add_u32 m0, s31, 139264
s_add_u32 s35, s43, 4096
buffer_load_dwordx4 v2, s[8:11], s43 offen offset:0 sc1 lds
v_mfma_f32_16x16x32_bf16 v[28:31], a[228:231], v[156:159], v[28:31]
buffer_load_dwordx4 v2, s[8:11], s43 offen offset:1024 sc1 lds
v_mfma_f32_16x16x32_bf16 v[32:35], a[232:235], v[156:159], v[32:35]
buffer_load_dwordx4 v2, s[8:11], s43 offen offset:2048 sc1 lds
v_mfma_f32_16x16x32_bf16 v[36:39], a[236:239], v[156:159], v[36:39]
buffer_load_dwordx4 v2, s[8:11], s43 offen offset:3072 sc1 lds
v_mfma_f32_16x16x32_bf16 v[24:27], a[240:243], v[160:163], v[24:27]
s_add_u32 m0, s31, 143360
s_nop 0
buffer_load_dwordx4 v2, s[8:11], s35 offen sc1 lds
v_mfma_f32_16x16x32_bf16 v[28:31], a[244:247], v[160:163], v[28:31]
s_add_u32 s42, s42, 61440
s_add_u32 s43, s43, 245760
s_sub_u32 s44, s44, 1
v_mfma_f32_16x16x32_bf16 v[32:35], a[248:251], v[160:163], v[32:35]
v_mfma_f32_16x16x32_bf16 v[36:39], a[252:255], v[160:163], v[36:39]
s_waitcnt lgkmcnt(1)
v_mfma_f32_16x16x32_bf16 v[24:27], v[192:195], v[164:167], v[24:27]
v_mfma_f32_16x16x32_bf16 v[28:31], v[196:199], v[164:167], v[28:31]
v_mfma_f32_16x16x32_bf16 v[32:35], v[200:203], v[164:167], v[32:35]
v_mfma_f32_16x16x32_bf16 v[36:39], v[204:207], v[164:167], v[36:39]
v_mfma_f32_16x16x32_bf16 v[24:27], v[208:211], v[168:171], v[24:27]
v_mfma_f32_16x16x32_bf16 v[28:31], v[212:215], v[168:171], v[28:31]
v_mfma_f32_16x16x32_bf16 v[32:35], v[216:219], v[168:171], v[32:35]
v_mfma_f32_16x16x32_bf16 v[36:39], v[220:223], v[168:171], v[36:39]
s_waitcnt vmcnt(9)
s_barrier
ds_read_b128 v[8:11], v185 offset:20480
ds_read_b128 v[12:15], v185 offset:21504
v_mfma_f32_16x16x32_bf16 v[24:27], v[224:227], v[172:175], v[24:27]
ds_read_b128 v[16:19], v185 offset:22528
v_mfma_f32_16x16x32_bf16 v[28:31], v[228:231], v[172:175], v[28:31]
ds_read_b128 v[20:23], v185 offset:23552
v_mfma_f32_16x16x32_bf16 v[32:35], v[232:235], v[172:175], v[32:35]
ds_read_b128 v[156:159], v185 offset:24576
v_mfma_f32_16x16x32_bf16 v[36:39], v[236:239], v[172:175], v[36:39]
ds_read_b128 v[160:163], v185 offset:25600
v_mfma_f32_16x16x32_bf16 v[24:27], v[240:243], v[176:179], v[24:27]
ds_read_b128 v[164:167], v185 offset:26624
v_mfma_f32_16x16x32_bf16 v[28:31], v[244:247], v[176:179], v[28:31]
ds_read_b128 v[168:171], v185 offset:27648
v_mfma_f32_16x16x32_bf16 v[32:35], v[248:251], v[176:179], v[32:35]
ds_read_b128 v[172:175], v185 offset:28672
v_mfma_f32_16x16x32_bf16 v[36:39], v[252:255], v[176:179], v[36:39]
ds_read_b128 v[176:179], v185 offset:29696
s_cmp_gt_i32 s25, 0
s_cbranch_scc1 Lg1_late0
Lg1_ret0:
s_sub_u32 s34, s34, 1
s_cmp_eq_u32 s34, 0
s_cbranch_scc1 Lg1_tail0
s_waitcnt lgkmcnt(6)
v_mfma_f32_16x16x32_bf16 v[40:43], a[0:3], v[8:11], 0
buffer_load_dwordx3 v[100:102], v3, s[4:7], s42 offen sc1
v_fma_f32 v120, v88, v72, v24
v_fma_f32 v128, v88, v80, v32
v_fma_f32 v121, v88, v73, v25
v_mfma_f32_16x16x32_bf16 v[44:47], a[4:7], v[8:11], 0
buffer_load_dwordx3 v[104:106], v182, s[4:7], s42 offen sc1
v_fma_f32 v129, v88, v81, v33
v_fma_f32 v122, v88, v74, v26
v_fma_f32 v130, v88, v82, v34
v_mfma_f32_16x16x32_bf16 v[48:51], a[8:11], v[8:11], 0
v_fma_f32 v123, v88, v75, v27
v_fma_f32 v131, v88, v83, v35
v_fma_f32 v124, v88, v76, v28
v_fma_f32 v132, v88, v84, v36
v_fma_f32 v125, v88, v77, v29
v_mfma_f32_16x16x32_bf16 v[52:55], a[12:15], v[8:11], 0
ds_read_b128 v[8:11], v185 offset:30720
v_fma_f32 v133, v88, v85, v37
v_mfma_f32_16x16x32_bf16 v[40:43], a[16:19], v[12:15], v[40:43]
s_waitcnt vmcnt(7)
buffer_store_dword v181, v5, s[4:7], s33 offen sc1
v_fma_f32 v126, v88, v78, v30
v_fma_f32 v134, v88, v86, v38
v_mfma_f32_16x16x32_bf16 v[44:47], a[20:23], v[12:15], v[44:47]
v_fma_f32 v127, v88, v79, v31
v_fma_f32 v135, v88, v87, v39
v_mul_f32 v136, v120, v89
v_mul_f32 v137, v121, v89
v_mul_f32 v138, v122, v89
v_mfma_f32_16x16x32_bf16 v[48:51], a[24:27], v[12:15], v[48:51]
v_mul_f32 v139, v123, v89
v_mul_f32 v140, v124, v89
v_mul_f32 v141, v125, v89
v_mul_f32 v142, v126, v89
v_mul_f32 v143, v127, v89
v_mfma_f32_16x16x32_bf16 v[52:55], a[28:31], v[12:15], v[52:55]
ds_read_b128 v[12:15], v185 offset:31744
v_exp_f32 v136, v136
v_mfma_f32_16x16x32_bf16 v[40:43], a[32:35], v[16:19], v[40:43]
v_exp_f32 v137, v137
v_mfma_f32_16x16x32_bf16 v[44:47], a[36:39], v[16:19], v[44:47]
v_exp_f32 v138, v138
v_mfma_f32_16x16x32_bf16 v[48:51], a[40:43], v[16:19], v[48:51]
v_exp_f32 v139, v139
v_mfma_f32_16x16x32_bf16 v[52:55], a[44:47], v[16:19], v[52:55]
ds_read_b128 v[16:19], v185 offset:32768
v_exp_f32 v140, v140
v_mfma_f32_16x16x32_bf16 v[40:43], a[48:51], v[20:23], v[40:43]
v_exp_f32 v141, v141
v_mfma_f32_16x16x32_bf16 v[44:47], a[52:55], v[20:23], v[44:47]
v_exp_f32 v142, v142
v_mfma_f32_16x16x32_bf16 v[48:51], a[56:59], v[20:23], v[48:51]
v_exp_f32 v143, v143
v_mfma_f32_16x16x32_bf16 v[52:55], a[60:63], v[20:23], v[52:55]
ds_read_b128 v[20:23], v185 offset:33792
v_mul_f32 v120, v120, v128
v_mul_f32 v121, v121, v129
v_mul_f32 v122, v122, v130
s_waitcnt lgkmcnt(6)
v_mfma_f32_16x16x32_bf16 v[40:43], a[64:67], v[156:159], v[40:43]
v_mul_f32 v123, v123, v131
v_mul_f32 v124, v124, v132
v_mul_f32 v125, v125, v133
v_mul_f32 v126, v126, v134
v_mul_f32 v127, v127, v135
v_mfma_f32_16x16x32_bf16 v[44:47], a[68:71], v[156:159], v[44:47]
v_fma_f32 v136, v136, v90, v90
v_fma_f32 v137, v137, v90, v90
v_fma_f32 v138, v138, v90, v90
v_fma_f32 v139, v139, v90, v90
v_fma_f32 v140, v140, v90, v90
v_mfma_f32_16x16x32_bf16 v[48:51], a[72:75], v[156:159], v[48:51]
v_fma_f32 v141, v141, v90, v90
v_fma_f32 v142, v142, v90, v90
v_fma_f32 v143, v143, v90, v90
v_mfma_f32_16x16x32_bf16 v[52:55], a[76:79], v[156:159], v[52:55]
ds_read_b128 v[156:159], v185 offset:34816
v_rcp_f32 v136, v136
v_mfma_f32_16x16x32_bf16 v[40:43], a[80:83], v[160:163], v[40:43]
v_rcp_f32 v137, v137
v_mfma_f32_16x16x32_bf16 v[44:47], a[84:87], v[160:163], v[44:47]
v_rcp_f32 v138, v138
v_mfma_f32_16x16x32_bf16 v[48:51], a[88:91], v[160:163], v[48:51]
v_rcp_f32 v139, v139
v_mfma_f32_16x16x32_bf16 v[52:55], a[92:95], v[160:163], v[52:55]
ds_read_b128 v[160:163], v185 offset:35840
v_rcp_f32 v140, v140
v_mfma_f32_16x16x32_bf16 v[40:43], a[96:99], v[164:167], v[40:43]
v_rcp_f32 v141, v141
v_mfma_f32_16x16x32_bf16 v[44:47], a[100:103], v[164:167], v[44:47]
v_rcp_f32 v142, v142
v_mfma_f32_16x16x32_bf16 v[48:51], a[104:107], v[164:167], v[48:51]
v_rcp_f32 v143, v143
v_mfma_f32_16x16x32_bf16 v[52:55], a[108:111], v[164:167], v[52:55]
ds_read_b128 v[164:167], v185 offset:36864
v_mul_f32 v120, v120, v136
v_mfma_f32_16x16x32_bf16 v[40:43], a[112:115], v[168:171], v[40:43]
v_mul_f32 v121, v121, v137
v_mul_f32 v122, v122, v138
v_mfma_f32_16x16x32_bf16 v[44:47], a[116:119], v[168:171], v[44:47]
v_mul_f32 v123, v123, v139
v_mul_f32 v124, v124, v140
v_mfma_f32_16x16x32_bf16 v[48:51], a[120:123], v[168:171], v[48:51]
v_mul_f32 v125, v125, v141
v_mul_f32 v126, v126, v142
v_mfma_f32_16x16x32_bf16 v[52:55], a[124:127], v[168:171], v[52:55]
ds_read_b128 v[168:171], v185 offset:37888
s_waitcnt lgkmcnt(6)
v_mfma_f32_16x16x32_bf16 v[40:43], a[128:131], v[172:175], v[40:43]
v_mul_f32 v127, v127, v143
v_cvt_pk_bf16_f32 v152, v120, v121
v_mfma_f32_16x16x32_bf16 v[44:47], a[132:135], v[172:175], v[44:47]
v_cvt_pk_bf16_f32 v153, v122, v123
v_cvt_pk_bf16_f32 v154, v124, v125
v_mfma_f32_16x16x32_bf16 v[48:51], a[136:139], v[172:175], v[48:51]
v_cvt_pk_bf16_f32 v155, v126, v127
v_mfma_f32_16x16x32_bf16 v[52:55], a[140:143], v[172:175], v[52:55]
ds_read_b128 v[172:175], v185 offset:38912
v_mfma_f32_16x16x32_bf16 v[40:43], a[144:147], v[176:179], v[40:43]
buffer_store_dwordx4 v[152:155], v4, s[4:7], s45 offen sc1
v_mfma_f32_16x16x32_bf16 v[44:47], a[148:151], v[176:179], v[44:47]
s_mov_b32 s45, s46
s_add_u32 s46, s46, 663552
s_mov_b32 s33, s32
v_mfma_f32_16x16x32_bf16 v[48:51], a[152:155], v[176:179], v[48:51]
s_mov_b32 s32, s47
s_add_u32 s47, s47, 12288
ds_read_b64 v[108:109], v184 offset:512
v_mfma_f32_16x16x32_bf16 v[52:55], a[156:159], v[176:179], v[52:55]
ds_read_b128 v[176:179], v185 offset:39936
s_waitcnt lgkmcnt(1)
v_permlane32_swap_b32 v108, v109
v_mfma_f32_16x16x32_bf16 v[40:43], a[160:163], v[8:11], v[40:43]
v_add_f32 v108, v108, v109
v_mov_b32 v7, v108
v_mfma_f32_16x16x32_bf16 v[44:47], a[164:167], v[8:11], v[44:47]
v_permlane16_swap_b32 v108, v7
v_mfma_f32_16x16x32_bf16 v[48:51], a[168:171], v[8:11], v[48:51]
v_add_f32 v108, v108, v7
v_mov_b32 v109, v108
v_mfma_f32_16x16x32_bf16 v[52:55], a[172:175], v[8:11], v[52:55]
v_permlane32_swap_b32 v108, v109
v_mfma_f32_16x16x32_bf16 v[40:43], a[176:179], v[12:15], v[40:43]
v_mul_f32 v110, 0x3acccccd, v108
v_mul_f32 v111, 0x3acccccd, v109
v_mfma_f32_16x16x32_bf16 v[44:47], a[180:183], v[12:15], v[44:47]
v_fma_f32 v111, -v110, v110, v111
v_add_f32 v94, 0x3727c5ac, v111
v_mfma_f32_16x16x32_bf16 v[48:51], a[184:187], v[12:15], v[48:51]
v_rsq_f32 v112, v94
v_mfma_f32_16x16x32_bf16 v[52:55], a[188:191], v[12:15], v[52:55]
v_sub_f32 v92, 0, v110
v_mfma_f32_16x16x32_bf16 v[40:43], a[192:195], v[16:19], v[40:43]
v_mul_f32 v93, 0xbfb8aa3b, v112
s_waitcnt vmcnt(2)
v_mfma_f32_16x16x32_bf16 v[44:47], a[196:199], v[16:19], v[44:47]
v_cmp_ne_u32 vcc, s20, v102
v_cmp_ne_u32 s[28:29], s20, v106
v_mfma_f32_16x16x32_bf16 v[48:51], a[200:203], v[16:19], v[48:51]
s_or_b64 vcc, vcc, s[28:29]
s_cmp_eq_u64 vcc, 0
s_cselect_b32 s10, 0x10000000, 0
s_cselect_b32 s25, 0, s44
s_cmp_gt_i32 s44, 0
s_cselect_b32 s10, s10, 0
v_mfma_f32_16x16x32_bf16 v[52:55], a[204:207], v[16:19], v[52:55]
v_fmac_f32 v100, 0x3e800000, v104
v_fmac_f32 v101, 0x3e800000, v105
v_mfma_f32_16x16x32_bf16 v[40:43], a[208:211], v[20:23], v[40:43]
v_permlane32_swap_b32 v100, v101
v_mfma_f32_16x16x32_bf16 v[44:47], a[212:215], v[20:23], v[44:47]
v_add_f32 v100, v100, v101
v_mov_b32 v6, v100
v_mfma_f32_16x16x32_bf16 v[48:51], a[216:219], v[20:23], v[48:51]
v_permlane16_swap_b32 v100, v6
v_mfma_f32_16x16x32_bf16 v[52:55], a[220:223], v[20:23], v[52:55]
v_add_f32 v100, v100, v6
v_mfma_f32_16x16x32_bf16 v[40:43], a[224:227], v[156:159], v[40:43]
ds_write_b32 v183, v100 offset:0
s_add_u32 m0, s31, 98304
s_add_u32 s35, s43, 4096
buffer_load_dwordx4 v2, s[8:11], s43 offen offset:0 sc1 lds
v_mfma_f32_16x16x32_bf16 v[44:47], a[228:231], v[156:159], v[44:47]
buffer_load_dwordx4 v2, s[8:11], s43 offen offset:1024 sc1 lds
v_mfma_f32_16x16x32_bf16 v[48:51], a[232:235], v[156:159], v[48:51]
buffer_load_dwordx4 v2, s[8:11], s43 offen offset:2048 sc1 lds
v_mfma_f32_16x16x32_bf16 v[52:55], a[236:239], v[156:159], v[52:55]
buffer_load_dwordx4 v2, s[8:11], s43 offen offset:3072 sc1 lds
v_mfma_f32_16x16x32_bf16 v[40:43], a[240:243], v[160:163], v[40:43]
s_add_u32 m0, s31, 102400
s_nop 0
buffer_load_dwordx4 v2, s[8:11], s35 offen sc1 lds
v_mfma_f32_16x16x32_bf16 v[44:47], a[244:247], v[160:163], v[44:47]
s_add_u32 s42, s42, 61440
s_add_u32 s43, s43, 245760
s_sub_u32 s44, s44, 1
v_mfma_f32_16x16x32_bf16 v[48:51], a[248:251], v[160:163], v[48:51]
v_mfma_f32_16x16x32_bf16 v[52:55], a[252:255], v[160:163], v[52:55]
s_waitcnt lgkmcnt(1)
v_mfma_f32_16x16x32_bf16 v[40:43], v[192:195], v[164:167], v[40:43]
v_mfma_f32_16x16x32_bf16 v[44:47], v[196:199], v[164:167], v[44:47]
v_mfma_f32_16x16x32_bf16 v[48:51], v[200:203], v[164:167], v[48:51]
v_mfma_f32_16x16x32_bf16 v[52:55], v[204:207], v[164:167], v[52:55]
v_mfma_f32_16x16x32_bf16 v[40:43], v[208:211], v[168:171], v[40:43]
v_mfma_f32_16x16x32_bf16 v[44:47], v[212:215], v[168:171], v[44:47]
v_mfma_f32_16x16x32_bf16 v[48:51], v[216:219], v[168:171], v[48:51]
v_mfma_f32_16x16x32_bf16 v[52:55], v[220:223], v[168:171], v[52:55]
s_waitcnt vmcnt(9)
s_barrier
ds_read_b128 v[8:11], v185 offset:40960
ds_read_b128 v[12:15], v185 offset:41984
v_mfma_f32_16x16x32_bf16 v[40:43], v[224:227], v[172:175], v[40:43]
ds_read_b128 v[16:19], v185 offset:43008
v_mfma_f32_16x16x32_bf16 v[44:47], v[228:231], v[172:175], v[44:47]
ds_read_b128 v[20:23], v185 offset:44032
v_mfma_f32_16x16x32_bf16 v[48:51], v[232:235], v[172:175], v[48:51]
ds_read_b128 v[156:159], v185 offset:45056
v_mfma_f32_16x16x32_bf16 v[52:55], v[236:239], v[172:175], v[52:55]
ds_read_b128 v[160:163], v185 offset:46080
v_mfma_f32_16x16x32_bf16 v[40:43], v[240:243], v[176:179], v[40:43]
ds_read_b128 v[164:167], v185 offset:47104
v_mfma_f32_16x16x32_bf16 v[44:47], v[244:247], v[176:179], v[44:47]
ds_read_b128 v[168:171], v185 offset:48128
v_mfma_f32_16x16x32_bf16 v[48:51], v[248:251], v[176:179], v[48:51]
ds_read_b128 v[172:175], v185 offset:49152
v_mfma_f32_16x16x32_bf16 v[52:55], v[252:255], v[176:179], v[52:55]
ds_read_b128 v[176:179], v185 offset:50176
s_cmp_gt_i32 s25, 0
s_cbranch_scc1 Lg1_late1
Lg1_ret1:
s_sub_u32 s34, s34, 1
s_cmp_eq_u32 s34, 0
s_cbranch_scc1 Lg1_tail1
s_waitcnt lgkmcnt(6)
v_mfma_f32_16x16x32_bf16 v[56:59], a[0:3], v[8:11], 0
buffer_load_dwordx3 v[100:102], v3, s[4:7], s42 offen sc1
v_fma_f32 v120, v92, v72, v40
v_fma_f32 v128, v92, v80, v48
v_fma_f32 v121, v92, v73, v41
v_mfma_f32_16x16x32_bf16 v[60:63], a[4:7], v[8:11], 0
buffer_load_dwordx3 v[104:106], v182, s[4:7], s42 offen sc1
v_fma_f32 v129, v92, v81, v49
v_fma_f32 v122, v92, v74, v42
v_fma_f32 v130, v92, v82, v50
v_mfma_f32_16x16x32_bf16 v[64:67], a[8:11], v[8:11], 0
v_fma_f32 v123, v92, v75, v43
v_fma_f32 v131, v92, v83, v51
v_fma_f32 v124, v92, v76, v44
v_fma_f32 v132, v92, v84, v52
v_fma_f32 v125, v92, v77, v45
v_mfma_f32_16x16x32_bf16 v[68:71], a[12:15], v[8:11], 0
ds_read_b128 v[8:11], v185 offset:51200
v_fma_f32 v133, v92, v85, v53
v_mfma_f32_16x16x32_bf16 v[56:59], a[16:19], v[12:15], v[56:59]
s_waitcnt vmcnt(7)
buffer_store_dword v181, v5, s[4:7], s33 offen sc1
v_fma_f32 v126, v92, v78, v46
v_fma_f32 v134, v92, v86, v54
v_mfma_f32_16x16x32_bf16 v[60:63], a[20:23], v[12:15], v[60:63]
v_fma_f32 v127, v92, v79, v47
v_fma_f32 v135, v92, v87, v55
v_mul_f32 v136, v120, v93
v_mul_f32 v137, v121, v93
v_mul_f32 v138, v122, v93
v_mfma_f32_16x16x32_bf16 v[64:67], a[24:27], v[12:15], v[64:67]
v_mul_f32 v139, v123, v93
v_mul_f32 v140, v124, v93
v_mul_f32 v141, v125, v93
v_mul_f32 v142, v126, v93
v_mul_f32 v143, v127, v93
v_mfma_f32_16x16x32_bf16 v[68:71], a[28:31], v[12:15], v[68:71]
ds_read_b128 v[12:15], v185 offset:52224
v_exp_f32 v136, v136
v_mfma_f32_16x16x32_bf16 v[56:59], a[32:35], v[16:19], v[56:59]
v_exp_f32 v137, v137
v_mfma_f32_16x16x32_bf16 v[60:63], a[36:39], v[16:19], v[60:63]
v_exp_f32 v138, v138
v_mfma_f32_16x16x32_bf16 v[64:67], a[40:43], v[16:19], v[64:67]
v_exp_f32 v139, v139
v_mfma_f32_16x16x32_bf16 v[68:71], a[44:47], v[16:19], v[68:71]
ds_read_b128 v[16:19], v185 offset:53248
v_exp_f32 v140, v140
v_mfma_f32_16x16x32_bf16 v[56:59], a[48:51], v[20:23], v[56:59]
v_exp_f32 v141, v141
v_mfma_f32_16x16x32_bf16 v[60:63], a[52:55], v[20:23], v[60:63]
v_exp_f32 v142, v142
v_mfma_f32_16x16x32_bf16 v[64:67], a[56:59], v[20:23], v[64:67]
v_exp_f32 v143, v143
v_mfma_f32_16x16x32_bf16 v[68:71], a[60:63], v[20:23], v[68:71]
ds_read_b128 v[20:23], v185 offset:54272
v_mul_f32 v120, v120, v128
v_mul_f32 v121, v121, v129
v_mul_f32 v122, v122, v130
s_waitcnt lgkmcnt(6)
v_mfma_f32_16x16x32_bf16 v[56:59], a[64:67], v[156:159], v[56:59]
v_mul_f32 v123, v123, v131
v_mul_f32 v124, v124, v132
v_mul_f32 v125, v125, v133
v_mul_f32 v126, v126, v134
v_mul_f32 v127, v127, v135
v_mfma_f32_16x16x32_bf16 v[60:63], a[68:71], v[156:159], v[60:63]
v_fma_f32 v136, v136, v94, v94
v_fma_f32 v137, v137, v94, v94
v_fma_f32 v138, v138, v94, v94
v_fma_f32 v139, v139, v94, v94
v_fma_f32 v140, v140, v94, v94
v_mfma_f32_16x16x32_bf16 v[64:67], a[72:75], v[156:159], v[64:67]
v_fma_f32 v141, v141, v94, v94
v_fma_f32 v142, v142, v94, v94
v_fma_f32 v143, v143, v94, v94
v_mfma_f32_16x16x32_bf16 v[68:71], a[76:79], v[156:159], v[68:71]
ds_read_b128 v[156:159], v185 offset:55296
v_rcp_f32 v136, v136
v_mfma_f32_16x16x32_bf16 v[56:59], a[80:83], v[160:163], v[56:59]
v_rcp_f32 v137, v137
v_mfma_f32_16x16x32_bf16 v[60:63], a[84:87], v[160:163], v[60:63]
v_rcp_f32 v138, v138
v_mfma_f32_16x16x32_bf16 v[64:67], a[88:91], v[160:163], v[64:67]
v_rcp_f32 v139, v139
v_mfma_f32_16x16x32_bf16 v[68:71], a[92:95], v[160:163], v[68:71]
ds_read_b128 v[160:163], v185 offset:56320
v_rcp_f32 v140, v140
v_mfma_f32_16x16x32_bf16 v[56:59], a[96:99], v[164:167], v[56:59]
v_rcp_f32 v141, v141
v_mfma_f32_16x16x32_bf16 v[60:63], a[100:103], v[164:167], v[60:63]
v_rcp_f32 v142, v142
v_mfma_f32_16x16x32_bf16 v[64:67], a[104:107], v[164:167], v[64:67]
v_rcp_f32 v143, v143
v_mfma_f32_16x16x32_bf16 v[68:71], a[108:111], v[164:167], v[68:71]
ds_read_b128 v[164:167], v185 offset:57344
v_mul_f32 v120, v120, v136
v_mfma_f32_16x16x32_bf16 v[56:59], a[112:115], v[168:171], v[56:59]
v_mul_f32 v121, v121, v137
v_mul_f32 v122, v122, v138
v_mfma_f32_16x16x32_bf16 v[60:63], a[116:119], v[168:171], v[60:63]
v_mul_f32 v123, v123, v139
v_mul_f32 v124, v124, v140
v_mfma_f32_16x16x32_bf16 v[64:67], a[120:123], v[168:171], v[64:67]
v_mul_f32 v125, v125, v141
v_mul_f32 v126, v126, v142
v_mfma_f32_16x16x32_bf16 v[68:71], a[124:127], v[168:171], v[68:71]
ds_read_b128 v[168:171], v185 offset:58368
s_waitcnt lgkmcnt(6)
v_mfma_f32_16x16x32_bf16 v[56:59], a[128:131], v[172:175], v[56:59]
v_mul_f32 v127, v127, v143
v_cvt_pk_bf16_f32 v152, v120, v121
v_mfma_f32_16x16x32_bf16 v[60:63], a[132:135], v[172:175], v[60:63]
v_cvt_pk_bf16_f32 v153, v122, v123
v_cvt_pk_bf16_f32 v154, v124, v125
v_mfma_f32_16x16x32_bf16 v[64:67], a[136:139], v[172:175], v[64:67]
v_cvt_pk_bf16_f32 v155, v126, v127
v_mfma_f32_16x16x32_bf16 v[68:71], a[140:143], v[172:175], v[68:71]
ds_read_b128 v[172:175], v185 offset:59392
v_mfma_f32_16x16x32_bf16 v[56:59], a[144:147], v[176:179], v[56:59]
buffer_store_dwordx4 v[152:155], v4, s[4:7], s45 offen sc1
v_mfma_f32_16x16x32_bf16 v[60:63], a[148:151], v[176:179], v[60:63]
s_mov_b32 s45, s46
s_add_u32 s46, s46, 663552
s_mov_b32 s33, s32
v_mfma_f32_16x16x32_bf16 v[64:67], a[152:155], v[176:179], v[64:67]
s_mov_b32 s32, s47
s_add_u32 s47, s47, 12288
ds_read_b64 v[108:109], v184 offset:1024
v_mfma_f32_16x16x32_bf16 v[68:71], a[156:159], v[176:179], v[68:71]
ds_read_b128 v[176:179], v185 offset:60416
s_waitcnt lgkmcnt(1)
v_permlane32_swap_b32 v108, v109
v_mfma_f32_16x16x32_bf16 v[56:59], a[160:163], v[8:11], v[56:59]
v_add_f32 v108, v108, v109
v_mov_b32 v7, v108
v_mfma_f32_16x16x32_bf16 v[60:63], a[164:167], v[8:11], v[60:63]
v_permlane16_swap_b32 v108, v7
v_mfma_f32_16x16x32_bf16 v[64:67], a[168:171], v[8:11], v[64:67]
v_add_f32 v108, v108, v7
v_mov_b32 v109, v108
v_mfma_f32_16x16x32_bf16 v[68:71], a[172:175], v[8:11], v[68:71]
v_permlane32_swap_b32 v108, v109
v_mfma_f32_16x16x32_bf16 v[56:59], a[176:179], v[12:15], v[56:59]
v_mul_f32 v110, 0x3acccccd, v108
v_mul_f32 v111, 0x3acccccd, v109
v_mfma_f32_16x16x32_bf16 v[60:63], a[180:183], v[12:15], v[60:63]
v_fma_f32 v111, -v110, v110, v111
v_add_f32 v98, 0x3727c5ac, v111
v_mfma_f32_16x16x32_bf16 v[64:67], a[184:187], v[12:15], v[64:67]
v_rsq_f32 v112, v98
v_mfma_f32_16x16x32_bf16 v[68:71], a[188:191], v[12:15], v[68:71]
v_sub_f32 v96, 0, v110
v_mfma_f32_16x16x32_bf16 v[56:59], a[192:195], v[16:19], v[56:59]
v_mul_f32 v97, 0xbfb8aa3b, v112
s_waitcnt vmcnt(2)
v_mfma_f32_16x16x32_bf16 v[60:63], a[196:199], v[16:19], v[60:63]
v_cmp_ne_u32 vcc, s20, v102
v_cmp_ne_u32 s[28:29], s20, v106
v_mfma_f32_16x16x32_bf16 v[64:67], a[200:203], v[16:19], v[64:67]
s_or_b64 vcc, vcc, s[28:29]
s_cmp_eq_u64 vcc, 0
s_cselect_b32 s10, 0x10000000, 0
s_cselect_b32 s25, 0, s44
s_cmp_gt_i32 s44, 0
s_cselect_b32 s10, s10, 0
v_mfma_f32_16x16x32_bf16 v[68:71], a[204:207], v[16:19], v[68:71]
v_fmac_f32 v100, 0x3e800000, v104
v_fmac_f32 v101, 0x3e800000, v105
v_mfma_f32_16x16x32_bf16 v[56:59], a[208:211], v[20:23], v[56:59]
v_permlane32_swap_b32 v100, v101
v_mfma_f32_16x16x32_bf16 v[60:63], a[212:215], v[20:23], v[60:63]
v_add_f32 v100, v100, v101
v_mov_b32 v6, v100
v_mfma_f32_16x16x32_bf16 v[64:67], a[216:219], v[20:23], v[64:67]
v_permlane16_swap_b32 v100, v6
v_mfma_f32_16x16x32_bf16 v[68:71], a[220:223], v[20:23], v[68:71]
v_add_f32 v100, v100, v6
v_mfma_f32_16x16x32_bf16 v[56:59], a[224:227], v[156:159], v[56:59]
ds_write_b32 v183, v100 offset:512
s_add_u32 m0, s31, 118784
s_add_u32 s35, s43, 4096
buffer_load_dwordx4 v2, s[8:11], s43 offen offset:0 sc1 lds
v_mfma_f32_16x16x32_bf16 v[60:63], a[228:231], v[156:159], v[60:63]
buffer_load_dwordx4 v2, s[8:11], s43 offen offset:1024 sc1 lds
v_mfma_f32_16x16x32_bf16 v[64:67], a[232:235], v[156:159], v[64:67]
buffer_load_dwordx4 v2, s[8:11], s43 offen offset:2048 sc1 lds
v_mfma_f32_16x16x32_bf16 v[68:71], a[236:239], v[156:159], v[68:71]
buffer_load_dwordx4 v2, s[8:11], s43 offen offset:3072 sc1 lds
v_mfma_f32_16x16x32_bf16 v[56:59], a[240:243], v[160:163], v[56:59]
s_add_u32 m0, s31, 122880
s_nop 0
buffer_load_dwordx4 v2, s[8:11], s35 offen sc1 lds
v_mfma_f32_16x16x32_bf16 v[60:63], a[244:247], v[160:163], v[60:63]
s_add_u32 s42, s42, 61440
s_add_u32 s43, s43, 245760
s_sub_u32 s44, s44, 1
v_mfma_f32_16x16x32_bf16 v[64:67], a[248:251], v[160:163], v[64:67]
v_mfma_f32_16x16x32_bf16 v[68:71], a[252:255], v[160:163], v[68:71]
s_waitcnt lgkmcnt(1)
v_mfma_f32_16x16x32_bf16 v[56:59], v[192:195], v[164:167], v[56:59]
v_mfma_f32_16x16x32_bf16 v[60:63], v[196:199], v[164:167], v[60:63]
v_mfma_f32_16x16x32_bf16 v[64:67], v[200:203], v[164:167], v[64:67]
v_mfma_f32_16x16x32_bf16 v[68:71], v[204:207], v[164:167], v[68:71]
v_mfma_f32_16x16x32_bf16 v[56:59], v[208:211], v[168:171], v[56:59]
v_mfma_f32_16x16x32_bf16 v[60:63], v[212:215], v[168:171], v[60:63]
v_mfma_f32_16x16x32_bf16 v[64:67], v[216:219], v[168:171], v[64:67]
v_mfma_f32_16x16x32_bf16 v[68:71], v[220:223], v[168:171], v[68:71]
s_waitcnt vmcnt(9)
s_barrier
ds_read_b128 v[8:11], v185 offset:0
ds_read_b128 v[12:15], v185 offset:1024
v_mfma_f32_16x16x32_bf16 v[56:59], v[224:227], v[172:175], v[56:59]
ds_read_b128 v[16:19], v185 offset:2048
v_mfma_f32_16x16x32_bf16 v[60:63], v[228:231], v[172:175], v[60:63]
ds_read_b128 v[20:23], v185 offset:3072
v_mfma_f32_16x16x32_bf16 v[64:67], v[232:235], v[172:175], v[64:67]
ds_read_b128 v[156:159], v185 offset:4096
v_mfma_f32_16x16x32_bf16 v[68:71], v[236:239], v[172:175], v[68:71]
ds_read_b128 v[160:163], v185 offset:5120
v_mfma_f32_16x16x32_bf16 v[56:59], v[240:243], v[176:179], v[56:59]
ds_read_b128 v[164:167], v185 offset:6144
v_mfma_f32_16x16x32_bf16 v[60:63], v[244:247], v[176:179], v[60:63]
ds_read_b128 v[168:171], v185 offset:7168
v_mfma_f32_16x16x32_bf16 v[64:67], v[248:251], v[176:179], v[64:67]
ds_read_b128 v[172:175], v185 offset:8192
v_mfma_f32_16x16x32_bf16 v[68:71], v[252:255], v[176:179], v[68:71]
ds_read_b128 v[176:179], v185 offset:9216
s_cmp_gt_i32 s25, 0
s_cbranch_scc1 Lg1_late2
Lg1_ret2:
s_sub_u32 s34, s34, 1
s_cmp_eq_u32 s34, 0
s_cbranch_scc1 Lg1_tail2
s_branch Lg1_loop
Lg1_late0:
s_waitcnt vmcnt(0)
buffer_store_dword v181, v5, s[4:7], s33 offen sc1
s_sub_u32 s30, s42, 61440
s_sub_u32 s27, s43, 245760
s_mov_b32 s90, 40000
Lpg_14:
buffer_load_dwordx3 v[100:102], v3, s[4:7], s30 offen sc1
buffer_load_dwordx3 v[104:106], v182, s[4:7], s30 offen sc1
s_waitcnt vmcnt(0)
v_cmp_ne_u32 vcc, s20, v102
v_cmp_ne_u32 s[28:29], s20, v106
s_nop 0
s_or_b64 vcc, vcc, s[28:29]
s_cmp_eq_u64 vcc, 0
s_cbranch_scc1 Lpgok_15
s_sub_u32 s90, s90, 1
s_cmp_lg_u32 s90, 0
s_cbranch_scc1 Lpg_14
s_mov_b32 s8, s86
s_mov_b32 s9, s87
s_mov_b32 s10, 0x100
s_mov_b32 s11, 0x20000
v_mov_b32 v2, 0x5
v_mov_b32 v3, 0x14
s_nop 1
buffer_store_dword v2, v3, s[8:11], 0 offen
s_waitcnt vmcnt(0)
s_endpgm
Lpgok_15:
s_waitcnt vmcnt(0)
v_fmac_f32 v100, 0x3e800000, v104
v_fmac_f32 v101, 0x3e800000, v105
s_nop 1
v_permlane32_swap_b32 v100, v101
v_add_f32 v100, v100, v101
v_mov_b32 v6, v100
s_nop 1
v_permlane16_swap_b32 v100, v6
v_add_f32 v100, v100, v6
ds_write_b32 v183, v100 offset:1024
s_add_u32 m0, s31, 139264
s_add_u32 s35, s27, 4096
buffer_load_dwordx4 v2, s[4:7], s27 offen offset:0 sc1 lds
buffer_load_dwordx4 v2, s[4:7], s27 offen offset:1024 sc1 lds
buffer_load_dwordx4 v2, s[4:7], s27 offen offset:2048 sc1 lds
buffer_load_dwordx4 v2, s[4:7], s27 offen offset:3072 sc1 lds
s_add_u32 m0, s31, 143360
s_nop 0
buffer_load_dwordx4 v2, s[4:7], s35 offen sc1 lds
s_branch Lg1_ret0
Lg1_late1:
s_waitcnt vmcnt(0)
buffer_store_dword v181, v5, s[4:7], s33 offen sc1
s_sub_u32 s30, s42, 61440
s_sub_u32 s27, s43, 245760
s_mov_b32 s90, 40000
Lpg_16:
buffer_load_dwordx3 v[100:102], v3, s[4:7], s30 offen sc1
buffer_load_dwordx3 v[104:106], v182, s[4:7], s30 offen sc1
s_waitcnt vmcnt(0)
v_cmp_ne_u32 vcc, s20, v102
v_cmp_ne_u32 s[28:29], s20, v106
s_nop 0
s_or_b64 vcc, vcc, s[28:29]
s_cmp_eq_u64 vcc, 0
s_cbranch_scc1 Lpgok_17
s_sub_u32 s90, s90, 1
s_cmp_lg_u32 s90, 0
s_cbranch_scc1 Lpg_16
s_mov_b32 s8, s86
s_mov_b32 s9, s87
s_mov_b32 s10, 0x100
s_mov_b32 s11, 0x20000
v_mov_b32 v2, 0x5
v_mov_b32 v3, 0x14
s_nop 1
buffer_store_dword v2, v3, s[8:11], 0 offen
s_waitcnt vmcnt(0)
s_endpgm
Lpgok_17:
s_waitcnt vmcnt(0)
v_fmac_f32 v100, 0x3e800000, v104
v_fmac_f32 v101, 0x3e800000, v105
s_nop 1
v_permlane32_swap_b32 v100, v101
v_add_f32 v100, v100, v101
v_mov_b32 v6, v100
s_nop 1
v_permlane16_swap_b32 v100, v6
v_add_f32 v100, v100, v6
ds_write_b32 v183, v100 offset:0
s_add_u32 m0, s31, 98304
s_add_u32 s35, s27, 4096
buffer_load_dwordx4 v2, s[4:7], s27 offen offset:0 sc1 lds
buffer_load_dwordx4 v2, s[4:7], s27 offen offset:1024 sc1 lds
buffer_load_dwordx4 v2, s[4:7], s27 offen offset:2048 sc1 lds
buffer_load_dwordx4 v2, s[4:7], s27 offen offset:3072 sc1 lds
s_add_u32 m0, s31, 102400
s_nop 0
buffer_load_dwordx4 v2, s[4:7], s35 offen sc1 lds
s_branch Lg1_ret1
Lg1_late2:
s_waitcnt vmcnt(0)
buffer_store_dword v181, v5, s[4:7], s33 offen sc1
s_sub_u32 s30, s42, 61440
s_sub_u32 s27, s43, 245760
s_mov_b32 s90, 40000
Lpg_18:
buffer_load_dwordx3 v[100:102], v3, s[4:7], s30 offen sc1
buffer_load_dwordx3 v[104:106], v182, s[4:7], s30 offen sc1
s_waitcnt vmcnt(0)
v_cmp_ne_u32 vcc, s20, v102
v_cmp_ne_u32 s[28:29], s20, v106
s_nop 0
s_or_b64 vcc, vcc, s[28:29]
s_cmp_eq_u64 vcc, 0
s_cbranch_scc1 Lpgok_19
s_sub_u32 s90, s90, 1
s_cmp_lg_u32 s90, 0
s_cbranch_scc1 Lpg_18
s_mov_b32 s8, s86
s_mov_b32 s9, s87
s_mov_b32 s10, 0x100
s_mov_b32 s11, 0x20000
v_mov_b32 v2, 0x5
v_mov_b32 v3, 0x14
s_nop 1
buffer_store_dword v2, v3, s[8:11], 0 offen
s_waitcnt vmcnt(0)
s_endpgm
Lpgok_19:
s_waitcnt vmcnt(0)
v_fmac_f32 v100, 0x3e800000, v104
v_fmac_f32 v101, 0x3e800000, v105
s_nop 1
v_permlane32_swap_b32 v100, v101
v_add_f32 v100, v100, v101
v_mov_b32 v6, v100
s_nop 1
v_permlane16_swap_b32 v100, v6
v_add_f32 v100, v100, v6
ds_write_b32 v183, v100 offset:512
s_add_u32 m0, s31, 118784
s_add_u32 s35, s27, 4096
buffer_load_dwordx4 v2, s[4:7], s27 offen offset:0 sc1 lds
buffer_load_dwordx4 v2, s[4:7], s27 offen offset:1024 sc1 lds
buffer_load_dwordx4 v2, s[4:7], s27 offen offset:2048 sc1 lds
buffer_load_dwordx4 v2, s[4:7], s27 offen offset:3072 sc1 lds
s_add_u32 m0, s31, 122880
s_nop 0
buffer_load_dwordx4 v2, s[4:7], s35 offen sc1 lds
s_branch Lg1_ret2
Lg1_tail0:
s_waitcnt vmcnt(0)
buffer_store_dword v181, v5, s[4:7], s33 offen sc1
s_nop 7
v_fma_f32 v120, v88, v72, v24
v_fma_f32 v128, v88, v80, v32
v_fma_f32 v121, v88, v73, v25
v_fma_f32 v129, v88, v81, v33
v_fma_f32 v122, v88, v74, v26
v_fma_f32 v130, v88, v82, v34
v_fma_f32 v123, v88, v75, v27
v_fma_f32 v131, v88, v83, v35
v_fma_f32 v124, v88, v76, v28
v_fma_f32 v132, v88, v84, v36
v_fma_f32 v125, v88, v77, v29
v_fma_f32 v133, v88, v85, v37
v_fma_f32 v126, v88, v78, v30
v_fma_f32 v134, v88, v86, v38
v_fma_f32 v127, v88, v79, v31
v_fma_f32 v135, v88, v87, v39
v_mul_f32 v136, v120, v89
v_mul_f32 v137, v121, v89
v_mul_f32 v138, v122, v89
v_mul_f32 v139, v123, v89
v_mul_f32 v140, v124, v89
v_mul_f32 v141, v125, v89
v_mul_f32 v142, v126, v89
v_mul_f32 v143, v127, v89
v_exp_f32 v136, v136
v_exp_f32 v137, v137
v_exp_f32 v138, v138
v_exp_f32 v139, v139
v_exp_f32 v140, v140
v_exp_f32 v141, v141
v_exp_f32 v142, v142
v_exp_f32 v143, v143
v_mul_f32 v120, v120, v128
v_mul_f32 v121, v121, v129
v_mul_f32 v122, v122, v130
v_mul_f32 v123, v123, v131
v_mul_f32 v124, v124, v132
v_mul_f32 v125, v125, v133
v_mul_f32 v126, v126, v134
v_mul_f32 v127, v127, v135
v_fma_f32 v136, v136, v90, v90
v_fma_f32 v137, v137, v90, v90
v_fma_f32 v138, v138, v90, v90
v_fma_f32 v139, v139, v90, v90
v_fma_f32 v140, v140, v90, v90
v_fma_f32 v141, v141, v90, v90
v_fma_f32 v142, v142, v90, v90
v_fma_f32 v143, v143, v90, v90
v_rcp_f32 v136, v136
v_rcp_f32 v137, v137
v_rcp_f32 v138, v138
v_rcp_f32 v139, v139
v_rcp_f32 v140, v140
v_rcp_f32 v141, v141
v_rcp_f32 v142, v142
v_rcp_f32 v143, v143
v_mul_f32 v120, v120, v136
v_mul_f32 v121, v121, v137
v_mul_f32 v122, v122, v138
v_mul_f32 v123, v123, v139
v_mul_f32 v124, v124, v140
v_mul_f32 v125, v125, v141
v_mul_f32 v126, v126, v142
v_mul_f32 v127, v127, v143
v_cvt_pk_bf16_f32 v152, v120, v121
v_cvt_pk_bf16_f32 v153, v122, v123
v_cvt_pk_bf16_f32 v154, v124, v125
v_cvt_pk_bf16_f32 v155, v126, v127
buffer_store_dwordx4 v[152:155], v4, s[4:7], s45 offen sc1
s_waitcnt vmcnt(0)
buffer_store_dword v181, v5, s[4:7], s32 offen sc1
s_add_u32 s36, s36, 1
s_cmp_lt_u32 s36, 2
s_cbranch_scc1 Lg1_layer
s_branch Lg1_done
Lg1_tail1:
s_waitcnt vmcnt(0)
buffer_store_dword v181, v5, s[4:7], s33 offen sc1
s_nop 7
v_fma_f32 v120, v92, v72, v40
v_fma_f32 v128, v92, v80, v48
v_fma_f32 v121, v92, v73, v41
v_fma_f32 v129, v92, v81, v49
v_fma_f32 v122, v92, v74, v42
v_fma_f32 v130, v92, v82, v50
v_fma_f32 v123, v92, v75, v43
v_fma_f32 v131, v92, v83, v51
v_fma_f32 v124, v92, v76, v44
v_fma_f32 v132, v92, v84, v52
v_fma_f32 v125, v92, v77, v45
v_fma_f32 v133, v92, v85, v53
v_fma_f32 v126, v92, v78, v46
v_fma_f32 v134, v92, v86, v54
v_fma_f32 v127, v92, v79, v47
v_fma_f32 v135, v92, v87, v55
v_mul_f32 v136, v120, v93
v_mul_f32 v137, v121, v93
v_mul_f32 v138, v122, v93
v_mul_f32 v139, v123, v93
v_mul_f32 v140, v124, v93
v_mul_f32 v141, v125, v93
v_mul_f32 v142, v126, v93
v_mul_f32 v143, v127, v93
v_exp_f32 v136, v136
v_exp_f32 v137, v137
v_exp_f32 v138, v138
v_exp_f32 v139, v139
v_exp_f32 v140, v140
v_exp_f32 v141, v141
v_exp_f32 v142, v142
v_exp_f32 v143, v143
v_mul_f32 v120, v120, v128
v_mul_f32 v121, v121, v129
v_mul_f32 v122, v122, v130
v_mul_f32 v123, v123, v131
v_mul_f32 v124, v124, v132
v_mul_f32 v125, v125, v133
v_mul_f32 v126, v126, v134
v_mul_f32 v127, v127, v135
v_fma_f32 v136, v136, v94, v94
v_fma_f32 v137, v137, v94, v94
v_fma_f32 v138, v138, v94, v94
v_fma_f32 v139, v139, v94, v94
v_fma_f32 v140, v140, v94, v94
v_fma_f32 v141, v141, v94, v94
v_fma_f32 v142, v142, v94, v94
v_fma_f32 v143, v143, v94, v94
v_rcp_f32 v136, v136
v_rcp_f32 v137, v137
v_rcp_f32 v138, v138
v_rcp_f32 v139, v139
v_rcp_f32 v140, v140
v_rcp_f32 v141, v141
v_rcp_f32 v142, v142
v_rcp_f32 v143, v143
v_mul_f32 v120, v120, v136
v_mul_f32 v121, v121, v137
v_mul_f32 v122, v122, v138
v_mul_f32 v123, v123, v139
v_mul_f32 v124, v124, v140
v_mul_f32 v125, v125, v141
v_mul_f32 v126, v126, v142
v_mul_f32 v127, v127, v143
v_cvt_pk_bf16_f32 v152, v120, v121
v_cvt_pk_bf16_f32 v153, v122, v123
v_cvt_pk_bf16_f32 v154, v124, v125
v_cvt_pk_bf16_f32 v155, v126, v127
buffer_store_dwordx4 v[152:155], v4, s[4:7], s45 offen sc1
s_waitcnt vmcnt(0)
buffer_store_dword v181, v5, s[4:7], s32 offen sc1
s_add_u32 s36, s36, 1
s_cmp_lt_u32 s36, 2
s_cbranch_scc1 Lg1_layer
s_branch Lg1_done
Lg1_tail2:
s_waitcnt vmcnt(0)
buffer_store_dword v181, v5, s[4:7], s33 offen sc1
s_nop 7
v_fma_f32 v120, v96, v72, v56
v_fma_f32 v128, v96, v80, v64
v_fma_f32 v121, v96, v73, v57
v_fma_f32 v129, v96, v81, v65
v_fma_f32 v122, v96, v74, v58
v_fma_f32 v130, v96, v82, v66
v_fma_f32 v123, v96, v75, v59
v_fma_f32 v131, v96, v83, v67
v_fma_f32 v124, v96, v76, v60
v_fma_f32 v132, v96, v84, v68
v_fma_f32 v125, v96, v77, v61
v_fma_f32 v133, v96, v85, v69
v_fma_f32 v126, v96, v78, v62
v_fma_f32 v134, v96, v86, v70
v_fma_f32 v127, v96, v79, v63
v_fma_f32 v135, v96, v87, v71
v_mul_f32 v136, v120, v97
v_mul_f32 v137, v121, v97
v_mul_f32 v138, v122, v97
v_mul_f32 v139, v123, v97
v_mul_f32 v140, v124, v97
v_mul_f32 v141, v125, v97
v_mul_f32 v142, v126, v97
v_mul_f32 v143, v127, v97
v_exp_f32 v136, v136
v_exp_f32 v137, v137
v_exp_f32 v138, v138
v_exp_f32 v139, v139
v_exp_f32 v140, v140
v_exp_f32 v141, v141
v_exp_f32 v142, v142
v_exp_f32 v143, v143
v_mul_f32 v120, v120, v128
v_mul_f32 v121, v121, v129
v_mul_f32 v122, v122, v130
v_mul_f32 v123, v123, v131
v_mul_f32 v124, v124, v132
v_mul_f32 v125, v125, v133
v_mul_f32 v126, v126, v134
v_mul_f32 v127, v127, v135
v_fma_f32 v136, v136, v98, v98
v_fma_f32 v137, v137, v98, v98
v_fma_f32 v138, v138, v98, v98
v_fma_f32 v139, v139, v98, v98
v_fma_f32 v140, v140, v98, v98
v_fma_f32 v141, v141, v98, v98
v_fma_f32 v142, v142, v98, v98
v_fma_f32 v143, v143, v98, v98
v_rcp_f32 v136, v136
v_rcp_f32 v137, v137
v_rcp_f32 v138, v138
v_rcp_f32 v139, v139
v_rcp_f32 v140, v140
v_rcp_f32 v141, v141
v_rcp_f32 v142, v142
v_rcp_f32 v143, v143
v_mul_f32 v120, v120, v136
v_mul_f32 v121, v121, v137
v_mul_f32 v122, v122, v138
v_mul_f32 v123, v123, v139
v_mul_f32 v124, v124, v140
v_mul_f32 v125, v125, v141
v_mul_f32 v126, v126, v142
v_mul_f32 v127, v127, v143
v_cvt_pk_bf16_f32 v152, v120, v121
v_cvt_pk_bf16_f32 v153, v122, v123
v_cvt_pk_bf16_f32 v154, v124, v125
v_cvt_pk_bf16_f32 v155, v126, v127
buffer_store_dwordx4 v[152:155], v4, s[4:7], s45 offen sc1
s_waitcnt vmcnt(0)
buffer_store_dword v181, v5, s[4:7], s32 offen sc1
s_add_u32 s36, s36, 1
s_cmp_lt_u32 s36, 2
s_cbranch_scc1 Lg1_layer
s_branch Lg1_done
Lg1_done:
s_branch Lfin
Lrole_g2:
s_sub_u32 s37, s22, 21
s_cmp_ge_u32 s37, 5
s_cselect_b32 s38, 1, 0
s_mul_i32 s39, s38, 5
s_sub_u32 s39, s37, s39
s_lshl_b32 s26, s24, 1
s_add_u32 s38, s38, s26
s_lshl_b32 s40, s39, 2
s_add_u32 s40, s40, s3
s_lshl_b32 s41, s38, 2
s_add_u32 s41, s41, s23
v_and_b32 v20, 15, v1
v_lshrrev_b32 v21, 4, v1
v_lshlrev_b32 v2, 4, v1
v_mul_u32_u24 v4, 1280, v20
v_lshl_add_u32 v4, v21, 3, v4
s_lshl_b32 s26, s40, 6
v_add_u32 v4, s26, v4
v_lshlrev_b32 v5, 4, v20
v_mov_b32 v22, 0x40000000
v_cmp_eq_u32 vcc, 0, v21
v_mul_u32_u24 v6, 1280, v21
v_lshl_add_u32 v6, v20, 4, v6
v_cndmask_b32 v5, v22, v5, vcc
v_lshlrev_b32 v7, 7, v21
v_lshl_add_u32 v7, v20, 3, v7
s_lshl_b32 s26, s40, 10
v_add_u32 v7, s26, v7
s_lshl_b32 s26, s3, 10
s_add_u32 s26, s26, 110592
v_add_u32 v8, s26, v2
v_lshlrev_b32 v11, 3, v20
v_add_u32 v11, 143360, v11
s_lshl_b32 s26, s39, 8
v_lshrrev_b32 v20, 4, v1
v_bfe_u32 v21, v1, 1, 3
v_xor_b32 v21, v20, v21
v_lshlrev_b32 v21, 5, v21
v_mul_u32_u24 v20, 1280, v20
v_add_u32 v20, s26, v20
v_and_b32 v0, 1, v1
v_lshl_add_u32 v20, v0, 4, v20
v_add_u32 v0, v21, v20
v_xor_b32 v21, 128, v21
v_add_u32 v3, v21, v20
s_lshl_b32 s27, s3, 1
s_add_u32 s27, s27, 0
v_lshrrev_b32 v20, 4, v1
v_bfe_u32 v21, v1, 2, 2
v_lshlrev_b32 v9, 8, v21
v_lshl_add_u32 v9, v20, 10, v9
v_and_b32 v20, 1, v20
v_lshl_add_u32 v21, v20, 2, v21
v_xor_b32 v21, s27, v21
v_lshl_add_u32 v9, v21, 5, v9
v_and_b32 v20, 3, v1
v_lshl_add_u32 v9, v20, 3, v9
s_lshl_b32 s27, s3, 1
s_add_u32 s27, s27, 1
v_lshrrev_b32 v20, 4, v1
v_bfe_u32 v21, v1, 2, 2
v_lshlrev_b32 v22, 8, v21
v_lshl_add_u32 v22, v20, 10, v22
v_and_b32 v20, 1, v20
v_lshl_add_u32 v21, v20, 2, v21
v_xor_b32 v21, s27, v21
v_lshl_add_u32 v22, v21, 5, v22
v_and_b32 v20, 3, v1
v_lshl_add_u32 v22, v20, 3, v22
v_mov_b32 v1, v22
s_mul_i32 s42, s3, 10240
s_lshl_b32 s43, s3, 11
s_mul_i32 s26, s41, 20480
s_waitcnt lgkmcnt(0)
s_mov_b32 s4, s88
s_mov_b32 s5, s89
s_mov_b32 s6, 0x10000000
s_mov_b32 s7, 0x20000
s_mov_b32 s8, s64
s_mov_b32 s9, s65
s_mov_b32 s10, 0x280000
s_mov_b32 s11, 0x20000
s_mov_b32 s12, s82
s_mov_b32 s13, s83
s_mov_b32 s14, 0x21c000
s_mov_b32 s15, 0x20000
s_mov_b32 s28, 0x1f80000
v_mov_b32 v63, 0
buffer_load_dword v62, v63, s[4:7], s28 offen sc1
s_add_u32 s27, s26, 0
buffer_load_dwordx2 v[16:17], v4, s[8:11], s27 offen
buffer_load_dwordx2 v[18:19], v4, s[8:11], s27 offen offset:32
s_add_u32 s27, s26, 327680
buffer_load_dwordx2 v[20:21], v4, s[8:11], s27 offen
buffer_load_dwordx2 v[22:23], v4, s[8:11], s27 offen offset:32
s_add_u32 s27, s26, 655360
buffer_load_dwordx2 v[24:25], v4, s[8:11], s27 offen
buffer_load_dwordx2 v[26:27], v4, s[8:11], s27 offen offset:32
s_add_u32 s27, s26, 983040
buffer_load_dwordx2 v[28:29], v4, s[8:11], s27 offen
buffer_load_dwordx2 v[30:31], v4, s[8:11], s27 offen offset:32
s_add_u32 s27, s26, 1310720
buffer_load_dwordx2 v[32:33], v4, s[8:11], s27 offen
buffer_load_dwordx2 v[34:35], v4, s[8:11], s27 offen offset:32
s_add_u32 s27, s26, 1638400
buffer_load_dwordx2 v[36:37], v4, s[8:11], s27 offen
buffer_load_dwordx2 v[38:39], v4, s[8:11], s27 offen offset:32
s_add_u32 s27, s26, 1966080
buffer_load_dwordx2 v[40:41], v4, s[8:11], s27 offen
buffer_load_dwordx2 v[42:43], v4, s[8:11], s27 offen offset:32
s_add_u32 s27, s26, 2293760
buffer_load_dwordx2 v[44:45], v4, s[8:11], s27 offen
buffer_load_dwordx2 v[46:47], v4, s[8:11], s27 offen offset:32
s_add_u32 m0, s43, 0
s_add_u32 s44, s42, 0
buffer_load_dwordx4 v0, s[12:15], s44 offen lds
s_add_u32 m0, s43, 1024
s_add_u32 s44, s42, 5120
buffer_load_dwordx4 v3, s[12:15], s44 offen lds
s_add_u32 m0, s43, 8192
s_add_u32 s44, s42, 40960
buffer_load_dwordx4 v0, s[12:15], s44 offen lds
s_add_u32 m0, s43, 9216
s_add_u32 s44, s42, 46080
buffer_load_dwordx4 v3, s[12:15], s44 offen lds
s_add_u32 m0, s43, 16384
s_add_u32 s44, s42, 81920
buffer_load_dwordx4 v0, s[12:15], s44 offen lds
s_add_u32 m0, s43, 17408
s_add_u32 s44, s42, 87040
buffer_load_dwordx4 v3, s[12:15], s44 offen lds
s_add_u32 m0, s43, 24576
s_add_u32 s44, s42, 122880
buffer_load_dwordx4 v0, s[12:15], s44 offen lds
s_add_u32 m0, s43, 25600
s_add_u32 s44, s42, 128000
buffer_load_dwordx4 v3, s[12:15], s44 offen lds
s_waitcnt vmcnt(24)
v_readfirstlane_b32 s20, v62
s_add_u32 s20, s20, 1
s_nop 0
v_mov_b32 v14, s20
v_mov_b32 v15, s20
s_mul_i32 s26, s41, 5120
s_lshl_b32 s27, s40, 8
s_add_u32 s26, s26, s27
s_add_u32 s26, s26, 0x1a00000
s_waitcnt vmcnt(23)
v_lshlrev_b32 v68, 16, v16
v_and_b32 v69, 0xffff0000, v16
v_lshlrev_b32 v70, 16, v17
v_and_b32 v71, 0xffff0000, v17
s_waitcnt vmcnt(22)
v_lshlrev_b32 v72, 16, v18
v_and_b32 v73, 0xffff0000, v18
v_lshlrev_b32 v74, 16, v19
v_and_b32 v75, 0xffff0000, v19
v_add_f32 v12, v68, v69
v_mul_f32 v13, v68, v68
v_fmac_f32 v13, v69, v69
v_add_f32 v12, v12, v70
v_fmac_f32 v13, v70, v70
v_add_f32 v12, v12, v71
v_fmac_f32 v13, v71, v71
v_add_f32 v12, v12, v72
v_fmac_f32 v13, v72, v72
v_add_f32 v12, v12, v73
v_fmac_f32 v13, v73, v73
v_add_f32 v12, v12, v74
v_fmac_f32 v13, v74, v74
v_add_f32 v12, v12, v75
v_fmac_f32 v13, v75, v75
s_nop 1
v_permlane32_swap_b32 v12, v13
v_add_f32 v12, v12, v13
v_mov_b32 v63, v12
s_nop 1
v_permlane16_swap_b32 v12, v63
v_add_f32 v12, v12, v63
v_mov_b32 v13, v12
s_nop 1
v_permlane32_swap_b32 v12, v13
s_add_u32 s27, s26, 0
buffer_store_dwordx4 v[12:15], v5, s[4:7], s27 offen sc1
s_waitcnt vmcnt(22)
v_lshlrev_b32 v68, 16, v20
v_and_b32 v69, 0xffff0000, v20
v_lshlrev_b32 v70, 16, v21
v_and_b32 v71, 0xffff0000, v21
s_waitcnt vmcnt(21)
v_lshlrev_b32 v72, 16, v22
v_and_b32 v73, 0xffff0000, v22
v_lshlrev_b32 v74, 16, v23
v_and_b32 v75, 0xffff0000, v23
v_add_f32 v12, v68, v69
v_mul_f32 v13, v68, v68
v_fmac_f32 v13, v69, v69
v_add_f32 v12, v12, v70
v_fmac_f32 v13, v70, v70
v_add_f32 v12, v12, v71
v_fmac_f32 v13, v71, v71
v_add_f32 v12, v12, v72
v_fmac_f32 v13, v72, v72
v_add_f32 v12, v12, v73
v_fmac_f32 v13, v73, v73
v_add_f32 v12, v12, v74
v_fmac_f32 v13, v74, v74
v_add_f32 v12, v12, v75
v_fmac_f32 v13, v75, v75
s_nop 1
v_permlane32_swap_b32 v12, v13
v_add_f32 v12, v12, v13
v_mov_b32 v63, v12
s_nop 1
v_permlane16_swap_b32 v12, v63
v_add_f32 v12, v12, v63
v_mov_b32 v13, v12
s_nop 1
v_permlane32_swap_b32 v12, v13
s_add_u32 s27, s26, 81920
buffer_store_dwordx4 v[12:15], v5, s[4:7], s27 offen sc1
s_waitcnt vmcnt(21)
v_lshlrev_b32 v68, 16, v24
v_and_b32 v69, 0xffff0000, v24
v_lshlrev_b32 v70, 16, v25
v_and_b32 v71, 0xffff0000, v25
s_waitcnt vmcnt(20)
v_lshlrev_b32 v72, 16, v26
v_and_b32 v73, 0xffff0000, v26
v_lshlrev_b32 v74, 16, v27
v_and_b32 v75, 0xffff0000, v27
v_add_f32 v12, v68, v69
v_mul_f32 v13, v68, v68
v_fmac_f32 v13, v69, v69
v_add_f32 v12, v12, v70
v_fmac_f32 v13, v70, v70
v_add_f32 v12, v12, v71
v_fmac_f32 v13, v71, v71
v_add_f32 v12, v12, v72
v_fmac_f32 v13, v72, v72
v_add_f32 v12, v12, v73
v_fmac_f32 v13, v73, v73
v_add_f32 v12, v12, v74
v_fmac_f32 v13, v74, v74
v_add_f32 v12, v12, v75
v_fmac_f32 v13, v75, v75
s_nop 1
v_permlane32_swap_b32 v12, v13
v_add_f32 v12, v12, v13
v_mov_b32 v63, v12
s_nop 1
v_permlane16_swap_b32 v12, v63
v_add_f32 v12, v12, v63
v_mov_b32 v13, v12
s_nop 1
v_permlane32_swap_b32 v12, v13
s_add_u32 s27, s26, 163840
buffer_store_dwordx4 v[12:15], v5, s[4:7], s27 offen sc1
s_waitcnt vmcnt(20)
v_lshlrev_b32 v68, 16, v28
v_and_b32 v69, 0xffff0000, v28
v_lshlrev_b32 v70, 16, v29
v_and_b32 v71, 0xffff0000, v29
s_waitcnt vmcnt(19)
v_lshlrev_b32 v72, 16, v30
v_and_b32 v73, 0xffff0000, v30
v_lshlrev_b32 v74, 16, v31
v_and_b32 v75, 0xffff0000, v31
v_add_f32 v12, v68, v69
v_mul_f32 v13, v68, v68
v_fmac_f32 v13, v69, v69
v_add_f32 v12, v12, v70
v_fmac_f32 v13, v70, v70
v_add_f32 v12, v12, v71
v_fmac_f32 v13, v71, v71
v_add_f32 v12, v12, v72
v_fmac_f32 v13, v72, v72
v_add_f32 v12, v12, v73
v_fmac_f32 v13, v73, v73
v_add_f32 v12, v12, v74
v_fmac_f32 v13, v74, v74
v_add_f32 v12, v12, v75
v_fmac_f32 v13, v75, v75
s_nop 1
v_permlane32_swap_b32 v12, v13
v_add_f32 v12, v12, v13
v_mov_b32 v63, v12
s_nop 1
v_permlane16_swap_b32 v12, v63
v_add_f32 v12, v12, v63
v_mov_b32 v13, v12
s_nop 1
v_permlane32_swap_b32 v12, v13
s_add_u32 s27, s26, 245760
buffer_store_dwordx4 v[12:15], v5, s[4:7], s27 offen sc1
s_waitcnt vmcnt(19)
v_lshlrev_b32 v68, 16, v32
v_and_b32 v69, 0xffff0000, v32
v_lshlrev_b32 v70, 16, v33
v_and_b32 v71, 0xffff0000, v33
s_waitcnt vmcnt(18)
v_lshlrev_b32 v72, 16, v34
v_and_b32 v73, 0xffff0000, v34
v_lshlrev_b32 v74, 16, v35
v_and_b32 v75, 0xffff0000, v35
v_add_f32 v12, v68, v69
v_mul_f32 v13, v68, v68
v_fmac_f32 v13, v69, v69
v_add_f32 v12, v12, v70
v_fmac_f32 v13, v70, v70
v_add_f32 v12, v12, v71
v_fmac_f32 v13, v71, v71
v_add_f32 v12, v12, v72
v_fmac_f32 v13, v72, v72
v_add_f32 v12, v12, v73
v_fmac_f32 v13, v73, v73
v_add_f32 v12, v12, v74
v_fmac_f32 v13, v74, v74
v_add_f32 v12, v12, v75
v_fmac_f32 v13, v75, v75
s_nop 1
v_permlane32_swap_b32 v12, v13
v_add_f32 v12, v12, v13
v_mov_b32 v63, v12
s_nop 1
v_permlane16_swap_b32 v12, v63
v_add_f32 v12, v12, v63
v_mov_b32 v13, v12
s_nop 1
v_permlane32_swap_b32 v12, v13
s_add_u32 s27, s26, 327680
buffer_store_dwordx4 v[12:15], v5, s[4:7], s27 offen sc1
s_waitcnt vmcnt(18)
v_lshlrev_b32 v68, 16, v36
v_and_b32 v69, 0xffff0000, v36
v_lshlrev_b32 v70, 16, v37
v_and_b32 v71, 0xffff0000, v37
s_waitcnt vmcnt(17)
v_lshlrev_b32 v72, 16, v38
v_and_b32 v73, 0xffff0000, v38
v_lshlrev_b32 v74, 16, v39
v_and_b32 v75, 0xffff0000, v39
v_add_f32 v12, v68, v69
v_mul_f32 v13, v68, v68
v_fmac_f32 v13, v69, v69
v_add_f32 v12, v12, v70
v_fmac_f32 v13, v70, v70
v_add_f32 v12, v12, v71
v_fmac_f32 v13, v71, v71
v_add_f32 v12, v12, v72
v_fmac_f32 v13, v72, v72
v_add_f32 v12, v12, v73
v_fmac_f32 v13, v73, v73
v_add_f32 v12, v12, v74
v_fmac_f32 v13, v74, v74
v_add_f32 v12, v12, v75
v_fmac_f32 v13, v75, v75
s_nop 1
v_permlane32_swap_b32 v12, v13
v_add_f32 v12, v12, v13
v_mov_b32 v63, v12
s_nop 1
v_permlane16_swap_b32 v12, v63
v_add_f32 v12, v12, v63
v_mov_b32 v13, v12
s_nop 1
v_permlane32_swap_b32 v12, v13
s_add_u32 s27, s26, 409600
buffer_store_dwordx4 v[12:15], v5, s[4:7], s27 offen sc1
s_waitcnt vmcnt(17)
v_lshlrev_b32 v68, 16, v40
v_and_b32 v69, 0xffff0000, v40
v_lshlrev_b32 v70, 16, v41
v_and_b32 v71, 0xffff0000, v41
s_waitcnt vmcnt(16)
v_lshlrev_b32 v72, 16, v42
v_and_b32 v73, 0xffff0000, v42
v_lshlrev_b32 v74, 16, v43
v_and_b32 v75, 0xffff0000, v43
v_add_f32 v12, v68, v69
v_mul_f32 v13, v68, v68
v_fmac_f32 v13, v69, v69
v_add_f32 v12, v12, v70
v_fmac_f32 v13, v70, v70
v_add_f32 v12, v12, v71
v_fmac_f32 v13, v71, v71
v_add_f32 v12, v12, v72
v_fmac_f32 v13, v72, v72
v_add_f32 v12, v12, v73
v_fmac_f32 v13, v73, v73
v_add_f32 v12, v12, v74
v_fmac_f32 v13, v74, v74
v_add_f32 v12, v12, v75
v_fmac_f32 v13, v75, v75
s_nop 1
v_permlane32_swap_b32 v12, v13
v_add_f32 v12, v12, v13
v_mov_b32 v63, v12
s_nop 1
v_permlane16_swap_b32 v12, v63
v_add_f32 v12, v12, v63
v_mov_b32 v13, v12
s_nop 1
v_permlane32_swap_b32 v12, v13
s_add_u32 s27, s26, 491520
buffer_store_dwordx4 v[12:15], v5, s[4:7], s27 offen sc1
s_waitcnt vmcnt(16)
v_lshlrev_b32 v68, 16, v44
v_and_b32 v69, 0xffff0000, v44
v_lshlrev_b32 v70, 16, v45
v_and_b32 v71, 0xffff0000, v45
s_waitcnt vmcnt(15)
v_lshlrev_b32 v72, 16, v46
v_and_b32 v73, 0xffff0000, v46
v_lshlrev_b32 v74, 16, v47
v_and_b32 v75, 0xffff0000, v47
v_add_f32 v12, v68, v69
v_mul_f32 v13, v68, v68
v_fmac_f32 v13, v69, v69
v_add_f32 v12, v12, v70
v_fmac_f32 v13, v70, v70
v_add_f32 v12, v12, v71
v_fmac_f32 v13, v71, v71
v_add_f32 v12, v12, v72
v_fmac_f32 v13, v72, v72
v_add_f32 v12, v12, v73
v_fmac_f32 v13, v73, v73
v_add_f32 v12, v12, v74
v_fmac_f32 v13, v74, v74
v_add_f32 v12, v12, v75
v_fmac_f32 v13, v75, v75
s_nop 1
v_permlane32_swap_b32 v12, v13
v_add_f32 v12, v12, v13
v_mov_b32 v63, v12
s_nop 1
v_permlane16_swap_b32 v12, v63
v_add_f32 v12, v12, v63
v_mov_b32 v13, v12
s_nop 1
v_permlane32_swap_b32 v12, v13
s_add_u32 s27, s26, 573440
buffer_store_dwordx4 v[12:15], v5, s[4:7], s27 offen sc1
s_add_u32 m0, s43, 32768
s_add_u32 s44, s42, 163840
buffer_load_dwordx4 v0, s[12:15], s44 offen lds
s_add_u32 m0, s43, 33792
s_add_u32 s44, s42, 168960
buffer_load_dwordx4 v3, s[12:15], s44 offen lds
s_add_u32 m0, s43, 40960
s_add_u32 s44, s42, 204800
buffer_load_dwordx4 v0, s[12:15], s44 offen lds
s_add_u32 m0, s43, 41984
s_add_u32 s44, s42, 209920
buffer_load_dwordx4 v3, s[12:15], s44 offen lds
s_waitcnt vmcnt(16) lgkmcnt(0)
s_barrier
s_add_u32 m0, s43, 49152
s_add_u32 s44, s42, 245760
buffer_load_dwordx4 v0, s[12:15], s44 offen lds
s_add_u32 m0, s43, 50176
s_add_u32 s44, s42, 250880
buffer_load_dwordx4 v3, s[12:15], s44 offen lds
s_add_u32 m0, s43, 57344
s_add_u32 s44, s42, 286720
buffer_load_dwordx4 v0, s[12:15], s44 offen lds
s_add_u32 m0, s43, 58368
s_add_u32 s44, s42, 291840
buffer_load_dwordx4 v3, s[12:15], s44 offen lds
ds_read_b64_tr_b16 a[0:1], v9 offset:0
ds_read_b64_tr_b16 a[2:3], v9 offset:4096
ds_read_b64_tr_b16 a[4:5], v1 offset:0
ds_read_b64_tr_b16 a[6:7], v1 offset:4096
ds_read_b64_tr_b16 a[8:9], v9 offset:8192
ds_read_b64_tr_b16 a[10:11], v9 offset:12288
ds_read_b64_tr_b16 a[12:13], v1 offset:8192
ds_read_b64_tr_b16 a[14:15], v1 offset:12288
s_waitcnt vmcnt(16) lgkmcnt(0)
s_barrier
s_add_u32 m0, s43, 0
s_add_u32 s44, s42, 327680
buffer_load_dwordx4 v0, s[12:15], s44 offen lds
s_add_u32 m0, s43, 1024
s_add_u32 s44, s42, 332800
buffer_load_dwordx4 v3, s[12:15], s44 offen lds
s_add_u32 m0, s43, 8192
s_add_u32 s44, s42, 368640
buffer_load_dwordx4 v0, s[12:15], s44 offen lds
s_add_u32 m0, s43, 9216
s_add_u32 s44, s42, 373760
buffer_load_dwordx4 v3, s[12:15], s44 offen lds
ds_read_b64_tr_b16 a[16:17], v9 offset:16384
ds_read_b64_tr_b16 a[18:19], v9 offset:20480
ds_read_b64_tr_b16 a[20:21], v1 offset:16384
ds_read_b64_tr_b16 a[22:23], v1 offset:20480
ds_read_b64_tr_b16 a[24:25], v9 offset:24576
ds_read_b64_tr_b16 a[26:27], v9 offset:28672
ds_read_b64_tr_b16 a[28:29], v1 offset:24576
ds_read_b64_tr_b16 a[30:31], v1 offset:28672
s_waitcnt vmcnt(8) lgkmcnt(0)
s_barrier
s_add_u32 m0, s43, 16384
s_add_u32 s44, s42, 409600
buffer_load_dwordx4 v0, s[12:15], s44 offen lds
s_add_u32 m0, s43, 17408
s_add_u32 s44, s42, 414720
buffer_load_dwordx4 v3, s[12:15], s44 offen lds
s_add_u32 m0, s43, 24576
s_add_u32 s44, s42, 450560
buffer_load_dwordx4 v0, s[12:15], s44 offen lds
s_add_u32 m0, s43, 25600
s_add_u32 s44, s42, 455680
buffer_load_dwordx4 v3, s[12:15], s44 offen lds
ds_read_b64_tr_b16 a[32:33], v9 offset:32768
ds_read_b64_tr_b16 a[34:35], v9 offset:36864
ds_read_b64_tr_b16 a[36:37], v1 offset:32768
ds_read_b64_tr_b16 a[38:39], v1 offset:36864
ds_read_b64_tr_b16 a[40:41], v9 offset:40960
ds_read_b64_tr_b16 a[42:43], v9 offset:45056
ds_read_b64_tr_b16 a[44:45], v1 offset:40960
ds_read_b64_tr_b16 a[46:47], v1 offset:45056
s_waitcnt vmcnt(8) lgkmcnt(0)
s_barrier
s_add_u32 m0, s43, 32768
s_add_u32 s44, s42, 491520
buffer_load_dwordx4 v0, s[12:15], s44 offen lds
s_add_u32 m0, s43, 33792
s_add_u32 s44, s42, 496640
buffer_load_dwordx4 v3, s[12:15], s44 offen lds
s_add_u32 m0, s43, 40960
s_add_u32 s44, s42, 532480
buffer_load_dwordx4 v0, s[12:15], s44 offen lds
s_add_u32 m0, s43, 41984
s_add_u32 s44, s42, 537600
buffer_load_dwordx4 v3, s[12:15], s44 offen lds
ds_read_b64_tr_b16 a[48:49], v9 offset:49152
ds_read_b64_tr_b16 a[50:51], v9 offset:53248
ds_read_b64_tr_b16 a[52:53], v1 offset:49152
ds_read_b64_tr_b16 a[54:55], v1 offset:53248
ds_read_b64_tr_b16 a[56:57], v9 offset:57344
ds_read_b64_tr_b16 a[58:59], v9 offset:61440
ds_read_b64_tr_b16 a[60:61], v1 offset:57344
ds_read_b64_tr_b16 a[62:63], v1 offset:61440
s_waitcnt vmcnt(8) lgkmcnt(0)
s_barrier
s_add_u32 m0, s43, 49152
s_add_u32 s44, s42, 573440
buffer_load_dwordx4 v0, s[12:15], s44 offen lds
s_add_u32 m0, s43, 50176
s_add_u32 s44, s42, 578560
buffer_load_dwordx4 v3, s[12:15], s44 offen lds
s_add_u32 m0, s43, 57344
s_add_u32 s44, s42, 614400
buffer_load_dwordx4 v0, s[12:15], s44 offen lds
s_add_u32 m0, s43, 58368
s_add_u32 s44, s42, 619520
buffer_load_dwordx4 v3, s[12:15], s44 offen lds
ds_read_b64_tr_b16 a[64:65], v9 offset:0
ds_read_b64_tr_b16 a[66:67], v9 offset:4096
ds_read_b64_tr_b16 a[68:69], v1 offset:0
ds_read_b64_tr_b16 a[70:71], v1 offset:4096
ds_read_b64_tr_b16 a[72:73], v9 offset:8192
ds_read_b64_tr_b16 a[74:75], v9 offset:12288
ds_read_b64_tr_b16 a[76:77], v1 offset:8192
ds_read_b64_tr_b16 a[78:79], v1 offset:12288
s_waitcnt vmcnt(8) lgkmcnt(0)
s_barrier
s_add_u32 m0, s43, 0
s_add_u32 s44, s42, 655360
buffer_load_dwordx4 v0, s[12:15], s44 offen lds
s_add_u32 m0, s43, 1024
s_add_u32 s44, s42, 660480
buffer_load_dwordx4 v3, s[12:15], s44 offen lds
s_add_u32 m0, s43, 8192
s_add_u32 s44, s42, 696320
buffer_load_dwordx4 v0, s[12:15], s44 offen lds
s_add_u32 m0, s43, 9216
s_add_u32 s44, s42, 701440
buffer_load_dwordx4 v3, s[12:15], s44 offen lds
ds_read_b64_tr_b16 a[80:81], v9 offset:16384
ds_read_b64_tr_b16 a[82:83], v9 offset:20480
ds_read_b64_tr_b16 a[84:85], v1 offset:16384
ds_read_b64_tr_b16 a[86:87], v1 offset:20480
ds_read_b64_tr_b16 a[88:89], v9 offset:24576
ds_read_b64_tr_b16 a[90:91], v9 offset:28672
ds_read_b64_tr_b16 a[92:93], v1 offset:24576
ds_read_b64_tr_b16 a[94:95], v1 offset:28672
s_waitcnt vmcnt(8) lgkmcnt(0)
s_barrier
s_add_u32 m0, s43, 16384
s_add_u32 s44, s42, 737280
buffer_load_dwordx4 v0, s[12:15], s44 offen lds
s_add_u32 m0, s43, 17408
s_add_u32 s44, s42, 742400
buffer_load_dwordx4 v3, s[12:15], s44 offen lds
s_add_u32 m0, s43, 24576
s_add_u32 s44, s42, 778240
buffer_load_dwordx4 v0, s[12:15], s44 offen lds
s_add_u32 m0, s43, 25600
s_add_u32 s44, s42, 783360
buffer_load_dwordx4 v3, s[12:15], s44 offen lds
ds_read_b64_tr_b16 a[96:97], v9 offset:32768
ds_read_b64_tr_b16 a[98:99], v9 offset:36864
ds_read_b64_tr_b16 a[100:101], v1 offset:32768
ds_read_b64_tr_b16 a[102:103], v1 offset:36864
ds_read_b64_tr_b16 a[104:105], v9 offset:40960
ds_read_b64_tr_b16 a[106:107], v9 offset:45056
ds_read_b64_tr_b16 a[108:109], v1 offset:40960
ds_read_b64_tr_b16 a[110:111], v1 offset:45056
s_lshl_b32 s30, s3, 1
s_add_u32 s30, s30, 0
s_lshl_b32 s31, s30, 4
s_add_u32 s31, s31, s41
s_mul_i32 s34, s31, 5120
s_add_u32 s34, s34, 0x1a00000
s_lshl_b32 s30, s30, 7
s_mov_b32 s90, 40000
Lg_20:
buffer_load_dwordx3 v[48:50], v6, s[4:7], s34 offen offset:0 sc1
buffer_load_dwordx3 v[52:54], v6, s[4:7], s34 offen offset:256 sc1
buffer_load_dwordx3 v[56:58], v6, s[4:7], s34 offen offset:512 sc1
buffer_load_dwordx3 v[60:62], v6, s[4:7], s34 offen offset:768 sc1
buffer_load_dwordx3 v[64:66], v6, s[4:7], s34 offen offset:1024 sc1
s_waitcnt vmcnt(0)
v_min3_u32 v63, v50, v54, v58
v_max3_u32 v67, v50, v54, v58
v_min3_u32 v63, v63, v62, v66
v_max3_u32 v67, v67, v62, v66
v_cmp_ne_u32 vcc, s20, v63
v_cmp_ne_u32 s[28:29], s20, v67
s_nop 0
s_or_b64 vcc, vcc, s[28:29]
s_cmp_eq_u64 vcc, 0
s_cbranch_scc1 Lgok_21
s_sub_u32 s90, s90, 1
s_cmp_lg_u32 s90, 0
s_cbranch_scc1 Lg_20
s_mov_b32 s8, s86
s_mov_b32 s9, s87
s_mov_b32 s10, 0x100
s_mov_b32 s11, 0x20000
v_mov_b32 v2, 0x3
v_mov_b32 v3, 0xc
s_nop 1
buffer_store_dword v2, v3, s[8:11], 0 offen
s_waitcnt vmcnt(0)
s_endpgm
Lgok_21:
s_waitcnt vmcnt(0)
v_add_f32 v48, v48, v52
v_add_f32 v49, v49, v53
v_add_f32 v48, v48, v56
v_add_f32 v49, v49, v57
v_add_f32 v48, v48, v60
v_add_f32 v49, v49, v61
v_add_f32 v48, v48, v64
v_add_f32 v49, v49, v65
s_nop 1
v_permlane32_swap_b32 v48, v49
v_add_f32 v48, v48, v49
v_mov_b32 v63, v48
s_nop 1
v_permlane16_swap_b32 v48, v63
v_add_f32 v48, v48, v63
v_mov_b32 v49, v48
s_nop 1
v_permlane32_swap_b32 v48, v49
v_mul_f32 v52, 0x3acccccd, v48
v_mul_f32 v53, 0x3acccccd, v49
v_fma_f32 v53, -v52, v52, v53
v_add_f32 v53, 0x3727c5ac, v53
v_rsq_f32 v56, v53
v_add_u32 v54, s30, v11
v_mul_f32 v57, v52, v56
ds_write_b64 v54, v[56:57]
s_lshl_b32 s30, s3, 1
s_add_u32 s30, s30, 1
s_lshl_b32 s31, s30, 4
s_add_u32 s31, s31, s41
s_mul_i32 s34, s31, 5120
s_add_u32 s34, s34, 0x1a00000
s_lshl_b32 s30, s30, 7
s_mov_b32 s90, 40000
Lg_22:
buffer_load_dwordx3 v[48:50], v6, s[4:7], s34 offen offset:0 sc1
buffer_load_dwordx3 v[52:54], v6, s[4:7], s34 offen offset:256 sc1
buffer_load_dwordx3 v[56:58], v6, s[4:7], s34 offen offset:512 sc1
buffer_load_dwordx3 v[60:62], v6, s[4:7], s34 offen offset:768 sc1
buffer_load_dwordx3 v[64:66], v6, s[4:7], s34 offen offset:1024 sc1
s_waitcnt vmcnt(0)
v_min3_u32 v63, v50, v54, v58
v_max3_u32 v67, v50, v54, v58
v_min3_u32 v63, v63, v62, v66
v_max3_u32 v67, v67, v62, v66
v_cmp_ne_u32 vcc, s20, v63
v_cmp_ne_u32 s[28:29], s20, v67
s_nop 0
s_or_b64 vcc, vcc, s[28:29]
s_cmp_eq_u64 vcc, 0
s_cbranch_scc1 Lgok_23
s_sub_u32 s90, s90, 1
s_cmp_lg_u32 s90, 0
s_cbranch_scc1 Lg_22
s_mov_b32 s8, s86
s_mov_b32 s9, s87
s_mov_b32 s10, 0x100
s_mov_b32 s11, 0x20000
v_mov_b32 v2, 0x3
v_mov_b32 v3, 0xc
s_nop 1
buffer_store_dword v2, v3, s[8:11], 0 offen
s_waitcnt vmcnt(0)
s_endpgm
Lgok_23:
s_waitcnt vmcnt(0)
v_add_f32 v48, v48, v52
v_add_f32 v49, v49, v53
v_add_f32 v48, v48, v56
v_add_f32 v49, v49, v57
v_add_f32 v48, v48, v60
v_add_f32 v49, v49, v61
v_add_f32 v48, v48, v64
v_add_f32 v49, v49, v65
s_nop 1
v_permlane32_swap_b32 v48, v49
v_add_f32 v48, v48, v49
v_mov_b32 v63, v48
s_nop 1
v_permlane16_swap_b32 v48, v63
v_add_f32 v48, v48, v63
v_mov_b32 v49, v48
s_nop 1
v_permlane32_swap_b32 v48, v49
v_mul_f32 v52, 0x3acccccd, v48
v_mul_f32 v53, 0x3acccccd, v49
v_fma_f32 v53, -v52, v52, v53
v_add_f32 v53, 0x3727c5ac, v53
v_rsq_f32 v56, v53
v_add_u32 v54, s30, v11
v_mul_f32 v57, v52, v56
ds_write_b64 v54, v[56:57]
s_waitcnt lgkmcnt(0)
s_barrier
s_waitcnt vmcnt(8) lgkmcnt(0)
s_barrier
s_add_u32 m0, s43, 32768
s_add_u32 s44, s42, 819200
buffer_load_dwordx4 v0, s[12:15], s44 offen lds
s_add_u32 m0, s43, 33792
s_add_u32 s44, s42, 824320
buffer_load_dwordx4 v3, s[12:15], s44 offen lds
s_add_u32 m0, s43, 40960
s_add_u32 s44, s42, 860160
buffer_load_dwordx4 v0, s[12:15], s44 offen lds
s_add_u32 m0, s43, 41984
s_add_u32 s44, s42, 865280
buffer_load_dwordx4 v3, s[12:15], s44 offen lds
ds_read_b64_tr_b16 a[112:113], v9 offset:49152
ds_read_b64_tr_b16 a[114:115], v9 offset:53248
ds_read_b64_tr_b16 a[116:117], v1 offset:49152
ds_read_b64_tr_b16 a[118:119], v1 offset:53248
ds_read_b64_tr_b16 a[120:121], v9 offset:57344
ds_read_b64_tr_b16 a[122:123], v9 offset:61440
ds_read_b64_tr_b16 a[124:125], v1 offset:57344
ds_read_b64_tr_b16 a[126:127], v1 offset:61440
s_waitcnt vmcnt(8) lgkmcnt(0)
s_barrier
s_add_u32 m0, s43, 49152
s_add_u32 s44, s42, 901120
buffer_load_dwordx4 v0, s[12:15], s44 offen lds
s_add_u32 m0, s43, 50176
s_add_u32 s44, s42, 906240
buffer_load_dwordx4 v3, s[12:15], s44 offen lds
s_add_u32 m0, s43, 57344
s_add_u32 s44, s42, 942080
buffer_load_dwordx4 v0, s[12:15], s44 offen lds
s_add_u32 m0, s43, 58368
s_add_u32 s44, s42, 947200
buffer_load_dwordx4 v3, s[12:15], s44 offen lds
ds_read_b64_tr_b16 a[128:129], v9 offset:0
ds_read_b64_tr_b16 a[130:131], v9 offset:4096
ds_read_b64_tr_b16 a[132:133], v1 offset:0
ds_read_b64_tr_b16 a[134:135], v1 offset:4096
ds_read_b64_tr_b16 a[136:137], v9 offset:8192
ds_read_b64_tr_b16 a[138:139], v9 offset:12288
ds_read_b64_tr_b16 a[140:141], v1 offset:8192
ds_read_b64_tr_b16 a[142:143], v1 offset:12288
s_waitcnt vmcnt(8) lgkmcnt(0)
s_barrier
s_add_u32 m0, s43, 0
s_add_u32 s44, s42, 983040
buffer_load_dwordx4 v0, s[12:15], s44 offen lds
s_add_u32 m0, s43, 1024
s_add_u32 s44, s42, 988160
buffer_load_dwordx4 v3, s[12:15], s44 offen lds
s_add_u32 m0, s43, 8192
s_add_u32 s44, s42, 1024000
buffer_load_dwordx4 v0, s[12:15], s44 offen lds
s_add_u32 m0, s43, 9216
s_add_u32 s44, s42, 1029120
buffer_load_dwordx4 v3, s[12:15], s44 offen lds
ds_read_b64_tr_b16 a[144:145], v9 offset:16384
ds_read_b64_tr_b16 a[146:147], v9 offset:20480
ds_read_b64_tr_b16 a[148:149], v1 offset:16384
ds_read_b64_tr_b16 a[150:151], v1 offset:20480
ds_read_b64_tr_b16 a[152:153], v9 offset:24576
ds_read_b64_tr_b16 a[154:155], v9 offset:28672
ds_read_b64_tr_b16 a[156:157], v1 offset:24576
ds_read_b64_tr_b16 a[158:159], v1 offset:28672
s_waitcnt vmcnt(8) lgkmcnt(0)
s_barrier
s_add_u32 m0, s43, 16384
s_add_u32 s44, s42, 1064960
buffer_load_dwordx4 v0, s[12:15], s44 offen lds
s_add_u32 m0, s43, 17408
s_add_u32 s44, s42, 1070080
buffer_load_dwordx4 v3, s[12:15], s44 offen lds
s_add_u32 m0, s43, 24576
s_add_u32 s44, s42, 1105920
buffer_load_dwordx4 v0, s[12:15], s44 offen lds
s_add_u32 m0, s43, 25600
s_add_u32 s44, s42, 1111040
buffer_load_dwordx4 v3, s[12:15], s44 offen lds
ds_read_b64_tr_b16 a[160:161], v9 offset:32768
ds_read_b64_tr_b16 a[162:163], v9 offset:36864
ds_read_b64_tr_b16 a[164:165], v1 offset:32768
ds_read_b64_tr_b16 a[166:167], v1 offset:36864
ds_read_b64_tr_b16 a[168:169], v9 offset:40960
ds_read_b64_tr_b16 a[170:171], v9 offset:45056
ds_read_b64_tr_b16 a[172:173], v1 offset:40960
ds_read_b64_tr_b16 a[174:175], v1 offset:45056
s_waitcnt vmcnt(8) lgkmcnt(0)
s_barrier
s_add_u32 m0, s43, 32768
s_add_u32 s44, s42, 1146880
buffer_load_dwordx4 v0, s[12:15], s44 offen lds
s_add_u32 m0, s43, 33792
s_add_u32 s44, s42, 1152000
buffer_load_dwordx4 v3, s[12:15], s44 offen lds
s_add_u32 m0, s43, 40960
s_add_u32 s44, s42, 1187840
buffer_load_dwordx4 v0, s[12:15], s44 offen lds
s_add_u32 m0, s43, 41984
s_add_u32 s44, s42, 1192960
buffer_load_dwordx4 v3, s[12:15], s44 offen lds
ds_read_b64_tr_b16 a[176:177], v9 offset:49152
ds_read_b64_tr_b16 a[178:179], v9 offset:53248
ds_read_b64_tr_b16 a[180:181], v1 offset:49152
ds_read_b64_tr_b16 a[182:183], v1 offset:53248
ds_read_b64_tr_b16 a[184:185], v9 offset:57344
ds_read_b64_tr_b16 a[186:187], v9 offset:61440
ds_read_b64_tr_b16 a[188:189], v1 offset:57344
ds_read_b64_tr_b16 a[190:191], v1 offset:61440
s_waitcnt vmcnt(8) lgkmcnt(0)
s_barrier
s_add_u32 m0, s43, 49152
s_add_u32 s44, s42, 1228800
buffer_load_dwordx4 v0, s[12:15], s44 offen lds
s_add_u32 m0, s43, 50176
s_add_u32 s44, s42, 1233920
buffer_load_dwordx4 v3, s[12:15], s44 offen lds
s_add_u32 m0, s43, 57344
s_add_u32 s44, s42, 1269760
buffer_load_dwordx4 v0, s[12:15], s44 offen lds
s_add_u32 m0, s43, 58368
s_add_u32 s44, s42, 1274880
buffer_load_dwordx4 v3, s[12:15], s44 offen lds
ds_read_b64_tr_b16 a[192:193], v9 offset:0
ds_read_b64_tr_b16 a[194:195], v9 offset:4096
ds_read_b64_tr_b16 a[196:197], v1 offset:0
ds_read_b64_tr_b16 a[198:199], v1 offset:4096
ds_read_b64_tr_b16 a[200:201], v9 offset:8192
ds_read_b64_tr_b16 a[202:203], v9 offset:12288
ds_read_b64_tr_b16 a[204:205], v1 offset:8192
ds_read_b64_tr_b16 a[206:207], v1 offset:12288
s_waitcnt vmcnt(8) lgkmcnt(0)
s_barrier
s_add_u32 m0, s43, 0
s_add_u32 s44, s42, 1310720
buffer_load_dwordx4 v0, s[12:15], s44 offen lds
s_add_u32 m0, s43, 1024
s_add_u32 s44, s42, 1315840
buffer_load_dwordx4 v3, s[12:15], s44 offen lds
s_add_u32 m0, s43, 8192
s_add_u32 s44, s42, 1351680
buffer_load_dwordx4 v0, s[12:15], s44 offen lds
s_add_u32 m0, s43, 9216
s_add_u32 s44, s42, 1356800
buffer_load_dwordx4 v3, s[12:15], s44 offen lds
ds_read_b64_tr_b16 a[208:209], v9 offset:16384
ds_read_b64_tr_b16 a[210:211], v9 offset:20480
ds_read_b64_tr_b16 a[212:213], v1 offset:16384
ds_read_b64_tr_b16 a[214:215], v1 offset:20480
ds_read_b64_tr_b16 a[216:217], v9 offset:24576
ds_read_b64_tr_b16 a[218:219], v9 offset:28672
ds_read_b64_tr_b16 a[220:221], v1 offset:24576
ds_read_b64_tr_b16 a[222:223], v1 offset:28672
s_mul_i32 s31, s41, 20480
s_mul_i32 s32, s41, 5120
s_add_u32 s33, s31, 0x300000
s_lshl_b32 s35, s40, 10
s_add_u32 s35, s35, s31
s_add_u32 s35, s35, 0x600000
s_lshl_b32 s36, s40, 8
s_add_u32 s36, s36, s32
s_add_u32 s36, s36, 0x1d00000
s_lshl_b32 s26, s40, 7
s_add_u32 s26, s26, 0x1f02000
v_and_b32 v10, 0x70, v2
s_mov_b32 s90, 40000
Lpoll_24:
buffer_load_dword v64, v10, s[4:7], s26 offen sc1
s_waitcnt vmcnt(0)
v_cmp_ne_u32 vcc, s20, v64
s_cmp_eq_u64 vcc, 0
s_cbranch_scc1 Lpok_25

s_sub_u32 s90, s90, 1
s_cmp_lg_u32 s90, 0
s_cbranch_scc1 Lpoll_24
s_mov_b32 s8, s86
s_mov_b32 s9, s87
s_mov_b32 s10, 0x100
s_mov_b32 s11, 0x20000
v_mov_b32 v2, 0x2
v_mov_b32 v3, 0x8
s_nop 1
buffer_store_dword v2, v3, s[8:11], 0 offen
s_waitcnt vmcnt(0)
s_endpgm
Lpok_25:
s_waitcnt vmcnt(0)
s_add_u32 s27, s33, 0
buffer_load_dwordx2 v[48:49], v7, s[4:7], s27 offen sc1
buffer_load_dwordx2 v[50:51], v7, s[4:7], s27 offen offset:512 sc1
s_add_u32 s27, s33, 327680
buffer_load_dwordx2 v[52:53], v7, s[4:7], s27 offen sc1
buffer_load_dwordx2 v[54:55], v7, s[4:7], s27 offen offset:512 sc1
s_add_u32 s27, s33, 655360
buffer_load_dwordx2 v[56:57], v7, s[4:7], s27 offen sc1
buffer_load_dwordx2 v[58:59], v7, s[4:7], s27 offen offset:512 sc1
s_add_u32 s27, s33, 983040
buffer_load_dwordx2 v[60:61], v7, s[4:7], s27 offen sc1
buffer_load_dwordx2 v[62:63], v7, s[4:7], s27 offen offset:512 sc1
ds_read_b64 v[64:65], v11 offset:0
v_lshlrev_b32 v68, 16, v16
v_and_b32 v69, 0xffff0000, v16
v_lshlrev_b32 v70, 16, v17
v_and_b32 v71, 0xffff0000, v17
v_lshlrev_b32 v72, 16, v18
v_and_b32 v73, 0xffff0000, v18
v_lshlrev_b32 v74, 16, v19
v_and_b32 v75, 0xffff0000, v19
s_waitcnt lgkmcnt(0)
v_fma_f32 v12, v68, v64, -v65
v_fma_f32 v13, v69, v64, -v65
s_waitcnt vmcnt(7)
v_lshlrev_b32 v66, 16, v48
v_and_b32 v67, 0xffff0000, v48
v_fmac_f32 v68, v12, v66
v_fmac_f32 v69, v13, v67
v_fma_f32 v12, v70, v64, -v65
v_fma_f32 v13, v71, v64, -v65
v_lshlrev_b32 v66, 16, v49
v_and_b32 v67, 0xffff0000, v49
v_fmac_f32 v70, v12, v66
v_fmac_f32 v71, v13, v67
v_fma_f32 v12, v72, v64, -v65
v_fma_f32 v13, v73, v64, -v65
s_waitcnt vmcnt(6)
v_lshlrev_b32 v66, 16, v50
v_and_b32 v67, 0xffff0000, v50
v_fmac_f32 v72, v12, v66
v_fmac_f32 v73, v13, v67
v_fma_f32 v12, v74, v64, -v65
v_fma_f32 v13, v75, v64, -v65
v_lshlrev_b32 v66, 16, v51
v_and_b32 v67, 0xffff0000, v51
v_fmac_f32 v74, v12, v66
v_fmac_f32 v75, v13, v67
v_cvt_pk_bf16_f32 v76, v68, v69
v_cvt_pk_bf16_f32 v77, v70, v71
v_cvt_pk_bf16_f32 v78, v72, v73
v_cvt_pk_bf16_f32 v79, v74, v75
s_add_u32 s27, s35, 0
buffer_store_dwordx4 v[76:79], v2, s[4:7], s27 offen sc1
ds_write_b128 v8, v[76:79] offset:0
v_add_f32 v48, v68, v69
v_mul_f32 v49, v68, v68
v_fmac_f32 v49, v69, v69
v_add_f32 v48, v48, v70
v_fmac_f32 v49, v70, v70
v_add_f32 v48, v48, v71
v_fmac_f32 v49, v71, v71
v_add_f32 v48, v48, v72
v_fmac_f32 v49, v72, v72
v_add_f32 v48, v48, v73
v_fmac_f32 v49, v73, v73
v_add_f32 v48, v48, v74
v_fmac_f32 v49, v74, v74
v_add_f32 v48, v48, v75
v_fmac_f32 v49, v75, v75
s_nop 1
v_permlane32_swap_b32 v48, v49
v_add_f32 v48, v48, v49
v_mov_b32 v10, v48
s_nop 1
v_permlane16_swap_b32 v48, v10
v_add_f32 v48, v48, v10
v_mov_b32 v49, v48
s_nop 1
v_permlane32_swap_b32 v48, v49
v_mov_b32 v50, s20
v_mov_b32 v51, s20
ds_read_b64 v[64:65], v11 offset:128
v_lshlrev_b32 v68, 16, v20
v_and_b32 v69, 0xffff0000, v20
v_lshlrev_b32 v70, 16, v21
v_and_b32 v71, 0xffff0000, v21
v_lshlrev_b32 v72, 16, v22
v_and_b32 v73, 0xffff0000, v22
v_lshlrev_b32 v74, 16, v23
v_and_b32 v75, 0xffff0000, v23
s_waitcnt lgkmcnt(0)
v_fma_f32 v12, v68, v64, -v65
v_fma_f32 v13, v69, v64, -v65
s_waitcnt vmcnt(6)
v_lshlrev_b32 v66, 16, v52
v_and_b32 v67, 0xffff0000, v52
v_fmac_f32 v68, v12, v66
v_fmac_f32 v69, v13, v67
v_fma_f32 v12, v70, v64, -v65
v_fma_f32 v13, v71, v64, -v65
v_lshlrev_b32 v66, 16, v53
v_and_b32 v67, 0xffff0000, v53
v_fmac_f32 v70, v12, v66
v_fmac_f32 v71, v13, v67
v_fma_f32 v12, v72, v64, -v65
v_fma_f32 v13, v73, v64, -v65
s_waitcnt vmcnt(5)
v_lshlrev_b32 v66, 16, v54
v_and_b32 v67, 0xffff0000, v54
v_fmac_f32 v72, v12, v66
v_fmac_f32 v73, v13, v67
v_fma_f32 v12, v74, v64, -v65
v_fma_f32 v13, v75, v64, -v65
v_lshlrev_b32 v66, 16, v55
v_and_b32 v67, 0xffff0000, v55
v_fmac_f32 v74, v12, v66
v_fmac_f32 v75, v13, v67
v_cvt_pk_bf16_f32 v76, v68, v69
v_cvt_pk_bf16_f32 v77, v70, v71
v_cvt_pk_bf16_f32 v78, v72, v73
v_cvt_pk_bf16_f32 v79, v74, v75
s_add_u32 s27, s35, 327680
buffer_store_dwordx4 v[76:79], v2, s[4:7], s27 offen sc1
ds_write_b128 v8, v[76:79] offset:4096
v_add_f32 v52, v68, v69
v_mul_f32 v53, v68, v68
v_fmac_f32 v53, v69, v69
v_add_f32 v52, v52, v70
v_fmac_f32 v53, v70, v70
v_add_f32 v52, v52, v71
v_fmac_f32 v53, v71, v71
v_add_f32 v52, v52, v72
v_fmac_f32 v53, v72, v72
v_add_f32 v52, v52, v73
v_fmac_f32 v53, v73, v73
v_add_f32 v52, v52, v74
v_fmac_f32 v53, v74, v74
v_add_f32 v52, v52, v75
v_fmac_f32 v53, v75, v75
s_nop 1
v_permlane32_swap_b32 v52, v53
v_add_f32 v52, v52, v53
v_mov_b32 v10, v52
s_nop 1
v_permlane16_swap_b32 v52, v10
v_add_f32 v52, v52, v10
v_mov_b32 v53, v52
s_nop 1
v_permlane32_swap_b32 v52, v53
v_mov_b32 v54, s20
v_mov_b32 v55, s20
ds_read_b64 v[64:65], v11 offset:256
v_lshlrev_b32 v68, 16, v24
v_and_b32 v69, 0xffff0000, v24
v_lshlrev_b32 v70, 16, v25
v_and_b32 v71, 0xffff0000, v25
v_lshlrev_b32 v72, 16, v26
v_and_b32 v73, 0xffff0000, v26
v_lshlrev_b32 v74, 16, v27
v_and_b32 v75, 0xffff0000, v27
s_waitcnt lgkmcnt(0)
v_fma_f32 v12, v68, v64, -v65
v_fma_f32 v13, v69, v64, -v65
s_waitcnt vmcnt(5)
v_lshlrev_b32 v66, 16, v56
v_and_b32 v67, 0xffff0000, v56
v_fmac_f32 v68, v12, v66
v_fmac_f32 v69, v13, v67
v_fma_f32 v12, v70, v64, -v65
v_fma_f32 v13, v71, v64, -v65
v_lshlrev_b32 v66, 16, v57
v_and_b32 v67, 0xffff0000, v57
v_fmac_f32 v70, v12, v66
v_fmac_f32 v71, v13, v67
v_fma_f32 v12, v72, v64, -v65
v_fma_f32 v13, v73, v64, -v65
s_waitcnt vmcnt(4)
v_lshlrev_b32 v66, 16, v58
v_and_b32 v67, 0xffff0000, v58
v_fmac_f32 v72, v12, v66
v_fmac_f32 v73, v13, v67
v_fma_f32 v12, v74, v64, -v65
v_fma_f32 v13, v75, v64, -v65
v_lshlrev_b32 v66, 16, v59
v_and_b32 v67, 0xffff0000, v59
v_fmac_f32 v74, v12, v66
v_fmac_f32 v75, v13, v67
v_cvt_pk_bf16_f32 v76, v68, v69
v_cvt_pk_bf16_f32 v77, v70, v71
v_cvt_pk_bf16_f32 v78, v72, v73
v_cvt_pk_bf16_f32 v79, v74, v75
s_add_u32 s27, s35, 655360
buffer_store_dwordx4 v[76:79], v2, s[4:7], s27 offen sc1
ds_write_b128 v8, v[76:79] offset:8192
v_add_f32 v56, v68, v69
v_mul_f32 v57, v68, v68
v_fmac_f32 v57, v69, v69
v_add_f32 v56, v56, v70
v_fmac_f32 v57, v70, v70
v_add_f32 v56, v56, v71
v_fmac_f32 v57, v71, v71
v_add_f32 v56, v56, v72
v_fmac_f32 v57, v72, v72
v_add_f32 v56, v56, v73
v_fmac_f32 v57, v73, v73
v_add_f32 v56, v56, v74
v_fmac_f32 v57, v74, v74
v_add_f32 v56, v56, v75
v_fmac_f32 v57, v75, v75
s_nop 1
v_permlane32_swap_b32 v56, v57
v_add_f32 v56, v56, v57
v_mov_b32 v10, v56
s_nop 1
v_permlane16_swap_b32 v56, v10
v_add_f32 v56, v56, v10
v_mov_b32 v57, v56
s_nop 1
v_permlane32_swap_b32 v56, v57
v_mov_b32 v58, s20
v_mov_b32 v59, s20
ds_read_b64 v[64:65], v11 offset:384
v_lshlrev_b32 v68, 16, v28
v_and_b32 v69, 0xffff0000, v28
v_lshlrev_b32 v70, 16, v29
v_and_b32 v71, 0xffff0000, v29
v_lshlrev_b32 v72, 16, v30
v_and_b32 v73, 0xffff0000, v30
v_lshlrev_b32 v74, 16, v31
v_and_b32 v75, 0xffff0000, v31
s_waitcnt lgkmcnt(0)
v_fma_f32 v12, v68, v64, -v65
v_fma_f32 v13, v69, v64, -v65
s_waitcnt vmcnt(4)
v_lshlrev_b32 v66, 16, v60
v_and_b32 v67, 0xffff0000, v60
v_fmac_f32 v68, v12, v66
v_fmac_f32 v69, v13, v67
v_fma_f32 v12, v70, v64, -v65
v_fma_f32 v13, v71, v64, -v65
v_lshlrev_b32 v66, 16, v61
v_and_b32 v67, 0xffff0000, v61
v_fmac_f32 v70, v12, v66
v_fmac_f32 v71, v13, v67
v_fma_f32 v12, v72, v64, -v65
v_fma_f32 v13, v73, v64, -v65
s_waitcnt vmcnt(3)
v_lshlrev_b32 v66, 16, v62
v_and_b32 v67, 0xffff0000, v62
v_fmac_f32 v72, v12, v66
v_fmac_f32 v73, v13, v67
v_fma_f32 v12, v74, v64, -v65
v_fma_f32 v13, v75, v64, -v65
v_lshlrev_b32 v66, 16, v63
v_and_b32 v67, 0xffff0000, v63
v_fmac_f32 v74, v12, v66
v_fmac_f32 v75, v13, v67
v_cvt_pk_bf16_f32 v76, v68, v69
v_cvt_pk_bf16_f32 v77, v70, v71
v_cvt_pk_bf16_f32 v78, v72, v73
v_cvt_pk_bf16_f32 v79, v74, v75
s_add_u32 s27, s35, 983040
buffer_store_dwordx4 v[76:79], v2, s[4:7], s27 offen sc1
ds_write_b128 v8, v[76:79] offset:12288
v_add_f32 v60, v68, v69
v_mul_f32 v61, v68, v68
v_fmac_f32 v61, v69, v69
v_add_f32 v60, v60, v70
v_fmac_f32 v61, v70, v70
v_add_f32 v60, v60, v71
v_fmac_f32 v61, v71, v71
v_add_f32 v60, v60, v72
v_fmac_f32 v61, v72, v72
v_add_f32 v60, v60, v73
v_fmac_f32 v61, v73, v73
v_add_f32 v60, v60, v74
v_fmac_f32 v61, v74, v74
v_add_f32 v60, v60, v75
v_fmac_f32 v61, v75, v75
s_nop 1
v_permlane32_swap_b32 v60, v61
v_add_f32 v60, v60, v61
v_mov_b32 v10, v60
s_nop 1
v_permlane16_swap_b32 v60, v10
v_add_f32 v60, v60, v10
v_mov_b32 v61, v60
s_nop 1
v_permlane32_swap_b32 v60, v61
v_mov_b32 v62, s20
v_mov_b32 v63, s20
s_add_u32 s27, s36, 0
s_waitcnt vmcnt(3)
buffer_store_dwordx4 v[48:51], v5, s[4:7], s27 offen sc1
s_add_u32 s27, s36, 81920
s_waitcnt vmcnt(3)
buffer_store_dwordx4 v[52:55], v5, s[4:7], s27 offen sc1
s_add_u32 s27, s36, 163840
s_waitcnt vmcnt(3)
buffer_store_dwordx4 v[56:59], v5, s[4:7], s27 offen sc1
s_add_u32 s27, s36, 245760
s_waitcnt vmcnt(3)
buffer_store_dwordx4 v[60:63], v5, s[4:7], s27 offen sc1
s_waitcnt vmcnt(24) lgkmcnt(0)
s_barrier
s_add_u32 m0, s43, 16384
s_add_u32 s44, s42, 1392640
buffer_load_dwordx4 v0, s[12:15], s44 offen lds
s_add_u32 m0, s43, 17408
s_add_u32 s44, s42, 1397760
buffer_load_dwordx4 v3, s[12:15], s44 offen lds
s_add_u32 m0, s43, 24576
s_add_u32 s44, s42, 1433600
buffer_load_dwordx4 v0, s[12:15], s44 offen lds
s_add_u32 m0, s43, 25600
s_add_u32 s44, s42, 1438720
buffer_load_dwordx4 v3, s[12:15], s44 offen lds
ds_read_b64_tr_b16 a[224:225], v9 offset:32768
ds_read_b64_tr_b16 a[226:227], v9 offset:36864
ds_read_b64_tr_b16 a[228:229], v1 offset:32768
ds_read_b64_tr_b16 a[230:231], v1 offset:36864
ds_read_b64_tr_b16 a[232:233], v9 offset:40960
ds_read_b64_tr_b16 a[234:235], v9 offset:45056
ds_read_b64_tr_b16 a[236:237], v1 offset:40960
ds_read_b64_tr_b16 a[238:239], v1 offset:45056
s_waitcnt vmcnt(24) lgkmcnt(0)
s_barrier
s_add_u32 m0, s43, 32768
s_add_u32 s44, s42, 1474560
buffer_load_dwordx4 v0, s[12:15], s44 offen lds
s_add_u32 m0, s43, 33792
s_add_u32 s44, s42, 1479680
buffer_load_dwordx4 v3, s[12:15], s44 offen lds
s_add_u32 m0, s43, 40960
s_add_u32 s44, s42, 1515520
buffer_load_dwordx4 v0, s[12:15], s44 offen lds
s_add_u32 m0, s43, 41984
s_add_u32 s44, s42, 1520640
buffer_load_dwordx4 v3, s[12:15], s44 offen lds
ds_read_b64_tr_b16 a[240:241], v9 offset:49152
ds_read_b64_tr_b16 a[242:243], v9 offset:53248
ds_read_b64_tr_b16 a[244:245], v1 offset:49152
ds_read_b64_tr_b16 a[246:247], v1 offset:53248
ds_read_b64_tr_b16 a[248:249], v9 offset:57344
ds_read_b64_tr_b16 a[250:251], v9 offset:61440
ds_read_b64_tr_b16 a[252:253], v1 offset:57344
ds_read_b64_tr_b16 a[254:255], v1 offset:61440
s_waitcnt vmcnt(24) lgkmcnt(0)
s_barrier
s_add_u32 m0, s43, 49152
s_add_u32 s44, s42, 1556480
buffer_load_dwordx4 v0, s[12:15], s44 offen lds
s_add_u32 m0, s43, 50176
s_add_u32 s44, s42, 1561600
buffer_load_dwordx4 v3, s[12:15], s44 offen lds
s_add_u32 m0, s43, 57344
s_add_u32 s44, s42, 1597440
buffer_load_dwordx4 v0, s[12:15], s44 offen lds
s_add_u32 m0, s43, 58368
s_add_u32 s44, s42, 1602560
buffer_load_dwordx4 v3, s[12:15], s44 offen lds
ds_read_b64_tr_b16 v[80:81], v9 offset:0
ds_read_b64_tr_b16 v[82:83], v9 offset:4096
ds_read_b64_tr_b16 v[84:85], v1 offset:0
ds_read_b64_tr_b16 v[86:87], v1 offset:4096
ds_read_b64_tr_b16 v[88:89], v9 offset:8192
ds_read_b64_tr_b16 v[90:91], v9 offset:12288
ds_read_b64_tr_b16 v[92:93], v1 offset:8192
ds_read_b64_tr_b16 v[94:95], v1 offset:12288
s_waitcnt vmcnt(8) lgkmcnt(0)
s_barrier
s_add_u32 m0, s43, 0
s_add_u32 s44, s42, 1638400
buffer_load_dwordx4 v0, s[12:15], s44 offen lds
s_add_u32 m0, s43, 1024
s_add_u32 s44, s42, 1643520
buffer_load_dwordx4 v3, s[12:15], s44 offen lds
s_add_u32 m0, s43, 8192
s_add_u32 s44, s42, 1679360
buffer_load_dwordx4 v0, s[12:15], s44 offen lds
s_add_u32 m0, s43, 9216
s_add_u32 s44, s42, 1684480
buffer_load_dwordx4 v3, s[12:15], s44 offen lds
ds_read_b64_tr_b16 v[96:97], v9 offset:16384
ds_read_b64_tr_b16 v[98:99], v9 offset:20480
ds_read_b64_tr_b16 v[100:101], v1 offset:16384
ds_read_b64_tr_b16 v[102:103], v1 offset:20480
ds_read_b64_tr_b16 v[104:105], v9 offset:24576
ds_read_b64_tr_b16 v[106:107], v9 offset:28672
ds_read_b64_tr_b16 v[108:109], v1 offset:24576
ds_read_b64_tr_b16 v[110:111], v1 offset:28672
s_waitcnt vmcnt(8) lgkmcnt(0)
s_barrier
s_add_u32 m0, s43, 16384
s_add_u32 s44, s42, 1720320
buffer_load_dwordx4 v0, s[12:15], s44 offen lds
s_add_u32 m0, s43, 17408
s_add_u32 s44, s42, 1725440
buffer_load_dwordx4 v3, s[12:15], s44 offen lds
s_add_u32 m0, s43, 24576
s_add_u32 s44, s42, 1761280
buffer_load_dwordx4 v0, s[12:15], s44 offen lds
s_add_u32 m0, s43, 25600
s_add_u32 s44, s42, 1766400
buffer_load_dwordx4 v3, s[12:15], s44 offen lds
ds_read_b64_tr_b16 v[112:113], v9 offset:32768
ds_read_b64_tr_b16 v[114:115], v9 offset:36864
ds_read_b64_tr_b16 v[116:117], v1 offset:32768
ds_read_b64_tr_b16 v[118:119], v1 offset:36864
ds_read_b64_tr_b16 v[120:121], v9 offset:40960
ds_read_b64_tr_b16 v[122:123], v9 offset:45056
ds_read_b64_tr_b16 v[124:125], v1 offset:40960
ds_read_b64_tr_b16 v[126:127], v1 offset:45056
s_waitcnt vmcnt(8) lgkmcnt(0)
s_barrier
s_add_u32 m0, s43, 32768
s_add_u32 s44, s42, 1802240
buffer_load_dwordx4 v0, s[12:15], s44 offen lds
s_add_u32 m0, s43, 33792
s_add_u32 s44, s42, 1807360
buffer_load_dwordx4 v3, s[12:15], s44 offen lds
s_add_u32 m0, s43, 40960
s_add_u32 s44, s42, 1843200
buffer_load_dwordx4 v0, s[12:15], s44 offen lds
s_add_u32 m0, s43, 41984
s_add_u32 s44, s42, 1848320
buffer_load_dwordx4 v3, s[12:15], s44 offen lds
ds_read_b64_tr_b16 v[128:129], v9 offset:49152
ds_read_b64_tr_b16 v[130:131], v9 offset:53248
ds_read_b64_tr_b16 v[132:133], v1 offset:49152
ds_read_b64_tr_b16 v[134:135], v1 offset:53248
ds_read_b64_tr_b16 v[136:137], v9 offset:57344
ds_read_b64_tr_b16 v[138:139], v9 offset:61440
ds_read_b64_tr_b16 v[140:141], v1 offset:57344
ds_read_b64_tr_b16 v[142:143], v1 offset:61440
s_mul_i32 s31, s41, 20480
s_mul_i32 s32, s41, 5120
s_add_u32 s33, s31, 0x300000
s_lshl_b32 s35, s40, 10
s_add_u32 s35, s35, s31
s_add_u32 s35, s35, 0x600000
s_lshl_b32 s36, s40, 8
s_add_u32 s36, s36, s32
s_add_u32 s36, s36, 0x1d00000
s_lshl_b32 s26, s40, 7
s_add_u32 s26, s26, 0x1f02a00
v_and_b32 v10, 0x70, v2
s_mov_b32 s90, 40000
Lpoll_27:
buffer_load_dword v64, v10, s[4:7], s26 offen sc1
s_waitcnt vmcnt(0)
v_cmp_ne_u32 vcc, s20, v64
s_cmp_eq_u64 vcc, 0
s_cbranch_scc1 Lpok_28

s_sub_u32 s90, s90, 1
s_cmp_lg_u32 s90, 0
s_cbranch_scc1 Lpoll_27
s_mov_b32 s8, s86
s_mov_b32 s9, s87
s_mov_b32 s10, 0x100
s_mov_b32 s11, 0x20000
v_mov_b32 v2, 0x2
v_mov_b32 v3, 0x8
s_nop 1
buffer_store_dword v2, v3, s[8:11], 0 offen
s_waitcnt vmcnt(0)
s_endpgm
Lpok_28:
s_waitcnt vmcnt(0)
s_add_u32 s27, s33, 1310720
buffer_load_dwordx2 v[48:49], v7, s[4:7], s27 offen sc1
buffer_load_dwordx2 v[50:51], v7, s[4:7], s27 offen offset:512 sc1
s_add_u32 s27, s33, 1638400
buffer_load_dwordx2 v[52:53], v7, s[4:7], s27 offen sc1
buffer_load_dwordx2 v[54:55], v7, s[4:7], s27 offen offset:512 sc1
s_add_u32 s27, s33, 1966080
buffer_load_dwordx2 v[56:57], v7, s[4:7], s27 offen sc1
buffer_load_dwordx2 v[58:59], v7, s[4:7], s27 offen offset:512 sc1
s_add_u32 s27, s33, 2293760
buffer_load_dwordx2 v[60:61], v7, s[4:7], s27 offen sc1
buffer_load_dwordx2 v[62:63], v7, s[4:7], s27 offen offset:512 sc1
ds_read_b64 v[64:65], v11 offset:512
v_lshlrev_b32 v68, 16, v32
v_and_b32 v69, 0xffff0000, v32
v_lshlrev_b32 v70, 16, v33
v_and_b32 v71, 0xffff0000, v33
v_lshlrev_b32 v72, 16, v34
v_and_b32 v73, 0xffff0000, v34
v_lshlrev_b32 v74, 16, v35
v_and_b32 v75, 0xffff0000, v35
s_waitcnt lgkmcnt(0)
v_fma_f32 v12, v68, v64, -v65
v_fma_f32 v13, v69, v64, -v65
s_waitcnt vmcnt(7)
v_lshlrev_b32 v66, 16, v48
v_and_b32 v67, 0xffff0000, v48
v_fmac_f32 v68, v12, v66
v_fmac_f32 v69, v13, v67
v_fma_f32 v12, v70, v64, -v65
v_fma_f32 v13, v71, v64, -v65
v_lshlrev_b32 v66, 16, v49
v_and_b32 v67, 0xffff0000, v49
v_fmac_f32 v70, v12, v66
v_fmac_f32 v71, v13, v67
v_fma_f32 v12, v72, v64, -v65
v_fma_f32 v13, v73, v64, -v65
s_waitcnt vmcnt(6)
v_lshlrev_b32 v66, 16, v50
v_and_b32 v67, 0xffff0000, v50
v_fmac_f32 v72, v12, v66
v_fmac_f32 v73, v13, v67
v_fma_f32 v12, v74, v64, -v65
v_fma_f32 v13, v75, v64, -v65
v_lshlrev_b32 v66, 16, v51
v_and_b32 v67, 0xffff0000, v51
v_fmac_f32 v74, v12, v66
v_fmac_f32 v75, v13, v67
v_cvt_pk_bf16_f32 v76, v68, v69
v_cvt_pk_bf16_f32 v77, v70, v71
v_cvt_pk_bf16_f32 v78, v72, v73
v_cvt_pk_bf16_f32 v79, v74, v75
s_add_u32 s27, s35, 1310720
buffer_store_dwordx4 v[76:79], v2, s[4:7], s27 offen sc1
ds_write_b128 v8, v[76:79] offset:16384
v_add_f32 v48, v68, v69
v_mul_f32 v49, v68, v68
v_fmac_f32 v49, v69, v69
v_add_f32 v48, v48, v70
v_fmac_f32 v49, v70, v70
v_add_f32 v48, v48, v71
v_fmac_f32 v49, v71, v71
v_add_f32 v48, v48, v72
v_fmac_f32 v49, v72, v72
v_add_f32 v48, v48, v73
v_fmac_f32 v49, v73, v73
v_add_f32 v48, v48, v74
v_fmac_f32 v49, v74, v74
v_add_f32 v48, v48, v75
v_fmac_f32 v49, v75, v75
s_nop 1
v_permlane32_swap_b32 v48, v49
v_add_f32 v48, v48, v49
v_mov_b32 v10, v48
s_nop 1
v_permlane16_swap_b32 v48, v10
v_add_f32 v48, v48, v10
v_mov_b32 v49, v48
s_nop 1
v_permlane32_swap_b32 v48, v49
v_mov_b32 v50, s20
v_mov_b32 v51, s20
ds_read_b64 v[64:65], v11 offset:640
v_lshlrev_b32 v68, 16, v36
v_and_b32 v69, 0xffff0000, v36
v_lshlrev_b32 v70, 16, v37
v_and_b32 v71, 0xffff0000, v37
v_lshlrev_b32 v72, 16, v38
v_and_b32 v73, 0xffff0000, v38
v_lshlrev_b32 v74, 16, v39
v_and_b32 v75, 0xffff0000, v39
s_waitcnt lgkmcnt(0)
v_fma_f32 v12, v68, v64, -v65
v_fma_f32 v13, v69, v64, -v65
s_waitcnt vmcnt(6)
v_lshlrev_b32 v66, 16, v52
v_and_b32 v67, 0xffff0000, v52
v_fmac_f32 v68, v12, v66
v_fmac_f32 v69, v13, v67
v_fma_f32 v12, v70, v64, -v65
v_fma_f32 v13, v71, v64, -v65
v_lshlrev_b32 v66, 16, v53
v_and_b32 v67, 0xffff0000, v53
v_fmac_f32 v70, v12, v66
v_fmac_f32 v71, v13, v67
v_fma_f32 v12, v72, v64, -v65
v_fma_f32 v13, v73, v64, -v65
s_waitcnt vmcnt(5)
v_lshlrev_b32 v66, 16, v54
v_and_b32 v67, 0xffff0000, v54
v_fmac_f32 v72, v12, v66
v_fmac_f32 v73, v13, v67
v_fma_f32 v12, v74, v64, -v65
v_fma_f32 v13, v75, v64, -v65
v_lshlrev_b32 v66, 16, v55
v_and_b32 v67, 0xffff0000, v55
v_fmac_f32 v74, v12, v66
v_fmac_f32 v75, v13, v67
v_cvt_pk_bf16_f32 v76, v68, v69
v_cvt_pk_bf16_f32 v77, v70, v71
v_cvt_pk_bf16_f32 v78, v72, v73
v_cvt_pk_bf16_f32 v79, v74, v75
s_add_u32 s27, s35, 1638400
buffer_store_dwordx4 v[76:79], v2, s[4:7], s27 offen sc1
ds_write_b128 v8, v[76:79] offset:20480
v_add_f32 v52, v68, v69
v_mul_f32 v53, v68, v68
v_fmac_f32 v53, v69, v69
v_add_f32 v52, v52, v70
v_fmac_f32 v53, v70, v70
v_add_f32 v52, v52, v71
v_fmac_f32 v53, v71, v71
v_add_f32 v52, v52, v72
v_fmac_f32 v53, v72, v72
v_add_f32 v52, v52, v73
v_fmac_f32 v53, v73, v73
v_add_f32 v52, v52, v74
v_fmac_f32 v53, v74, v74
v_add_f32 v52, v52, v75
v_fmac_f32 v53, v75, v75
s_nop 1
v_permlane32_swap_b32 v52, v53
v_add_f32 v52, v52, v53
v_mov_b32 v10, v52
s_nop 1
v_permlane16_swap_b32 v52, v10
v_add_f32 v52, v52, v10
v_mov_b32 v53, v52
s_nop 1
v_permlane32_swap_b32 v52, v53
v_mov_b32 v54, s20
v_mov_b32 v55, s20
ds_read_b64 v[64:65], v11 offset:768
v_lshlrev_b32 v68, 16, v40
v_and_b32 v69, 0xffff0000, v40
v_lshlrev_b32 v70, 16, v41
v_and_b32 v71, 0xffff0000, v41
v_lshlrev_b32 v72, 16, v42
v_and_b32 v73, 0xffff0000, v42
v_lshlrev_b32 v74, 16, v43
v_and_b32 v75, 0xffff0000, v43
s_waitcnt lgkmcnt(0)
v_fma_f32 v12, v68, v64, -v65
v_fma_f32 v13, v69, v64, -v65
s_waitcnt vmcnt(5)
v_lshlrev_b32 v66, 16, v56
v_and_b32 v67, 0xffff0000, v56
v_fmac_f32 v68, v12, v66
v_fmac_f32 v69, v13, v67
v_fma_f32 v12, v70, v64, -v65
v_fma_f32 v13, v71, v64, -v65
v_lshlrev_b32 v66, 16, v57
v_and_b32 v67, 0xffff0000, v57
v_fmac_f32 v70, v12, v66
v_fmac_f32 v71, v13, v67
v_fma_f32 v12, v72, v64, -v65
v_fma_f32 v13, v73, v64, -v65
s_waitcnt vmcnt(4)
v_lshlrev_b32 v66, 16, v58
v_and_b32 v67, 0xffff0000, v58
v_fmac_f32 v72, v12, v66
v_fmac_f32 v73, v13, v67
v_fma_f32 v12, v74, v64, -v65
v_fma_f32 v13, v75, v64, -v65
v_lshlrev_b32 v66, 16, v59
v_and_b32 v67, 0xffff0000, v59
v_fmac_f32 v74, v12, v66
v_fmac_f32 v75, v13, v67
v_cvt_pk_bf16_f32 v76, v68, v69
v_cvt_pk_bf16_f32 v77, v70, v71
v_cvt_pk_bf16_f32 v78, v72, v73
v_cvt_pk_bf16_f32 v79, v74, v75
s_add_u32 s27, s35, 1966080
buffer_store_dwordx4 v[76:79], v2, s[4:7], s27 offen sc1
ds_write_b128 v8, v[76:79] offset:24576
v_add_f32 v56, v68, v69
v_mul_f32 v57, v68, v68
v_fmac_f32 v57, v69, v69
v_add_f32 v56, v56, v70
v_fmac_f32 v57, v70, v70
v_add_f32 v56, v56, v71
v_fmac_f32 v57, v71, v71
v_add_f32 v56, v56, v72
v_fmac_f32 v57, v72, v72
v_add_f32 v56, v56, v73
v_fmac_f32 v57, v73, v73
v_add_f32 v56, v56, v74
v_fmac_f32 v57, v74, v74
v_add_f32 v56, v56, v75
v_fmac_f32 v57, v75, v75
s_nop 1
v_permlane32_swap_b32 v56, v57
v_add_f32 v56, v56, v57
v_mov_b32 v10, v56
s_nop 1
v_permlane16_swap_b32 v56, v10
v_add_f32 v56, v56, v10
v_mov_b32 v57, v56
s_nop 1
v_permlane32_swap_b32 v56, v57
v_mov_b32 v58, s20
v_mov_b32 v59, s20
ds_read_b64 v[64:65], v11 offset:896
v_lshlrev_b32 v68, 16, v44
v_and_b32 v69, 0xffff0000, v44
v_lshlrev_b32 v70, 16, v45
v_and_b32 v71, 0xffff0000, v45
v_lshlrev_b32 v72, 16, v46
v_and_b32 v73, 0xffff0000, v46
v_lshlrev_b32 v74, 16, v47
v_and_b32 v75, 0xffff0000, v47
s_waitcnt lgkmcnt(0)
v_fma_f32 v12, v68, v64, -v65
v_fma_f32 v13, v69, v64, -v65
s_waitcnt vmcnt(4)
v_lshlrev_b32 v66, 16, v60
v_and_b32 v67, 0xffff0000, v60
v_fmac_f32 v68, v12, v66
v_fmac_f32 v69, v13, v67
v_fma_f32 v12, v70, v64, -v65
v_fma_f32 v13, v71, v64, -v65
v_lshlrev_b32 v66, 16, v61
v_and_b32 v67, 0xffff0000, v61
v_fmac_f32 v70, v12, v66
v_fmac_f32 v71, v13, v67
v_fma_f32 v12, v72, v64, -v65
v_fma_f32 v13, v73, v64, -v65
s_waitcnt vmcnt(3)
v_lshlrev_b32 v66, 16, v62
v_and_b32 v67, 0xffff0000, v62
v_fmac_f32 v72, v12, v66
v_fmac_f32 v73, v13, v67
v_fma_f32 v12, v74, v64, -v65
v_fma_f32 v13, v75, v64, -v65
v_lshlrev_b32 v66, 16, v63
v_and_b32 v67, 0xffff0000, v63
v_fmac_f32 v74, v12, v66
v_fmac_f32 v75, v13, v67
v_cvt_pk_bf16_f32 v76, v68, v69
v_cvt_pk_bf16_f32 v77, v70, v71
v_cvt_pk_bf16_f32 v78, v72, v73
v_cvt_pk_bf16_f32 v79, v74, v75
s_add_u32 s27, s35, 2293760
buffer_store_dwordx4 v[76:79], v2, s[4:7], s27 offen sc1
ds_write_b128 v8, v[76:79] offset:28672
v_add_f32 v60, v68, v69
v_mul_f32 v61, v68, v68
v_fmac_f32 v61, v69, v69
v_add_f32 v60, v60, v70
v_fmac_f32 v61, v70, v70
v_add_f32 v60, v60, v71
v_fmac_f32 v61, v71, v71
v_add_f32 v60, v60, v72
v_fmac_f32 v61, v72, v72
v_add_f32 v60, v60, v73
v_fmac_f32 v61, v73, v73
v_add_f32 v60, v60, v74
v_fmac_f32 v61, v74, v74
v_add_f32 v60, v60, v75
v_fmac_f32 v61, v75, v75
s_nop 1
v_permlane32_swap_b32 v60, v61
v_add_f32 v60, v60, v61
v_mov_b32 v10, v60
s_nop 1
v_permlane16_swap_b32 v60, v10
v_add_f32 v60, v60, v10
v_mov_b32 v61, v60
s_nop 1
v_permlane32_swap_b32 v60, v61
v_mov_b32 v62, s20
v_mov_b32 v63, s20
s_add_u32 s27, s36, 327680
s_waitcnt vmcnt(3)
buffer_store_dwordx4 v[48:51], v5, s[4:7], s27 offen sc1
s_add_u32 s27, s36, 409600
s_waitcnt vmcnt(3)
buffer_store_dwordx4 v[52:55], v5, s[4:7], s27 offen sc1
s_add_u32 s27, s36, 491520
s_waitcnt vmcnt(3)
buffer_store_dwordx4 v[56:59], v5, s[4:7], s27 offen sc1
s_add_u32 s27, s36, 573440
s_waitcnt vmcnt(3)
buffer_store_dwordx4 v[60:63], v5, s[4:7], s27 offen sc1
s_waitcnt vmcnt(24) lgkmcnt(0)
s_barrier
s_add_u32 m0, s43, 49152
s_add_u32 s44, s42, 1884160
buffer_load_dwordx4 v0, s[12:15], s44 offen lds
s_add_u32 m0, s43, 50176
s_add_u32 s44, s42, 1889280
buffer_load_dwordx4 v3, s[12:15], s44 offen lds
s_add_u32 m0, s43, 57344
s_add_u32 s44, s42, 1925120
buffer_load_dwordx4 v0, s[12:15], s44 offen lds
s_add_u32 m0, s43, 58368
s_add_u32 s44, s42, 1930240
buffer_load_dwordx4 v3, s[12:15], s44 offen lds
ds_read_b64_tr_b16 v[144:145], v9 offset:0
ds_read_b64_tr_b16 v[146:147], v9 offset:4096
ds_read_b64_tr_b16 v[148:149], v1 offset:0
ds_read_b64_tr_b16 v[150:151], v1 offset:4096
ds_read_b64_tr_b16 v[152:153], v9 offset:8192
ds_read_b64_tr_b16 v[154:155], v9 offset:12288
ds_read_b64_tr_b16 v[156:157], v1 offset:8192
ds_read_b64_tr_b16 v[158:159], v1 offset:12288
s_waitcnt vmcnt(24) lgkmcnt(0)
s_barrier
s_add_u32 m0, s43, 0
s_add_u32 s44, s42, 1966080
buffer_load_dwordx4 v0, s[12:15], s44 offen lds
s_add_u32 m0, s43, 1024
s_add_u32 s44, s42, 1971200
buffer_load_dwordx4 v3, s[12:15], s44 offen lds
s_add_u32 m0, s43, 8192
s_add_u32 s44, s42, 2007040
buffer_load_dwordx4 v0, s[12:15], s44 offen lds
s_add_u32 m0, s43, 9216
s_add_u32 s44, s42, 2012160
buffer_load_dwordx4 v3, s[12:15], s44 offen lds
ds_read_b64_tr_b16 v[160:161], v9 offset:16384
ds_read_b64_tr_b16 v[162:163], v9 offset:20480
ds_read_b64_tr_b16 v[164:165], v1 offset:16384
ds_read_b64_tr_b16 v[166:167], v1 offset:20480
ds_read_b64_tr_b16 v[168:169], v9 offset:24576
ds_read_b64_tr_b16 v[170:171], v9 offset:28672
ds_read_b64_tr_b16 v[172:173], v1 offset:24576
ds_read_b64_tr_b16 v[174:175], v1 offset:28672
s_waitcnt vmcnt(24) lgkmcnt(0)
s_barrier
s_add_u32 m0, s43, 16384
s_add_u32 s44, s42, 2048000
buffer_load_dwordx4 v0, s[12:15], s44 offen lds
s_add_u32 m0, s43, 17408
s_add_u32 s44, s42, 2053120
buffer_load_dwordx4 v3, s[12:15], s44 offen lds
s_add_u32 m0, s43, 24576
s_add_u32 s44, s42, 2088960
buffer_load_dwordx4 v0, s[12:15], s44 offen lds
s_add_u32 m0, s43, 25600
s_add_u32 s44, s42, 2094080
buffer_load_dwordx4 v3, s[12:15], s44 offen lds
ds_read_b64_tr_b16 v[176:177], v9 offset:32768
ds_read_b64_tr_b16 v[178:179], v9 offset:36864
ds_read_b64_tr_b16 v[180:181], v1 offset:32768
ds_read_b64_tr_b16 v[182:183], v1 offset:36864
ds_read_b64_tr_b16 v[184:185], v9 offset:40960
ds_read_b64_tr_b16 v[186:187], v9 offset:45056
ds_read_b64_tr_b16 v[188:189], v1 offset:40960
ds_read_b64_tr_b16 v[190:191], v1 offset:45056
s_waitcnt vmcnt(8) lgkmcnt(0)
s_barrier
s_add_u32 m0, s43, 32768
s_add_u32 s44, s42, 2129920
buffer_load_dwordx4 v0, s[12:15], s44 offen lds
s_add_u32 m0, s43, 33792
s_add_u32 s44, s42, 2135040
buffer_load_dwordx4 v3, s[12:15], s44 offen lds
s_add_u32 m0, s43, 40960
s_add_u32 s44, s42, 2170880
buffer_load_dwordx4 v0, s[12:15], s44 offen lds
s_add_u32 m0, s43, 41984
s_add_u32 s44, s42, 2176000
buffer_load_dwordx4 v3, s[12:15], s44 offen lds
ds_read_b64_tr_b16 v[192:193], v9 offset:49152
ds_read_b64_tr_b16 v[194:195], v9 offset:53248
ds_read_b64_tr_b16 v[196:197], v1 offset:49152
ds_read_b64_tr_b16 v[198:199], v1 offset:53248
ds_read_b64_tr_b16 v[200:201], v9 offset:57344
ds_read_b64_tr_b16 v[202:203], v9 offset:61440
ds_read_b64_tr_b16 v[204:205], v1 offset:57344
ds_read_b64_tr_b16 v[206:207], v1 offset:61440
s_waitcnt vmcnt(8) lgkmcnt(0)
s_barrier
ds_read_b64_tr_b16 v[208:209], v9 offset:0
ds_read_b64_tr_b16 v[210:211], v9 offset:4096
ds_read_b64_tr_b16 v[212:213], v1 offset:0
ds_read_b64_tr_b16 v[214:215], v1 offset:4096
ds_read_b64_tr_b16 v[216:217], v9 offset:8192
ds_read_b64_tr_b16 v[218:219], v9 offset:12288
ds_read_b64_tr_b16 v[220:221], v1 offset:8192
ds_read_b64_tr_b16 v[222:223], v1 offset:12288
s_waitcnt vmcnt(4) lgkmcnt(0)
s_barrier
ds_read_b64_tr_b16 v[224:225], v9 offset:16384
ds_read_b64_tr_b16 v[226:227], v9 offset:20480
ds_read_b64_tr_b16 v[228:229], v1 offset:16384
ds_read_b64_tr_b16 v[230:231], v1 offset:20480
ds_read_b64_tr_b16 v[232:233], v9 offset:24576
ds_read_b64_tr_b16 v[234:235], v9 offset:28672
ds_read_b64_tr_b16 v[236:237], v1 offset:24576
ds_read_b64_tr_b16 v[238:239], v1 offset:28672
s_waitcnt vmcnt(0) lgkmcnt(0)
s_barrier
ds_read_b64_tr_b16 v[240:241], v9 offset:32768
ds_read_b64_tr_b16 v[242:243], v9 offset:36864
ds_read_b64_tr_b16 v[244:245], v1 offset:32768
ds_read_b64_tr_b16 v[246:247], v1 offset:36864
ds_read_b64_tr_b16 v[248:249], v9 offset:40960
ds_read_b64_tr_b16 v[250:251], v9 offset:45056
ds_read_b64_tr_b16 v[252:253], v1 offset:40960
ds_read_b64_tr_b16 v[254:255], v1 offset:45056
s_waitcnt lgkmcnt(0)
s_barrier
v_lshrrev_b32 v63, 4, v2
v_and_b32 v67, 15, v63
v_lshrrev_b32 v63, 4, v63
s_mul_i32 s26, s3, 1280
v_lshlrev_b32 v65, 4, v67
v_add_u32 v65, s26, v65
v_lshl_add_u32 v64, v63, 8, v65
v_add_u32 v65, 1024, v65
v_lshlrev_b32 v62, 3, v67
v_add_u32 v62, 151552, v62
s_lshl_b32 s26, s3, 7
v_lshrrev_b32 v67, 1, v63
v_lshl_add_u32 v66, v67, 2, v62
v_add_u32 v66, s26, v66
v_lshl_add_u32 v62, v63, 7, v62
s_mul_i32 s45, s3, 14
s_min_u32 s45, s45, 40
v_add_u32 v3, 55296, v2
v_lshrrev_b32 v9, 4, v2
v_min_u32 v9, 13, v9
v_add_u32 v9, s45, v9
v_lshlrev_b32 v9, 4, v9
s_lshl_b32 s45, s45, 10
s_mov_b32 s8, s88
s_mov_b32 s9, s89
s_mov_b32 s10, 0x10000000
s_mov_b32 s11, 0x20000
s_mov_b32 s12, s84
s_mov_b32 s13, s85
s_mov_b32 s14, 0x280000
s_mov_b32 s15, 0x20000
s_mul_i32 s26, s41, 55296
s_add_u32 s30, s45, s26
s_add_u32 s30, s30, 0xc00000
s_lshl_b32 s31, s41, 10
s_add_u32 s31, s31, 0x1f10000
s_mul_i32 s26, s41, 5120
s_lshl_b32 s27, s40, 8
s_add_u32 s33, s26, 0x1b00000
s_add_u32 s32, s33, s27
s_add_u32 s36, s26, s27
s_add_u32 s36, s36, 0x1da0000
s_mul_i32 s37, s41, 20480
s_add_u32 s34, s37, 0x300000
s_lshl_b32 s27, s40, 10
s_add_u32 s35, s37, s27
s_add_u32 s35, s35, 0x880000
s_mul_i32 s26, s41, 55296
s_mul_i32 s27, s40, 2816
s_add_u32 s38, s26, s27
s_add_u32 s38, s38, 0xc00000
s_mov_b32 s26, s31
s_mov_b32 s90, 40000
Lpoll_30:
buffer_load_dword v63, v9, s[4:7], s26 offen sc1
s_waitcnt vmcnt(0)
v_cmp_ne_u32 vcc, s20, v63
s_cmp_eq_u64 vcc, 0
s_cbranch_scc1 Lpok_31

s_sub_u32 s90, s90, 1
s_cmp_lg_u32 s90, 0
s_cbranch_scc1 Lpoll_30
s_mov_b32 s8, s86
s_mov_b32 s9, s87
s_mov_b32 s10, 0x100
s_mov_b32 s11, 0x20000
v_mov_b32 v2, 0x6
v_mov_b32 v3, 0x18
s_nop 1
buffer_store_dword v2, v3, s[8:11], 0 offen
s_waitcnt vmcnt(0)
s_endpgm
Lpok_31:
s_waitcnt vmcnt(0)
s_add_u32 s26, s30, 0x0
s_add_u32 m0, s45, 0
s_nop 0
buffer_load_dwordx4 v2, s[4:7], s26 offen offset:0 sc1 lds
buffer_load_dwordx4 v2, s[4:7], s26 offen offset:1024 sc1 lds
buffer_load_dwordx4 v2, s[4:7], s26 offen offset:2048 sc1 lds
buffer_load_dwordx4 v2, s[4:7], s26 offen offset:3072 sc1 lds
s_add_u32 s26, s26, 4096
s_add_u32 m0, s45, 4096
s_nop 0
buffer_load_dwordx4 v2, s[4:7], s26 offen offset:0 sc1 lds
buffer_load_dwordx4 v2, s[4:7], s26 offen offset:1024 sc1 lds
buffer_load_dwordx4 v2, s[4:7], s26 offen offset:2048 sc1 lds
buffer_load_dwordx4 v2, s[4:7], s26 offen offset:3072 sc1 lds
s_add_u32 s26, s26, 4096
s_add_u32 m0, s45, 8192
s_nop 0
buffer_load_dwordx4 v2, s[4:7], s26 offen offset:0 sc1 lds
buffer_load_dwordx4 v2, s[4:7], s26 offen offset:1024 sc1 lds
buffer_load_dwordx4 v2, s[4:7], s26 offen offset:2048 sc1 lds
buffer_load_dwordx4 v2, s[4:7], s26 offen offset:3072 sc1 lds
s_add_u32 s26, s26, 4096
s_add_u32 m0, s45, 12288
s_nop 0
buffer_load_dwordx4 v2, s[4:7], s26 offen offset:0 sc1 lds
buffer_load_dwordx4 v2, s[4:7], s26 offen offset:1024 sc1 lds
s_add_u32 s27, s31, 16384
buffer_load_dword v59, v9, s[4:7], s27 offen sc1
s_waitcnt vmcnt(0)
s_barrier
ds_read_b128 v[76:79], v8 offset:0
s_waitcnt lgkmcnt(0)
v_lshlrev_b32 v32, 16, v76
v_and_b32 v33, 0xffff0000, v76
v_lshlrev_b32 v34, 16, v77
v_and_b32 v35, 0xffff0000, v77
v_lshlrev_b32 v36, 16, v78
v_and_b32 v37, 0xffff0000, v78
v_lshlrev_b32 v38, 16, v79
v_and_b32 v39, 0xffff0000, v79
ds_read_b128 v[16:19], v2 offset:0
ds_read_b128 v[20:23], v2 offset:1024
ds_read_b128 v[24:27], v2 offset:2048
ds_read_b128 v[28:31], v2 offset:3072
s_waitcnt lgkmcnt(2)
v_mfma_f32_16x16x32_bf16 v[32:35], a[0:3], v[16:19], v[32:35]
v_cmp_ne_u32 vcc, s20, v59
s_cmp_eq_u64 vcc, 0
s_cselect_b32 s10, 0x10000000, 0
v_mfma_f32_16x16x32_bf16 v[36:39], a[4:7], v[16:19], v[36:39]
ds_read_b128 v[16:19], v2 offset:4096
v_mfma_f32_16x16x32_bf16 v[32:35], a[8:11], v[20:23], v[32:35]
s_add_u32 s42, s30, 0xd8000
s_add_u32 m0, s45, 55296
s_nop 0
buffer_load_dwordx4 v2, s[8:11], s42 offen offset:0 sc1 lds
v_mfma_f32_16x16x32_bf16 v[36:39], a[12:15], v[20:23], v[36:39]
ds_read_b128 v[20:23], v2 offset:5120
s_waitcnt lgkmcnt(2)
v_mfma_f32_16x16x32_bf16 v[32:35], a[16:19], v[24:27], v[32:35]
buffer_load_dwordx4 v2, s[8:11], s42 offen offset:1024 sc1 lds
v_mfma_f32_16x16x32_bf16 v[36:39], a[20:23], v[24:27], v[36:39]
ds_read_b128 v[24:27], v2 offset:6144
v_mfma_f32_16x16x32_bf16 v[32:35], a[24:27], v[28:31], v[32:35]
buffer_load_dwordx4 v2, s[8:11], s42 offen offset:2048 sc1 lds
v_mfma_f32_16x16x32_bf16 v[36:39], a[28:31], v[28:31], v[36:39]
ds_read_b128 v[28:31], v2 offset:7168
s_waitcnt lgkmcnt(2)
v_mfma_f32_16x16x32_bf16 v[32:35], a[32:35], v[16:19], v[32:35]
buffer_load_dwordx4 v2, s[8:11], s42 offen offset:3072 sc1 lds
v_mfma_f32_16x16x32_bf16 v[36:39], a[36:39], v[16:19], v[36:39]
ds_read_b128 v[16:19], v2 offset:8192
v_mfma_f32_16x16x32_bf16 v[32:35], a[40:43], v[20:23], v[32:35]
s_add_u32 s42, s42, 4096
s_add_u32 m0, s45, 59392
s_nop 0
buffer_load_dwordx4 v2, s[8:11], s42 offen offset:0 sc1 lds
v_mfma_f32_16x16x32_bf16 v[36:39], a[44:47], v[20:23], v[36:39]
ds_read_b128 v[20:23], v2 offset:9216
s_waitcnt lgkmcnt(2)
v_mfma_f32_16x16x32_bf16 v[32:35], a[48:51], v[24:27], v[32:35]
buffer_load_dwordx4 v2, s[8:11], s42 offen offset:1024 sc1 lds
v_mfma_f32_16x16x32_bf16 v[36:39], a[52:55], v[24:27], v[36:39]
ds_read_b128 v[24:27], v2 offset:10240
v_mfma_f32_16x16x32_bf16 v[32:35], a[56:59], v[28:31], v[32:35]
v_mfma_f32_16x16x32_bf16 v[36:39], a[60:63], v[28:31], v[36:39]
ds_read_b128 v[28:31], v2 offset:11264
s_waitcnt lgkmcnt(2)
v_mfma_f32_16x16x32_bf16 v[32:35], a[64:67], v[16:19], v[32:35]
v_mfma_f32_16x16x32_bf16 v[36:39], a[68:71], v[16:19], v[36:39]
ds_read_b128 v[16:19], v2 offset:12288
v_mfma_f32_16x16x32_bf16 v[32:35], a[72:75], v[20:23], v[32:35]
buffer_load_dwordx4 v2, s[8:11], s42 offen offset:2048 sc1 lds
v_mfma_f32_16x16x32_bf16 v[36:39], a[76:79], v[20:23], v[36:39]
ds_read_b128 v[20:23], v2 offset:13312
s_waitcnt lgkmcnt(2)
v_mfma_f32_16x16x32_bf16 v[32:35], a[80:83], v[24:27], v[32:35]
v_mfma_f32_16x16x32_bf16 v[36:39], a[84:87], v[24:27], v[36:39]
ds_read_b128 v[24:27], v2 offset:14336
v_mfma_f32_16x16x32_bf16 v[32:35], a[88:91], v[28:31], v[32:35]
buffer_load_dwordx4 v2, s[8:11], s42 offen offset:3072 sc1 lds
v_mfma_f32_16x16x32_bf16 v[36:39], a[92:95], v[28:31], v[36:39]
ds_read_b128 v[28:31], v2 offset:15360
s_waitcnt lgkmcnt(2)
v_mfma_f32_16x16x32_bf16 v[32:35], a[96:99], v[16:19], v[32:35]
v_mfma_f32_16x16x32_bf16 v[36:39], a[100:103], v[16:19], v[36:39]
ds_read_b128 v[16:19], v2 offset:16384
v_mfma_f32_16x16x32_bf16 v[32:35], a[104:107], v[20:23], v[32:35]
s_add_u32 s42, s42, 4096
s_add_u32 m0, s45, 63488
s_nop 0
buffer_load_dwordx4 v2, s[8:11], s42 offen offset:0 sc1 lds
v_mfma_f32_16x16x32_bf16 v[36:39], a[108:111], v[20:23], v[36:39]
ds_read_b128 v[20:23], v2 offset:17408
s_waitcnt lgkmcnt(2)
v_mfma_f32_16x16x32_bf16 v[32:35], a[112:115], v[24:27], v[32:35]
v_mfma_f32_16x16x32_bf16 v[36:39], a[116:119], v[24:27], v[36:39]
ds_read_b128 v[24:27], v2 offset:18432
v_mfma_f32_16x16x32_bf16 v[32:35], a[120:123], v[28:31], v[32:35]
buffer_load_dwordx4 v2, s[8:11], s42 offen offset:1024 sc1 lds
v_mfma_f32_16x16x32_bf16 v[36:39], a[124:127], v[28:31], v[36:39]
ds_read_b128 v[28:31], v2 offset:19456
s_waitcnt lgkmcnt(2)
v_mfma_f32_16x16x32_bf16 v[32:35], a[128:131], v[16:19], v[32:35]
v_mfma_f32_16x16x32_bf16 v[36:39], a[132:135], v[16:19], v[36:39]
ds_read_b128 v[16:19], v2 offset:20480
v_mfma_f32_16x16x32_bf16 v[32:35], a[136:139], v[20:23], v[32:35]
v_mfma_f32_16x16x32_bf16 v[36:39], a[140:143], v[20:23], v[36:39]
ds_read_b128 v[20:23], v2 offset:21504
s_waitcnt lgkmcnt(2)
v_mfma_f32_16x16x32_bf16 v[32:35], a[144:147], v[24:27], v[32:35]
buffer_load_dwordx4 v2, s[8:11], s42 offen offset:2048 sc1 lds
v_mfma_f32_16x16x32_bf16 v[36:39], a[148:151], v[24:27], v[36:39]
ds_read_b128 v[24:27], v2 offset:22528
v_mfma_f32_16x16x32_bf16 v[32:35], a[152:155], v[28:31], v[32:35]
v_mfma_f32_16x16x32_bf16 v[36:39], a[156:159], v[28:31], v[36:39]
ds_read_b128 v[28:31], v2 offset:23552
s_waitcnt lgkmcnt(2)
v_mfma_f32_16x16x32_bf16 v[32:35], a[160:163], v[16:19], v[32:35]
buffer_load_dwordx4 v2, s[8:11], s42 offen offset:3072 sc1 lds
v_mfma_f32_16x16x32_bf16 v[36:39], a[164:167], v[16:19], v[36:39]
ds_read_b128 v[16:19], v2 offset:24576
v_mfma_f32_16x16x32_bf16 v[32:35], a[168:171], v[20:23], v[32:35]
v_mfma_f32_16x16x32_bf16 v[36:39], a[172:175], v[20:23], v[36:39]
ds_read_b128 v[20:23], v2 offset:25600
s_waitcnt lgkmcnt(2)
v_mfma_f32_16x16x32_bf16 v[32:35], a[176:179], v[24:27], v[32:35]
s_add_u32 s42, s42, 4096
s_add_u32 m0, s45, 67584
s_nop 0
buffer_load_dwordx4 v2, s[8:11], s42 offen offset:0 sc1 lds
v_mfma_f32_16x16x32_bf16 v[36:39], a[180:183], v[24:27], v[36:39]
ds_read_b128 v[24:27], v2 offset:26624
v_mfma_f32_16x16x32_bf16 v[32:35], a[184:187], v[28:31], v[32:35]
v_mfma_f32_16x16x32_bf16 v[36:39], a[188:191], v[28:31], v[36:39]
ds_read_b128 v[28:31], v2 offset:27648
s_waitcnt lgkmcnt(2)
v_mfma_f32_16x16x32_bf16 v[32:35], a[192:195], v[16:19], v[32:35]
v_mfma_f32_16x16x32_bf16 v[36:39], a[196:199], v[16:19], v[36:39]
ds_read_b128 v[16:19], v2 offset:28672
v_mfma_f32_16x16x32_bf16 v[32:35], a[200:203], v[20:23], v[32:35]
buffer_load_dwordx4 v2, s[8:11], s42 offen offset:1024 sc1 lds
v_mfma_f32_16x16x32_bf16 v[36:39], a[204:207], v[20:23], v[36:39]
ds_read_b128 v[20:23], v2 offset:29696
s_waitcnt lgkmcnt(2)
v_mfma_f32_16x16x32_bf16 v[32:35], a[208:211], v[24:27], v[32:35]
v_mfma_f32_16x16x32_bf16 v[36:39], a[212:215], v[24:27], v[36:39]
ds_read_b128 v[24:27], v2 offset:30720
v_mfma_f32_16x16x32_bf16 v[32:35], a[216:219], v[28:31], v[32:35]
s_add_u32 s43, s31, 32768
buffer_load_dword v59, v9, s[4:7], s43 offen sc1
v_mfma_f32_16x16x32_bf16 v[36:39], a[220:223], v[28:31], v[36:39]
ds_read_b128 v[28:31], v2 offset:31744
s_waitcnt lgkmcnt(2)
v_mfma_f32_16x16x32_bf16 v[32:35], a[224:227], v[16:19], v[32:35]
v_mfma_f32_16x16x32_bf16 v[36:39], a[228:231], v[16:19], v[36:39]
ds_read_b128 v[16:19], v2 offset:32768
v_mfma_f32_16x16x32_bf16 v[32:35], a[232:235], v[20:23], v[32:35]
v_mfma_f32_16x16x32_bf16 v[36:39], a[236:239], v[20:23], v[36:39]
ds_read_b128 v[20:23], v2 offset:33792
s_waitcnt lgkmcnt(2)
v_mfma_f32_16x16x32_bf16 v[32:35], a[240:243], v[24:27], v[32:35]
v_mfma_f32_16x16x32_bf16 v[36:39], a[244:247], v[24:27], v[36:39]
ds_read_b128 v[24:27], v2 offset:34816
v_mfma_f32_16x16x32_bf16 v[32:35], a[248:251], v[28:31], v[32:35]
v_mfma_f32_16x16x32_bf16 v[36:39], a[252:255], v[28:31], v[36:39]
ds_read_b128 v[28:31], v2 offset:35840
s_waitcnt lgkmcnt(2)
v_mfma_f32_16x16x32_bf16 v[32:35], v[80:83], v[16:19], v[32:35]
v_mfma_f32_16x16x32_bf16 v[36:39], v[84:87], v[16:19], v[36:39]
ds_read_b128 v[16:19], v2 offset:36864
v_mfma_f32_16x16x32_bf16 v[32:35], v[88:91], v[20:23], v[32:35]
v_mfma_f32_16x16x32_bf16 v[36:39], v[92:95], v[20:23], v[36:39]
ds_read_b128 v[20:23], v2 offset:37888
s_waitcnt lgkmcnt(2)
v_mfma_f32_16x16x32_bf16 v[32:35], v[96:99], v[24:27], v[32:35]
v_mfma_f32_16x16x32_bf16 v[36:39], v[100:103], v[24:27], v[36:39]
ds_read_b128 v[24:27], v2 offset:38912
v_mfma_f32_16x16x32_bf16 v[32:35], v[104:107], v[28:31], v[32:35]
v_mfma_f32_16x16x32_bf16 v[36:39], v[108:111], v[28:31], v[36:39]
ds_read_b128 v[28:31], v2 offset:39936
s_waitcnt lgkmcnt(2)
v_mfma_f32_16x16x32_bf16 v[32:35], v[112:115], v[16:19], v[32:35]
v_mfma_f32_16x16x32_bf16 v[36:39], v[116:119], v[16:19], v[36:39]
ds_read_b128 v[16:19], v2 offset:40960
v_mfma_f32_16x16x32_bf16 v[32:35], v[120:123], v[20:23], v[32:35]
v_mfma_f32_16x16x32_bf16 v[36:39], v[124:127], v[20:23], v[36:39]
ds_read_b128 v[20:23], v2 offset:41984
s_waitcnt lgkmcnt(2)
v_mfma_f32_16x16x32_bf16 v[32:35], v[128:131], v[24:27], v[32:35]
v_mfma_f32_16x16x32_bf16 v[36:39], v[132:135], v[24:27], v[36:39]
ds_read_b128 v[24:27], v2 offset:43008
v_mfma_f32_16x16x32_bf16 v[32:35], v[136:139], v[28:31], v[32:35]
v_mfma_f32_16x16x32_bf16 v[36:39], v[140:143], v[28:31], v[36:39]
ds_read_b128 v[28:31], v2 offset:44032
s_waitcnt lgkmcnt(2)
v_mfma_f32_16x16x32_bf16 v[32:35], v[144:147], v[16:19], v[32:35]
v_mfma_f32_16x16x32_bf16 v[36:39], v[148:151], v[16:19], v[36:39]
ds_read_b128 v[16:19], v2 offset:45056
v_mfma_f32_16x16x32_bf16 v[32:35], v[152:155], v[20:23], v[32:35]
v_mfma_f32_16x16x32_bf16 v[36:39], v[156:159], v[20:23], v[36:39]
ds_read_b128 v[20:23], v2 offset:46080
s_waitcnt lgkmcnt(2)
v_mfma_f32_16x16x32_bf16 v[32:35], v[160:163], v[24:27], v[32:35]
v_mfma_f32_16x16x32_bf16 v[36:39], v[164:167], v[24:27], v[36:39]
ds_read_b128 v[24:27], v2 offset:47104
v_mfma_f32_16x16x32_bf16 v[32:35], v[168:171], v[28:31], v[32:35]
v_mfma_f32_16x16x32_bf16 v[36:39], v[172:175], v[28:31], v[36:39]
ds_read_b128 v[28:31], v2 offset:48128
s_waitcnt lgkmcnt(2)
v_mfma_f32_16x16x32_bf16 v[32:35], v[176:179], v[16:19], v[32:35]
v_mfma_f32_16x16x32_bf16 v[36:39], v[180:183], v[16:19], v[36:39]
ds_read_b128 v[16:19], v2 offset:49152
v_mfma_f32_16x16x32_bf16 v[32:35], v[184:187], v[20:23], v[32:35]
v_mfma_f32_16x16x32_bf16 v[36:39], v[188:191], v[20:23], v[36:39]
ds_read_b128 v[20:23], v2 offset:50176
s_waitcnt lgkmcnt(2)
v_mfma_f32_16x16x32_bf16 v[32:35], v[192:195], v[24:27], v[32:35]
v_mfma_f32_16x16x32_bf16 v[36:39], v[196:199], v[24:27], v[36:39]
ds_read_b128 v[24:27], v2 offset:51200
v_mfma_f32_16x16x32_bf16 v[32:35], v[200:203], v[28:31], v[32:35]
v_mfma_f32_16x16x32_bf16 v[36:39], v[204:207], v[28:31], v[36:39]
ds_read_b128 v[28:31], v2 offset:52224
s_waitcnt lgkmcnt(2)
v_mfma_f32_16x16x32_bf16 v[32:35], v[208:211], v[16:19], v[32:35]
v_mfma_f32_16x16x32_bf16 v[36:39], v[212:215], v[16:19], v[36:39]
ds_read_b128 v[16:19], v2 offset:53248
v_mfma_f32_16x16x32_bf16 v[32:35], v[216:219], v[20:23], v[32:35]
v_mfma_f32_16x16x32_bf16 v[36:39], v[220:223], v[20:23], v[36:39]
ds_read_b128 v[20:23], v2 offset:54272
ds_read_b128 v[76:79], v8 offset:4096
s_waitcnt lgkmcnt(3)
v_mfma_f32_16x16x32_bf16 v[32:35], v[224:227], v[24:27], v[32:35]
s_waitcnt lgkmcnt(0)
v_lshlrev_b32 v40, 16, v76
v_and_b32 v41, 0xffff0000, v76
v_lshlrev_b32 v42, 16, v77
v_mfma_f32_16x16x32_bf16 v[36:39], v[228:231], v[24:27], v[36:39]
v_and_b32 v43, 0xffff0000, v77
v_lshlrev_b32 v44, 16, v78
v_and_b32 v45, 0xffff0000, v78
v_mfma_f32_16x16x32_bf16 v[32:35], v[232:235], v[28:31], v[32:35]
v_lshlrev_b32 v46, 16, v79
v_and_b32 v47, 0xffff0000, v79
v_mfma_f32_16x16x32_bf16 v[36:39], v[236:239], v[28:31], v[36:39]
s_cmp_eq_u32 s10, 0
s_cbranch_scc1 Lg2_falate0
Lg2_faret0:
s_waitcnt vmcnt(1) lgkmcnt(0)
s_barrier
ds_read_b128 v[24:27], v3 offset:0
ds_read_b128 v[28:31], v3 offset:1024
v_mfma_f32_16x16x32_bf16 v[32:35], v[240:243], v[16:19], v[32:35]
v_mfma_f32_16x16x32_bf16 v[36:39], v[244:247], v[16:19], v[36:39]
ds_read_b128 v[16:19], v3 offset:2048
v_mfma_f32_16x16x32_bf16 v[32:35], v[248:251], v[20:23], v[32:35]
v_mfma_f32_16x16x32_bf16 v[36:39], v[252:255], v[20:23], v[36:39]
ds_read_b128 v[20:23], v3 offset:3072
s_waitcnt lgkmcnt(2)
v_mfma_f32_16x16x32_bf16 v[40:43], a[0:3], v[24:27], v[40:43]
s_waitcnt vmcnt(0)
v_cmp_ne_u32 vcc, s20, v59
s_cmp_eq_u64 vcc, 0
s_cselect_b32 s10, 0x10000000, 0
s_add_u32 s26, s32, 0
v_cvt_pk_bf16_f32 v76, v32, v33
v_cvt_pk_bf16_f32 v77, v34, v35
v_mfma_f32_16x16x32_bf16 v[44:47], a[4:7], v[24:27], v[44:47]
ds_read_b128 v[24:27], v3 offset:4096
v_cvt_pk_bf16_f32 v78, v36, v37
v_cvt_pk_bf16_f32 v79, v38, v39
v_mfma_f32_16x16x32_bf16 v[40:43], a[8:11], v[28:31], v[40:43]
s_add_u32 s42, s30, 0x1b0000
s_add_u32 m0, s45, 0
s_nop 0
buffer_load_dwordx4 v2, s[8:11], s42 offen offset:0 sc1 lds
ds_write_b128 v8, v[76:79] offset:0
v_mfma_f32_16x16x32_bf16 v[44:47], a[12:15], v[28:31], v[44:47]
ds_read_b128 v[28:31], v3 offset:5120
v_add_f32 v12, v32, v33
v_mul_f32 v13, v32, v32
v_fmac_f32 v13, v33, v33
s_waitcnt lgkmcnt(3)
v_mfma_f32_16x16x32_bf16 v[40:43], a[16:19], v[16:19], v[40:43]
buffer_load_dwordx4 v2, s[8:11], s42 offen offset:1024 sc1 lds
v_add_f32 v12, v12, v34
v_fmac_f32 v13, v34, v34
v_add_f32 v12, v12, v35
v_mfma_f32_16x16x32_bf16 v[44:47], a[20:23], v[16:19], v[44:47]
ds_read_b128 v[16:19], v3 offset:6144
v_fmac_f32 v13, v35, v35
v_add_f32 v12, v12, v36
v_fmac_f32 v13, v36, v36
v_add_f32 v12, v12, v37
v_mfma_f32_16x16x32_bf16 v[40:43], a[24:27], v[20:23], v[40:43]
buffer_load_dwordx4 v2, s[8:11], s42 offen offset:2048 sc1 lds
v_fmac_f32 v13, v37, v37
v_add_f32 v12, v12, v38
v_fmac_f32 v13, v38, v38
v_mfma_f32_16x16x32_bf16 v[44:47], a[28:31], v[20:23], v[44:47]
ds_read_b128 v[20:23], v3 offset:7168
v_add_f32 v12, v12, v39
v_fmac_f32 v13, v39, v39
s_waitcnt lgkmcnt(2)
v_mfma_f32_16x16x32_bf16 v[40:43], a[32:35], v[24:27], v[40:43]
buffer_load_dwordx4 v2, s[8:11], s42 offen offset:3072 sc1 lds
v_mfma_f32_16x16x32_bf16 v[44:47], a[36:39], v[24:27], v[44:47]
ds_read_b128 v[24:27], v3 offset:8192
v_permlane32_swap_b32 v12, v13
v_mfma_f32_16x16x32_bf16 v[40:43], a[40:43], v[28:31], v[40:43]
s_add_u32 s42, s42, 4096
s_add_u32 m0, s45, 4096
s_nop 0
buffer_load_dwordx4 v2, s[8:11], s42 offen offset:0 sc1 lds
v_add_f32 v12, v12, v13
v_mfma_f32_16x16x32_bf16 v[44:47], a[44:47], v[28:31], v[44:47]
ds_read_b128 v[28:31], v3 offset:9216
v_mov_b32 v63, v12
s_waitcnt lgkmcnt(2)
v_mfma_f32_16x16x32_bf16 v[40:43], a[48:51], v[16:19], v[40:43]
buffer_load_dwordx4 v2, s[8:11], s42 offen offset:1024 sc1 lds
v_mfma_f32_16x16x32_bf16 v[44:47], a[52:55], v[16:19], v[44:47]
ds_read_b128 v[16:19], v3 offset:10240
v_permlane16_swap_b32 v12, v63
v_mfma_f32_16x16x32_bf16 v[40:43], a[56:59], v[20:23], v[40:43]
buffer_load_dwordx4 v2, s[8:11], s42 offen offset:2048 sc1 lds
v_mfma_f32_16x16x32_bf16 v[44:47], a[60:63], v[20:23], v[44:47]
ds_read_b128 v[20:23], v3 offset:11264
s_waitcnt lgkmcnt(2)
v_mfma_f32_16x16x32_bf16 v[40:43], a[64:67], v[24:27], v[40:43]
buffer_load_dwordx4 v2, s[8:11], s42 offen offset:3072 sc1 lds
v_mfma_f32_16x16x32_bf16 v[44:47], a[68:71], v[24:27], v[44:47]
ds_read_b128 v[24:27], v3 offset:12288
v_add_f32 v12, v12, v63
v_mfma_f32_16x16x32_bf16 v[40:43], a[72:75], v[28:31], v[40:43]
v_mov_b32 v13, v12
s_nop 1
v_permlane32_swap_b32 v12, v13
v_mfma_f32_16x16x32_bf16 v[44:47], a[76:79], v[28:31], v[44:47]
ds_read_b128 v[28:31], v3 offset:13312
s_waitcnt lgkmcnt(2)
v_mfma_f32_16x16x32_bf16 v[40:43], a[80:83], v[16:19], v[40:43]
buffer_store_dwordx4 v[12:15], v5, s[4:7], s26 offen sc1
v_mfma_f32_16x16x32_bf16 v[44:47], a[84:87], v[16:19], v[44:47]
ds_read_b128 v[16:19], v3 offset:14336
v_mfma_f32_16x16x32_bf16 v[40:43], a[88:91], v[20:23], v[40:43]
v_mfma_f32_16x16x32_bf16 v[44:47], a[92:95], v[20:23], v[44:47]
ds_read_b128 v[20:23], v3 offset:15360
s_waitcnt lgkmcnt(2)
v_mfma_f32_16x16x32_bf16 v[40:43], a[96:99], v[24:27], v[40:43]
s_add_u32 s42, s42, 4096
s_add_u32 m0, s45, 8192
s_nop 0
buffer_load_dwordx4 v2, s[8:11], s42 offen offset:0 sc1 lds
v_mfma_f32_16x16x32_bf16 v[44:47], a[100:103], v[24:27], v[44:47]
ds_read_b128 v[24:27], v3 offset:16384
v_mfma_f32_16x16x32_bf16 v[40:43], a[104:107], v[28:31], v[40:43]
v_mfma_f32_16x16x32_bf16 v[44:47], a[108:111], v[28:31], v[44:47]
ds_read_b128 v[28:31], v3 offset:17408
s_waitcnt lgkmcnt(2)
v_mfma_f32_16x16x32_bf16 v[40:43], a[112:115], v[16:19], v[40:43]
buffer_load_dwordx4 v2, s[8:11], s42 offen offset:1024 sc1 lds
v_mfma_f32_16x16x32_bf16 v[44:47], a[116:119], v[16:19], v[44:47]
ds_read_b128 v[16:19], v3 offset:18432
v_mfma_f32_16x16x32_bf16 v[40:43], a[120:123], v[20:23], v[40:43]
v_mfma_f32_16x16x32_bf16 v[44:47], a[124:127], v[20:23], v[44:47]
ds_read_b128 v[20:23], v3 offset:19456
s_waitcnt lgkmcnt(2)
v_mfma_f32_16x16x32_bf16 v[40:43], a[128:131], v[24:27], v[40:43]
v_mfma_f32_16x16x32_bf16 v[44:47], a[132:135], v[24:27], v[44:47]
ds_read_b128 v[24:27], v3 offset:20480
v_mfma_f32_16x16x32_bf16 v[40:43], a[136:139], v[28:31], v[40:43]
buffer_load_dwordx4 v2, s[8:11], s42 offen offset:2048 sc1 lds
v_mfma_f32_16x16x32_bf16 v[44:47], a[140:143], v[28:31], v[44:47]
ds_read_b128 v[28:31], v3 offset:21504
s_waitcnt lgkmcnt(2)
v_mfma_f32_16x16x32_bf16 v[40:43], a[144:147], v[16:19], v[40:43]
v_mfma_f32_16x16x32_bf16 v[44:47], a[148:151], v[16:19], v[44:47]
ds_read_b128 v[16:19], v3 offset:22528
v_mfma_f32_16x16x32_bf16 v[40:43], a[152:155], v[20:23], v[40:43]
buffer_load_dwordx4 v2, s[8:11], s42 offen offset:3072 sc1 lds
v_mfma_f32_16x16x32_bf16 v[44:47], a[156:159], v[20:23], v[44:47]
ds_read_b128 v[20:23], v3 offset:23552
s_waitcnt lgkmcnt(2)
v_mfma_f32_16x16x32_bf16 v[40:43], a[160:163], v[24:27], v[40:43]
v_mfma_f32_16x16x32_bf16 v[44:47], a[164:167], v[24:27], v[44:47]
ds_read_b128 v[24:27], v3 offset:24576
v_mfma_f32_16x16x32_bf16 v[40:43], a[168:171], v[28:31], v[40:43]
s_add_u32 s42, s42, 4096
s_add_u32 m0, s45, 12288
s_nop 0
buffer_load_dwordx4 v2, s[8:11], s42 offen offset:0 sc1 lds
v_mfma_f32_16x16x32_bf16 v[44:47], a[172:175], v[28:31], v[44:47]
ds_read_b128 v[28:31], v3 offset:25600
s_waitcnt lgkmcnt(2)
v_mfma_f32_16x16x32_bf16 v[40:43], a[176:179], v[16:19], v[40:43]
v_mfma_f32_16x16x32_bf16 v[44:47], a[180:183], v[16:19], v[44:47]
ds_read_b128 v[16:19], v3 offset:26624
v_mfma_f32_16x16x32_bf16 v[40:43], a[184:187], v[20:23], v[40:43]
v_mfma_f32_16x16x32_bf16 v[44:47], a[188:191], v[20:23], v[44:47]
ds_read_b128 v[20:23], v3 offset:27648
s_waitcnt lgkmcnt(2)
v_mfma_f32_16x16x32_bf16 v[40:43], a[192:195], v[24:27], v[40:43]
buffer_load_dwordx4 v2, s[8:11], s42 offen offset:1024 sc1 lds
v_mfma_f32_16x16x32_bf16 v[44:47], a[196:199], v[24:27], v[44:47]
ds_read_b128 v[24:27], v3 offset:28672
v_mfma_f32_16x16x32_bf16 v[40:43], a[200:203], v[28:31], v[40:43]
v_mfma_f32_16x16x32_bf16 v[44:47], a[204:207], v[28:31], v[44:47]
ds_read_b128 v[28:31], v3 offset:29696
s_waitcnt lgkmcnt(2)
v_mfma_f32_16x16x32_bf16 v[40:43], a[208:211], v[16:19], v[40:43]
s_add_u32 s43, s31, 49152
buffer_load_dword v59, v9, s[4:7], s43 offen sc1
v_mfma_f32_16x16x32_bf16 v[44:47], a[212:215], v[16:19], v[44:47]
ds_read_b128 v[16:19], v3 offset:30720
v_mfma_f32_16x16x32_bf16 v[40:43], a[216:219], v[20:23], v[40:43]
v_mfma_f32_16x16x32_bf16 v[44:47], a[220:223], v[20:23], v[44:47]
ds_read_b128 v[20:23], v3 offset:31744
s_waitcnt lgkmcnt(2)
v_mfma_f32_16x16x32_bf16 v[40:43], a[224:227], v[24:27], v[40:43]
v_mfma_f32_16x16x32_bf16 v[44:47], a[228:231], v[24:27], v[44:47]
ds_read_b128 v[24:27], v3 offset:32768
v_mfma_f32_16x16x32_bf16 v[40:43], a[232:235], v[28:31], v[40:43]
v_mfma_f32_16x16x32_bf16 v[44:47], a[236:239], v[28:31], v[44:47]
ds_read_b128 v[28:31], v3 offset:33792
s_waitcnt lgkmcnt(2)
v_mfma_f32_16x16x32_bf16 v[40:43], a[240:243], v[16:19], v[40:43]
v_mfma_f32_16x16x32_bf16 v[44:47], a[244:247], v[16:19], v[44:47]
ds_read_b128 v[16:19], v3 offset:34816
v_mfma_f32_16x16x32_bf16 v[40:43], a[248:251], v[20:23], v[40:43]
v_mfma_f32_16x16x32_bf16 v[44:47], a[252:255], v[20:23], v[44:47]
ds_read_b128 v[20:23], v3 offset:35840
s_waitcnt lgkmcnt(2)
v_mfma_f32_16x16x32_bf16 v[40:43], v[80:83], v[24:27], v[40:43]
v_mfma_f32_16x16x32_bf16 v[44:47], v[84:87], v[24:27], v[44:47]
ds_read_b128 v[24:27], v3 offset:36864
v_mfma_f32_16x16x32_bf16 v[40:43], v[88:91], v[28:31], v[40:43]
v_mfma_f32_16x16x32_bf16 v[44:47], v[92:95], v[28:31], v[44:47]
ds_read_b128 v[28:31], v3 offset:37888
s_waitcnt lgkmcnt(2)
v_mfma_f32_16x16x32_bf16 v[40:43], v[96:99], v[16:19], v[40:43]
v_mfma_f32_16x16x32_bf16 v[44:47], v[100:103], v[16:19], v[44:47]
ds_read_b128 v[16:19], v3 offset:38912
v_mfma_f32_16x16x32_bf16 v[40:43], v[104:107], v[20:23], v[40:43]
v_mfma_f32_16x16x32_bf16 v[44:47], v[108:111], v[20:23], v[44:47]
ds_read_b128 v[20:23], v3 offset:39936
s_waitcnt lgkmcnt(2)
v_mfma_f32_16x16x32_bf16 v[40:43], v[112:115], v[24:27], v[40:43]
v_mfma_f32_16x16x32_bf16 v[44:47], v[116:119], v[24:27], v[44:47]
ds_read_b128 v[24:27], v3 offset:40960
v_mfma_f32_16x16x32_bf16 v[40:43], v[120:123], v[28:31], v[40:43]
v_mfma_f32_16x16x32_bf16 v[44:47], v[124:127], v[28:31], v[44:47]
ds_read_b128 v[28:31], v3 offset:41984
s_waitcnt lgkmcnt(2)
v_mfma_f32_16x16x32_bf16 v[40:43], v[128:131], v[16:19], v[40:43]
v_mfma_f32_16x16x32_bf16 v[44:47], v[132:135], v[16:19], v[44:47]
ds_read_b128 v[16:19], v3 offset:43008
v_mfma_f32_16x16x32_bf16 v[40:43], v[136:139], v[20:23], v[40:43]
v_mfma_f32_16x16x32_bf16 v[44:47], v[140:143], v[20:23], v[44:47]
ds_read_b128 v[20:23], v3 offset:44032
s_waitcnt lgkmcnt(2)
v_mfma_f32_16x16x32_bf16 v[40:43], v[144:147], v[24:27], v[40:43]
v_mfma_f32_16x16x32_bf16 v[44:47], v[148:151], v[24:27], v[44:47]
ds_read_b128 v[24:27], v3 offset:45056
v_mfma_f32_16x16x32_bf16 v[40:43], v[152:155], v[28:31], v[40:43]
v_mfma_f32_16x16x32_bf16 v[44:47], v[156:159], v[28:31], v[44:47]
ds_read_b128 v[28:31], v3 offset:46080
s_waitcnt lgkmcnt(2)
v_mfma_f32_16x16x32_bf16 v[40:43], v[160:163], v[16:19], v[40:43]
v_mfma_f32_16x16x32_bf16 v[44:47], v[164:167], v[16:19], v[44:47]
ds_read_b128 v[16:19], v3 offset:47104
v_mfma_f32_16x16x32_bf16 v[40:43], v[168:171], v[20:23], v[40:43]
v_mfma_f32_16x16x32_bf16 v[44:47], v[172:175], v[20:23], v[44:47]
ds_read_b128 v[20:23], v3 offset:48128
s_waitcnt lgkmcnt(2)
v_mfma_f32_16x16x32_bf16 v[40:43], v[176:179], v[24:27], v[40:43]
v_mfma_f32_16x16x32_bf16 v[44:47], v[180:183], v[24:27], v[44:47]
ds_read_b128 v[24:27], v3 offset:49152
v_mfma_f32_16x16x32_bf16 v[40:43], v[184:187], v[28:31], v[40:43]
v_mfma_f32_16x16x32_bf16 v[44:47], v[188:191], v[28:31], v[44:47]
ds_read_b128 v[28:31], v3 offset:50176
s_waitcnt lgkmcnt(2)
v_mfma_f32_16x16x32_bf16 v[40:43], v[192:195], v[16:19], v[40:43]
v_mfma_f32_16x16x32_bf16 v[44:47], v[196:199], v[16:19], v[44:47]
ds_read_b128 v[16:19], v3 offset:51200
v_mfma_f32_16x16x32_bf16 v[40:43], v[200:203], v[20:23], v[40:43]
v_mfma_f32_16x16x32_bf16 v[44:47], v[204:207], v[20:23], v[44:47]
ds_read_b128 v[20:23], v3 offset:52224
s_waitcnt lgkmcnt(2)
v_mfma_f32_16x16x32_bf16 v[40:43], v[208:211], v[24:27], v[40:43]
v_mfma_f32_16x16x32_bf16 v[44:47], v[212:215], v[24:27], v[44:47]
ds_read_b128 v[24:27], v3 offset:53248
v_mfma_f32_16x16x32_bf16 v[40:43], v[216:219], v[28:31], v[40:43]
v_mfma_f32_16x16x32_bf16 v[44:47], v[220:223], v[28:31], v[44:47]
ds_read_b128 v[28:31], v3 offset:54272
s_waitcnt lgkmcnt(2)
v_mfma_f32_16x16x32_bf16 v[40:43], v[224:227], v[16:19], v[40:43]
s_add_u32 s26, s33, 0
s_add_u32 s27, s34, 0
buffer_load_dwordx3 v[48:50], v64, s[4:7], s26 offen sc1
v_mfma_f32_16x16x32_bf16 v[44:47], v[228:231], v[16:19], v[44:47]
buffer_load_dwordx3 v[52:54], v65, s[4:7], s26 offen sc1
v_mfma_f32_16x16x32_bf16 v[40:43], v[232:235], v[20:23], v[40:43]
buffer_load_dwordx2 v[0:1], v7, s[4:7], s27 offen
buffer_load_dwordx2 v[10:11], v7, s[4:7], s27 offen offset:512
ds_read_b128 v[76:79], v8 offset:8192
s_waitcnt lgkmcnt(0)
v_lshlrev_b32 v32, 16, v76
v_and_b32 v33, 0xffff0000, v76
v_lshlrev_b32 v34, 16, v77
v_and_b32 v35, 0xffff0000, v77
v_lshlrev_b32 v36, 16, v78
v_and_b32 v37, 0xffff0000, v78
v_lshlrev_b32 v38, 16, v79
v_and_b32 v39, 0xffff0000, v79
v_mfma_f32_16x16x32_bf16 v[44:47], v[236:239], v[20:23], v[44:47]
s_cmp_eq_u32 s10, 0
s_cbranch_scc1 Lg2_falate1
Lg2_faret1:
s_waitcnt vmcnt(5) lgkmcnt(0)
s_barrier
ds_read_b128 v[16:19], v2 offset:0
ds_read_b128 v[20:23], v2 offset:1024
v_mfma_f32_16x16x32_bf16 v[40:43], v[240:243], v[24:27], v[40:43]
v_mfma_f32_16x16x32_bf16 v[44:47], v[244:247], v[24:27], v[44:47]
ds_read_b128 v[24:27], v2 offset:2048
v_mfma_f32_16x16x32_bf16 v[40:43], v[248:251], v[28:31], v[40:43]
v_mfma_f32_16x16x32_bf16 v[44:47], v[252:255], v[28:31], v[44:47]
ds_read_b128 v[28:31], v2 offset:3072
s_waitcnt lgkmcnt(2)
v_mfma_f32_16x16x32_bf16 v[32:35], a[0:3], v[16:19], v[32:35]
s_waitcnt vmcnt(4)
v_cmp_ne_u32 vcc, s20, v59
s_cmp_eq_u64 vcc, 0
s_cselect_b32 s10, 0x10000000, 0
s_add_u32 s26, s32, 81920
v_cvt_pk_bf16_f32 v76, v40, v41
v_cvt_pk_bf16_f32 v77, v42, v43
v_mfma_f32_16x16x32_bf16 v[36:39], a[4:7], v[16:19], v[36:39]
ds_read_b128 v[16:19], v2 offset:4096
v_cvt_pk_bf16_f32 v78, v44, v45
v_cvt_pk_bf16_f32 v79, v46, v47
v_mfma_f32_16x16x32_bf16 v[32:35], a[8:11], v[20:23], v[32:35]
s_add_u32 s42, s30, 0x288000
s_add_u32 m0, s45, 55296
s_nop 0
buffer_load_dwordx4 v2, s[8:11], s42 offen offset:0 sc1 lds
ds_write_b128 v8, v[76:79] offset:4096
v_mfma_f32_16x16x32_bf16 v[36:39], a[12:15], v[20:23], v[36:39]
ds_read_b128 v[20:23], v2 offset:5120
v_add_f32 v12, v40, v41
v_mul_f32 v13, v40, v40
v_fmac_f32 v13, v41, v41
s_waitcnt lgkmcnt(3)
v_mfma_f32_16x16x32_bf16 v[32:35], a[16:19], v[24:27], v[32:35]
buffer_load_dwordx4 v2, s[8:11], s42 offen offset:1024 sc1 lds
v_add_f32 v12, v12, v42
v_fmac_f32 v13, v42, v42
v_add_f32 v12, v12, v43
v_mfma_f32_16x16x32_bf16 v[36:39], a[20:23], v[24:27], v[36:39]
ds_read_b128 v[24:27], v2 offset:6144
v_fmac_f32 v13, v43, v43
v_add_f32 v12, v12, v44
v_fmac_f32 v13, v44, v44
v_add_f32 v12, v12, v45
v_mfma_f32_16x16x32_bf16 v[32:35], a[24:27], v[28:31], v[32:35]
buffer_load_dwordx4 v2, s[8:11], s42 offen offset:2048 sc1 lds
v_fmac_f32 v13, v45, v45
v_add_f32 v12, v12, v46
v_fmac_f32 v13, v46, v46
v_mfma_f32_16x16x32_bf16 v[36:39], a[28:31], v[28:31], v[36:39]
ds_read_b128 v[28:31], v2 offset:7168
v_add_f32 v12, v12, v47
v_fmac_f32 v13, v47, v47
s_waitcnt lgkmcnt(2)
v_mfma_f32_16x16x32_bf16 v[32:35], a[32:35], v[16:19], v[32:35]
buffer_load_dwordx4 v2, s[8:11], s42 offen offset:3072 sc1 lds
v_mfma_f32_16x16x32_bf16 v[36:39], a[36:39], v[16:19], v[36:39]
ds_read_b128 v[16:19], v2 offset:8192
v_permlane32_swap_b32 v12, v13
v_mfma_f32_16x16x32_bf16 v[32:35], a[40:43], v[20:23], v[32:35]
s_add_u32 s42, s42, 4096
s_add_u32 m0, s45, 59392
s_nop 0
buffer_load_dwordx4 v2, s[8:11], s42 offen offset:0 sc1 lds
v_add_f32 v12, v12, v13
v_mfma_f32_16x16x32_bf16 v[36:39], a[44:47], v[20:23], v[36:39]
ds_read_b128 v[20:23], v2 offset:9216
v_mov_b32 v63, v12
s_waitcnt lgkmcnt(2)
v_mfma_f32_16x16x32_bf16 v[32:35], a[48:51], v[24:27], v[32:35]
buffer_load_dwordx4 v2, s[8:11], s42 offen offset:1024 sc1 lds
v_mfma_f32_16x16x32_bf16 v[36:39], a[52:55], v[24:27], v[36:39]
ds_read_b128 v[24:27], v2 offset:10240
v_permlane16_swap_b32 v12, v63
v_mfma_f32_16x16x32_bf16 v[32:35], a[56:59], v[28:31], v[32:35]
buffer_load_dwordx4 v2, s[8:11], s42 offen offset:2048 sc1 lds
v_mfma_f32_16x16x32_bf16 v[36:39], a[60:63], v[28:31], v[36:39]
ds_read_b128 v[28:31], v2 offset:11264
v_add_f32 v12, v12, v63
s_waitcnt lgkmcnt(2)
v_mfma_f32_16x16x32_bf16 v[32:35], a[64:67], v[16:19], v[32:35]
buffer_load_dwordx4 v2, s[8:11], s42 offen offset:3072 sc1 lds
v_mfma_f32_16x16x32_bf16 v[36:39], a[68:71], v[16:19], v[36:39]
ds_read_b128 v[16:19], v2 offset:12288
v_mov_b32 v13, v12
v_mfma_f32_16x16x32_bf16 v[32:35], a[72:75], v[20:23], v[32:35]
v_permlane32_swap_b32 v12, v13
v_mfma_f32_16x16x32_bf16 v[36:39], a[76:79], v[20:23], v[36:39]
ds_read_b128 v[20:23], v2 offset:13312
s_waitcnt lgkmcnt(2)
v_mfma_f32_16x16x32_bf16 v[32:35], a[80:83], v[24:27], v[32:35]
buffer_store_dwordx4 v[12:15], v5, s[4:7], s26 offen sc1
v_mfma_f32_16x16x32_bf16 v[36:39], a[84:87], v[24:27], v[36:39]
ds_read_b128 v[24:27], v2 offset:14336
s_waitcnt vmcnt(11)
v_cmp_ne_u32 vcc, s20, v50
v_mfma_f32_16x16x32_bf16 v[32:35], a[88:91], v[28:31], v[32:35]
v_cmp_ne_u32 s[28:29], s20, v54
s_or_b64 vcc, vcc, s[28:29]
s_cmp_eq_u64 vcc, 0
s_cbranch_scc0 Lg2_e2late0
Lg2_e2ret0:
v_mfma_f32_16x16x32_bf16 v[36:39], a[92:95], v[28:31], v[36:39]
ds_read_b128 v[28:31], v2 offset:15360
v_fmac_f32 v48, 0x3e800000, v52
s_waitcnt lgkmcnt(2)
v_mfma_f32_16x16x32_bf16 v[32:35], a[96:99], v[16:19], v[32:35]
s_add_u32 s42, s42, 4096
s_add_u32 m0, s45, 63488
s_nop 0
buffer_load_dwordx4 v2, s[8:11], s42 offen offset:0 sc1 lds
v_mfma_f32_16x16x32_bf16 v[36:39], a[100:103], v[16:19], v[36:39]
ds_read_b128 v[16:19], v2 offset:16384
v_fmac_f32 v49, 0x3e800000, v53
v_mfma_f32_16x16x32_bf16 v[32:35], a[104:107], v[20:23], v[32:35]
v_permlane32_swap_b32 v48, v49
v_mfma_f32_16x16x32_bf16 v[36:39], a[108:111], v[20:23], v[36:39]
ds_read_b128 v[20:23], v2 offset:17408
v_add_f32 v48, v48, v49
s_waitcnt lgkmcnt(2)
v_mfma_f32_16x16x32_bf16 v[32:35], a[112:115], v[24:27], v[32:35]
buffer_load_dwordx4 v2, s[8:11], s42 offen offset:1024 sc1 lds
v_mfma_f32_16x16x32_bf16 v[36:39], a[116:119], v[24:27], v[36:39]
ds_read_b128 v[24:27], v2 offset:18432
v_mov_b32 v63, v48
v_mfma_f32_16x16x32_bf16 v[32:35], a[120:123], v[28:31], v[32:35]
v_permlane16_swap_b32 v48, v63
v_mfma_f32_16x16x32_bf16 v[36:39], a[124:127], v[28:31], v[36:39]
ds_read_b128 v[28:31], v2 offset:19456
v_add_f32 v48, v48, v63
s_waitcnt lgkmcnt(2)
v_mfma_f32_16x16x32_bf16 v[32:35], a[128:131], v[16:19], v[32:35]
buffer_load_dwordx4 v2, s[8:11], s42 offen offset:2048 sc1 lds
v_mfma_f32_16x16x32_bf16 v[36:39], a[132:135], v[16:19], v[36:39]
ds_read_b128 v[16:19], v2 offset:20480
ds_write_b32 v66, v48 offset:0
v_mfma_f32_16x16x32_bf16 v[32:35], a[136:139], v[20:23], v[32:35]
s_waitcnt lgkmcnt(0)
s_barrier
v_mfma_f32_16x16x32_bf16 v[36:39], a[140:143], v[20:23], v[36:39]
ds_read_b128 v[20:23], v2 offset:21504
ds_read_b64 v[48:49], v62 offset:0
v_mfma_f32_16x16x32_bf16 v[32:35], a[144:147], v[24:27], v[32:35]
buffer_load_dwordx4 v2, s[8:11], s42 offen offset:3072 sc1 lds
v_mfma_f32_16x16x32_bf16 v[36:39], a[148:151], v[24:27], v[36:39]
ds_read_b128 v[24:27], v2 offset:22528
ds_read_b128 v[76:79], v8 offset:0
v_mfma_f32_16x16x32_bf16 v[32:35], a[152:155], v[28:31], v[32:35]
s_waitcnt lgkmcnt(2)
v_permlane32_swap_b32 v48, v49
v_mfma_f32_16x16x32_bf16 v[36:39], a[156:159], v[28:31], v[36:39]
ds_read_b128 v[28:31], v2 offset:23552
v_add_f32 v48, v48, v49
v_mfma_f32_16x16x32_bf16 v[32:35], a[160:163], v[16:19], v[32:35]
s_add_u32 s42, s42, 4096
s_add_u32 m0, s45, 67584
s_nop 0
buffer_load_dwordx4 v2, s[8:11], s42 offen offset:0 sc1 lds
v_mfma_f32_16x16x32_bf16 v[36:39], a[164:167], v[16:19], v[36:39]
ds_read_b128 v[16:19], v2 offset:24576
v_mov_b32 v63, v48
v_mfma_f32_16x16x32_bf16 v[32:35], a[168:171], v[20:23], v[32:35]
v_permlane16_swap_b32 v48, v63
v_mfma_f32_16x16x32_bf16 v[36:39], a[172:175], v[20:23], v[36:39]
ds_read_b128 v[20:23], v2 offset:25600
v_add_f32 v48, v48, v63
s_waitcnt lgkmcnt(2)
v_mfma_f32_16x16x32_bf16 v[32:35], a[176:179], v[24:27], v[32:35]
buffer_load_dwordx4 v2, s[8:11], s42 offen offset:1024 sc1 lds
v_mfma_f32_16x16x32_bf16 v[36:39], a[180:183], v[24:27], v[36:39]
ds_read_b128 v[24:27], v2 offset:26624
v_mov_b32 v49, v48
v_mfma_f32_16x16x32_bf16 v[32:35], a[184:187], v[28:31], v[32:35]
v_permlane32_swap_b32 v48, v49
v_mfma_f32_16x16x32_bf16 v[36:39], a[188:191], v[28:31], v[36:39]
ds_read_b128 v[28:31], v2 offset:27648
s_add_u32 s26, s35, 0
s_waitcnt lgkmcnt(2)
v_mfma_f32_16x16x32_bf16 v[32:35], a[192:195], v[16:19], v[32:35]
s_add_u32 s43, s31, 65536
buffer_load_dword v59, v9, s[4:7], s43 offen sc1
v_mfma_f32_16x16x32_bf16 v[36:39], a[196:199], v[16:19], v[36:39]
ds_read_b128 v[16:19], v2 offset:28672
v_mul_f32 v52, 0x3acccccd, v48
v_mul_f32 v56, 0x3acccccd, v49
v_mfma_f32_16x16x32_bf16 v[32:35], a[200:203], v[20:23], v[32:35]
v_fma_f32 v56, -v52, v52, v56
v_add_f32 v56, 0x3727c5ac, v56
v_mfma_f32_16x16x32_bf16 v[36:39], a[204:207], v[20:23], v[36:39]
ds_read_b128 v[20:23], v2 offset:29696
s_waitcnt lgkmcnt(2)
v_mfma_f32_16x16x32_bf16 v[32:35], a[208:211], v[24:27], v[32:35]
v_rsq_f32 v53, v56
v_mfma_f32_16x16x32_bf16 v[36:39], a[212:215], v[24:27], v[36:39]
ds_read_b128 v[24:27], v2 offset:30720
v_lshlrev_b32 v68, 16, v76
v_and_b32 v69, 0xffff0000, v76
v_mfma_f32_16x16x32_bf16 v[32:35], a[216:219], v[28:31], v[32:35]
v_lshlrev_b32 v70, 16, v77
v_and_b32 v71, 0xffff0000, v77
v_lshlrev_b32 v72, 16, v78
v_mfma_f32_16x16x32_bf16 v[36:39], a[220:223], v[28:31], v[36:39]
ds_read_b128 v[28:31], v2 offset:31744
v_and_b32 v73, 0xffff0000, v78
s_waitcnt lgkmcnt(2)
v_mfma_f32_16x16x32_bf16 v[32:35], a[224:227], v[16:19], v[32:35]
v_lshlrev_b32 v74, 16, v79
v_and_b32 v75, 0xffff0000, v79
v_mul_f32 v54, v52, v53
v_mfma_f32_16x16x32_bf16 v[36:39], a[228:231], v[16:19], v[36:39]
ds_read_b128 v[16:19], v2 offset:32768
s_waitcnt vmcnt(17)
v_lshlrev_b32 v56, 16, v0
v_and_b32 v57, 0xffff0000, v0
v_mfma_f32_16x16x32_bf16 v[32:35], a[232:235], v[20:23], v[32:35]
v_fma_f32 v60, v68, v53, -v54
v_fma_f32 v61, v69, v53, -v54
v_fmac_f32 v68, v60, v56
v_mfma_f32_16x16x32_bf16 v[36:39], a[236:239], v[20:23], v[36:39]
ds_read_b128 v[20:23], v2 offset:33792
v_fmac_f32 v69, v61, v57
s_waitcnt lgkmcnt(2)
v_mfma_f32_16x16x32_bf16 v[32:35], a[240:243], v[24:27], v[32:35]
v_lshlrev_b32 v56, 16, v1
v_and_b32 v57, 0xffff0000, v1
v_fma_f32 v60, v70, v53, -v54
v_mfma_f32_16x16x32_bf16 v[36:39], a[244:247], v[24:27], v[36:39]
ds_read_b128 v[24:27], v2 offset:34816
v_fma_f32 v61, v71, v53, -v54
v_fmac_f32 v70, v60, v56
v_mfma_f32_16x16x32_bf16 v[32:35], a[248:251], v[28:31], v[32:35]
v_fmac_f32 v71, v61, v57
s_waitcnt vmcnt(16)
v_lshlrev_b32 v56, 16, v10
v_and_b32 v57, 0xffff0000, v10
v_mfma_f32_16x16x32_bf16 v[36:39], a[252:255], v[28:31], v[36:39]
ds_read_b128 v[28:31], v2 offset:35840
v_fma_f32 v60, v72, v53, -v54
s_waitcnt lgkmcnt(2)
v_mfma_f32_16x16x32_bf16 v[32:35], v[80:83], v[16:19], v[32:35]
v_fma_f32 v61, v73, v53, -v54
v_fmac_f32 v72, v60, v56
v_mfma_f32_16x16x32_bf16 v[36:39], v[84:87], v[16:19], v[36:39]
ds_read_b128 v[16:19], v2 offset:36864
v_fmac_f32 v73, v61, v57
v_lshlrev_b32 v56, 16, v11
v_mfma_f32_16x16x32_bf16 v[32:35], v[88:91], v[20:23], v[32:35]
v_and_b32 v57, 0xffff0000, v11
v_fma_f32 v60, v74, v53, -v54
v_mfma_f32_16x16x32_bf16 v[36:39], v[92:95], v[20:23], v[36:39]
ds_read_b128 v[20:23], v2 offset:37888
v_fma_f32 v61, v75, v53, -v54
s_waitcnt lgkmcnt(2)
v_mfma_f32_16x16x32_bf16 v[32:35], v[96:99], v[24:27], v[32:35]
v_fmac_f32 v74, v60, v56
v_fmac_f32 v75, v61, v57
v_mfma_f32_16x16x32_bf16 v[36:39], v[100:103], v[24:27], v[36:39]
ds_read_b128 v[24:27], v2 offset:38912
v_cvt_pk_bf16_f32 v76, v68, v69
v_cvt_pk_bf16_f32 v77, v70, v71
v_mfma_f32_16x16x32_bf16 v[32:35], v[104:107], v[28:31], v[32:35]
v_cvt_pk_bf16_f32 v78, v72, v73
v_cvt_pk_bf16_f32 v79, v74, v75
v_mfma_f32_16x16x32_bf16 v[36:39], v[108:111], v[28:31], v[36:39]
ds_read_b128 v[28:31], v2 offset:39936
s_waitcnt lgkmcnt(2)
v_mfma_f32_16x16x32_bf16 v[32:35], v[112:115], v[16:19], v[32:35]
buffer_store_dwordx4 v[76:79], v2, s[4:7], s26 offen sc1
v_mfma_f32_16x16x32_bf16 v[36:39], v[116:119], v[16:19], v[36:39]
ds_read_b128 v[16:19], v2 offset:40960
ds_write_b128 v8, v[76:79] offset:0
v_mfma_f32_16x16x32_bf16 v[32:35], v[120:123], v[20:23], v[32:35]
v_add_f32 v51, v68, v69
v_mul_f32 v55, v68, v68
v_mfma_f32_16x16x32_bf16 v[36:39], v[124:127], v[20:23], v[36:39]
ds_read_b128 v[20:23], v2 offset:41984
s_waitcnt lgkmcnt(3)
v_mfma_f32_16x16x32_bf16 v[32:35], v[128:131], v[24:27], v[32:35]
v_fmac_f32 v55, v69, v69
v_add_f32 v51, v51, v70
v_mfma_f32_16x16x32_bf16 v[36:39], v[132:135], v[24:27], v[36:39]
ds_read_b128 v[24:27], v2 offset:43008
v_fmac_f32 v55, v70, v70
v_mfma_f32_16x16x32_bf16 v[32:35], v[136:139], v[28:31], v[32:35]
v_add_f32 v51, v51, v71
v_fmac_f32 v55, v71, v71
v_mfma_f32_16x16x32_bf16 v[36:39], v[140:143], v[28:31], v[36:39]
ds_read_b128 v[28:31], v2 offset:44032
s_waitcnt lgkmcnt(2)
v_mfma_f32_16x16x32_bf16 v[32:35], v[144:147], v[16:19], v[32:35]
v_add_f32 v51, v51, v72
v_fmac_f32 v55, v72, v72
v_mfma_f32_16x16x32_bf16 v[36:39], v[148:151], v[16:19], v[36:39]
ds_read_b128 v[16:19], v2 offset:45056
v_add_f32 v51, v51, v73
v_mfma_f32_16x16x32_bf16 v[32:35], v[152:155], v[20:23], v[32:35]
v_fmac_f32 v55, v73, v73
v_add_f32 v51, v51, v74
v_mfma_f32_16x16x32_bf16 v[36:39], v[156:159], v[20:23], v[36:39]
ds_read_b128 v[20:23], v2 offset:46080
s_waitcnt lgkmcnt(2)
v_mfma_f32_16x16x32_bf16 v[32:35], v[160:163], v[24:27], v[32:35]
v_fmac_f32 v55, v74, v74
v_add_f32 v51, v51, v75
v_mfma_f32_16x16x32_bf16 v[36:39], v[164:167], v[24:27], v[36:39]
ds_read_b128 v[24:27], v2 offset:47104
v_fmac_f32 v55, v75, v75
v_mfma_f32_16x16x32_bf16 v[32:35], v[168:171], v[28:31], v[32:35]
v_permlane32_swap_b32 v51, v55
v_mfma_f32_16x16x32_bf16 v[36:39], v[172:175], v[28:31], v[36:39]
ds_read_b128 v[28:31], v2 offset:48128
s_waitcnt lgkmcnt(2)
v_mfma_f32_16x16x32_bf16 v[32:35], v[176:179], v[16:19], v[32:35]
v_add_f32 v51, v51, v55
v_mov_b32 v63, v51
v_mfma_f32_16x16x32_bf16 v[36:39], v[180:183], v[16:19], v[36:39]
ds_read_b128 v[16:19], v2 offset:49152
v_permlane16_swap_b32 v51, v63
v_mfma_f32_16x16x32_bf16 v[32:35], v[184:187], v[20:23], v[32:35]
v_add_f32 v51, v51, v63
v_mov_b32 v55, v51
v_mfma_f32_16x16x32_bf16 v[36:39], v[188:191], v[20:23], v[36:39]
ds_read_b128 v[20:23], v2 offset:50176
s_waitcnt lgkmcnt(2)
v_mfma_f32_16x16x32_bf16 v[32:35], v[192:195], v[24:27], v[32:35]
v_permlane32_swap_b32 v51, v55
v_mfma_f32_16x16x32_bf16 v[36:39], v[196:199], v[24:27], v[36:39]
ds_read_b128 v[24:27], v2 offset:51200
v_mfma_f32_16x16x32_bf16 v[32:35], v[200:203], v[28:31], v[32:35]
v_mfma_f32_16x16x32_bf16 v[36:39], v[204:207], v[28:31], v[36:39]
ds_read_b128 v[28:31], v2 offset:52224
s_waitcnt lgkmcnt(2)
v_mfma_f32_16x16x32_bf16 v[32:35], v[208:211], v[16:19], v[32:35]
v_mfma_f32_16x16x32_bf16 v[36:39], v[212:215], v[16:19], v[36:39]
ds_read_b128 v[16:19], v2 offset:53248
v_mfma_f32_16x16x32_bf16 v[32:35], v[216:219], v[20:23], v[32:35]
v_mfma_f32_16x16x32_bf16 v[36:39], v[220:223], v[20:23], v[36:39]
ds_read_b128 v[20:23], v2 offset:54272
s_waitcnt lgkmcnt(2)
v_mfma_f32_16x16x32_bf16 v[32:35], v[224:227], v[24:27], v[32:35]
s_add_u32 s26, s33, 81920
s_add_u32 s27, s34, 327680
buffer_load_dwordx3 v[48:50], v64, s[4:7], s26 offen sc1
v_mfma_f32_16x16x32_bf16 v[36:39], v[228:231], v[24:27], v[36:39]
buffer_load_dwordx3 v[52:54], v65, s[4:7], s26 offen sc1
v_mfma_f32_16x16x32_bf16 v[32:35], v[232:235], v[28:31], v[32:35]
buffer_load_dwordx2 v[0:1], v7, s[4:7], s27 offen
buffer_load_dwordx2 v[10:11], v7, s[4:7], s27 offen offset:512
ds_read_b128 v[76:79], v8 offset:12288
s_waitcnt lgkmcnt(0)
v_lshlrev_b32 v40, 16, v76
v_and_b32 v41, 0xffff0000, v76
v_lshlrev_b32 v42, 16, v77
v_and_b32 v43, 0xffff0000, v77
v_lshlrev_b32 v44, 16, v78
v_and_b32 v45, 0xffff0000, v78
v_lshlrev_b32 v46, 16, v79
v_and_b32 v47, 0xffff0000, v79
v_mfma_f32_16x16x32_bf16 v[36:39], v[236:239], v[28:31], v[36:39]
s_cmp_eq_u32 s10, 0
s_cbranch_scc1 Lg2_falate2
Lg2_faret2:
s_waitcnt vmcnt(6) lgkmcnt(0)
s_barrier
ds_read_b128 v[24:27], v3 offset:0
ds_read_b128 v[28:31], v3 offset:1024
v_mfma_f32_16x16x32_bf16 v[32:35], v[240:243], v[16:19], v[32:35]
v_mfma_f32_16x16x32_bf16 v[36:39], v[244:247], v[16:19], v[36:39]
ds_read_b128 v[16:19], v3 offset:2048
v_mfma_f32_16x16x32_bf16 v[32:35], v[248:251], v[20:23], v[32:35]
v_mfma_f32_16x16x32_bf16 v[36:39], v[252:255], v[20:23], v[36:39]
ds_read_b128 v[20:23], v3 offset:3072
s_waitcnt lgkmcnt(2)
v_mfma_f32_16x16x32_bf16 v[40:43], a[0:3], v[24:27], v[40:43]
s_waitcnt vmcnt(5)
v_cmp_ne_u32 vcc, s20, v59
s_cmp_eq_u64 vcc, 0
s_cselect_b32 s10, 0x10000000, 0
s_add_u32 s26, s32, 163840
v_cvt_pk_bf16_f32 v76, v32, v33
v_cvt_pk_bf16_f32 v77, v34, v35
v_mfma_f32_16x16x32_bf16 v[44:47], a[4:7], v[24:27], v[44:47]
ds_read_b128 v[24:27], v3 offset:4096
v_cvt_pk_bf16_f32 v78, v36, v37
v_cvt_pk_bf16_f32 v79, v38, v39
v_mfma_f32_16x16x32_bf16 v[40:43], a[8:11], v[28:31], v[40:43]
s_add_u32 s42, s30, 0x360000
s_add_u32 m0, s45, 0
s_nop 0
buffer_load_dwordx4 v2, s[8:11], s42 offen offset:0 sc1 lds
ds_write_b128 v8, v[76:79] offset:8192
v_mfma_f32_16x16x32_bf16 v[44:47], a[12:15], v[28:31], v[44:47]
ds_read_b128 v[28:31], v3 offset:5120
v_add_f32 v12, v32, v33
v_mul_f32 v13, v32, v32
v_fmac_f32 v13, v33, v33
s_waitcnt lgkmcnt(3)
v_mfma_f32_16x16x32_bf16 v[40:43], a[16:19], v[16:19], v[40:43]
buffer_load_dwordx4 v2, s[8:11], s42 offen offset:1024 sc1 lds
v_add_f32 v12, v12, v34
v_fmac_f32 v13, v34, v34
v_add_f32 v12, v12, v35
v_mfma_f32_16x16x32_bf16 v[44:47], a[20:23], v[16:19], v[44:47]
ds_read_b128 v[16:19], v3 offset:6144
v_fmac_f32 v13, v35, v35
v_add_f32 v12, v12, v36
v_fmac_f32 v13, v36, v36
v_add_f32 v12, v12, v37
v_mfma_f32_16x16x32_bf16 v[40:43], a[24:27], v[20:23], v[40:43]
buffer_load_dwordx4 v2, s[8:11], s42 offen offset:2048 sc1 lds
v_fmac_f32 v13, v37, v37
v_add_f32 v12, v12, v38
v_fmac_f32 v13, v38, v38
v_mfma_f32_16x16x32_bf16 v[44:47], a[28:31], v[20:23], v[44:47]
ds_read_b128 v[20:23], v3 offset:7168
v_add_f32 v12, v12, v39
v_fmac_f32 v13, v39, v39
s_waitcnt lgkmcnt(2)
v_mfma_f32_16x16x32_bf16 v[40:43], a[32:35], v[24:27], v[40:43]
buffer_load_dwordx4 v2, s[8:11], s42 offen offset:3072 sc1 lds
v_mfma_f32_16x16x32_bf16 v[44:47], a[36:39], v[24:27], v[44:47]
ds_read_b128 v[24:27], v3 offset:8192
v_permlane32_swap_b32 v12, v13
v_mfma_f32_16x16x32_bf16 v[40:43], a[40:43], v[28:31], v[40:43]
s_add_u32 s42, s42, 4096
s_add_u32 m0, s45, 4096
s_nop 0
buffer_load_dwordx4 v2, s[8:11], s42 offen offset:0 sc1 lds
v_add_f32 v12, v12, v13
v_mfma_f32_16x16x32_bf16 v[44:47], a[44:47], v[28:31], v[44:47]
ds_read_b128 v[28:31], v3 offset:9216
v_mov_b32 v63, v12
s_waitcnt lgkmcnt(2)
v_mfma_f32_16x16x32_bf16 v[40:43], a[48:51], v[16:19], v[40:43]
buffer_load_dwordx4 v2, s[8:11], s42 offen offset:1024 sc1 lds
v_mfma_f32_16x16x32_bf16 v[44:47], a[52:55], v[16:19], v[44:47]
ds_read_b128 v[16:19], v3 offset:10240
v_permlane16_swap_b32 v12, v63
v_mfma_f32_16x16x32_bf16 v[40:43], a[56:59], v[20:23], v[40:43]
buffer_load_dwordx4 v2, s[8:11], s42 offen offset:2048 sc1 lds
v_mfma_f32_16x16x32_bf16 v[44:47], a[60:63], v[20:23], v[44:47]
ds_read_b128 v[20:23], v3 offset:11264
v_add_f32 v12, v12, v63
s_waitcnt lgkmcnt(2)
v_mfma_f32_16x16x32_bf16 v[40:43], a[64:67], v[24:27], v[40:43]
buffer_load_dwordx4 v2, s[8:11], s42 offen offset:3072 sc1 lds
v_mfma_f32_16x16x32_bf16 v[44:47], a[68:71], v[24:27], v[44:47]
ds_read_b128 v[24:27], v3 offset:12288
v_mov_b32 v13, v12
v_mfma_f32_16x16x32_bf16 v[40:43], a[72:75], v[28:31], v[40:43]
v_permlane32_swap_b32 v12, v13
v_mfma_f32_16x16x32_bf16 v[44:47], a[76:79], v[28:31], v[44:47]
ds_read_b128 v[28:31], v3 offset:13312
s_waitcnt lgkmcnt(2)
v_mfma_f32_16x16x32_bf16 v[40:43], a[80:83], v[16:19], v[40:43]
buffer_store_dwordx4 v[12:15], v5, s[4:7], s26 offen sc1
v_mfma_f32_16x16x32_bf16 v[44:47], a[84:87], v[16:19], v[44:47]
ds_read_b128 v[16:19], v3 offset:14336
s_waitcnt vmcnt(11)
v_cmp_ne_u32 vcc, s20, v50
v_mfma_f32_16x16x32_bf16 v[40:43], a[88:91], v[20:23], v[40:43]
v_cmp_ne_u32 s[28:29], s20, v54
s_or_b64 vcc, vcc, s[28:29]
s_cmp_eq_u64 vcc, 0
s_cbranch_scc0 Lg2_e2late1
Lg2_e2ret1:
v_mfma_f32_16x16x32_bf16 v[44:47], a[92:95], v[20:23], v[44:47]
ds_read_b128 v[20:23], v3 offset:15360
v_fmac_f32 v48, 0x3e800000, v52
s_waitcnt lgkmcnt(2)
v_mfma_f32_16x16x32_bf16 v[40:43], a[96:99], v[24:27], v[40:43]
s_add_u32 s42, s42, 4096
s_add_u32 m0, s45, 8192
s_nop 0
buffer_load_dwordx4 v2, s[8:11], s42 offen offset:0 sc1 lds
v_mfma_f32_16x16x32_bf16 v[44:47], a[100:103], v[24:27], v[44:47]
ds_read_b128 v[24:27], v3 offset:16384
v_fmac_f32 v49, 0x3e800000, v53
v_mfma_f32_16x16x32_bf16 v[40:43], a[104:107], v[28:31], v[40:43]
v_permlane32_swap_b32 v48, v49
v_mfma_f32_16x16x32_bf16 v[44:47], a[108:111], v[28:31], v[44:47]
ds_read_b128 v[28:31], v3 offset:17408
v_add_f32 v48, v48, v49
s_waitcnt lgkmcnt(2)
v_mfma_f32_16x16x32_bf16 v[40:43], a[112:115], v[16:19], v[40:43]
buffer_load_dwordx4 v2, s[8:11], s42 offen offset:1024 sc1 lds
v_mfma_f32_16x16x32_bf16 v[44:47], a[116:119], v[16:19], v[44:47]
ds_read_b128 v[16:19], v3 offset:18432
v_mov_b32 v63, v48
v_mfma_f32_16x16x32_bf16 v[40:43], a[120:123], v[20:23], v[40:43]
v_permlane16_swap_b32 v48, v63
v_mfma_f32_16x16x32_bf16 v[44:47], a[124:127], v[20:23], v[44:47]
ds_read_b128 v[20:23], v3 offset:19456
v_add_f32 v48, v48, v63
s_waitcnt lgkmcnt(2)
v_mfma_f32_16x16x32_bf16 v[40:43], a[128:131], v[24:27], v[40:43]
buffer_load_dwordx4 v2, s[8:11], s42 offen offset:2048 sc1 lds
v_mfma_f32_16x16x32_bf16 v[44:47], a[132:135], v[24:27], v[44:47]
ds_read_b128 v[24:27], v3 offset:20480
ds_write_b32 v66, v48 offset:512
v_mfma_f32_16x16x32_bf16 v[40:43], a[136:139], v[28:31], v[40:43]
s_waitcnt lgkmcnt(0)
s_barrier
v_mfma_f32_16x16x32_bf16 v[44:47], a[140:143], v[28:31], v[44:47]
ds_read_b128 v[28:31], v3 offset:21504
ds_read_b64 v[48:49], v62 offset:512
v_mfma_f32_16x16x32_bf16 v[40:43], a[144:147], v[16:19], v[40:43]
buffer_load_dwordx4 v2, s[8:11], s42 offen offset:3072 sc1 lds
v_mfma_f32_16x16x32_bf16 v[44:47], a[148:151], v[16:19], v[44:47]
ds_read_b128 v[16:19], v3 offset:22528
s_add_u32 s26, s36, 0
s_waitcnt vmcnt(17)
v_mfma_f32_16x16x32_bf16 v[40:43], a[152:155], v[20:23], v[40:43]
v_mov_b32 v12, v51
v_mov_b32 v13, v55
v_mfma_f32_16x16x32_bf16 v[44:47], a[156:159], v[20:23], v[44:47]
ds_read_b128 v[20:23], v3 offset:23552
s_waitcnt lgkmcnt(3)
v_mfma_f32_16x16x32_bf16 v[40:43], a[160:163], v[24:27], v[40:43]
buffer_store_dwordx4 v[12:15], v5, s[4:7], s26 offen sc1
v_mfma_f32_16x16x32_bf16 v[44:47], a[164:167], v[24:27], v[44:47]
ds_read_b128 v[24:27], v3 offset:24576
ds_read_b128 v[76:79], v8 offset:4096
v_mfma_f32_16x16x32_bf16 v[40:43], a[168:171], v[28:31], v[40:43]
s_waitcnt lgkmcnt(4)
v_permlane32_swap_b32 v48, v49
v_mfma_f32_16x16x32_bf16 v[44:47], a[172:175], v[28:31], v[44:47]
ds_read_b128 v[28:31], v3 offset:25600
v_add_f32 v48, v48, v49
s_waitcnt lgkmcnt(3)
v_mfma_f32_16x16x32_bf16 v[40:43], a[176:179], v[16:19], v[40:43]
s_add_u32 s42, s42, 4096
s_add_u32 m0, s45, 12288
s_nop 0
buffer_load_dwordx4 v2, s[8:11], s42 offen offset:0 sc1 lds
v_mfma_f32_16x16x32_bf16 v[44:47], a[180:183], v[16:19], v[44:47]
ds_read_b128 v[16:19], v3 offset:26624
v_mov_b32 v63, v48
v_mfma_f32_16x16x32_bf16 v[40:43], a[184:187], v[20:23], v[40:43]
v_permlane16_swap_b32 v48, v63
v_mfma_f32_16x16x32_bf16 v[44:47], a[188:191], v[20:23], v[44:47]
ds_read_b128 v[20:23], v3 offset:27648
v_add_f32 v48, v48, v63
s_waitcnt lgkmcnt(2)
v_mfma_f32_16x16x32_bf16 v[40:43], a[192:195], v[24:27], v[40:43]
buffer_load_dwordx4 v2, s[8:11], s42 offen offset:1024 sc1 lds
v_mfma_f32_16x16x32_bf16 v[44:47], a[196:199], v[24:27], v[44:47]
ds_read_b128 v[24:27], v3 offset:28672
v_mov_b32 v49, v48
v_mfma_f32_16x16x32_bf16 v[40:43], a[200:203], v[28:31], v[40:43]
v_permlane32_swap_b32 v48, v49
v_mfma_f32_16x16x32_bf16 v[44:47], a[204:207], v[28:31], v[44:47]
ds_read_b128 v[28:31], v3 offset:29696
s_add_u32 s26, s35, 327680
s_waitcnt lgkmcnt(2)
v_mfma_f32_16x16x32_bf16 v[40:43], a[208:211], v[16:19], v[40:43]
s_add_u32 s43, s31, 81920
buffer_load_dword v59, v9, s[4:7], s43 offen sc1
v_mfma_f32_16x16x32_bf16 v[44:47], a[212:215], v[16:19], v[44:47]
ds_read_b128 v[16:19], v3 offset:30720
v_mul_f32 v52, 0x3acccccd, v48
v_mul_f32 v56, 0x3acccccd, v49
v_mfma_f32_16x16x32_bf16 v[40:43], a[216:219], v[20:23], v[40:43]
v_fma_f32 v56, -v52, v52, v56
v_add_f32 v56, 0x3727c5ac, v56
v_mfma_f32_16x16x32_bf16 v[44:47], a[220:223], v[20:23], v[44:47]
ds_read_b128 v[20:23], v3 offset:31744
s_waitcnt lgkmcnt(2)
v_mfma_f32_16x16x32_bf16 v[40:43], a[224:227], v[24:27], v[40:43]
v_rsq_f32 v53, v56
v_mfma_f32_16x16x32_bf16 v[44:47], a[228:231], v[24:27], v[44:47]
ds_read_b128 v[24:27], v3 offset:32768
v_lshlrev_b32 v68, 16, v76
v_and_b32 v69, 0xffff0000, v76
v_mfma_f32_16x16x32_bf16 v[40:43], a[232:235], v[28:31], v[40:43]
v_lshlrev_b32 v70, 16, v77
v_and_b32 v71, 0xffff0000, v77
v_lshlrev_b32 v72, 16, v78
v_mfma_f32_16x16x32_bf16 v[44:47], a[236:239], v[28:31], v[44:47]
ds_read_b128 v[28:31], v3 offset:33792
v_and_b32 v73, 0xffff0000, v78
s_waitcnt lgkmcnt(2)
v_mfma_f32_16x16x32_bf16 v[40:43], a[240:243], v[16:19], v[40:43]
v_lshlrev_b32 v74, 16, v79
v_and_b32 v75, 0xffff0000, v79
v_mul_f32 v54, v52, v53
v_mfma_f32_16x16x32_bf16 v[44:47], a[244:247], v[16:19], v[44:47]
ds_read_b128 v[16:19], v3 offset:34816
s_waitcnt vmcnt(18)
v_lshlrev_b32 v56, 16, v0
v_and_b32 v57, 0xffff0000, v0
v_mfma_f32_16x16x32_bf16 v[40:43], a[248:251], v[20:23], v[40:43]
v_fma_f32 v60, v68, v53, -v54
v_fma_f32 v61, v69, v53, -v54
v_fmac_f32 v68, v60, v56
v_mfma_f32_16x16x32_bf16 v[44:47], a[252:255], v[20:23], v[44:47]
ds_read_b128 v[20:23], v3 offset:35840
v_fmac_f32 v69, v61, v57
s_waitcnt lgkmcnt(2)
v_mfma_f32_16x16x32_bf16 v[40:43], v[80:83], v[24:27], v[40:43]
v_lshlrev_b32 v56, 16, v1
v_and_b32 v57, 0xffff0000, v1
v_fma_f32 v60, v70, v53, -v54
v_mfma_f32_16x16x32_bf16 v[44:47], v[84:87], v[24:27], v[44:47]
ds_read_b128 v[24:27], v3 offset:36864
v_fma_f32 v61, v71, v53, -v54
v_fmac_f32 v70, v60, v56
v_mfma_f32_16x16x32_bf16 v[40:43], v[88:91], v[28:31], v[40:43]
v_fmac_f32 v71, v61, v57
s_waitcnt vmcnt(17)
v_lshlrev_b32 v56, 16, v10
v_and_b32 v57, 0xffff0000, v10
v_mfma_f32_16x16x32_bf16 v[44:47], v[92:95], v[28:31], v[44:47]
ds_read_b128 v[28:31], v3 offset:37888
v_fma_f32 v60, v72, v53, -v54
s_waitcnt lgkmcnt(2)
v_mfma_f32_16x16x32_bf16 v[40:43], v[96:99], v[16:19], v[40:43]
v_fma_f32 v61, v73, v53, -v54
v_fmac_f32 v72, v60, v56
v_fmac_f32 v73, v61, v57
v_mfma_f32_16x16x32_bf16 v[44:47], v[100:103], v[16:19], v[44:47]
ds_read_b128 v[16:19], v3 offset:38912
v_lshlrev_b32 v56, 16, v11
v_and_b32 v57, 0xffff0000, v11
v_mfma_f32_16x16x32_bf16 v[40:43], v[104:107], v[20:23], v[40:43]
v_fma_f32 v60, v74, v53, -v54
v_fma_f32 v61, v75, v53, -v54
v_fmac_f32 v74, v60, v56
v_mfma_f32_16x16x32_bf16 v[44:47], v[108:111], v[20:23], v[44:47]
ds_read_b128 v[20:23], v3 offset:39936
v_fmac_f32 v75, v61, v57
s_waitcnt lgkmcnt(2)
v_mfma_f32_16x16x32_bf16 v[40:43], v[112:115], v[24:27], v[40:43]
v_cvt_pk_bf16_f32 v76, v68, v69
v_cvt_pk_bf16_f32 v77, v70, v71
v_cvt_pk_bf16_f32 v78, v72, v73
v_mfma_f32_16x16x32_bf16 v[44:47], v[116:119], v[24:27], v[44:47]
ds_read_b128 v[24:27], v3 offset:40960
v_cvt_pk_bf16_f32 v79, v74, v75
v_mfma_f32_16x16x32_bf16 v[40:43], v[120:123], v[28:31], v[40:43]
buffer_store_dwordx4 v[76:79], v2, s[4:7], s26 offen sc1
v_mfma_f32_16x16x32_bf16 v[44:47], v[124:127], v[28:31], v[44:47]
ds_read_b128 v[28:31], v3 offset:41984
ds_write_b128 v8, v[76:79] offset:4096
s_waitcnt lgkmcnt(3)
v_mfma_f32_16x16x32_bf16 v[40:43], v[128:131], v[16:19], v[40:43]
v_add_f32 v51, v68, v69
v_mul_f32 v55, v68, v68
v_mfma_f32_16x16x32_bf16 v[44:47], v[132:135], v[16:19], v[44:47]
ds_read_b128 v[16:19], v3 offset:43008
v_fmac_f32 v55, v69, v69
v_mfma_f32_16x16x32_bf16 v[40:43], v[136:139], v[20:23], v[40:43]
v_add_f32 v51, v51, v70
v_fmac_f32 v55, v70, v70
v_mfma_f32_16x16x32_bf16 v[44:47], v[140:143], v[20:23], v[44:47]
ds_read_b128 v[20:23], v3 offset:44032
s_waitcnt lgkmcnt(3)
v_mfma_f32_16x16x32_bf16 v[40:43], v[144:147], v[24:27], v[40:43]
v_add_f32 v51, v51, v71
v_fmac_f32 v55, v71, v71
v_mfma_f32_16x16x32_bf16 v[44:47], v[148:151], v[24:27], v[44:47]
ds_read_b128 v[24:27], v3 offset:45056
v_add_f32 v51, v51, v72
v_mfma_f32_16x16x32_bf16 v[40:43], v[152:155], v[28:31], v[40:43]
v_fmac_f32 v55, v72, v72
v_add_f32 v51, v51, v73
v_mfma_f32_16x16x32_bf16 v[44:47], v[156:159], v[28:31], v[44:47]
ds_read_b128 v[28:31], v3 offset:46080
s_waitcnt lgkmcnt(2)
v_mfma_f32_16x16x32_bf16 v[40:43], v[160:163], v[16:19], v[40:43]
v_fmac_f32 v55, v73, v73
v_add_f32 v51, v51, v74
v_fmac_f32 v55, v74, v74
v_mfma_f32_16x16x32_bf16 v[44:47], v[164:167], v[16:19], v[44:47]
ds_read_b128 v[16:19], v3 offset:47104
v_add_f32 v51, v51, v75
v_mfma_f32_16x16x32_bf16 v[40:43], v[168:171], v[20:23], v[40:43]
v_fmac_f32 v55, v75, v75
s_nop 1
v_permlane32_swap_b32 v51, v55
v_mfma_f32_16x16x32_bf16 v[44:47], v[172:175], v[20:23], v[44:47]
ds_read_b128 v[20:23], v3 offset:48128
s_waitcnt lgkmcnt(2)
v_mfma_f32_16x16x32_bf16 v[40:43], v[176:179], v[24:27], v[40:43]
v_add_f32 v51, v51, v55
v_mov_b32 v63, v51
v_mfma_f32_16x16x32_bf16 v[44:47], v[180:183], v[24:27], v[44:47]
ds_read_b128 v[24:27], v3 offset:49152
v_permlane16_swap_b32 v51, v63
v_mfma_f32_16x16x32_bf16 v[40:43], v[184:187], v[28:31], v[40:43]
v_add_f32 v51, v51, v63
v_mov_b32 v55, v51
v_mfma_f32_16x16x32_bf16 v[44:47], v[188:191], v[28:31], v[44:47]
ds_read_b128 v[28:31], v3 offset:50176
s_waitcnt lgkmcnt(2)
v_mfma_f32_16x16x32_bf16 v[40:43], v[192:195], v[16:19], v[40:43]
v_permlane32_swap_b32 v51, v55
v_mfma_f32_16x16x32_bf16 v[44:47], v[196:199], v[16:19], v[44:47]
ds_read_b128 v[16:19], v3 offset:51200
v_mfma_f32_16x16x32_bf16 v[40:43], v[200:203], v[20:23], v[40:43]
v_mfma_f32_16x16x32_bf16 v[44:47], v[204:207], v[20:23], v[44:47]
ds_read_b128 v[20:23], v3 offset:52224
s_waitcnt lgkmcnt(2)
v_mfma_f32_16x16x32_bf16 v[40:43], v[208:211], v[24:27], v[40:43]
v_mfma_f32_16x16x32_bf16 v[44:47], v[212:215], v[24:27], v[44:47]
ds_read_b128 v[24:27], v3 offset:53248
v_mfma_f32_16x16x32_bf16 v[40:43], v[216:219], v[28:31], v[40:43]
v_mfma_f32_16x16x32_bf16 v[44:47], v[220:223], v[28:31], v[44:47]
ds_read_b128 v[28:31], v3 offset:54272
s_waitcnt lgkmcnt(2)
v_mfma_f32_16x16x32_bf16 v[40:43], v[224:227], v[16:19], v[40:43]
s_add_u32 s26, s33, 163840
s_add_u32 s27, s34, 655360
buffer_load_dwordx3 v[48:50], v64, s[4:7], s26 offen sc1
v_mfma_f32_16x16x32_bf16 v[44:47], v[228:231], v[16:19], v[44:47]
buffer_load_dwordx3 v[52:54], v65, s[4:7], s26 offen sc1
v_mfma_f32_16x16x32_bf16 v[40:43], v[232:235], v[20:23], v[40:43]
buffer_load_dwordx2 v[0:1], v7, s[4:7], s27 offen
buffer_load_dwordx2 v[10:11], v7, s[4:7], s27 offen offset:512
ds_read_b128 v[76:79], v8 offset:16384
s_waitcnt lgkmcnt(0)
v_lshlrev_b32 v32, 16, v76
v_and_b32 v33, 0xffff0000, v76
v_lshlrev_b32 v34, 16, v77
v_and_b32 v35, 0xffff0000, v77
v_lshlrev_b32 v36, 16, v78
v_and_b32 v37, 0xffff0000, v78
v_lshlrev_b32 v38, 16, v79
v_and_b32 v39, 0xffff0000, v79
v_mfma_f32_16x16x32_bf16 v[44:47], v[236:239], v[20:23], v[44:47]
s_cmp_eq_u32 s10, 0
s_cbranch_scc1 Lg2_falate3
Lg2_faret3:
s_waitcnt vmcnt(6) lgkmcnt(0)
s_barrier
ds_read_b128 v[16:19], v2 offset:0
ds_read_b128 v[20:23], v2 offset:1024
v_mfma_f32_16x16x32_bf16 v[40:43], v[240:243], v[24:27], v[40:43]
v_mfma_f32_16x16x32_bf16 v[44:47], v[244:247], v[24:27], v[44:47]
ds_read_b128 v[24:27], v2 offset:2048
v_mfma_f32_16x16x32_bf16 v[40:43], v[248:251], v[28:31], v[40:43]
v_mfma_f32_16x16x32_bf16 v[44:47], v[252:255], v[28:31], v[44:47]
ds_read_b128 v[28:31], v2 offset:3072
s_waitcnt lgkmcnt(2)
v_mfma_f32_16x16x32_bf16 v[32:35], a[0:3], v[16:19], v[32:35]
s_waitcnt vmcnt(5)
v_cmp_ne_u32 vcc, s20, v59
s_cmp_eq_u64 vcc, 0
s_cselect_b32 s10, 0x10000000, 0
s_add_u32 s26, s32, 245760
v_cvt_pk_bf16_f32 v76, v40, v41
v_cvt_pk_bf16_f32 v77, v42, v43
v_mfma_f32_16x16x32_bf16 v[36:39], a[4:7], v[16:19], v[36:39]
ds_read_b128 v[16:19], v2 offset:4096
v_cvt_pk_bf16_f32 v78, v44, v45
v_cvt_pk_bf16_f32 v79, v46, v47
v_mfma_f32_16x16x32_bf16 v[32:35], a[8:11], v[20:23], v[32:35]
s_add_u32 s42, s30, 0x438000
s_add_u32 m0, s45, 55296
s_nop 0
buffer_load_dwordx4 v2, s[8:11], s42 offen offset:0 sc1 lds
ds_write_b128 v8, v[76:79] offset:12288
v_mfma_f32_16x16x32_bf16 v[36:39], a[12:15], v[20:23], v[36:39]
ds_read_b128 v[20:23], v2 offset:5120
v_add_f32 v12, v40, v41
v_mul_f32 v13, v40, v40
v_fmac_f32 v13, v41, v41
s_waitcnt lgkmcnt(3)
v_mfma_f32_16x16x32_bf16 v[32:35], a[16:19], v[24:27], v[32:35]
buffer_load_dwordx4 v2, s[8:11], s42 offen offset:1024 sc1 lds
v_add_f32 v12, v12, v42
v_fmac_f32 v13, v42, v42
v_add_f32 v12, v12, v43
v_mfma_f32_16x16x32_bf16 v[36:39], a[20:23], v[24:27], v[36:39]
ds_read_b128 v[24:27], v2 offset:6144
v_fmac_f32 v13, v43, v43
v_add_f32 v12, v12, v44
v_fmac_f32 v13, v44, v44
v_add_f32 v12, v12, v45
v_mfma_f32_16x16x32_bf16 v[32:35], a[24:27], v[28:31], v[32:35]
buffer_load_dwordx4 v2, s[8:11], s42 offen offset:2048 sc1 lds
v_fmac_f32 v13, v45, v45
v_add_f32 v12, v12, v46
v_fmac_f32 v13, v46, v46
v_mfma_f32_16x16x32_bf16 v[36:39], a[28:31], v[28:31], v[36:39]
ds_read_b128 v[28:31], v2 offset:7168
v_add_f32 v12, v12, v47
v_fmac_f32 v13, v47, v47
s_waitcnt lgkmcnt(2)
v_mfma_f32_16x16x32_bf16 v[32:35], a[32:35], v[16:19], v[32:35]
buffer_load_dwordx4 v2, s[8:11], s42 offen offset:3072 sc1 lds
v_mfma_f32_16x16x32_bf16 v[36:39], a[36:39], v[16:19], v[36:39]
ds_read_b128 v[16:19], v2 offset:8192
v_permlane32_swap_b32 v12, v13
v_mfma_f32_16x16x32_bf16 v[32:35], a[40:43], v[20:23], v[32:35]
s_add_u32 s42, s42, 4096
s_add_u32 m0, s45, 59392
s_nop 0
buffer_load_dwordx4 v2, s[8:11], s42 offen offset:0 sc1 lds
v_add_f32 v12, v12, v13
v_mfma_f32_16x16x32_bf16 v[36:39], a[44:47], v[20:23], v[36:39]
ds_read_b128 v[20:23], v2 offset:9216
v_mov_b32 v63, v12
s_waitcnt lgkmcnt(2)
v_mfma_f32_16x16x32_bf16 v[32:35], a[48:51], v[24:27], v[32:35]
buffer_load_dwordx4 v2, s[8:11], s42 offen offset:1024 sc1 lds
v_mfma_f32_16x16x32_bf16 v[36:39], a[52:55], v[24:27], v[36:39]
ds_read_b128 v[24:27], v2 offset:10240
v_permlane16_swap_b32 v12, v63
v_mfma_f32_16x16x32_bf16 v[32:35], a[56:59], v[28:31], v[32:35]
buffer_load_dwordx4 v2, s[8:11], s42 offen offset:2048 sc1 lds
v_mfma_f32_16x16x32_bf16 v[36:39], a[60:63], v[28:31], v[36:39]
ds_read_b128 v[28:31], v2 offset:11264
v_add_f32 v12, v12, v63
s_waitcnt lgkmcnt(2)
v_mfma_f32_16x16x32_bf16 v[32:35], a[64:67], v[16:19], v[32:35]
buffer_load_dwordx4 v2, s[8:11], s42 offen offset:3072 sc1 lds
v_mfma_f32_16x16x32_bf16 v[36:39], a[68:71], v[16:19], v[36:39]
ds_read_b128 v[16:19], v2 offset:12288
v_mov_b32 v13, v12
v_mfma_f32_16x16x32_bf16 v[32:35], a[72:75], v[20:23], v[32:35]
v_permlane32_swap_b32 v12, v13
v_mfma_f32_16x16x32_bf16 v[36:39], a[76:79], v[20:23], v[36:39]
ds_read_b128 v[20:23], v2 offset:13312
s_waitcnt lgkmcnt(2)
v_mfma_f32_16x16x32_bf16 v[32:35], a[80:83], v[24:27], v[32:35]
buffer_store_dwordx4 v[12:15], v5, s[4:7], s26 offen sc1
v_mfma_f32_16x16x32_bf16 v[36:39], a[84:87], v[24:27], v[36:39]
ds_read_b128 v[24:27], v2 offset:14336
s_waitcnt vmcnt(11)
v_cmp_ne_u32 vcc, s20, v50
v_mfma_f32_16x16x32_bf16 v[32:35], a[88:91], v[28:31], v[32:35]
v_cmp_ne_u32 s[28:29], s20, v54
s_or_b64 vcc, vcc, s[28:29]
s_cmp_eq_u64 vcc, 0
s_cbranch_scc0 Lg2_e2late2
Lg2_e2ret2:
v_mfma_f32_16x16x32_bf16 v[36:39], a[92:95], v[28:31], v[36:39]
ds_read_b128 v[28:31], v2 offset:15360
v_fmac_f32 v48, 0x3e800000, v52
s_waitcnt lgkmcnt(2)
v_mfma_f32_16x16x32_bf16 v[32:35], a[96:99], v[16:19], v[32:35]
s_add_u32 s42, s42, 4096
s_add_u32 m0, s45, 63488
s_nop 0
buffer_load_dwordx4 v2, s[8:11], s42 offen offset:0 sc1 lds
v_mfma_f32_16x16x32_bf16 v[36:39], a[100:103], v[16:19], v[36:39]
ds_read_b128 v[16:19], v2 offset:16384
v_fmac_f32 v49, 0x3e800000, v53
v_mfma_f32_16x16x32_bf16 v[32:35], a[104:107], v[20:23], v[32:35]
v_permlane32_swap_b32 v48, v49
v_mfma_f32_16x16x32_bf16 v[36:39], a[108:111], v[20:23], v[36:39]
ds_read_b128 v[20:23], v2 offset:17408
v_add_f32 v48, v48, v49
s_waitcnt lgkmcnt(2)
v_mfma_f32_16x16x32_bf16 v[32:35], a[112:115], v[24:27], v[32:35]
buffer_load_dwordx4 v2, s[8:11], s42 offen offset:1024 sc1 lds
v_mfma_f32_16x16x32_bf16 v[36:39], a[116:119], v[24:27], v[36:39]
ds_read_b128 v[24:27], v2 offset:18432
v_mov_b32 v63, v48
v_mfma_f32_16x16x32_bf16 v[32:35], a[120:123], v[28:31], v[32:35]
v_permlane16_swap_b32 v48, v63
v_mfma_f32_16x16x32_bf16 v[36:39], a[124:127], v[28:31], v[36:39]
ds_read_b128 v[28:31], v2 offset:19456
v_add_f32 v48, v48, v63
s_waitcnt lgkmcnt(2)
v_mfma_f32_16x16x32_bf16 v[32:35], a[128:131], v[16:19], v[32:35]
buffer_load_dwordx4 v2, s[8:11], s42 offen offset:2048 sc1 lds
v_mfma_f32_16x16x32_bf16 v[36:39], a[132:135], v[16:19], v[36:39]
ds_read_b128 v[16:19], v2 offset:20480
ds_write_b32 v66, v48 offset:0
v_mfma_f32_16x16x32_bf16 v[32:35], a[136:139], v[20:23], v[32:35]
s_waitcnt lgkmcnt(0)
s_barrier
v_mfma_f32_16x16x32_bf16 v[36:39], a[140:143], v[20:23], v[36:39]
ds_read_b128 v[20:23], v2 offset:21504
ds_read_b64 v[48:49], v62 offset:0
v_mfma_f32_16x16x32_bf16 v[32:35], a[144:147], v[24:27], v[32:35]
buffer_load_dwordx4 v2, s[8:11], s42 offen offset:3072 sc1 lds
v_mfma_f32_16x16x32_bf16 v[36:39], a[148:151], v[24:27], v[36:39]
ds_read_b128 v[24:27], v2 offset:22528
s_add_u32 s26, s36, 81920
s_waitcnt vmcnt(17)
v_mfma_f32_16x16x32_bf16 v[32:35], a[152:155], v[28:31], v[32:35]
v_mov_b32 v12, v51
v_mov_b32 v13, v55
v_mfma_f32_16x16x32_bf16 v[36:39], a[156:159], v[28:31], v[36:39]
ds_read_b128 v[28:31], v2 offset:23552
s_waitcnt lgkmcnt(3)
v_mfma_f32_16x16x32_bf16 v[32:35], a[160:163], v[16:19], v[32:35]
buffer_store_dwordx4 v[12:15], v5, s[4:7], s26 offen sc1
v_mfma_f32_16x16x32_bf16 v[36:39], a[164:167], v[16:19], v[36:39]
ds_read_b128 v[16:19], v2 offset:24576
ds_read_b128 v[76:79], v8 offset:8192
v_mfma_f32_16x16x32_bf16 v[32:35], a[168:171], v[20:23], v[32:35]
s_waitcnt lgkmcnt(4)
v_permlane32_swap_b32 v48, v49
v_mfma_f32_16x16x32_bf16 v[36:39], a[172:175], v[20:23], v[36:39]
ds_read_b128 v[20:23], v2 offset:25600
v_add_f32 v48, v48, v49
s_waitcnt lgkmcnt(3)
v_mfma_f32_16x16x32_bf16 v[32:35], a[176:179], v[24:27], v[32:35]
s_add_u32 s42, s42, 4096
s_add_u32 m0, s45, 67584
s_nop 0
buffer_load_dwordx4 v2, s[8:11], s42 offen offset:0 sc1 lds
v_mfma_f32_16x16x32_bf16 v[36:39], a[180:183], v[24:27], v[36:39]
ds_read_b128 v[24:27], v2 offset:26624
v_mov_b32 v63, v48
v_mfma_f32_16x16x32_bf16 v[32:35], a[184:187], v[28:31], v[32:35]
v_permlane16_swap_b32 v48, v63
v_mfma_f32_16x16x32_bf16 v[36:39], a[188:191], v[28:31], v[36:39]
ds_read_b128 v[28:31], v2 offset:27648
v_add_f32 v48, v48, v63
s_waitcnt lgkmcnt(2)
v_mfma_f32_16x16x32_bf16 v[32:35], a[192:195], v[16:19], v[32:35]
buffer_load_dwordx4 v2, s[8:11], s42 offen offset:1024 sc1 lds
v_mfma_f32_16x16x32_bf16 v[36:39], a[196:199], v[16:19], v[36:39]
ds_read_b128 v[16:19], v2 offset:28672
v_mov_b32 v49, v48
v_mfma_f32_16x16x32_bf16 v[32:35], a[200:203], v[20:23], v[32:35]
v_permlane32_swap_b32 v48, v49
v_mfma_f32_16x16x32_bf16 v[36:39], a[204:207], v[20:23], v[36:39]
ds_read_b128 v[20:23], v2 offset:29696
s_add_u32 s26, s35, 655360
s_waitcnt lgkmcnt(2)
v_mfma_f32_16x16x32_bf16 v[32:35], a[208:211], v[24:27], v[32:35]
s_add_u32 s43, s31, 98304
buffer_load_dword v59, v9, s[4:7], s43 offen sc1
v_mfma_f32_16x16x32_bf16 v[36:39], a[212:215], v[24:27], v[36:39]
ds_read_b128 v[24:27], v2 offset:30720
v_mul_f32 v52, 0x3acccccd, v48
v_mul_f32 v56, 0x3acccccd, v49
v_mfma_f32_16x16x32_bf16 v[32:35], a[216:219], v[28:31], v[32:35]
v_fma_f32 v56, -v52, v52, v56
v_add_f32 v56, 0x3727c5ac, v56
v_mfma_f32_16x16x32_bf16 v[36:39], a[220:223], v[28:31], v[36:39]
ds_read_b128 v[28:31], v2 offset:31744
s_waitcnt lgkmcnt(2)
v_mfma_f32_16x16x32_bf16 v[32:35], a[224:227], v[16:19], v[32:35]
v_rsq_f32 v53, v56
v_mfma_f32_16x16x32_bf16 v[36:39], a[228:231], v[16:19], v[36:39]
ds_read_b128 v[16:19], v2 offset:32768
v_lshlrev_b32 v68, 16, v76
v_and_b32 v69, 0xffff0000, v76
v_mfma_f32_16x16x32_bf16 v[32:35], a[232:235], v[20:23], v[32:35]
v_lshlrev_b32 v70, 16, v77
v_and_b32 v71, 0xffff0000, v77
v_lshlrev_b32 v72, 16, v78
v_mfma_f32_16x16x32_bf16 v[36:39], a[236:239], v[20:23], v[36:39]
ds_read_b128 v[20:23], v2 offset:33792
v_and_b32 v73, 0xffff0000, v78
s_waitcnt lgkmcnt(2)
v_mfma_f32_16x16x32_bf16 v[32:35], a[240:243], v[24:27], v[32:35]
v_lshlrev_b32 v74, 16, v79
v_and_b32 v75, 0xffff0000, v79
v_mul_f32 v54, v52, v53
v_mfma_f32_16x16x32_bf16 v[36:39], a[244:247], v[24:27], v[36:39]
ds_read_b128 v[24:27], v2 offset:34816
s_waitcnt vmcnt(18)
v_lshlrev_b32 v56, 16, v0
v_and_b32 v57, 0xffff0000, v0
v_mfma_f32_16x16x32_bf16 v[32:35], a[248:251], v[28:31], v[32:35]
v_fma_f32 v60, v68, v53, -v54
v_fma_f32 v61, v69, v53, -v54
v_fmac_f32 v68, v60, v56
v_mfma_f32_16x16x32_bf16 v[36:39], a[252:255], v[28:31], v[36:39]
ds_read_b128 v[28:31], v2 offset:35840
v_fmac_f32 v69, v61, v57
s_waitcnt lgkmcnt(2)
v_mfma_f32_16x16x32_bf16 v[32:35], v[80:83], v[16:19], v[32:35]
v_lshlrev_b32 v56, 16, v1
v_and_b32 v57, 0xffff0000, v1
v_fma_f32 v60, v70, v53, -v54
v_mfma_f32_16x16x32_bf16 v[36:39], v[84:87], v[16:19], v[36:39]
ds_read_b128 v[16:19], v2 offset:36864
v_fma_f32 v61, v71, v53, -v54
v_fmac_f32 v70, v60, v56
v_mfma_f32_16x16x32_bf16 v[32:35], v[88:91], v[20:23], v[32:35]
v_fmac_f32 v71, v61, v57
s_waitcnt vmcnt(17)
v_lshlrev_b32 v56, 16, v10
v_and_b32 v57, 0xffff0000, v10
v_mfma_f32_16x16x32_bf16 v[36:39], v[92:95], v[20:23], v[36:39]
ds_read_b128 v[20:23], v2 offset:37888
v_fma_f32 v60, v72, v53, -v54
s_waitcnt lgkmcnt(2)
v_mfma_f32_16x16x32_bf16 v[32:35], v[96:99], v[24:27], v[32:35]
v_fma_f32 v61, v73, v53, -v54
v_fmac_f32 v72, v60, v56
v_fmac_f32 v73, v61, v57
v_mfma_f32_16x16x32_bf16 v[36:39], v[100:103], v[24:27], v[36:39]
ds_read_b128 v[24:27], v2 offset:38912
v_lshlrev_b32 v56, 16, v11
v_and_b32 v57, 0xffff0000, v11
v_mfma_f32_16x16x32_bf16 v[32:35], v[104:107], v[28:31], v[32:35]
v_fma_f32 v60, v74, v53, -v54
v_fma_f32 v61, v75, v53, -v54
v_fmac_f32 v74, v60, v56
v_mfma_f32_16x16x32_bf16 v[36:39], v[108:111], v[28:31], v[36:39]
ds_read_b128 v[28:31], v2 offset:39936
v_fmac_f32 v75, v61, v57
s_waitcnt lgkmcnt(2)
v_mfma_f32_16x16x32_bf16 v[32:35], v[112:115], v[16:19], v[32:35]
v_cvt_pk_bf16_f32 v76, v68, v69
v_cvt_pk_bf16_f32 v77, v70, v71
v_cvt_pk_bf16_f32 v78, v72, v73
v_mfma_f32_16x16x32_bf16 v[36:39], v[116:119], v[16:19], v[36:39]
ds_read_b128 v[16:19], v2 offset:40960
v_cvt_pk_bf16_f32 v79, v74, v75
v_mfma_f32_16x16x32_bf16 v[32:35], v[120:123], v[20:23], v[32:35]
buffer_store_dwordx4 v[76:79], v2, s[4:7], s26 offen sc1
v_mfma_f32_16x16x32_bf16 v[36:39], v[124:127], v[20:23], v[36:39]
ds_read_b128 v[20:23], v2 offset:41984
ds_write_b128 v8, v[76:79] offset:8192
s_waitcnt lgkmcnt(3)
v_mfma_f32_16x16x32_bf16 v[32:35], v[128:131], v[24:27], v[32:35]
v_add_f32 v51, v68, v69
v_mul_f32 v55, v68, v68
v_mfma_f32_16x16x32_bf16 v[36:39], v[132:135], v[24:27], v[36:39]
ds_read_b128 v[24:27], v2 offset:43008
v_fmac_f32 v55, v69, v69
v_mfma_f32_16x16x32_bf16 v[32:35], v[136:139], v[28:31], v[32:35]
v_add_f32 v51, v51, v70
v_fmac_f32 v55, v70, v70
v_mfma_f32_16x16x32_bf16 v[36:39], v[140:143], v[28:31], v[36:39]
ds_read_b128 v[28:31], v2 offset:44032
s_waitcnt lgkmcnt(3)
v_mfma_f32_16x16x32_bf16 v[32:35], v[144:147], v[16:19], v[32:35]
v_add_f32 v51, v51, v71
v_fmac_f32 v55, v71, v71
v_mfma_f32_16x16x32_bf16 v[36:39], v[148:151], v[16:19], v[36:39]
ds_read_b128 v[16:19], v2 offset:45056
v_add_f32 v51, v51, v72
v_mfma_f32_16x16x32_bf16 v[32:35], v[152:155], v[20:23], v[32:35]
v_fmac_f32 v55, v72, v72
v_add_f32 v51, v51, v73
v_mfma_f32_16x16x32_bf16 v[36:39], v[156:159], v[20:23], v[36:39]
ds_read_b128 v[20:23], v2 offset:46080
s_waitcnt lgkmcnt(2)
v_mfma_f32_16x16x32_bf16 v[32:35], v[160:163], v[24:27], v[32:35]
v_fmac_f32 v55, v73, v73
v_add_f32 v51, v51, v74
v_fmac_f32 v55, v74, v74
v_mfma_f32_16x16x32_bf16 v[36:39], v[164:167], v[24:27], v[36:39]
ds_read_b128 v[24:27], v2 offset:47104
v_add_f32 v51, v51, v75
v_mfma_f32_16x16x32_bf16 v[32:35], v[168:171], v[28:31], v[32:35]
v_fmac_f32 v55, v75, v75
s_nop 1
v_permlane32_swap_b32 v51, v55
v_mfma_f32_16x16x32_bf16 v[36:39], v[172:175], v[28:31], v[36:39]
ds_read_b128 v[28:31], v2 offset:48128
s_waitcnt lgkmcnt(2)
v_mfma_f32_16x16x32_bf16 v[32:35], v[176:179], v[16:19], v[32:35]
v_add_f32 v51, v51, v55
v_mov_b32 v63, v51
v_mfma_f32_16x16x32_bf16 v[36:39], v[180:183], v[16:19], v[36:39]
ds_read_b128 v[16:19], v2 offset:49152
v_permlane16_swap_b32 v51, v63
v_mfma_f32_16x16x32_bf16 v[32:35], v[184:187], v[20:23], v[32:35]
v_add_f32 v51, v51, v63
v_mov_b32 v55, v51
v_mfma_f32_16x16x32_bf16 v[36:39], v[188:191], v[20:23], v[36:39]
ds_read_b128 v[20:23], v2 offset:50176
s_waitcnt lgkmcnt(2)
v_mfma_f32_16x16x32_bf16 v[32:35], v[192:195], v[24:27], v[32:35]
v_permlane32_swap_b32 v51, v55
v_mfma_f32_16x16x32_bf16 v[36:39], v[196:199], v[24:27], v[36:39]
ds_read_b128 v[24:27], v2 offset:51200
v_mfma_f32_16x16x32_bf16 v[32:35], v[200:203], v[28:31], v[32:35]
v_mfma_f32_16x16x32_bf16 v[36:39], v[204:207], v[28:31], v[36:39]
ds_read_b128 v[28:31], v2 offset:52224
s_waitcnt lgkmcnt(2)
v_mfma_f32_16x16x32_bf16 v[32:35], v[208:211], v[16:19], v[32:35]
v_mfma_f32_16x16x32_bf16 v[36:39], v[212:215], v[16:19], v[36:39]
ds_read_b128 v[16:19], v2 offset:53248
v_mfma_f32_16x16x32_bf16 v[32:35], v[216:219], v[20:23], v[32:35]
v_mfma_f32_16x16x32_bf16 v[36:39], v[220:223], v[20:23], v[36:39]
ds_read_b128 v[20:23], v2 offset:54272
s_waitcnt lgkmcnt(2)
v_mfma_f32_16x16x32_bf16 v[32:35], v[224:227], v[24:27], v[32:35]
s_add_u32 s26, s33, 245760
s_add_u32 s27, s34, 983040
buffer_load_dwordx3 v[48:50], v64, s[4:7], s26 offen sc1
v_mfma_f32_16x16x32_bf16 v[36:39], v[228:231], v[24:27], v[36:39]
buffer_load_dwordx3 v[52:54], v65, s[4:7], s26 offen sc1
v_mfma_f32_16x16x32_bf16 v[32:35], v[232:235], v[28:31], v[32:35]
buffer_load_dwordx2 v[0:1], v7, s[4:7], s27 offen
buffer_load_dwordx2 v[10:11], v7, s[4:7], s27 offen offset:512
ds_read_b128 v[76:79], v8 offset:20480
s_waitcnt lgkmcnt(0)
v_lshlrev_b32 v40, 16, v76
v_and_b32 v41, 0xffff0000, v76
v_lshlrev_b32 v42, 16, v77
v_and_b32 v43, 0xffff0000, v77
v_lshlrev_b32 v44, 16, v78
v_and_b32 v45, 0xffff0000, v78
v_lshlrev_b32 v46, 16, v79
v_and_b32 v47, 0xffff0000, v79
v_mfma_f32_16x16x32_bf16 v[36:39], v[236:239], v[28:31], v[36:39]
s_cmp_eq_u32 s10, 0
s_cbranch_scc1 Lg2_falate4
Lg2_faret4:
s_waitcnt vmcnt(6) lgkmcnt(0)
s_barrier
ds_read_b128 v[24:27], v3 offset:0
ds_read_b128 v[28:31], v3 offset:1024
v_mfma_f32_16x16x32_bf16 v[32:35], v[240:243], v[16:19], v[32:35]
v_mfma_f32_16x16x32_bf16 v[36:39], v[244:247], v[16:19], v[36:39]
ds_read_b128 v[16:19], v3 offset:2048
v_mfma_f32_16x16x32_bf16 v[32:35], v[248:251], v[20:23], v[32:35]
v_mfma_f32_16x16x32_bf16 v[36:39], v[252:255], v[20:23], v[36:39]
ds_read_b128 v[20:23], v3 offset:3072
s_waitcnt lgkmcnt(2)
v_mfma_f32_16x16x32_bf16 v[40:43], a[0:3], v[24:27], v[40:43]
s_waitcnt vmcnt(5)
v_cmp_ne_u32 vcc, s20, v59
s_cmp_eq_u64 vcc, 0
s_cselect_b32 s10, 0x10000000, 0
s_add_u32 s26, s32, 327680
v_cvt_pk_bf16_f32 v76, v32, v33
v_cvt_pk_bf16_f32 v77, v34, v35
v_mfma_f32_16x16x32_bf16 v[44:47], a[4:7], v[24:27], v[44:47]
ds_read_b128 v[24:27], v3 offset:4096
v_cvt_pk_bf16_f32 v78, v36, v37
v_cvt_pk_bf16_f32 v79, v38, v39
v_mfma_f32_16x16x32_bf16 v[40:43], a[8:11], v[28:31], v[40:43]
s_add_u32 s42, s30, 0x510000
s_add_u32 m0, s45, 0
s_nop 0
buffer_load_dwordx4 v2, s[8:11], s42 offen offset:0 sc1 lds
ds_write_b128 v8, v[76:79] offset:16384
v_mfma_f32_16x16x32_bf16 v[44:47], a[12:15], v[28:31], v[44:47]
ds_read_b128 v[28:31], v3 offset:5120
v_add_f32 v12, v32, v33
v_mul_f32 v13, v32, v32
v_fmac_f32 v13, v33, v33
s_waitcnt lgkmcnt(3)
v_mfma_f32_16x16x32_bf16 v[40:43], a[16:19], v[16:19], v[40:43]
buffer_load_dwordx4 v2, s[8:11], s42 offen offset:1024 sc1 lds
v_add_f32 v12, v12, v34
v_fmac_f32 v13, v34, v34
v_add_f32 v12, v12, v35
v_mfma_f32_16x16x32_bf16 v[44:47], a[20:23], v[16:19], v[44:47]
ds_read_b128 v[16:19], v3 offset:6144
v_fmac_f32 v13, v35, v35
v_add_f32 v12, v12, v36
v_fmac_f32 v13, v36, v36
v_add_f32 v12, v12, v37
v_mfma_f32_16x16x32_bf16 v[40:43], a[24:27], v[20:23], v[40:43]
buffer_load_dwordx4 v2, s[8:11], s42 offen offset:2048 sc1 lds
v_fmac_f32 v13, v37, v37
v_add_f32 v12, v12, v38
v_fmac_f32 v13, v38, v38
v_mfma_f32_16x16x32_bf16 v[44:47], a[28:31], v[20:23], v[44:47]
ds_read_b128 v[20:23], v3 offset:7168
v_add_f32 v12, v12, v39
v_fmac_f32 v13, v39, v39
s_waitcnt lgkmcnt(2)
v_mfma_f32_16x16x32_bf16 v[40:43], a[32:35], v[24:27], v[40:43]
buffer_load_dwordx4 v2, s[8:11], s42 offen offset:3072 sc1 lds
v_mfma_f32_16x16x32_bf16 v[44:47], a[36:39], v[24:27], v[44:47]
ds_read_b128 v[24:27], v3 offset:8192
v_permlane32_swap_b32 v12, v13
v_mfma_f32_16x16x32_bf16 v[40:43], a[40:43], v[28:31], v[40:43]
s_add_u32 s42, s42, 4096
s_add_u32 m0, s45, 4096
s_nop 0
buffer_load_dwordx4 v2, s[8:11], s42 offen offset:0 sc1 lds
v_add_f32 v12, v12, v13
v_mfma_f32_16x16x32_bf16 v[44:47], a[44:47], v[28:31], v[44:47]
ds_read_b128 v[28:31], v3 offset:9216
v_mov_b32 v63, v12
s_waitcnt lgkmcnt(2)
v_mfma_f32_16x16x32_bf16 v[40:43], a[48:51], v[16:19], v[40:43]
buffer_load_dwordx4 v2, s[8:11], s42 offen offset:1024 sc1 lds
v_mfma_f32_16x16x32_bf16 v[44:47], a[52:55], v[16:19], v[44:47]
ds_read_b128 v[16:19], v3 offset:10240
v_permlane16_swap_b32 v12, v63
v_mfma_f32_16x16x32_bf16 v[40:43], a[56:59], v[20:23], v[40:43]
buffer_load_dwordx4 v2, s[8:11], s42 offen offset:2048 sc1 lds
v_mfma_f32_16x16x32_bf16 v[44:47], a[60:63], v[20:23], v[44:47]
ds_read_b128 v[20:23], v3 offset:11264
v_add_f32 v12, v12, v63
s_waitcnt lgkmcnt(2)
v_mfma_f32_16x16x32_bf16 v[40:43], a[64:67], v[24:27], v[40:43]
buffer_load_dwordx4 v2, s[8:11], s42 offen offset:3072 sc1 lds
v_mfma_f32_16x16x32_bf16 v[44:47], a[68:71], v[24:27], v[44:47]
ds_read_b128 v[24:27], v3 offset:12288
v_mov_b32 v13, v12
v_mfma_f32_16x16x32_bf16 v[40:43], a[72:75], v[28:31], v[40:43]
v_permlane32_swap_b32 v12, v13
v_mfma_f32_16x16x32_bf16 v[44:47], a[76:79], v[28:31], v[44:47]
ds_read_b128 v[28:31], v3 offset:13312
s_waitcnt lgkmcnt(2)
v_mfma_f32_16x16x32_bf16 v[40:43], a[80:83], v[16:19], v[40:43]
buffer_store_dwordx4 v[12:15], v5, s[4:7], s26 offen sc1
v_mfma_f32_16x16x32_bf16 v[44:47], a[84:87], v[16:19], v[44:47]
ds_read_b128 v[16:19], v3 offset:14336
s_waitcnt vmcnt(11)
v_cmp_ne_u32 vcc, s20, v50
v_mfma_f32_16x16x32_bf16 v[40:43], a[88:91], v[20:23], v[40:43]
v_cmp_ne_u32 s[28:29], s20, v54
s_or_b64 vcc, vcc, s[28:29]
s_cmp_eq_u64 vcc, 0
s_cbranch_scc0 Lg2_e2late3
Lg2_e2ret3:
v_mfma_f32_16x16x32_bf16 v[44:47], a[92:95], v[20:23], v[44:47]
ds_read_b128 v[20:23], v3 offset:15360
v_fmac_f32 v48, 0x3e800000, v52
s_waitcnt lgkmcnt(2)
v_mfma_f32_16x16x32_bf16 v[40:43], a[96:99], v[24:27], v[40:43]
s_add_u32 s42, s42, 4096
s_add_u32 m0, s45, 8192
s_nop 0
buffer_load_dwordx4 v2, s[8:11], s42 offen offset:0 sc1 lds
v_mfma_f32_16x16x32_bf16 v[44:47], a[100:103], v[24:27], v[44:47]
ds_read_b128 v[24:27], v3 offset:16384
v_fmac_f32 v49, 0x3e800000, v53
v_mfma_f32_16x16x32_bf16 v[40:43], a[104:107], v[28:31], v[40:43]
v_permlane32_swap_b32 v48, v49
v_mfma_f32_16x16x32_bf16 v[44:47], a[108:111], v[28:31], v[44:47]
ds_read_b128 v[28:31], v3 offset:17408
v_add_f32 v48, v48, v49
s_waitcnt lgkmcnt(2)
v_mfma_f32_16x16x32_bf16 v[40:43], a[112:115], v[16:19], v[40:43]
buffer_load_dwordx4 v2, s[8:11], s42 offen offset:1024 sc1 lds
v_mfma_f32_16x16x32_bf16 v[44:47], a[116:119], v[16:19], v[44:47]
ds_read_b128 v[16:19], v3 offset:18432
v_mov_b32 v63, v48
v_mfma_f32_16x16x32_bf16 v[40:43], a[120:123], v[20:23], v[40:43]
v_permlane16_swap_b32 v48, v63
v_mfma_f32_16x16x32_bf16 v[44:47], a[124:127], v[20:23], v[44:47]
ds_read_b128 v[20:23], v3 offset:19456
v_add_f32 v48, v48, v63
s_waitcnt lgkmcnt(2)
v_mfma_f32_16x16x32_bf16 v[40:43], a[128:131], v[24:27], v[40:43]
buffer_load_dwordx4 v2, s[8:11], s42 offen offset:2048 sc1 lds
v_mfma_f32_16x16x32_bf16 v[44:47], a[132:135], v[24:27], v[44:47]
ds_read_b128 v[24:27], v3 offset:20480
ds_write_b32 v66, v48 offset:512
v_mfma_f32_16x16x32_bf16 v[40:43], a[136:139], v[28:31], v[40:43]
s_waitcnt lgkmcnt(0)
s_barrier
v_mfma_f32_16x16x32_bf16 v[44:47], a[140:143], v[28:31], v[44:47]
ds_read_b128 v[28:31], v3 offset:21504
ds_read_b64 v[48:49], v62 offset:512
v_mfma_f32_16x16x32_bf16 v[40:43], a[144:147], v[16:19], v[40:43]
buffer_load_dwordx4 v2, s[8:11], s42 offen offset:3072 sc1 lds
v_mfma_f32_16x16x32_bf16 v[44:47], a[148:151], v[16:19], v[44:47]
ds_read_b128 v[16:19], v3 offset:22528
s_add_u32 s26, s36, 163840
s_waitcnt vmcnt(17)
v_mfma_f32_16x16x32_bf16 v[40:43], a[152:155], v[20:23], v[40:43]
v_mov_b32 v12, v51
v_mov_b32 v13, v55
v_mfma_f32_16x16x32_bf16 v[44:47], a[156:159], v[20:23], v[44:47]
ds_read_b128 v[20:23], v3 offset:23552
s_waitcnt lgkmcnt(3)
v_mfma_f32_16x16x32_bf16 v[40:43], a[160:163], v[24:27], v[40:43]
buffer_store_dwordx4 v[12:15], v5, s[4:7], s26 offen sc1
v_mfma_f32_16x16x32_bf16 v[44:47], a[164:167], v[24:27], v[44:47]
ds_read_b128 v[24:27], v3 offset:24576
ds_read_b128 v[76:79], v8 offset:12288
v_mfma_f32_16x16x32_bf16 v[40:43], a[168:171], v[28:31], v[40:43]
s_waitcnt lgkmcnt(4)
v_permlane32_swap_b32 v48, v49
v_mfma_f32_16x16x32_bf16 v[44:47], a[172:175], v[28:31], v[44:47]
ds_read_b128 v[28:31], v3 offset:25600
v_add_f32 v48, v48, v49
s_waitcnt lgkmcnt(3)
v_mfma_f32_16x16x32_bf16 v[40:43], a[176:179], v[16:19], v[40:43]
s_add_u32 s42, s42, 4096
s_add_u32 m0, s45, 12288
s_nop 0
buffer_load_dwordx4 v2, s[8:11], s42 offen offset:0 sc1 lds
v_mfma_f32_16x16x32_bf16 v[44:47], a[180:183], v[16:19], v[44:47]
ds_read_b128 v[16:19], v3 offset:26624
v_mov_b32 v63, v48
v_mfma_f32_16x16x32_bf16 v[40:43], a[184:187], v[20:23], v[40:43]
v_permlane16_swap_b32 v48, v63
v_mfma_f32_16x16x32_bf16 v[44:47], a[188:191], v[20:23], v[44:47]
ds_read_b128 v[20:23], v3 offset:27648
v_add_f32 v48, v48, v63
s_waitcnt lgkmcnt(2)
v_mfma_f32_16x16x32_bf16 v[40:43], a[192:195], v[24:27], v[40:43]
buffer_load_dwordx4 v2, s[8:11], s42 offen offset:1024 sc1 lds
v_mfma_f32_16x16x32_bf16 v[44:47], a[196:199], v[24:27], v[44:47]
ds_read_b128 v[24:27], v3 offset:28672
v_mov_b32 v49, v48
v_mfma_f32_16x16x32_bf16 v[40:43], a[200:203], v[28:31], v[40:43]
v_permlane32_swap_b32 v48, v49
v_mfma_f32_16x16x32_bf16 v[44:47], a[204:207], v[28:31], v[44:47]
ds_read_b128 v[28:31], v3 offset:29696
s_add_u32 s26, s35, 983040
s_waitcnt lgkmcnt(2)
v_mfma_f32_16x16x32_bf16 v[40:43], a[208:211], v[16:19], v[40:43]
s_add_u32 s43, s31, 114688
buffer_load_dword v59, v9, s[4:7], s43 offen sc1
v_mfma_f32_16x16x32_bf16 v[44:47], a[212:215], v[16:19], v[44:47]
ds_read_b128 v[16:19], v3 offset:30720
v_mul_f32 v52, 0x3acccccd, v48
v_mul_f32 v56, 0x3acccccd, v49
v_mfma_f32_16x16x32_bf16 v[40:43], a[216:219], v[20:23], v[40:43]
v_fma_f32 v56, -v52, v52, v56
v_add_f32 v56, 0x3727c5ac, v56
v_mfma_f32_16x16x32_bf16 v[44:47], a[220:223], v[20:23], v[44:47]
ds_read_b128 v[20:23], v3 offset:31744
s_waitcnt lgkmcnt(2)
v_mfma_f32_16x16x32_bf16 v[40:43], a[224:227], v[24:27], v[40:43]
v_rsq_f32 v53, v56
v_mfma_f32_16x16x32_bf16 v[44:47], a[228:231], v[24:27], v[44:47]
ds_read_b128 v[24:27], v3 offset:32768
v_lshlrev_b32 v68, 16, v76
v_and_b32 v69, 0xffff0000, v76
v_mfma_f32_16x16x32_bf16 v[40:43], a[232:235], v[28:31], v[40:43]
v_lshlrev_b32 v70, 16, v77
v_and_b32 v71, 0xffff0000, v77
v_lshlrev_b32 v72, 16, v78
v_mfma_f32_16x16x32_bf16 v[44:47], a[236:239], v[28:31], v[44:47]
ds_read_b128 v[28:31], v3 offset:33792
v_and_b32 v73, 0xffff0000, v78
s_waitcnt lgkmcnt(2)
v_mfma_f32_16x16x32_bf16 v[40:43], a[240:243], v[16:19], v[40:43]
v_lshlrev_b32 v74, 16, v79
v_and_b32 v75, 0xffff0000, v79
v_mul_f32 v54, v52, v53
v_mfma_f32_16x16x32_bf16 v[44:47], a[244:247], v[16:19], v[44:47]
ds_read_b128 v[16:19], v3 offset:34816
s_waitcnt vmcnt(18)
v_lshlrev_b32 v56, 16, v0
v_and_b32 v57, 0xffff0000, v0
v_mfma_f32_16x16x32_bf16 v[40:43], a[248:251], v[20:23], v[40:43]
v_fma_f32 v60, v68, v53, -v54
v_fma_f32 v61, v69, v53, -v54
v_fmac_f32 v68, v60, v56
v_mfma_f32_16x16x32_bf16 v[44:47], a[252:255], v[20:23], v[44:47]
ds_read_b128 v[20:23], v3 offset:35840
v_fmac_f32 v69, v61, v57
s_waitcnt lgkmcnt(2)
v_mfma_f32_16x16x32_bf16 v[40:43], v[80:83], v[24:27], v[40:43]
v_lshlrev_b32 v56, 16, v1
v_and_b32 v57, 0xffff0000, v1
v_fma_f32 v60, v70, v53, -v54
v_mfma_f32_16x16x32_bf16 v[44:47], v[84:87], v[24:27], v[44:47]
ds_read_b128 v[24:27], v3 offset:36864
v_fma_f32 v61, v71, v53, -v54
v_fmac_f32 v70, v60, v56
v_mfma_f32_16x16x32_bf16 v[40:43], v[88:91], v[28:31], v[40:43]
v_fmac_f32 v71, v61, v57
s_waitcnt vmcnt(17)
v_lshlrev_b32 v56, 16, v10
v_and_b32 v57, 0xffff0000, v10
v_mfma_f32_16x16x32_bf16 v[44:47], v[92:95], v[28:31], v[44:47]
ds_read_b128 v[28:31], v3 offset:37888
v_fma_f32 v60, v72, v53, -v54
s_waitcnt lgkmcnt(2)
v_mfma_f32_16x16x32_bf16 v[40:43], v[96:99], v[16:19], v[40:43]
v_fma_f32 v61, v73, v53, -v54
v_fmac_f32 v72, v60, v56
v_fmac_f32 v73, v61, v57
v_mfma_f32_16x16x32_bf16 v[44:47], v[100:103], v[16:19], v[44:47]
ds_read_b128 v[16:19], v3 offset:38912
v_lshlrev_b32 v56, 16, v11
v_and_b32 v57, 0xffff0000, v11
v_mfma_f32_16x16x32_bf16 v[40:43], v[104:107], v[20:23], v[40:43]
v_fma_f32 v60, v74, v53, -v54
v_fma_f32 v61, v75, v53, -v54
v_fmac_f32 v74, v60, v56
v_mfma_f32_16x16x32_bf16 v[44:47], v[108:111], v[20:23], v[44:47]
ds_read_b128 v[20:23], v3 offset:39936
v_fmac_f32 v75, v61, v57
s_waitcnt lgkmcnt(2)
v_mfma_f32_16x16x32_bf16 v[40:43], v[112:115], v[24:27], v[40:43]
v_cvt_pk_bf16_f32 v76, v68, v69
v_cvt_pk_bf16_f32 v77, v70, v71
v_cvt_pk_bf16_f32 v78, v72, v73
v_mfma_f32_16x16x32_bf16 v[44:47], v[116:119], v[24:27], v[44:47]
ds_read_b128 v[24:27], v3 offset:40960
v_cvt_pk_bf16_f32 v79, v74, v75
v_mfma_f32_16x16x32_bf16 v[40:43], v[120:123], v[28:31], v[40:43]
buffer_store_dwordx4 v[76:79], v2, s[4:7], s26 offen sc1
v_mfma_f32_16x16x32_bf16 v[44:47], v[124:127], v[28:31], v[44:47]
ds_read_b128 v[28:31], v3 offset:41984
ds_write_b128 v8, v[76:79] offset:12288
s_waitcnt lgkmcnt(3)
v_mfma_f32_16x16x32_bf16 v[40:43], v[128:131], v[16:19], v[40:43]
v_add_f32 v51, v68, v69
v_mul_f32 v55, v68, v68
v_mfma_f32_16x16x32_bf16 v[44:47], v[132:135], v[16:19], v[44:47]
ds_read_b128 v[16:19], v3 offset:43008
v_fmac_f32 v55, v69, v69
v_mfma_f32_16x16x32_bf16 v[40:43], v[136:139], v[20:23], v[40:43]
v_add_f32 v51, v51, v70
v_fmac_f32 v55, v70, v70
v_mfma_f32_16x16x32_bf16 v[44:47], v[140:143], v[20:23], v[44:47]
ds_read_b128 v[20:23], v3 offset:44032
s_waitcnt lgkmcnt(3)
v_mfma_f32_16x16x32_bf16 v[40:43], v[144:147], v[24:27], v[40:43]
v_add_f32 v51, v51, v71
v_fmac_f32 v55, v71, v71
v_mfma_f32_16x16x32_bf16 v[44:47], v[148:151], v[24:27], v[44:47]
ds_read_b128 v[24:27], v3 offset:45056
v_add_f32 v51, v51, v72
v_mfma_f32_16x16x32_bf16 v[40:43], v[152:155], v[28:31], v[40:43]
v_fmac_f32 v55, v72, v72
v_add_f32 v51, v51, v73
v_mfma_f32_16x16x32_bf16 v[44:47], v[156:159], v[28:31], v[44:47]
ds_read_b128 v[28:31], v3 offset:46080
s_waitcnt lgkmcnt(2)
v_mfma_f32_16x16x32_bf16 v[40:43], v[160:163], v[16:19], v[40:43]
v_fmac_f32 v55, v73, v73
v_add_f32 v51, v51, v74
v_fmac_f32 v55, v74, v74
v_mfma_f32_16x16x32_bf16 v[44:47], v[164:167], v[16:19], v[44:47]
ds_read_b128 v[16:19], v3 offset:47104
v_add_f32 v51, v51, v75
v_mfma_f32_16x16x32_bf16 v[40:43], v[168:171], v[20:23], v[40:43]
v_fmac_f32 v55, v75, v75
s_nop 1
v_permlane32_swap_b32 v51, v55
v_mfma_f32_16x16x32_bf16 v[44:47], v[172:175], v[20:23], v[44:47]
ds_read_b128 v[20:23], v3 offset:48128
s_waitcnt lgkmcnt(2)
v_mfma_f32_16x16x32_bf16 v[40:43], v[176:179], v[24:27], v[40:43]
v_add_f32 v51, v51, v55
v_mov_b32 v63, v51
v_mfma_f32_16x16x32_bf16 v[44:47], v[180:183], v[24:27], v[44:47]
ds_read_b128 v[24:27], v3 offset:49152
v_permlane16_swap_b32 v51, v63
v_mfma_f32_16x16x32_bf16 v[40:43], v[184:187], v[28:31], v[40:43]
v_add_f32 v51, v51, v63
v_mov_b32 v55, v51
v_mfma_f32_16x16x32_bf16 v[44:47], v[188:191], v[28:31], v[44:47]
ds_read_b128 v[28:31], v3 offset:50176
s_waitcnt lgkmcnt(2)
v_mfma_f32_16x16x32_bf16 v[40:43], v[192:195], v[16:19], v[40:43]
v_permlane32_swap_b32 v51, v55
v_mfma_f32_16x16x32_bf16 v[44:47], v[196:199], v[16:19], v[44:47]
ds_read_b128 v[16:19], v3 offset:51200
v_mfma_f32_16x16x32_bf16 v[40:43], v[200:203], v[20:23], v[40:43]
v_mfma_f32_16x16x32_bf16 v[44:47], v[204:207], v[20:23], v[44:47]
ds_read_b128 v[20:23], v3 offset:52224
s_waitcnt lgkmcnt(2)
v_mfma_f32_16x16x32_bf16 v[40:43], v[208:211], v[24:27], v[40:43]
v_mfma_f32_16x16x32_bf16 v[44:47], v[212:215], v[24:27], v[44:47]
ds_read_b128 v[24:27], v3 offset:53248
v_mfma_f32_16x16x32_bf16 v[40:43], v[216:219], v[28:31], v[40:43]
v_mfma_f32_16x16x32_bf16 v[44:47], v[220:223], v[28:31], v[44:47]
ds_read_b128 v[28:31], v3 offset:54272
s_waitcnt lgkmcnt(2)
v_mfma_f32_16x16x32_bf16 v[40:43], v[224:227], v[16:19], v[40:43]
s_add_u32 s26, s33, 327680
s_add_u32 s27, s34, 1310720
buffer_load_dwordx3 v[48:50], v64, s[4:7], s26 offen sc1
v_mfma_f32_16x16x32_bf16 v[44:47], v[228:231], v[16:19], v[44:47]
buffer_load_dwordx3 v[52:54], v65, s[4:7], s26 offen sc1
v_mfma_f32_16x16x32_bf16 v[40:43], v[232:235], v[20:23], v[40:43]
buffer_load_dwordx2 v[0:1], v7, s[4:7], s27 offen
buffer_load_dwordx2 v[10:11], v7, s[4:7], s27 offen offset:512
ds_read_b128 v[76:79], v8 offset:24576
s_waitcnt lgkmcnt(0)
v_lshlrev_b32 v32, 16, v76
v_and_b32 v33, 0xffff0000, v76
v_lshlrev_b32 v34, 16, v77
v_and_b32 v35, 0xffff0000, v77
v_lshlrev_b32 v36, 16, v78
v_and_b32 v37, 0xffff0000, v78
v_lshlrev_b32 v38, 16, v79
v_and_b32 v39, 0xffff0000, v79
v_mfma_f32_16x16x32_bf16 v[44:47], v[236:239], v[20:23], v[44:47]
s_cmp_eq_u32 s10, 0
s_cbranch_scc1 Lg2_falate5
Lg2_faret5:
s_waitcnt vmcnt(6) lgkmcnt(0)
s_barrier
ds_read_b128 v[16:19], v2 offset:0
ds_read_b128 v[20:23], v2 offset:1024
v_mfma_f32_16x16x32_bf16 v[40:43], v[240:243], v[24:27], v[40:43]
v_mfma_f32_16x16x32_bf16 v[44:47], v[244:247], v[24:27], v[44:47]
ds_read_b128 v[24:27], v2 offset:2048
v_mfma_f32_16x16x32_bf16 v[40:43], v[248:251], v[28:31], v[40:43]
v_mfma_f32_16x16x32_bf16 v[44:47], v[252:255], v[28:31], v[44:47]
ds_read_b128 v[28:31], v2 offset:3072
s_waitcnt lgkmcnt(2)
v_mfma_f32_16x16x32_bf16 v[32:35], a[0:3], v[16:19], v[32:35]
s_waitcnt vmcnt(5)
v_cmp_ne_u32 vcc, s20, v59
s_cmp_eq_u64 vcc, 0
s_cselect_b32 s10, 0x10000000, 0
s_add_u32 s26, s32, 409600
v_cvt_pk_bf16_f32 v76, v40, v41
v_cvt_pk_bf16_f32 v77, v42, v43
v_mfma_f32_16x16x32_bf16 v[36:39], a[4:7], v[16:19], v[36:39]
ds_read_b128 v[16:19], v2 offset:4096
v_cvt_pk_bf16_f32 v78, v44, v45
v_cvt_pk_bf16_f32 v79, v46, v47
v_mfma_f32_16x16x32_bf16 v[32:35], a[8:11], v[20:23], v[32:35]
s_add_u32 s42, s30, 0x5e8000
s_add_u32 m0, s45, 55296
s_nop 0
buffer_load_dwordx4 v2, s[8:11], s42 offen offset:0 sc1 lds
ds_write_b128 v8, v[76:79] offset:20480
v_mfma_f32_16x16x32_bf16 v[36:39], a[12:15], v[20:23], v[36:39]
ds_read_b128 v[20:23], v2 offset:5120
v_add_f32 v12, v40, v41
v_mul_f32 v13, v40, v40
v_fmac_f32 v13, v41, v41
s_waitcnt lgkmcnt(3)
v_mfma_f32_16x16x32_bf16 v[32:35], a[16:19], v[24:27], v[32:35]
buffer_load_dwordx4 v2, s[8:11], s42 offen offset:1024 sc1 lds
v_add_f32 v12, v12, v42
v_fmac_f32 v13, v42, v42
v_add_f32 v12, v12, v43
v_mfma_f32_16x16x32_bf16 v[36:39], a[20:23], v[24:27], v[36:39]
ds_read_b128 v[24:27], v2 offset:6144
v_fmac_f32 v13, v43, v43
v_add_f32 v12, v12, v44
v_fmac_f32 v13, v44, v44
v_add_f32 v12, v12, v45
v_mfma_f32_16x16x32_bf16 v[32:35], a[24:27], v[28:31], v[32:35]
buffer_load_dwordx4 v2, s[8:11], s42 offen offset:2048 sc1 lds
v_fmac_f32 v13, v45, v45
v_add_f32 v12, v12, v46
v_fmac_f32 v13, v46, v46
v_mfma_f32_16x16x32_bf16 v[36:39], a[28:31], v[28:31], v[36:39]
ds_read_b128 v[28:31], v2 offset:7168
v_add_f32 v12, v12, v47
v_fmac_f32 v13, v47, v47
s_waitcnt lgkmcnt(2)
v_mfma_f32_16x16x32_bf16 v[32:35], a[32:35], v[16:19], v[32:35]
buffer_load_dwordx4 v2, s[8:11], s42 offen offset:3072 sc1 lds
v_mfma_f32_16x16x32_bf16 v[36:39], a[36:39], v[16:19], v[36:39]
ds_read_b128 v[16:19], v2 offset:8192
v_permlane32_swap_b32 v12, v13
v_mfma_f32_16x16x32_bf16 v[32:35], a[40:43], v[20:23], v[32:35]
s_add_u32 s42, s42, 4096
s_add_u32 m0, s45, 59392
s_nop 0
buffer_load_dwordx4 v2, s[8:11], s42 offen offset:0 sc1 lds
v_add_f32 v12, v12, v13
v_mfma_f32_16x16x32_bf16 v[36:39], a[44:47], v[20:23], v[36:39]
ds_read_b128 v[20:23], v2 offset:9216
v_mov_b32 v63, v12
s_waitcnt lgkmcnt(2)
v_mfma_f32_16x16x32_bf16 v[32:35], a[48:51], v[24:27], v[32:35]
buffer_load_dwordx4 v2, s[8:11], s42 offen offset:1024 sc1 lds
v_mfma_f32_16x16x32_bf16 v[36:39], a[52:55], v[24:27], v[36:39]
ds_read_b128 v[24:27], v2 offset:10240
v_permlane16_swap_b32 v12, v63
v_mfma_f32_16x16x32_bf16 v[32:35], a[56:59], v[28:31], v[32:35]
buffer_load_dwordx4 v2, s[8:11], s42 offen offset:2048 sc1 lds
v_mfma_f32_16x16x32_bf16 v[36:39], a[60:63], v[28:31], v[36:39]
ds_read_b128 v[28:31], v2 offset:11264
v_add_f32 v12, v12, v63
s_waitcnt lgkmcnt(2)
v_mfma_f32_16x16x32_bf16 v[32:35], a[64:67], v[16:19], v[32:35]
buffer_load_dwordx4 v2, s[8:11], s42 offen offset:3072 sc1 lds
v_mfma_f32_16x16x32_bf16 v[36:39], a[68:71], v[16:19], v[36:39]
ds_read_b128 v[16:19], v2 offset:12288
v_mov_b32 v13, v12
v_mfma_f32_16x16x32_bf16 v[32:35], a[72:75], v[20:23], v[32:35]
v_permlane32_swap_b32 v12, v13
v_mfma_f32_16x16x32_bf16 v[36:39], a[76:79], v[20:23], v[36:39]
ds_read_b128 v[20:23], v2 offset:13312
s_waitcnt lgkmcnt(2)
v_mfma_f32_16x16x32_bf16 v[32:35], a[80:83], v[24:27], v[32:35]
buffer_store_dwordx4 v[12:15], v5, s[4:7], s26 offen sc1
v_mfma_f32_16x16x32_bf16 v[36:39], a[84:87], v[24:27], v[36:39]
ds_read_b128 v[24:27], v2 offset:14336
s_waitcnt vmcnt(11)
v_cmp_ne_u32 vcc, s20, v50
v_mfma_f32_16x16x32_bf16 v[32:35], a[88:91], v[28:31], v[32:35]
v_cmp_ne_u32 s[28:29], s20, v54
s_or_b64 vcc, vcc, s[28:29]
s_cmp_eq_u64 vcc, 0
s_cbranch_scc0 Lg2_e2late4
Lg2_e2ret4:
v_mfma_f32_16x16x32_bf16 v[36:39], a[92:95], v[28:31], v[36:39]
ds_read_b128 v[28:31], v2 offset:15360
v_fmac_f32 v48, 0x3e800000, v52
s_waitcnt lgkmcnt(2)
v_mfma_f32_16x16x32_bf16 v[32:35], a[96:99], v[16:19], v[32:35]
s_add_u32 s42, s42, 4096
s_add_u32 m0, s45, 63488
s_nop 0
buffer_load_dwordx4 v2, s[8:11], s42 offen offset:0 sc1 lds
v_mfma_f32_16x16x32_bf16 v[36:39], a[100:103], v[16:19], v[36:39]
ds_read_b128 v[16:19], v2 offset:16384
v_fmac_f32 v49, 0x3e800000, v53
v_mfma_f32_16x16x32_bf16 v[32:35], a[104:107], v[20:23], v[32:35]
v_permlane32_swap_b32 v48, v49
v_mfma_f32_16x16x32_bf16 v[36:39], a[108:111], v[20:23], v[36:39]
ds_read_b128 v[20:23], v2 offset:17408
v_add_f32 v48, v48, v49
s_waitcnt lgkmcnt(2)
v_mfma_f32_16x16x32_bf16 v[32:35], a[112:115], v[24:27], v[32:35]
buffer_load_dwordx4 v2, s[8:11], s42 offen offset:1024 sc1 lds
v_mfma_f32_16x16x32_bf16 v[36:39], a[116:119], v[24:27], v[36:39]
ds_read_b128 v[24:27], v2 offset:18432
v_mov_b32 v63, v48
v_mfma_f32_16x16x32_bf16 v[32:35], a[120:123], v[28:31], v[32:35]
v_permlane16_swap_b32 v48, v63
v_mfma_f32_16x16x32_bf16 v[36:39], a[124:127], v[28:31], v[36:39]
ds_read_b128 v[28:31], v2 offset:19456
v_add_f32 v48, v48, v63
s_waitcnt lgkmcnt(2)
v_mfma_f32_16x16x32_bf16 v[32:35], a[128:131], v[16:19], v[32:35]
buffer_load_dwordx4 v2, s[8:11], s42 offen offset:2048 sc1 lds
v_mfma_f32_16x16x32_bf16 v[36:39], a[132:135], v[16:19], v[36:39]
ds_read_b128 v[16:19], v2 offset:20480
ds_write_b32 v66, v48 offset:0
v_mfma_f32_16x16x32_bf16 v[32:35], a[136:139], v[20:23], v[32:35]
s_waitcnt lgkmcnt(0)
s_barrier
v_mfma_f32_16x16x32_bf16 v[36:39], a[140:143], v[20:23], v[36:39]
ds_read_b128 v[20:23], v2 offset:21504
ds_read_b64 v[48:49], v62 offset:0
v_mfma_f32_16x16x32_bf16 v[32:35], a[144:147], v[24:27], v[32:35]
buffer_load_dwordx4 v2, s[8:11], s42 offen offset:3072 sc1 lds
v_mfma_f32_16x16x32_bf16 v[36:39], a[148:151], v[24:27], v[36:39]
ds_read_b128 v[24:27], v2 offset:22528
s_add_u32 s26, s36, 245760
s_waitcnt vmcnt(17)
v_mfma_f32_16x16x32_bf16 v[32:35], a[152:155], v[28:31], v[32:35]
v_mov_b32 v12, v51
v_mov_b32 v13, v55
v_mfma_f32_16x16x32_bf16 v[36:39], a[156:159], v[28:31], v[36:39]
ds_read_b128 v[28:31], v2 offset:23552
s_waitcnt lgkmcnt(3)
v_mfma_f32_16x16x32_bf16 v[32:35], a[160:163], v[16:19], v[32:35]
buffer_store_dwordx4 v[12:15], v5, s[4:7], s26 offen sc1
v_mfma_f32_16x16x32_bf16 v[36:39], a[164:167], v[16:19], v[36:39]
ds_read_b128 v[16:19], v2 offset:24576
ds_read_b128 v[76:79], v8 offset:16384
v_mfma_f32_16x16x32_bf16 v[32:35], a[168:171], v[20:23], v[32:35]
s_waitcnt lgkmcnt(4)
v_permlane32_swap_b32 v48, v49
v_mfma_f32_16x16x32_bf16 v[36:39], a[172:175], v[20:23], v[36:39]
ds_read_b128 v[20:23], v2 offset:25600
v_add_f32 v48, v48, v49
s_waitcnt lgkmcnt(3)
v_mfma_f32_16x16x32_bf16 v[32:35], a[176:179], v[24:27], v[32:35]
s_add_u32 s42, s42, 4096
s_add_u32 m0, s45, 67584
s_nop 0
buffer_load_dwordx4 v2, s[8:11], s42 offen offset:0 sc1 lds
v_mfma_f32_16x16x32_bf16 v[36:39], a[180:183], v[24:27], v[36:39]
ds_read_b128 v[24:27], v2 offset:26624
v_mov_b32 v63, v48
v_mfma_f32_16x16x32_bf16 v[32:35], a[184:187], v[28:31], v[32:35]
v_permlane16_swap_b32 v48, v63
v_mfma_f32_16x16x32_bf16 v[36:39], a[188:191], v[28:31], v[36:39]
ds_read_b128 v[28:31], v2 offset:27648
v_add_f32 v48, v48, v63
s_waitcnt lgkmcnt(2)
v_mfma_f32_16x16x32_bf16 v[32:35], a[192:195], v[16:19], v[32:35]
buffer_load_dwordx4 v2, s[8:11], s42 offen offset:1024 sc1 lds
v_mfma_f32_16x16x32_bf16 v[36:39], a[196:199], v[16:19], v[36:39]
ds_read_b128 v[16:19], v2 offset:28672
v_mov_b32 v49, v48
v_mfma_f32_16x16x32_bf16 v[32:35], a[200:203], v[20:23], v[32:35]
v_permlane32_swap_b32 v48, v49
v_mfma_f32_16x16x32_bf16 v[36:39], a[204:207], v[20:23], v[36:39]
ds_read_b128 v[20:23], v2 offset:29696
s_add_u32 s26, s35, 1310720
s_waitcnt lgkmcnt(2)
v_mfma_f32_16x16x32_bf16 v[32:35], a[208:211], v[24:27], v[32:35]
v_mul_f32 v52, 0x3acccccd, v48
v_mul_f32 v56, 0x3acccccd, v49
v_fma_f32 v56, -v52, v52, v56
v_mfma_f32_16x16x32_bf16 v[36:39], a[212:215], v[24:27], v[36:39]
ds_read_b128 v[24:27], v2 offset:30720
v_add_f32 v56, 0x3727c5ac, v56
v_mfma_f32_16x16x32_bf16 v[32:35], a[216:219], v[28:31], v[32:35]
v_rsq_f32 v53, v56
v_mfma_f32_16x16x32_bf16 v[36:39], a[220:223], v[28:31], v[36:39]
ds_read_b128 v[28:31], v2 offset:31744
v_lshlrev_b32 v68, 16, v76
s_waitcnt lgkmcnt(2)
v_mfma_f32_16x16x32_bf16 v[32:35], a[224:227], v[16:19], v[32:35]
v_and_b32 v69, 0xffff0000, v76
v_lshlrev_b32 v70, 16, v77
v_and_b32 v71, 0xffff0000, v77
v_mfma_f32_16x16x32_bf16 v[36:39], a[228:231], v[16:19], v[36:39]
ds_read_b128 v[16:19], v2 offset:32768
v_lshlrev_b32 v72, 16, v78
v_and_b32 v73, 0xffff0000, v78
v_mfma_f32_16x16x32_bf16 v[32:35], a[232:235], v[20:23], v[32:35]
v_lshlrev_b32 v74, 16, v79
v_and_b32 v75, 0xffff0000, v79
v_mul_f32 v54, v52, v53
v_mfma_f32_16x16x32_bf16 v[36:39], a[236:239], v[20:23], v[36:39]
ds_read_b128 v[20:23], v2 offset:33792
s_waitcnt vmcnt(17)
v_lshlrev_b32 v56, 16, v0
s_waitcnt lgkmcnt(2)
v_mfma_f32_16x16x32_bf16 v[32:35], a[240:243], v[24:27], v[32:35]
v_and_b32 v57, 0xffff0000, v0
v_fma_f32 v60, v68, v53, -v54
v_fma_f32 v61, v69, v53, -v54
v_mfma_f32_16x16x32_bf16 v[36:39], a[244:247], v[24:27], v[36:39]
ds_read_b128 v[24:27], v2 offset:34816
v_fmac_f32 v68, v60, v56
v_fmac_f32 v69, v61, v57
v_mfma_f32_16x16x32_bf16 v[32:35], a[248:251], v[28:31], v[32:35]
v_lshlrev_b32 v56, 16, v1
v_and_b32 v57, 0xffff0000, v1
v_fma_f32 v60, v70, v53, -v54
v_mfma_f32_16x16x32_bf16 v[36:39], a[252:255], v[28:31], v[36:39]
ds_read_b128 v[28:31], v2 offset:35840
v_fma_f32 v61, v71, v53, -v54
s_waitcnt lgkmcnt(2)
v_mfma_f32_16x16x32_bf16 v[32:35], v[80:83], v[16:19], v[32:35]
v_fmac_f32 v70, v60, v56
v_fmac_f32 v71, v61, v57
s_waitcnt vmcnt(16)
v_lshlrev_b32 v56, 16, v10
v_mfma_f32_16x16x32_bf16 v[36:39], v[84:87], v[16:19], v[36:39]
ds_read_b128 v[16:19], v2 offset:36864
v_and_b32 v57, 0xffff0000, v10
v_fma_f32 v60, v72, v53, -v54
v_mfma_f32_16x16x32_bf16 v[32:35], v[88:91], v[20:23], v[32:35]
v_fma_f32 v61, v73, v53, -v54
v_fmac_f32 v72, v60, v56
v_fmac_f32 v73, v61, v57
v_mfma_f32_16x16x32_bf16 v[36:39], v[92:95], v[20:23], v[36:39]
ds_read_b128 v[20:23], v2 offset:37888
v_lshlrev_b32 v56, 16, v11
s_waitcnt lgkmcnt(2)
v_mfma_f32_16x16x32_bf16 v[32:35], v[96:99], v[24:27], v[32:35]
v_and_b32 v57, 0xffff0000, v11
v_fma_f32 v60, v74, v53, -v54
v_fma_f32 v61, v75, v53, -v54
v_mfma_f32_16x16x32_bf16 v[36:39], v[100:103], v[24:27], v[36:39]
ds_read_b128 v[24:27], v2 offset:38912
v_fmac_f32 v74, v60, v56
v_fmac_f32 v75, v61, v57
v_mfma_f32_16x16x32_bf16 v[32:35], v[104:107], v[28:31], v[32:35]
v_cvt_pk_bf16_f32 v76, v68, v69
v_cvt_pk_bf16_f32 v77, v70, v71
v_cvt_pk_bf16_f32 v78, v72, v73
v_mfma_f32_16x16x32_bf16 v[36:39], v[108:111], v[28:31], v[36:39]
ds_read_b128 v[28:31], v2 offset:39936
v_cvt_pk_bf16_f32 v79, v74, v75
s_waitcnt lgkmcnt(2)
v_mfma_f32_16x16x32_bf16 v[32:35], v[112:115], v[16:19], v[32:35]
buffer_store_dwordx4 v[76:79], v2, s[4:7], s26 offen sc1
v_mfma_f32_16x16x32_bf16 v[36:39], v[116:119], v[16:19], v[36:39]
ds_read_b128 v[16:19], v2 offset:40960
ds_write_b128 v8, v[76:79] offset:16384
v_mfma_f32_16x16x32_bf16 v[32:35], v[120:123], v[20:23], v[32:35]
v_add_f32 v51, v68, v69
v_mul_f32 v55, v68, v68
v_mfma_f32_16x16x32_bf16 v[36:39], v[124:127], v[20:23], v[36:39]
ds_read_b128 v[20:23], v2 offset:41984
s_waitcnt lgkmcnt(3)
v_mfma_f32_16x16x32_bf16 v[32:35], v[128:131], v[24:27], v[32:35]
v_fmac_f32 v55, v69, v69
v_add_f32 v51, v51, v70
v_mfma_f32_16x16x32_bf16 v[36:39], v[132:135], v[24:27], v[36:39]
ds_read_b128 v[24:27], v2 offset:43008
v_fmac_f32 v55, v70, v70
v_mfma_f32_16x16x32_bf16 v[32:35], v[136:139], v[28:31], v[32:35]
v_add_f32 v51, v51, v71
v_fmac_f32 v55, v71, v71
v_mfma_f32_16x16x32_bf16 v[36:39], v[140:143], v[28:31], v[36:39]
ds_read_b128 v[28:31], v2 offset:44032
s_waitcnt lgkmcnt(2)
v_mfma_f32_16x16x32_bf16 v[32:35], v[144:147], v[16:19], v[32:35]
v_add_f32 v51, v51, v72
v_fmac_f32 v55, v72, v72
v_mfma_f32_16x16x32_bf16 v[36:39], v[148:151], v[16:19], v[36:39]
ds_read_b128 v[16:19], v2 offset:45056
v_add_f32 v51, v51, v73
v_mfma_f32_16x16x32_bf16 v[32:35], v[152:155], v[20:23], v[32:35]
v_fmac_f32 v55, v73, v73
v_add_f32 v51, v51, v74
v_mfma_f32_16x16x32_bf16 v[36:39], v[156:159], v[20:23], v[36:39]
ds_read_b128 v[20:23], v2 offset:46080
s_waitcnt lgkmcnt(2)
v_mfma_f32_16x16x32_bf16 v[32:35], v[160:163], v[24:27], v[32:35]
v_fmac_f32 v55, v74, v74
v_add_f32 v51, v51, v75
v_mfma_f32_16x16x32_bf16 v[36:39], v[164:167], v[24:27], v[36:39]
ds_read_b128 v[24:27], v2 offset:47104
v_fmac_f32 v55, v75, v75
v_mfma_f32_16x16x32_bf16 v[32:35], v[168:171], v[28:31], v[32:35]
v_permlane32_swap_b32 v51, v55
v_mfma_f32_16x16x32_bf16 v[36:39], v[172:175], v[28:31], v[36:39]
ds_read_b128 v[28:31], v2 offset:48128
s_waitcnt lgkmcnt(2)
v_mfma_f32_16x16x32_bf16 v[32:35], v[176:179], v[16:19], v[32:35]
v_add_f32 v51, v51, v55
v_mov_b32 v63, v51
v_mfma_f32_16x16x32_bf16 v[36:39], v[180:183], v[16:19], v[36:39]
ds_read_b128 v[16:19], v2 offset:49152
v_permlane16_swap_b32 v51, v63
v_mfma_f32_16x16x32_bf16 v[32:35], v[184:187], v[20:23], v[32:35]
v_add_f32 v51, v51, v63
v_mov_b32 v55, v51
v_mfma_f32_16x16x32_bf16 v[36:39], v[188:191], v[20:23], v[36:39]
ds_read_b128 v[20:23], v2 offset:50176
s_waitcnt lgkmcnt(2)
v_mfma_f32_16x16x32_bf16 v[32:35], v[192:195], v[24:27], v[32:35]
v_permlane32_swap_b32 v51, v55
v_mfma_f32_16x16x32_bf16 v[36:39], v[196:199], v[24:27], v[36:39]
ds_read_b128 v[24:27], v2 offset:51200
v_mfma_f32_16x16x32_bf16 v[32:35], v[200:203], v[28:31], v[32:35]
v_mfma_f32_16x16x32_bf16 v[36:39], v[204:207], v[28:31], v[36:39]
ds_read_b128 v[28:31], v2 offset:52224
s_waitcnt lgkmcnt(2)
v_mfma_f32_16x16x32_bf16 v[32:35], v[208:211], v[16:19], v[32:35]
v_mfma_f32_16x16x32_bf16 v[36:39], v[212:215], v[16:19], v[36:39]
ds_read_b128 v[16:19], v2 offset:53248
v_mfma_f32_16x16x32_bf16 v[32:35], v[216:219], v[20:23], v[32:35]
v_mfma_f32_16x16x32_bf16 v[36:39], v[220:223], v[20:23], v[36:39]
ds_read_b128 v[20:23], v2 offset:54272
s_waitcnt lgkmcnt(2)
v_mfma_f32_16x16x32_bf16 v[32:35], v[224:227], v[24:27], v[32:35]
s_add_u32 s26, s33, 409600
s_add_u32 s27, s34, 1638400
buffer_load_dwordx3 v[48:50], v64, s[4:7], s26 offen sc1
v_mfma_f32_16x16x32_bf16 v[36:39], v[228:231], v[24:27], v[36:39]
buffer_load_dwordx3 v[52:54], v65, s[4:7], s26 offen sc1
v_mfma_f32_16x16x32_bf16 v[32:35], v[232:235], v[28:31], v[32:35]
buffer_load_dwordx2 v[0:1], v7, s[4:7], s27 offen
buffer_load_dwordx2 v[10:11], v7, s[4:7], s27 offen offset:512
ds_read_b128 v[76:79], v8 offset:28672
s_waitcnt lgkmcnt(0)
v_lshlrev_b32 v40, 16, v76
v_and_b32 v41, 0xffff0000, v76
v_lshlrev_b32 v42, 16, v77
v_and_b32 v43, 0xffff0000, v77
v_lshlrev_b32 v44, 16, v78
v_and_b32 v45, 0xffff0000, v78
v_lshlrev_b32 v46, 16, v79
v_and_b32 v47, 0xffff0000, v79
v_mfma_f32_16x16x32_bf16 v[36:39], v[236:239], v[28:31], v[36:39]
s_cmp_eq_u32 s10, 0
s_cbranch_scc1 Lg2_falate6
Lg2_faret6:
s_waitcnt vmcnt(5) lgkmcnt(0)
s_barrier
ds_read_b128 v[24:27], v3 offset:0
ds_read_b128 v[28:31], v3 offset:1024
v_mfma_f32_16x16x32_bf16 v[32:35], v[240:243], v[16:19], v[32:35]
v_mfma_f32_16x16x32_bf16 v[36:39], v[244:247], v[16:19], v[36:39]
ds_read_b128 v[16:19], v3 offset:2048
v_mfma_f32_16x16x32_bf16 v[32:35], v[248:251], v[20:23], v[32:35]
v_mfma_f32_16x16x32_bf16 v[36:39], v[252:255], v[20:23], v[36:39]
ds_read_b128 v[20:23], v3 offset:3072
s_waitcnt lgkmcnt(2)
v_mfma_f32_16x16x32_bf16 v[40:43], a[0:3], v[24:27], v[40:43]
s_add_u32 s26, s32, 491520
s_nop 2
v_cvt_pk_bf16_f32 v76, v32, v33
v_cvt_pk_bf16_f32 v77, v34, v35
v_cvt_pk_bf16_f32 v78, v36, v37
v_cvt_pk_bf16_f32 v79, v38, v39
v_mfma_f32_16x16x32_bf16 v[44:47], a[4:7], v[24:27], v[44:47]
ds_read_b128 v[24:27], v3 offset:4096
ds_write_b128 v8, v[76:79] offset:24576
v_mfma_f32_16x16x32_bf16 v[40:43], a[8:11], v[28:31], v[40:43]
v_add_f32 v12, v32, v33
v_mul_f32 v13, v32, v32
v_fmac_f32 v13, v33, v33
v_add_f32 v12, v12, v34
v_fmac_f32 v13, v34, v34
v_mfma_f32_16x16x32_bf16 v[44:47], a[12:15], v[28:31], v[44:47]
ds_read_b128 v[28:31], v3 offset:5120
v_add_f32 v12, v12, v35
v_fmac_f32 v13, v35, v35
v_add_f32 v12, v12, v36
s_waitcnt lgkmcnt(3)
v_mfma_f32_16x16x32_bf16 v[40:43], a[16:19], v[16:19], v[40:43]
v_fmac_f32 v13, v36, v36
v_add_f32 v12, v12, v37
v_fmac_f32 v13, v37, v37
v_add_f32 v12, v12, v38
v_fmac_f32 v13, v38, v38
v_mfma_f32_16x16x32_bf16 v[44:47], a[20:23], v[16:19], v[44:47]
ds_read_b128 v[16:19], v3 offset:6144
v_add_f32 v12, v12, v39
v_fmac_f32 v13, v39, v39
v_mfma_f32_16x16x32_bf16 v[40:43], a[24:27], v[20:23], v[40:43]
v_permlane32_swap_b32 v12, v13
v_mfma_f32_16x16x32_bf16 v[44:47], a[28:31], v[20:23], v[44:47]
ds_read_b128 v[20:23], v3 offset:7168
v_add_f32 v12, v12, v13
v_mov_b32 v63, v12
s_waitcnt lgkmcnt(2)
v_mfma_f32_16x16x32_bf16 v[40:43], a[32:35], v[24:27], v[40:43]
v_permlane16_swap_b32 v12, v63
v_mfma_f32_16x16x32_bf16 v[44:47], a[36:39], v[24:27], v[44:47]
ds_read_b128 v[24:27], v3 offset:8192
v_add_f32 v12, v12, v63
v_mov_b32 v13, v12
v_mfma_f32_16x16x32_bf16 v[40:43], a[40:43], v[28:31], v[40:43]
v_permlane32_swap_b32 v12, v13
v_mfma_f32_16x16x32_bf16 v[44:47], a[44:47], v[28:31], v[44:47]
ds_read_b128 v[28:31], v3 offset:9216
s_waitcnt lgkmcnt(2)
v_mfma_f32_16x16x32_bf16 v[40:43], a[48:51], v[16:19], v[40:43]
buffer_store_dwordx4 v[12:15], v5, s[4:7], s26 offen sc1
v_mfma_f32_16x16x32_bf16 v[44:47], a[52:55], v[16:19], v[44:47]
ds_read_b128 v[16:19], v3 offset:10240
s_waitcnt vmcnt(3)
v_cmp_ne_u32 vcc, s20, v50
v_cmp_ne_u32 s[28:29], s20, v54
s_or_b64 vcc, vcc, s[28:29]
s_cmp_eq_u64 vcc, 0
s_cbranch_scc0 Lg2_e2late5
Lg2_e2ret5:
v_mfma_f32_16x16x32_bf16 v[40:43], a[56:59], v[20:23], v[40:43]
v_fmac_f32 v48, 0x3e800000, v52
v_fmac_f32 v49, 0x3e800000, v53
v_mfma_f32_16x16x32_bf16 v[44:47], a[60:63], v[20:23], v[44:47]
ds_read_b128 v[20:23], v3 offset:11264
s_waitcnt lgkmcnt(2)
v_mfma_f32_16x16x32_bf16 v[40:43], a[64:67], v[24:27], v[40:43]
v_permlane32_swap_b32 v48, v49
v_mfma_f32_16x16x32_bf16 v[44:47], a[68:71], v[24:27], v[44:47]
ds_read_b128 v[24:27], v3 offset:12288
v_add_f32 v48, v48, v49
v_mfma_f32_16x16x32_bf16 v[40:43], a[72:75], v[28:31], v[40:43]
v_mov_b32 v63, v48
s_nop 1
v_permlane16_swap_b32 v48, v63
v_mfma_f32_16x16x32_bf16 v[44:47], a[76:79], v[28:31], v[44:47]
ds_read_b128 v[28:31], v3 offset:13312
s_waitcnt lgkmcnt(2)
v_mfma_f32_16x16x32_bf16 v[40:43], a[80:83], v[16:19], v[40:43]
v_add_f32 v48, v48, v63
v_mfma_f32_16x16x32_bf16 v[44:47], a[84:87], v[16:19], v[44:47]
ds_read_b128 v[16:19], v3 offset:14336
ds_write_b32 v66, v48 offset:512
v_mfma_f32_16x16x32_bf16 v[40:43], a[88:91], v[20:23], v[40:43]
s_waitcnt lgkmcnt(0)
s_barrier
v_mfma_f32_16x16x32_bf16 v[44:47], a[92:95], v[20:23], v[44:47]
ds_read_b128 v[20:23], v3 offset:15360
v_mfma_f32_16x16x32_bf16 v[40:43], a[96:99], v[24:27], v[40:43]
ds_read_b64 v[48:49], v62 offset:512
s_add_u32 s26, s36, 327680
v_mfma_f32_16x16x32_bf16 v[44:47], a[100:103], v[24:27], v[44:47]
ds_read_b128 v[24:27], v3 offset:16384
s_waitcnt vmcnt(5)
v_mfma_f32_16x16x32_bf16 v[40:43], a[104:107], v[28:31], v[40:43]
v_mov_b32 v12, v51
v_mov_b32 v13, v55
v_mfma_f32_16x16x32_bf16 v[44:47], a[108:111], v[28:31], v[44:47]
ds_read_b128 v[28:31], v3 offset:17408
s_waitcnt lgkmcnt(3)
v_mfma_f32_16x16x32_bf16 v[40:43], a[112:115], v[16:19], v[40:43]
buffer_store_dwordx4 v[12:15], v5, s[4:7], s26 offen sc1
v_mfma_f32_16x16x32_bf16 v[44:47], a[116:119], v[16:19], v[44:47]
ds_read_b128 v[16:19], v3 offset:18432
ds_read_b128 v[76:79], v8 offset:20480
v_mfma_f32_16x16x32_bf16 v[40:43], a[120:123], v[20:23], v[40:43]
s_waitcnt lgkmcnt(4)
v_permlane32_swap_b32 v48, v49
v_mfma_f32_16x16x32_bf16 v[44:47], a[124:127], v[20:23], v[44:47]
ds_read_b128 v[20:23], v3 offset:19456
s_waitcnt lgkmcnt(3)
v_mfma_f32_16x16x32_bf16 v[40:43], a[128:131], v[24:27], v[40:43]
v_add_f32 v48, v48, v49
v_mov_b32 v63, v48
v_mfma_f32_16x16x32_bf16 v[44:47], a[132:135], v[24:27], v[44:47]
ds_read_b128 v[24:27], v3 offset:20480
v_permlane16_swap_b32 v48, v63
v_mfma_f32_16x16x32_bf16 v[40:43], a[136:139], v[28:31], v[40:43]
v_add_f32 v48, v48, v63
v_mov_b32 v49, v48
v_mfma_f32_16x16x32_bf16 v[44:47], a[140:143], v[28:31], v[44:47]
ds_read_b128 v[28:31], v3 offset:21504
s_waitcnt lgkmcnt(2)
v_mfma_f32_16x16x32_bf16 v[40:43], a[144:147], v[16:19], v[40:43]
v_permlane32_swap_b32 v48, v49
v_mfma_f32_16x16x32_bf16 v[44:47], a[148:151], v[16:19], v[44:47]
ds_read_b128 v[16:19], v3 offset:22528
s_add_u32 s26, s35, 1638400
v_mfma_f32_16x16x32_bf16 v[40:43], a[152:155], v[20:23], v[40:43]
v_mul_f32 v52, 0x3acccccd, v48
v_mul_f32 v56, 0x3acccccd, v49
v_mfma_f32_16x16x32_bf16 v[44:47], a[156:159], v[20:23], v[44:47]
ds_read_b128 v[20:23], v3 offset:23552
s_waitcnt lgkmcnt(2)
v_mfma_f32_16x16x32_bf16 v[40:43], a[160:163], v[24:27], v[40:43]
v_fma_f32 v56, -v52, v52, v56
v_add_f32 v56, 0x3727c5ac, v56
v_mfma_f32_16x16x32_bf16 v[44:47], a[164:167], v[24:27], v[44:47]
ds_read_b128 v[24:27], v3 offset:24576
v_rsq_f32 v53, v56
v_mfma_f32_16x16x32_bf16 v[40:43], a[168:171], v[28:31], v[40:43]
v_lshlrev_b32 v68, 16, v76
v_and_b32 v69, 0xffff0000, v76
v_mfma_f32_16x16x32_bf16 v[44:47], a[172:175], v[28:31], v[44:47]
ds_read_b128 v[28:31], v3 offset:25600
s_waitcnt lgkmcnt(2)
v_mfma_f32_16x16x32_bf16 v[40:43], a[176:179], v[16:19], v[40:43]
v_lshlrev_b32 v70, 16, v77
v_and_b32 v71, 0xffff0000, v77
v_mfma_f32_16x16x32_bf16 v[44:47], a[180:183], v[16:19], v[44:47]
ds_read_b128 v[16:19], v3 offset:26624
v_lshlrev_b32 v72, 16, v78
v_mfma_f32_16x16x32_bf16 v[40:43], a[184:187], v[20:23], v[40:43]
v_and_b32 v73, 0xffff0000, v78
v_lshlrev_b32 v74, 16, v79
v_mfma_f32_16x16x32_bf16 v[44:47], a[188:191], v[20:23], v[44:47]
ds_read_b128 v[20:23], v3 offset:27648
s_waitcnt lgkmcnt(2)
v_mfma_f32_16x16x32_bf16 v[40:43], a[192:195], v[24:27], v[40:43]
v_and_b32 v75, 0xffff0000, v79
v_mul_f32 v54, v52, v53
v_mfma_f32_16x16x32_bf16 v[44:47], a[196:199], v[24:27], v[44:47]
ds_read_b128 v[24:27], v3 offset:28672
s_waitcnt vmcnt(3)
v_lshlrev_b32 v56, 16, v0
v_mfma_f32_16x16x32_bf16 v[40:43], a[200:203], v[28:31], v[40:43]
v_and_b32 v57, 0xffff0000, v0
v_fma_f32 v60, v68, v53, -v54
v_mfma_f32_16x16x32_bf16 v[44:47], a[204:207], v[28:31], v[44:47]
ds_read_b128 v[28:31], v3 offset:29696
s_waitcnt lgkmcnt(2)
v_mfma_f32_16x16x32_bf16 v[40:43], a[208:211], v[16:19], v[40:43]
v_fma_f32 v61, v69, v53, -v54
v_fmac_f32 v68, v60, v56
v_mfma_f32_16x16x32_bf16 v[44:47], a[212:215], v[16:19], v[44:47]
ds_read_b128 v[16:19], v3 offset:30720
v_fmac_f32 v69, v61, v57
v_mfma_f32_16x16x32_bf16 v[40:43], a[216:219], v[20:23], v[40:43]
v_lshlrev_b32 v56, 16, v1
v_and_b32 v57, 0xffff0000, v1
v_mfma_f32_16x16x32_bf16 v[44:47], a[220:223], v[20:23], v[44:47]
ds_read_b128 v[20:23], v3 offset:31744
s_waitcnt lgkmcnt(2)
v_mfma_f32_16x16x32_bf16 v[40:43], a[224:227], v[24:27], v[40:43]
v_fma_f32 v60, v70, v53, -v54
v_fma_f32 v61, v71, v53, -v54
v_mfma_f32_16x16x32_bf16 v[44:47], a[228:231], v[24:27], v[44:47]
ds_read_b128 v[24:27], v3 offset:32768
v_fmac_f32 v70, v60, v56
v_mfma_f32_16x16x32_bf16 v[40:43], a[232:235], v[28:31], v[40:43]
v_fmac_f32 v71, v61, v57
s_waitcnt vmcnt(2)
v_lshlrev_b32 v56, 16, v10
v_mfma_f32_16x16x32_bf16 v[44:47], a[236:239], v[28:31], v[44:47]
ds_read_b128 v[28:31], v3 offset:33792
s_waitcnt lgkmcnt(2)
v_mfma_f32_16x16x32_bf16 v[40:43], a[240:243], v[16:19], v[40:43]
v_and_b32 v57, 0xffff0000, v10
v_fma_f32 v60, v72, v53, -v54
v_mfma_f32_16x16x32_bf16 v[44:47], a[244:247], v[16:19], v[44:47]
ds_read_b128 v[16:19], v3 offset:34816
v_fma_f32 v61, v73, v53, -v54
v_mfma_f32_16x16x32_bf16 v[40:43], a[248:251], v[20:23], v[40:43]
v_fmac_f32 v72, v60, v56
v_fmac_f32 v73, v61, v57
v_mfma_f32_16x16x32_bf16 v[44:47], a[252:255], v[20:23], v[44:47]
ds_read_b128 v[20:23], v3 offset:35840
s_waitcnt lgkmcnt(2)
v_mfma_f32_16x16x32_bf16 v[40:43], v[80:83], v[24:27], v[40:43]
v_lshlrev_b32 v56, 16, v11
v_and_b32 v57, 0xffff0000, v11
v_mfma_f32_16x16x32_bf16 v[44:47], v[84:87], v[24:27], v[44:47]
ds_read_b128 v[24:27], v3 offset:36864
v_fma_f32 v60, v74, v53, -v54
v_mfma_f32_16x16x32_bf16 v[40:43], v[88:91], v[28:31], v[40:43]
v_fma_f32 v61, v75, v53, -v54
v_fmac_f32 v74, v60, v56
v_mfma_f32_16x16x32_bf16 v[44:47], v[92:95], v[28:31], v[44:47]
ds_read_b128 v[28:31], v3 offset:37888
s_waitcnt lgkmcnt(2)
v_mfma_f32_16x16x32_bf16 v[40:43], v[96:99], v[16:19], v[40:43]
v_fmac_f32 v75, v61, v57
v_cvt_pk_bf16_f32 v76, v68, v69
v_mfma_f32_16x16x32_bf16 v[44:47], v[100:103], v[16:19], v[44:47]
ds_read_b128 v[16:19], v3 offset:38912
v_cvt_pk_bf16_f32 v77, v70, v71
v_mfma_f32_16x16x32_bf16 v[40:43], v[104:107], v[20:23], v[40:43]
s_add_u32 s43, s31, 131072
buffer_load_dword v59, v9, s[4:7], s43 offen sc1
v_mfma_f32_16x16x32_bf16 v[44:47], v[108:111], v[20:23], v[44:47]
ds_read_b128 v[20:23], v3 offset:39936
s_waitcnt lgkmcnt(2)
v_mfma_f32_16x16x32_bf16 v[40:43], v[112:115], v[24:27], v[40:43]
v_cvt_pk_bf16_f32 v78, v72, v73
v_cvt_pk_bf16_f32 v79, v74, v75
v_mfma_f32_16x16x32_bf16 v[44:47], v[116:119], v[24:27], v[44:47]
ds_read_b128 v[24:27], v3 offset:40960
v_mfma_f32_16x16x32_bf16 v[40:43], v[120:123], v[28:31], v[40:43]
buffer_store_dwordx4 v[76:79], v2, s[4:7], s26 offen sc1
v_mfma_f32_16x16x32_bf16 v[44:47], v[124:127], v[28:31], v[44:47]
ds_read_b128 v[28:31], v3 offset:41984
s_waitcnt lgkmcnt(2)
v_mfma_f32_16x16x32_bf16 v[40:43], v[128:131], v[16:19], v[40:43]
ds_write_b128 v8, v[76:79] offset:20480
v_mfma_f32_16x16x32_bf16 v[44:47], v[132:135], v[16:19], v[44:47]
ds_read_b128 v[16:19], v3 offset:43008
v_add_f32 v51, v68, v69
v_mfma_f32_16x16x32_bf16 v[40:43], v[136:139], v[20:23], v[40:43]
v_mul_f32 v55, v68, v68
v_fmac_f32 v55, v69, v69
v_mfma_f32_16x16x32_bf16 v[44:47], v[140:143], v[20:23], v[44:47]
ds_read_b128 v[20:23], v3 offset:44032
s_waitcnt lgkmcnt(3)
v_mfma_f32_16x16x32_bf16 v[40:43], v[144:147], v[24:27], v[40:43]
v_add_f32 v51, v51, v70
v_fmac_f32 v55, v70, v70
v_mfma_f32_16x16x32_bf16 v[44:47], v[148:151], v[24:27], v[44:47]
ds_read_b128 v[24:27], v3 offset:45056
v_add_f32 v51, v51, v71
v_mfma_f32_16x16x32_bf16 v[40:43], v[152:155], v[28:31], v[40:43]
v_fmac_f32 v55, v71, v71
v_add_f32 v51, v51, v72
v_mfma_f32_16x16x32_bf16 v[44:47], v[156:159], v[28:31], v[44:47]
ds_read_b128 v[28:31], v3 offset:46080
s_waitcnt lgkmcnt(2)
v_mfma_f32_16x16x32_bf16 v[40:43], v[160:163], v[16:19], v[40:43]
v_fmac_f32 v55, v72, v72
v_add_f32 v51, v51, v73
v_mfma_f32_16x16x32_bf16 v[44:47], v[164:167], v[16:19], v[44:47]
ds_read_b128 v[16:19], v3 offset:47104
v_fmac_f32 v55, v73, v73
v_mfma_f32_16x16x32_bf16 v[40:43], v[168:171], v[20:23], v[40:43]
v_add_f32 v51, v51, v74
v_fmac_f32 v55, v74, v74
v_mfma_f32_16x16x32_bf16 v[44:47], v[172:175], v[20:23], v[44:47]
ds_read_b128 v[20:23], v3 offset:48128
s_waitcnt lgkmcnt(2)
v_mfma_f32_16x16x32_bf16 v[40:43], v[176:179], v[24:27], v[40:43]
v_add_f32 v51, v51, v75
v_fmac_f32 v55, v75, v75
v_mfma_f32_16x16x32_bf16 v[44:47], v[180:183], v[24:27], v[44:47]
ds_read_b128 v[24:27], v3 offset:49152
v_permlane32_swap_b32 v51, v55
v_mfma_f32_16x16x32_bf16 v[40:43], v[184:187], v[28:31], v[40:43]
v_add_f32 v51, v51, v55
v_mov_b32 v63, v51
v_mfma_f32_16x16x32_bf16 v[44:47], v[188:191], v[28:31], v[44:47]
ds_read_b128 v[28:31], v3 offset:50176
s_waitcnt lgkmcnt(2)
v_mfma_f32_16x16x32_bf16 v[40:43], v[192:195], v[16:19], v[40:43]
v_permlane16_swap_b32 v51, v63
v_mfma_f32_16x16x32_bf16 v[44:47], v[196:199], v[16:19], v[44:47]
ds_read_b128 v[16:19], v3 offset:51200
v_add_f32 v51, v51, v63
v_mfma_f32_16x16x32_bf16 v[40:43], v[200:203], v[20:23], v[40:43]
v_mov_b32 v55, v51
s_nop 1
v_permlane32_swap_b32 v51, v55
v_mfma_f32_16x16x32_bf16 v[44:47], v[204:207], v[20:23], v[44:47]
ds_read_b128 v[20:23], v3 offset:52224
s_waitcnt lgkmcnt(2)
v_mfma_f32_16x16x32_bf16 v[40:43], v[208:211], v[24:27], v[40:43]
v_mfma_f32_16x16x32_bf16 v[44:47], v[212:215], v[24:27], v[44:47]
ds_read_b128 v[24:27], v3 offset:53248
v_mfma_f32_16x16x32_bf16 v[40:43], v[216:219], v[28:31], v[40:43]
v_mfma_f32_16x16x32_bf16 v[44:47], v[220:223], v[28:31], v[44:47]
ds_read_b128 v[28:31], v3 offset:54272
s_waitcnt lgkmcnt(2)
v_mfma_f32_16x16x32_bf16 v[40:43], v[224:227], v[16:19], v[40:43]
s_add_u32 s26, s33, 491520
s_add_u32 s27, s34, 1966080
buffer_load_dwordx3 v[48:50], v64, s[4:7], s26 offen sc1
v_mfma_f32_16x16x32_bf16 v[44:47], v[228:231], v[16:19], v[44:47]
buffer_load_dwordx3 v[52:54], v65, s[4:7], s26 offen sc1
v_mfma_f32_16x16x32_bf16 v[40:43], v[232:235], v[20:23], v[40:43]
buffer_load_dwordx2 v[0:1], v7, s[4:7], s27 offen
buffer_load_dwordx2 v[10:11], v7, s[4:7], s27 offen offset:512
v_mfma_f32_16x16x32_bf16 v[44:47], v[236:239], v[20:23], v[44:47]
s_waitcnt lgkmcnt(0)
v_mfma_f32_16x16x32_bf16 v[40:43], v[240:243], v[24:27], v[40:43]
v_mfma_f32_16x16x32_bf16 v[44:47], v[244:247], v[24:27], v[44:47]
v_mfma_f32_16x16x32_bf16 v[40:43], v[248:251], v[28:31], v[40:43]
v_mfma_f32_16x16x32_bf16 v[44:47], v[252:255], v[28:31], v[44:47]
s_nop 7
s_add_u32 s26, s32, 573440
v_cvt_pk_bf16_f32 v76, v40, v41
v_cvt_pk_bf16_f32 v77, v42, v43
v_cvt_pk_bf16_f32 v78, v44, v45
v_cvt_pk_bf16_f32 v79, v46, v47
ds_write_b128 v8, v[76:79] offset:28672
v_add_f32 v12, v40, v41
v_mul_f32 v13, v40, v40
v_fmac_f32 v13, v41, v41
v_add_f32 v12, v12, v42
v_fmac_f32 v13, v42, v42
v_add_f32 v12, v12, v43
v_fmac_f32 v13, v43, v43
v_add_f32 v12, v12, v44
v_fmac_f32 v13, v44, v44
v_add_f32 v12, v12, v45
v_fmac_f32 v13, v45, v45
v_add_f32 v12, v12, v46
v_fmac_f32 v13, v46, v46
v_add_f32 v12, v12, v47
v_fmac_f32 v13, v47, v47
s_nop 1
v_permlane32_swap_b32 v12, v13
v_add_f32 v12, v12, v13
v_mov_b32 v63, v12
s_nop 1
v_permlane16_swap_b32 v12, v63
v_add_f32 v12, v12, v63
v_mov_b32 v13, v12
s_nop 1
v_permlane32_swap_b32 v12, v13
buffer_store_dwordx4 v[12:15], v5, s[4:7], s26 offen sc1
s_waitcnt vmcnt(3)
v_cmp_ne_u32 vcc, s20, v50
v_cmp_ne_u32 s[28:29], s20, v54
s_or_b64 vcc, vcc, s[28:29]
s_cmp_eq_u64 vcc, 0
s_cbranch_scc0 Lg2_e2late6
Lg2_e2ret6:
v_fmac_f32 v48, 0x3e800000, v52
v_fmac_f32 v49, 0x3e800000, v53
s_nop 1
v_permlane32_swap_b32 v48, v49
v_add_f32 v48, v48, v49
v_mov_b32 v63, v48
s_nop 1
v_permlane16_swap_b32 v48, v63
v_add_f32 v48, v48, v63
ds_write_b32 v66, v48 offset:0
s_waitcnt lgkmcnt(0)
s_barrier
ds_read_b64 v[48:49], v62 offset:0
s_add_u32 s26, s36, 409600
s_waitcnt vmcnt(5)
v_mov_b32 v12, v51
v_mov_b32 v13, v55
buffer_store_dwordx4 v[12:15], v5, s[4:7], s26 offen sc1
ds_read_b128 v[76:79], v8 offset:24576
s_waitcnt lgkmcnt(1)
v_permlane32_swap_b32 v48, v49
v_add_f32 v48, v48, v49
v_mov_b32 v63, v48
s_nop 1
v_permlane16_swap_b32 v48, v63
v_add_f32 v48, v48, v63
v_mov_b32 v49, v48
s_nop 1
v_permlane32_swap_b32 v48, v49
s_add_u32 s26, s35, 1966080
v_mul_f32 v52, 0x3acccccd, v48
v_mul_f32 v56, 0x3acccccd, v49
v_fma_f32 v56, -v52, v52, v56
v_add_f32 v56, 0x3727c5ac, v56
v_rsq_f32 v53, v56
s_waitcnt lgkmcnt(0)
v_lshlrev_b32 v68, 16, v76
v_and_b32 v69, 0xffff0000, v76
v_lshlrev_b32 v70, 16, v77
v_and_b32 v71, 0xffff0000, v77
v_lshlrev_b32 v72, 16, v78
v_and_b32 v73, 0xffff0000, v78
v_lshlrev_b32 v74, 16, v79
v_and_b32 v75, 0xffff0000, v79
v_mul_f32 v54, v52, v53
s_waitcnt vmcnt(3)
v_lshlrev_b32 v56, 16, v0
v_and_b32 v57, 0xffff0000, v0
v_fma_f32 v60, v68, v53, -v54
v_fma_f32 v61, v69, v53, -v54
v_fmac_f32 v68, v60, v56
v_fmac_f32 v69, v61, v57
v_lshlrev_b32 v56, 16, v1
v_and_b32 v57, 0xffff0000, v1
v_fma_f32 v60, v70, v53, -v54
v_fma_f32 v61, v71, v53, -v54
v_fmac_f32 v70, v60, v56
v_fmac_f32 v71, v61, v57
s_waitcnt vmcnt(2)
v_lshlrev_b32 v56, 16, v10
v_and_b32 v57, 0xffff0000, v10
v_fma_f32 v60, v72, v53, -v54
v_fma_f32 v61, v73, v53, -v54
v_fmac_f32 v72, v60, v56
v_fmac_f32 v73, v61, v57
v_lshlrev_b32 v56, 16, v11
v_and_b32 v57, 0xffff0000, v11
v_fma_f32 v60, v74, v53, -v54
v_fma_f32 v61, v75, v53, -v54
v_fmac_f32 v74, v60, v56
v_fmac_f32 v75, v61, v57
v_cvt_pk_bf16_f32 v76, v68, v69
v_cvt_pk_bf16_f32 v77, v70, v71
v_cvt_pk_bf16_f32 v78, v72, v73
v_cvt_pk_bf16_f32 v79, v74, v75
buffer_store_dwordx4 v[76:79], v2, s[4:7], s26 offen sc1
ds_write_b128 v8, v[76:79] offset:24576
v_add_f32 v51, v68, v69
v_mul_f32 v55, v68, v68
v_fmac_f32 v55, v69, v69
v_add_f32 v51, v51, v70
v_fmac_f32 v55, v70, v70
v_add_f32 v51, v51, v71
v_fmac_f32 v55, v71, v71
v_add_f32 v51, v51, v72
v_fmac_f32 v55, v72, v72
v_add_f32 v51, v51, v73
v_fmac_f32 v55, v73, v73
v_add_f32 v51, v51, v74
v_fmac_f32 v55, v74, v74
v_add_f32 v51, v51, v75
v_fmac_f32 v55, v75, v75
s_nop 1
v_permlane32_swap_b32 v51, v55
v_add_f32 v51, v51, v55
v_mov_b32 v63, v51
s_nop 1
v_permlane16_swap_b32 v51, v63
v_add_f32 v51, v51, v63
v_mov_b32 v55, v51
s_nop 1
v_permlane32_swap_b32 v51, v55
v_cmp_ne_u32 vcc, s20, v59
s_cmp_eq_u64 vcc, 0
s_cselect_b32 s10, 0x10000000, 0
s_add_u32 s42, s30, 0x6c0000
s_add_u32 m0, s45, 0
s_nop 0
buffer_load_dwordx4 v2, s[8:11], s42 offen offset:0 sc1 lds
buffer_load_dwordx4 v2, s[8:11], s42 offen offset:1024 sc1 lds
buffer_load_dwordx4 v2, s[8:11], s42 offen offset:2048 sc1 lds
buffer_load_dwordx4 v2, s[8:11], s42 offen offset:3072 sc1 lds
s_add_u32 s42, s42, 4096
s_add_u32 m0, s45, 4096
s_nop 0
buffer_load_dwordx4 v2, s[8:11], s42 offen offset:0 sc1 lds
buffer_load_dwordx4 v2, s[8:11], s42 offen offset:1024 sc1 lds
buffer_load_dwordx4 v2, s[8:11], s42 offen offset:2048 sc1 lds
buffer_load_dwordx4 v2, s[8:11], s42 offen offset:3072 sc1 lds
s_add_u32 s42, s42, 4096
s_add_u32 m0, s45, 8192
s_nop 0
buffer_load_dwordx4 v2, s[8:11], s42 offen offset:0 sc1 lds
buffer_load_dwordx4 v2, s[8:11], s42 offen offset:1024 sc1 lds
buffer_load_dwordx4 v2, s[8:11], s42 offen offset:2048 sc1 lds
buffer_load_dwordx4 v2, s[8:11], s42 offen offset:3072 sc1 lds
s_add_u32 s42, s42, 4096
s_add_u32 m0, s45, 12288
s_nop 0
buffer_load_dwordx4 v2, s[8:11], s42 offen offset:0 sc1 lds
buffer_load_dwordx4 v2, s[8:11], s42 offen offset:1024 sc1 lds
s_add_u32 s43, s31, 147456
buffer_load_dword v59, v9, s[4:7], s43 offen sc1
s_add_u32 s26, s33, 573440
s_add_u32 s27, s34, 2293760
buffer_load_dwordx3 v[48:50], v64, s[4:7], s26 offen sc1
buffer_load_dwordx3 v[52:54], v65, s[4:7], s26 offen sc1
buffer_load_dwordx2 v[0:1], v7, s[4:7], s27 offen
buffer_load_dwordx2 v[10:11], v7, s[4:7], s27 offen offset:512
s_add_u32 s26, s36, 491520
s_waitcnt vmcnt(19)
v_mov_b32 v12, v51
v_mov_b32 v13, v55
buffer_store_dwordx4 v[12:15], v5, s[4:7], s26 offen sc1
s_waitcnt vmcnt(3)
v_cmp_ne_u32 vcc, s20, v50
v_cmp_ne_u32 s[28:29], s20, v54
s_or_b64 vcc, vcc, s[28:29]
s_cmp_eq_u64 vcc, 0
s_cbranch_scc0 Lg2_e2late7
Lg2_e2ret7:
v_fmac_f32 v48, 0x3e800000, v52
v_fmac_f32 v49, 0x3e800000, v53
s_nop 1
v_permlane32_swap_b32 v48, v49
v_add_f32 v48, v48, v49
v_mov_b32 v63, v48
s_nop 1
v_permlane16_swap_b32 v48, v63
v_add_f32 v48, v48, v63
ds_write_b32 v66, v48 offset:512
s_waitcnt lgkmcnt(0)
s_barrier
ds_read_b64 v[48:49], v62 offset:512
ds_read_b128 v[76:79], v8 offset:28672
s_waitcnt lgkmcnt(1)
v_permlane32_swap_b32 v48, v49
v_add_f32 v48, v48, v49
v_mov_b32 v63, v48
s_nop 1
v_permlane16_swap_b32 v48, v63
v_add_f32 v48, v48, v63
v_mov_b32 v49, v48
s_nop 1
v_permlane32_swap_b32 v48, v49
s_add_u32 s26, s35, 2293760
v_mul_f32 v52, 0x3acccccd, v48
v_mul_f32 v56, 0x3acccccd, v49
v_fma_f32 v56, -v52, v52, v56
v_add_f32 v56, 0x3727c5ac, v56
v_rsq_f32 v53, v56
s_waitcnt lgkmcnt(0)
v_lshlrev_b32 v68, 16, v76
v_and_b32 v69, 0xffff0000, v76
v_lshlrev_b32 v70, 16, v77
v_and_b32 v71, 0xffff0000, v77
v_lshlrev_b32 v72, 16, v78
v_and_b32 v73, 0xffff0000, v78
v_lshlrev_b32 v74, 16, v79
v_and_b32 v75, 0xffff0000, v79
v_mul_f32 v54, v52, v53
s_waitcnt vmcnt(2)
v_lshlrev_b32 v56, 16, v0
v_and_b32 v57, 0xffff0000, v0
v_fma_f32 v60, v68, v53, -v54
v_fma_f32 v61, v69, v53, -v54
v_fmac_f32 v68, v60, v56
v_fmac_f32 v69, v61, v57
v_lshlrev_b32 v56, 16, v1
v_and_b32 v57, 0xffff0000, v1
v_fma_f32 v60, v70, v53, -v54
v_fma_f32 v61, v71, v53, -v54
v_fmac_f32 v70, v60, v56
v_fmac_f32 v71, v61, v57
s_waitcnt vmcnt(1)
v_lshlrev_b32 v56, 16, v10
v_and_b32 v57, 0xffff0000, v10
v_fma_f32 v60, v72, v53, -v54
v_fma_f32 v61, v73, v53, -v54
v_fmac_f32 v72, v60, v56
v_fmac_f32 v73, v61, v57
v_lshlrev_b32 v56, 16, v11
v_and_b32 v57, 0xffff0000, v11
v_fma_f32 v60, v74, v53, -v54
v_fma_f32 v61, v75, v53, -v54
v_fmac_f32 v74, v60, v56
v_fmac_f32 v75, v61, v57
v_cvt_pk_bf16_f32 v76, v68, v69
v_cvt_pk_bf16_f32 v77, v70, v71
v_cvt_pk_bf16_f32 v78, v72, v73
v_cvt_pk_bf16_f32 v79, v74, v75
buffer_store_dwordx4 v[76:79], v2, s[4:7], s26 offen sc1
ds_write_b128 v8, v[76:79] offset:28672
v_add_f32 v51, v68, v69
v_mul_f32 v55, v68, v68
v_fmac_f32 v55, v69, v69
v_add_f32 v51, v51, v70
v_fmac_f32 v55, v70, v70
v_add_f32 v51, v51, v71
v_fmac_f32 v55, v71, v71
v_add_f32 v51, v51, v72
v_fmac_f32 v55, v72, v72
v_add_f32 v51, v51, v73
v_fmac_f32 v55, v73, v73
v_add_f32 v51, v51, v74
v_fmac_f32 v55, v74, v74
v_add_f32 v51, v51, v75
v_fmac_f32 v55, v75, v75
s_nop 1
v_permlane32_swap_b32 v51, v55
v_add_f32 v51, v51, v55
v_mov_b32 v63, v51
s_nop 1
v_permlane16_swap_b32 v51, v63
v_add_f32 v51, v51, v63
v_mov_b32 v55, v51
s_nop 1
v_permlane32_swap_b32 v51, v55
s_cmp_eq_u32 s10, 0
s_cbranch_scc1 Lg2_falate7
Lg2_faret7:
ds_read_b128 v[76:79], v8 offset:0
s_waitcnt lgkmcnt(0)
v_lshlrev_b32 v32, 16, v76
v_and_b32 v33, 0xffff0000, v76
v_lshlrev_b32 v34, 16, v77
v_and_b32 v35, 0xffff0000, v77
v_lshlrev_b32 v36, 16, v78
v_and_b32 v37, 0xffff0000, v78
v_lshlrev_b32 v38, 16, v79
v_and_b32 v39, 0xffff0000, v79
s_waitcnt vmcnt(7)
s_barrier
ds_read_b128 v[16:19], v2 offset:0
ds_read_b128 v[20:23], v2 offset:1024
ds_read_b128 v[24:27], v2 offset:2048
ds_read_b128 v[28:31], v2 offset:3072
s_waitcnt lgkmcnt(2)
v_mfma_f32_16x16x32_bf16 v[32:35], a[0:3], v[16:19], v[32:35]
v_cmp_ne_u32 vcc, s20, v59
s_cmp_eq_u64 vcc, 0
s_cselect_b32 s10, 0x10000000, 0
v_mfma_f32_16x16x32_bf16 v[36:39], a[4:7], v[16:19], v[36:39]
ds_read_b128 v[16:19], v2 offset:4096
v_mfma_f32_16x16x32_bf16 v[32:35], a[8:11], v[20:23], v[32:35]
s_add_u32 s42, s30, 0x798000
s_add_u32 m0, s45, 55296
s_nop 0
buffer_load_dwordx4 v2, s[8:11], s42 offen offset:0 sc1 lds
v_mfma_f32_16x16x32_bf16 v[36:39], a[12:15], v[20:23], v[36:39]
ds_read_b128 v[20:23], v2 offset:5120
s_waitcnt lgkmcnt(2)
v_mfma_f32_16x16x32_bf16 v[32:35], a[16:19], v[24:27], v[32:35]
buffer_load_dwordx4 v2, s[8:11], s42 offen offset:1024 sc1 lds
v_mfma_f32_16x16x32_bf16 v[36:39], a[20:23], v[24:27], v[36:39]
ds_read_b128 v[24:27], v2 offset:6144
v_mfma_f32_16x16x32_bf16 v[32:35], a[24:27], v[28:31], v[32:35]
buffer_load_dwordx4 v2, s[8:11], s42 offen offset:2048 sc1 lds
v_mfma_f32_16x16x32_bf16 v[36:39], a[28:31], v[28:31], v[36:39]
ds_read_b128 v[28:31], v2 offset:7168
s_waitcnt lgkmcnt(2)
v_mfma_f32_16x16x32_bf16 v[32:35], a[32:35], v[16:19], v[32:35]
buffer_load_dwordx4 v2, s[8:11], s42 offen offset:3072 sc1 lds
v_mfma_f32_16x16x32_bf16 v[36:39], a[36:39], v[16:19], v[36:39]
ds_read_b128 v[16:19], v2 offset:8192
v_mfma_f32_16x16x32_bf16 v[32:35], a[40:43], v[20:23], v[32:35]
s_add_u32 s42, s42, 4096
s_add_u32 m0, s45, 59392
s_nop 0
buffer_load_dwordx4 v2, s[8:11], s42 offen offset:0 sc1 lds
v_mfma_f32_16x16x32_bf16 v[36:39], a[44:47], v[20:23], v[36:39]
ds_read_b128 v[20:23], v2 offset:9216
s_waitcnt lgkmcnt(2)
v_mfma_f32_16x16x32_bf16 v[32:35], a[48:51], v[24:27], v[32:35]
buffer_load_dwordx4 v2, s[8:11], s42 offen offset:1024 sc1 lds
v_mfma_f32_16x16x32_bf16 v[36:39], a[52:55], v[24:27], v[36:39]
ds_read_b128 v[24:27], v2 offset:10240
v_mfma_f32_16x16x32_bf16 v[32:35], a[56:59], v[28:31], v[32:35]
v_mfma_f32_16x16x32_bf16 v[36:39], a[60:63], v[28:31], v[36:39]
ds_read_b128 v[28:31], v2 offset:11264
s_waitcnt lgkmcnt(2)
v_mfma_f32_16x16x32_bf16 v[32:35], a[64:67], v[16:19], v[32:35]
s_add_u32 s26, s36, 573440
s_waitcnt vmcnt(6)
v_mfma_f32_16x16x32_bf16 v[36:39], a[68:71], v[16:19], v[36:39]
ds_read_b128 v[16:19], v2 offset:12288
v_mov_b32 v12, v51
v_mfma_f32_16x16x32_bf16 v[32:35], a[72:75], v[20:23], v[32:35]
buffer_load_dwordx4 v2, s[8:11], s42 offen offset:2048 sc1 lds
v_mfma_f32_16x16x32_bf16 v[36:39], a[76:79], v[20:23], v[36:39]
ds_read_b128 v[20:23], v2 offset:13312
s_waitcnt lgkmcnt(2)
v_mfma_f32_16x16x32_bf16 v[32:35], a[80:83], v[24:27], v[32:35]
v_mov_b32 v13, v55
v_mfma_f32_16x16x32_bf16 v[36:39], a[84:87], v[24:27], v[36:39]
ds_read_b128 v[24:27], v2 offset:14336
v_mfma_f32_16x16x32_bf16 v[32:35], a[88:91], v[28:31], v[32:35]
buffer_store_dwordx4 v[12:15], v5, s[4:7], s26 offen sc1
v_mfma_f32_16x16x32_bf16 v[36:39], a[92:95], v[28:31], v[36:39]
ds_read_b128 v[28:31], v2 offset:15360
s_waitcnt lgkmcnt(2)
v_mfma_f32_16x16x32_bf16 v[32:35], a[96:99], v[16:19], v[32:35]
v_mfma_f32_16x16x32_bf16 v[36:39], a[100:103], v[16:19], v[36:39]
ds_read_b128 v[16:19], v2 offset:16384
v_mfma_f32_16x16x32_bf16 v[32:35], a[104:107], v[20:23], v[32:35]
buffer_load_dwordx4 v2, s[8:11], s42 offen offset:3072 sc1 lds
v_mfma_f32_16x16x32_bf16 v[36:39], a[108:111], v[20:23], v[36:39]
ds_read_b128 v[20:23], v2 offset:17408
s_waitcnt lgkmcnt(2)
v_mfma_f32_16x16x32_bf16 v[32:35], a[112:115], v[24:27], v[32:35]
v_mfma_f32_16x16x32_bf16 v[36:39], a[116:119], v[24:27], v[36:39]
ds_read_b128 v[24:27], v2 offset:18432
v_mfma_f32_16x16x32_bf16 v[32:35], a[120:123], v[28:31], v[32:35]
s_add_u32 s42, s42, 4096
s_add_u32 m0, s45, 63488
s_nop 0
buffer_load_dwordx4 v2, s[8:11], s42 offen offset:0 sc1 lds
v_mfma_f32_16x16x32_bf16 v[36:39], a[124:127], v[28:31], v[36:39]
ds_read_b128 v[28:31], v2 offset:19456
s_waitcnt lgkmcnt(2)
v_mfma_f32_16x16x32_bf16 v[32:35], a[128:131], v[16:19], v[32:35]
v_mfma_f32_16x16x32_bf16 v[36:39], a[132:135], v[16:19], v[36:39]
ds_read_b128 v[16:19], v2 offset:20480
v_mfma_f32_16x16x32_bf16 v[32:35], a[136:139], v[20:23], v[32:35]
v_mfma_f32_16x16x32_bf16 v[36:39], a[140:143], v[20:23], v[36:39]
ds_read_b128 v[20:23], v2 offset:21504
s_waitcnt lgkmcnt(2)
v_mfma_f32_16x16x32_bf16 v[32:35], a[144:147], v[24:27], v[32:35]
buffer_load_dwordx4 v2, s[8:11], s42 offen offset:1024 sc1 lds
v_mfma_f32_16x16x32_bf16 v[36:39], a[148:151], v[24:27], v[36:39]
ds_read_b128 v[24:27], v2 offset:22528
v_mfma_f32_16x16x32_bf16 v[32:35], a[152:155], v[28:31], v[32:35]
v_mfma_f32_16x16x32_bf16 v[36:39], a[156:159], v[28:31], v[36:39]
ds_read_b128 v[28:31], v2 offset:23552
s_waitcnt lgkmcnt(2)
v_mfma_f32_16x16x32_bf16 v[32:35], a[160:163], v[16:19], v[32:35]
buffer_load_dwordx4 v2, s[8:11], s42 offen offset:2048 sc1 lds
v_mfma_f32_16x16x32_bf16 v[36:39], a[164:167], v[16:19], v[36:39]
ds_read_b128 v[16:19], v2 offset:24576
v_mfma_f32_16x16x32_bf16 v[32:35], a[168:171], v[20:23], v[32:35]
v_mfma_f32_16x16x32_bf16 v[36:39], a[172:175], v[20:23], v[36:39]
ds_read_b128 v[20:23], v2 offset:25600
s_waitcnt lgkmcnt(2)
v_mfma_f32_16x16x32_bf16 v[32:35], a[176:179], v[24:27], v[32:35]
buffer_load_dwordx4 v2, s[8:11], s42 offen offset:3072 sc1 lds
v_mfma_f32_16x16x32_bf16 v[36:39], a[180:183], v[24:27], v[36:39]
ds_read_b128 v[24:27], v2 offset:26624
v_mfma_f32_16x16x32_bf16 v[32:35], a[184:187], v[28:31], v[32:35]
v_mfma_f32_16x16x32_bf16 v[36:39], a[188:191], v[28:31], v[36:39]
ds_read_b128 v[28:31], v2 offset:27648
s_waitcnt lgkmcnt(2)
v_mfma_f32_16x16x32_bf16 v[32:35], a[192:195], v[16:19], v[32:35]
s_add_u32 s42, s42, 4096
s_add_u32 m0, s45, 67584
s_nop 0
buffer_load_dwordx4 v2, s[8:11], s42 offen offset:0 sc1 lds
v_mfma_f32_16x16x32_bf16 v[36:39], a[196:199], v[16:19], v[36:39]
ds_read_b128 v[16:19], v2 offset:28672
v_mfma_f32_16x16x32_bf16 v[32:35], a[200:203], v[20:23], v[32:35]
v_mfma_f32_16x16x32_bf16 v[36:39], a[204:207], v[20:23], v[36:39]
ds_read_b128 v[20:23], v2 offset:29696
s_waitcnt lgkmcnt(2)
v_mfma_f32_16x16x32_bf16 v[32:35], a[208:211], v[24:27], v[32:35]
v_mfma_f32_16x16x32_bf16 v[36:39], a[212:215], v[24:27], v[36:39]
ds_read_b128 v[24:27], v2 offset:30720
v_mfma_f32_16x16x32_bf16 v[32:35], a[216:219], v[28:31], v[32:35]
buffer_load_dwordx4 v2, s[8:11], s42 offen offset:1024 sc1 lds
v_mfma_f32_16x16x32_bf16 v[36:39], a[220:223], v[28:31], v[36:39]
ds_read_b128 v[28:31], v2 offset:31744
s_waitcnt lgkmcnt(2)
v_mfma_f32_16x16x32_bf16 v[32:35], a[224:227], v[16:19], v[32:35]
v_mfma_f32_16x16x32_bf16 v[36:39], a[228:231], v[16:19], v[36:39]
ds_read_b128 v[16:19], v2 offset:32768
v_mfma_f32_16x16x32_bf16 v[32:35], a[232:235], v[20:23], v[32:35]
s_add_u32 s43, s31, 163840
buffer_load_dword v59, v9, s[4:7], s43 offen sc1
v_mfma_f32_16x16x32_bf16 v[36:39], a[236:239], v[20:23], v[36:39]
ds_read_b128 v[20:23], v2 offset:33792
s_waitcnt lgkmcnt(2)
v_mfma_f32_16x16x32_bf16 v[32:35], a[240:243], v[24:27], v[32:35]
v_mfma_f32_16x16x32_bf16 v[36:39], a[244:247], v[24:27], v[36:39]
ds_read_b128 v[24:27], v2 offset:34816
v_mfma_f32_16x16x32_bf16 v[32:35], a[248:251], v[28:31], v[32:35]
v_mfma_f32_16x16x32_bf16 v[36:39], a[252:255], v[28:31], v[36:39]
ds_read_b128 v[28:31], v2 offset:35840
s_waitcnt lgkmcnt(2)
v_mfma_f32_16x16x32_bf16 v[32:35], v[80:83], v[16:19], v[32:35]
v_mfma_f32_16x16x32_bf16 v[36:39], v[84:87], v[16:19], v[36:39]
ds_read_b128 v[16:19], v2 offset:36864
v_mfma_f32_16x16x32_bf16 v[32:35], v[88:91], v[20:23], v[32:35]
v_mfma_f32_16x16x32_bf16 v[36:39], v[92:95], v[20:23], v[36:39]
ds_read_b128 v[20:23], v2 offset:37888
s_waitcnt lgkmcnt(2)
v_mfma_f32_16x16x32_bf16 v[32:35], v[96:99], v[24:27], v[32:35]
v_mfma_f32_16x16x32_bf16 v[36:39], v[100:103], v[24:27], v[36:39]
ds_read_b128 v[24:27], v2 offset:38912
v_mfma_f32_16x16x32_bf16 v[32:35], v[104:107], v[28:31], v[32:35]
v_mfma_f32_16x16x32_bf16 v[36:39], v[108:111], v[28:31], v[36:39]
ds_read_b128 v[28:31], v2 offset:39936
s_waitcnt lgkmcnt(2)
v_mfma_f32_16x16x32_bf16 v[32:35], v[112:115], v[16:19], v[32:35]
v_mfma_f32_16x16x32_bf16 v[36:39], v[116:119], v[16:19], v[36:39]
ds_read_b128 v[16:19], v2 offset:40960
v_mfma_f32_16x16x32_bf16 v[32:35], v[120:123], v[20:23], v[32:35]
v_mfma_f32_16x16x32_bf16 v[36:39], v[124:127], v[20:23], v[36:39]
ds_read_b128 v[20:23], v2 offset:41984
s_waitcnt lgkmcnt(2)
v_mfma_f32_16x16x32_bf16 v[32:35], v[128:131], v[24:27], v[32:35]
v_mfma_f32_16x16x32_bf16 v[36:39], v[132:135], v[24:27], v[36:39]
ds_read_b128 v[24:27], v2 offset:43008
v_mfma_f32_16x16x32_bf16 v[32:35], v[136:139], v[28:31], v[32:35]
v_mfma_f32_16x16x32_bf16 v[36:39], v[140:143], v[28:31], v[36:39]
ds_read_b128 v[28:31], v2 offset:44032
s_waitcnt lgkmcnt(2)
v_mfma_f32_16x16x32_bf16 v[32:35], v[144:147], v[16:19], v[32:35]
v_mfma_f32_16x16x32_bf16 v[36:39], v[148:151], v[16:19], v[36:39]
ds_read_b128 v[16:19], v2 offset:45056
v_mfma_f32_16x16x32_bf16 v[32:35], v[152:155], v[20:23], v[32:35]
v_mfma_f32_16x16x32_bf16 v[36:39], v[156:159], v[20:23], v[36:39]
ds_read_b128 v[20:23], v2 offset:46080
s_waitcnt lgkmcnt(2)
v_mfma_f32_16x16x32_bf16 v[32:35], v[160:163], v[24:27], v[32:35]
v_mfma_f32_16x16x32_bf16 v[36:39], v[164:167], v[24:27], v[36:39]
ds_read_b128 v[24:27], v2 offset:47104
v_mfma_f32_16x16x32_bf16 v[32:35], v[168:171], v[28:31], v[32:35]
v_mfma_f32_16x16x32_bf16 v[36:39], v[172:175], v[28:31], v[36:39]
ds_read_b128 v[28:31], v2 offset:48128
s_waitcnt lgkmcnt(2)
v_mfma_f32_16x16x32_bf16 v[32:35], v[176:179], v[16:19], v[32:35]
v_mfma_f32_16x16x32_bf16 v[36:39], v[180:183], v[16:19], v[36:39]
ds_read_b128 v[16:19], v2 offset:49152
v_mfma_f32_16x16x32_bf16 v[32:35], v[184:187], v[20:23], v[32:35]
v_mfma_f32_16x16x32_bf16 v[36:39], v[188:191], v[20:23], v[36:39]
ds_read_b128 v[20:23], v2 offset:50176
s_waitcnt lgkmcnt(2)
v_mfma_f32_16x16x32_bf16 v[32:35], v[192:195], v[24:27], v[32:35]
v_mfma_f32_16x16x32_bf16 v[36:39], v[196:199], v[24:27], v[36:39]
ds_read_b128 v[24:27], v2 offset:51200
v_mfma_f32_16x16x32_bf16 v[32:35], v[200:203], v[28:31], v[32:35]
v_mfma_f32_16x16x32_bf16 v[36:39], v[204:207], v[28:31], v[36:39]
ds_read_b128 v[28:31], v2 offset:52224
s_waitcnt lgkmcnt(2)
v_mfma_f32_16x16x32_bf16 v[32:35], v[208:211], v[16:19], v[32:35]
v_mfma_f32_16x16x32_bf16 v[36:39], v[212:215], v[16:19], v[36:39]
ds_read_b128 v[16:19], v2 offset:53248
v_mfma_f32_16x16x32_bf16 v[32:35], v[216:219], v[20:23], v[32:35]
v_mfma_f32_16x16x32_bf16 v[36:39], v[220:223], v[20:23], v[36:39]
ds_read_b128 v[20:23], v2 offset:54272
ds_read_b128 v[76:79], v8 offset:4096
s_waitcnt lgkmcnt(3)
v_mfma_f32_16x16x32_bf16 v[32:35], v[224:227], v[24:27], v[32:35]
s_waitcnt lgkmcnt(0)
v_lshlrev_b32 v40, 16, v76
v_and_b32 v41, 0xffff0000, v76
v_lshlrev_b32 v42, 16, v77
v_mfma_f32_16x16x32_bf16 v[36:39], v[228:231], v[24:27], v[36:39]
v_and_b32 v43, 0xffff0000, v77
v_lshlrev_b32 v44, 16, v78
v_and_b32 v45, 0xffff0000, v78
v_mfma_f32_16x16x32_bf16 v[32:35], v[232:235], v[28:31], v[32:35]
v_lshlrev_b32 v46, 16, v79
v_and_b32 v47, 0xffff0000, v79
v_mfma_f32_16x16x32_bf16 v[36:39], v[236:239], v[28:31], v[36:39]
s_cmp_eq_u32 s10, 0
s_cbranch_scc1 Lg2_falate8
Lg2_faret8:
s_waitcnt vmcnt(1) lgkmcnt(0)
s_barrier
ds_read_b128 v[24:27], v3 offset:0
ds_read_b128 v[28:31], v3 offset:1024
v_mfma_f32_16x16x32_bf16 v[32:35], v[240:243], v[16:19], v[32:35]
v_mfma_f32_16x16x32_bf16 v[36:39], v[244:247], v[16:19], v[36:39]
ds_read_b128 v[16:19], v3 offset:2048
v_mfma_f32_16x16x32_bf16 v[32:35], v[248:251], v[20:23], v[32:35]
v_mfma_f32_16x16x32_bf16 v[36:39], v[252:255], v[20:23], v[36:39]
ds_read_b128 v[20:23], v3 offset:3072
s_waitcnt lgkmcnt(2)
v_mfma_f32_16x16x32_bf16 v[40:43], a[0:3], v[24:27], v[40:43]
s_waitcnt vmcnt(0)
v_cmp_ne_u32 vcc, s20, v59
s_cmp_eq_u64 vcc, 0
s_cselect_b32 s10, 0x10000000, 0
v_mfma_f32_16x16x32_bf16 v[44:47], a[4:7], v[24:27], v[44:47]
ds_read_b128 v[24:27], v3 offset:4096
s_add_u32 s26, s37, 0
v_mfma_f32_16x16x32_bf16 v[40:43], a[8:11], v[28:31], v[40:43]
s_add_u32 s42, s30, 0x870000
s_add_u32 m0, s45, 0
s_nop 0
buffer_load_dwordx4 v2, s[8:11], s42 offen offset:0 sc1 lds
v_mfma_f32_16x16x32_bf16 v[44:47], a[12:15], v[28:31], v[44:47]
ds_read_b128 v[28:31], v3 offset:5120
s_waitcnt lgkmcnt(2)
v_mfma_f32_16x16x32_bf16 v[40:43], a[16:19], v[16:19], v[40:43]
buffer_load_dwordx4 v2, s[8:11], s42 offen offset:1024 sc1 lds
v_mfma_f32_16x16x32_bf16 v[44:47], a[20:23], v[16:19], v[44:47]
ds_read_b128 v[16:19], v3 offset:6144
v_cvt_pk_bf16_f32 v76, v32, v33
v_mfma_f32_16x16x32_bf16 v[40:43], a[24:27], v[20:23], v[40:43]
buffer_load_dwordx4 v2, s[8:11], s42 offen offset:2048 sc1 lds
v_mfma_f32_16x16x32_bf16 v[44:47], a[28:31], v[20:23], v[44:47]
ds_read_b128 v[20:23], v3 offset:7168
s_waitcnt lgkmcnt(2)
v_mfma_f32_16x16x32_bf16 v[40:43], a[32:35], v[24:27], v[40:43]
buffer_load_dwordx4 v2, s[8:11], s42 offen offset:3072 sc1 lds
v_mfma_f32_16x16x32_bf16 v[44:47], a[36:39], v[24:27], v[44:47]
ds_read_b128 v[24:27], v3 offset:8192
v_cvt_pk_bf16_f32 v77, v34, v35
v_mfma_f32_16x16x32_bf16 v[40:43], a[40:43], v[28:31], v[40:43]
s_add_u32 s42, s42, 4096
s_add_u32 m0, s45, 4096
s_nop 0
buffer_load_dwordx4 v2, s[8:11], s42 offen offset:0 sc1 lds
v_mfma_f32_16x16x32_bf16 v[44:47], a[44:47], v[28:31], v[44:47]
ds_read_b128 v[28:31], v3 offset:9216
s_waitcnt lgkmcnt(2)
v_mfma_f32_16x16x32_bf16 v[40:43], a[48:51], v[16:19], v[40:43]
buffer_load_dwordx4 v2, s[8:11], s42 offen offset:1024 sc1 lds
v_mfma_f32_16x16x32_bf16 v[44:47], a[52:55], v[16:19], v[44:47]
ds_read_b128 v[16:19], v3 offset:10240
v_cvt_pk_bf16_f32 v78, v36, v37
v_mfma_f32_16x16x32_bf16 v[40:43], a[56:59], v[20:23], v[40:43]
v_cvt_pk_bf16_f32 v79, v38, v39
v_mfma_f32_16x16x32_bf16 v[44:47], a[60:63], v[20:23], v[44:47]
ds_read_b128 v[20:23], v3 offset:11264
s_waitcnt lgkmcnt(2)
v_mfma_f32_16x16x32_bf16 v[40:43], a[64:67], v[24:27], v[40:43]
v_mfma_f32_16x16x32_bf16 v[44:47], a[68:71], v[24:27], v[44:47]
ds_read_b128 v[24:27], v3 offset:12288
v_mfma_f32_16x16x32_bf16 v[40:43], a[72:75], v[28:31], v[40:43]
buffer_load_dwordx4 v2, s[8:11], s42 offen offset:2048 sc1 lds
v_mfma_f32_16x16x32_bf16 v[44:47], a[76:79], v[28:31], v[44:47]
ds_read_b128 v[28:31], v3 offset:13312
s_waitcnt lgkmcnt(2)
v_mfma_f32_16x16x32_bf16 v[40:43], a[80:83], v[16:19], v[40:43]
v_mfma_f32_16x16x32_bf16 v[44:47], a[84:87], v[16:19], v[44:47]
ds_read_b128 v[16:19], v3 offset:14336
v_mfma_f32_16x16x32_bf16 v[40:43], a[88:91], v[20:23], v[40:43]
buffer_load_dwordx4 v2, s[8:11], s42 offen offset:3072 sc1 lds
v_mfma_f32_16x16x32_bf16 v[44:47], a[92:95], v[20:23], v[44:47]
ds_read_b128 v[20:23], v3 offset:15360
s_waitcnt lgkmcnt(2)
v_mfma_f32_16x16x32_bf16 v[40:43], a[96:99], v[24:27], v[40:43]
v_mfma_f32_16x16x32_bf16 v[44:47], a[100:103], v[24:27], v[44:47]
ds_read_b128 v[24:27], v3 offset:16384
v_mfma_f32_16x16x32_bf16 v[40:43], a[104:107], v[28:31], v[40:43]
s_add_u32 s42, s42, 4096
s_add_u32 m0, s45, 8192
s_nop 0
buffer_load_dwordx4 v2, s[8:11], s42 offen offset:0 sc1 lds
v_mfma_f32_16x16x32_bf16 v[44:47], a[108:111], v[28:31], v[44:47]
ds_read_b128 v[28:31], v3 offset:17408
s_waitcnt lgkmcnt(2)
v_mfma_f32_16x16x32_bf16 v[40:43], a[112:115], v[16:19], v[40:43]
v_mfma_f32_16x16x32_bf16 v[44:47], a[116:119], v[16:19], v[44:47]
ds_read_b128 v[16:19], v3 offset:18432
v_mfma_f32_16x16x32_bf16 v[40:43], a[120:123], v[20:23], v[40:43]
buffer_load_dwordx4 v2, s[8:11], s42 offen offset:1024 sc1 lds
v_mfma_f32_16x16x32_bf16 v[44:47], a[124:127], v[20:23], v[44:47]
ds_read_b128 v[20:23], v3 offset:19456
s_waitcnt lgkmcnt(2)
v_mfma_f32_16x16x32_bf16 v[40:43], a[128:131], v[24:27], v[40:43]
v_mfma_f32_16x16x32_bf16 v[44:47], a[132:135], v[24:27], v[44:47]
ds_read_b128 v[24:27], v3 offset:20480
v_mfma_f32_16x16x32_bf16 v[40:43], a[136:139], v[28:31], v[40:43]
v_mfma_f32_16x16x32_bf16 v[44:47], a[140:143], v[28:31], v[44:47]
ds_read_b128 v[28:31], v3 offset:21504
s_waitcnt lgkmcnt(2)
v_mfma_f32_16x16x32_bf16 v[40:43], a[144:147], v[16:19], v[40:43]
buffer_load_dwordx4 v2, s[8:11], s42 offen offset:2048 sc1 lds
v_mfma_f32_16x16x32_bf16 v[44:47], a[148:151], v[16:19], v[44:47]
ds_read_b128 v[16:19], v3 offset:22528
v_mfma_f32_16x16x32_bf16 v[40:43], a[152:155], v[20:23], v[40:43]
v_mfma_f32_16x16x32_bf16 v[44:47], a[156:159], v[20:23], v[44:47]
ds_read_b128 v[20:23], v3 offset:23552
s_waitcnt lgkmcnt(2)
v_mfma_f32_16x16x32_bf16 v[40:43], a[160:163], v[24:27], v[40:43]
buffer_load_dwordx4 v2, s[8:11], s42 offen offset:3072 sc1 lds
v_mfma_f32_16x16x32_bf16 v[44:47], a[164:167], v[24:27], v[44:47]
ds_read_b128 v[24:27], v3 offset:24576
v_mfma_f32_16x16x32_bf16 v[40:43], a[168:171], v[28:31], v[40:43]
v_mfma_f32_16x16x32_bf16 v[44:47], a[172:175], v[28:31], v[44:47]
ds_read_b128 v[28:31], v3 offset:25600
s_waitcnt lgkmcnt(2)
v_mfma_f32_16x16x32_bf16 v[40:43], a[176:179], v[16:19], v[40:43]
s_add_u32 s42, s42, 4096
s_add_u32 m0, s45, 12288
s_nop 0
buffer_load_dwordx4 v2, s[8:11], s42 offen offset:0 sc1 lds
v_mfma_f32_16x16x32_bf16 v[44:47], a[180:183], v[16:19], v[44:47]
ds_read_b128 v[16:19], v3 offset:26624
v_mfma_f32_16x16x32_bf16 v[40:43], a[184:187], v[20:23], v[40:43]
v_mfma_f32_16x16x32_bf16 v[44:47], a[188:191], v[20:23], v[44:47]
ds_read_b128 v[20:23], v3 offset:27648
s_waitcnt lgkmcnt(2)
v_mfma_f32_16x16x32_bf16 v[40:43], a[192:195], v[24:27], v[40:43]
v_mfma_f32_16x16x32_bf16 v[44:47], a[196:199], v[24:27], v[44:47]
ds_read_b128 v[24:27], v3 offset:28672
buffer_store_dwordx2 v[76:77], v4, s[12:15], s26 offen
v_mfma_f32_16x16x32_bf16 v[40:43], a[200:203], v[28:31], v[40:43]
v_mfma_f32_16x16x32_bf16 v[44:47], a[204:207], v[28:31], v[44:47]
ds_read_b128 v[28:31], v3 offset:29696
s_waitcnt lgkmcnt(2)
v_mfma_f32_16x16x32_bf16 v[40:43], a[208:211], v[16:19], v[40:43]
v_mfma_f32_16x16x32_bf16 v[44:47], a[212:215], v[16:19], v[44:47]
ds_read_b128 v[16:19], v3 offset:30720
v_mfma_f32_16x16x32_bf16 v[40:43], a[216:219], v[20:23], v[40:43]
v_mfma_f32_16x16x32_bf16 v[44:47], a[220:223], v[20:23], v[44:47]
ds_read_b128 v[20:23], v3 offset:31744
s_waitcnt lgkmcnt(2)
v_mfma_f32_16x16x32_bf16 v[40:43], a[224:227], v[24:27], v[40:43]
v_mfma_f32_16x16x32_bf16 v[44:47], a[228:231], v[24:27], v[44:47]
ds_read_b128 v[24:27], v3 offset:32768
v_mfma_f32_16x16x32_bf16 v[40:43], a[232:235], v[28:31], v[40:43]
v_mfma_f32_16x16x32_bf16 v[44:47], a[236:239], v[28:31], v[44:47]
ds_read_b128 v[28:31], v3 offset:33792
s_waitcnt lgkmcnt(2)
v_mfma_f32_16x16x32_bf16 v[40:43], a[240:243], v[16:19], v[40:43]
v_mfma_f32_16x16x32_bf16 v[44:47], a[244:247], v[16:19], v[44:47]
ds_read_b128 v[16:19], v3 offset:34816
v_mfma_f32_16x16x32_bf16 v[40:43], a[248:251], v[20:23], v[40:43]
v_mfma_f32_16x16x32_bf16 v[44:47], a[252:255], v[20:23], v[44:47]
ds_read_b128 v[20:23], v3 offset:35840
s_waitcnt lgkmcnt(2)
v_mfma_f32_16x16x32_bf16 v[40:43], v[80:83], v[24:27], v[40:43]
buffer_load_dwordx4 v2, s[8:11], s42 offen offset:1024 sc1 lds
v_mfma_f32_16x16x32_bf16 v[44:47], v[84:87], v[24:27], v[44:47]
ds_read_b128 v[24:27], v3 offset:36864
v_mfma_f32_16x16x32_bf16 v[40:43], v[88:91], v[28:31], v[40:43]
v_mfma_f32_16x16x32_bf16 v[44:47], v[92:95], v[28:31], v[44:47]
ds_read_b128 v[28:31], v3 offset:37888
s_waitcnt lgkmcnt(2)
v_mfma_f32_16x16x32_bf16 v[40:43], v[96:99], v[16:19], v[40:43]
v_mfma_f32_16x16x32_bf16 v[44:47], v[100:103], v[16:19], v[44:47]
ds_read_b128 v[16:19], v3 offset:38912
v_mfma_f32_16x16x32_bf16 v[40:43], v[104:107], v[20:23], v[40:43]
s_add_u32 s43, s31, 180224
buffer_load_dword v59, v9, s[4:7], s43 offen sc1
v_mfma_f32_16x16x32_bf16 v[44:47], v[108:111], v[20:23], v[44:47]
ds_read_b128 v[20:23], v3 offset:39936
s_waitcnt lgkmcnt(2)
v_mfma_f32_16x16x32_bf16 v[40:43], v[112:115], v[24:27], v[40:43]
buffer_store_dwordx2 v[78:79], v4, s[12:15], s26 offen offset:32
v_mfma_f32_16x16x32_bf16 v[44:47], v[116:119], v[24:27], v[44:47]
ds_read_b128 v[24:27], v3 offset:40960
v_mfma_f32_16x16x32_bf16 v[40:43], v[120:123], v[28:31], v[40:43]
v_mfma_f32_16x16x32_bf16 v[44:47], v[124:127], v[28:31], v[44:47]
ds_read_b128 v[28:31], v3 offset:41984
s_waitcnt lgkmcnt(2)
v_mfma_f32_16x16x32_bf16 v[40:43], v[128:131], v[16:19], v[40:43]
v_mfma_f32_16x16x32_bf16 v[44:47], v[132:135], v[16:19], v[44:47]
ds_read_b128 v[16:19], v3 offset:43008
v_mfma_f32_16x16x32_bf16 v[40:43], v[136:139], v[20:23], v[40:43]
v_mfma_f32_16x16x32_bf16 v[44:47], v[140:143], v[20:23], v[44:47]
ds_read_b128 v[20:23], v3 offset:44032
s_waitcnt lgkmcnt(2)
v_mfma_f32_16x16x32_bf16 v[40:43], v[144:147], v[24:27], v[40:43]
v_mfma_f32_16x16x32_bf16 v[44:47], v[148:151], v[24:27], v[44:47]
ds_read_b128 v[24:27], v3 offset:45056
v_mfma_f32_16x16x32_bf16 v[40:43], v[152:155], v[28:31], v[40:43]
v_mfma_f32_16x16x32_bf16 v[44:47], v[156:159], v[28:31], v[44:47]
ds_read_b128 v[28:31], v3 offset:46080
s_waitcnt lgkmcnt(2)
v_mfma_f32_16x16x32_bf16 v[40:43], v[160:163], v[16:19], v[40:43]
v_mfma_f32_16x16x32_bf16 v[44:47], v[164:167], v[16:19], v[44:47]
ds_read_b128 v[16:19], v3 offset:47104
v_mfma_f32_16x16x32_bf16 v[40:43], v[168:171], v[20:23], v[40:43]
v_mfma_f32_16x16x32_bf16 v[44:47], v[172:175], v[20:23], v[44:47]
ds_read_b128 v[20:23], v3 offset:48128
s_waitcnt lgkmcnt(2)
v_mfma_f32_16x16x32_bf16 v[40:43], v[176:179], v[24:27], v[40:43]
v_mfma_f32_16x16x32_bf16 v[44:47], v[180:183], v[24:27], v[44:47]
ds_read_b128 v[24:27], v3 offset:49152
v_mfma_f32_16x16x32_bf16 v[40:43], v[184:187], v[28:31], v[40:43]
v_mfma_f32_16x16x32_bf16 v[44:47], v[188:191], v[28:31], v[44:47]
ds_read_b128 v[28:31], v3 offset:50176
s_waitcnt lgkmcnt(2)
v_mfma_f32_16x16x32_bf16 v[40:43], v[192:195], v[16:19], v[40:43]
v_mfma_f32_16x16x32_bf16 v[44:47], v[196:199], v[16:19], v[44:47]
ds_read_b128 v[16:19], v3 offset:51200
v_mfma_f32_16x16x32_bf16 v[40:43], v[200:203], v[20:23], v[40:43]
v_mfma_f32_16x16x32_bf16 v[44:47], v[204:207], v[20:23], v[44:47]
ds_read_b128 v[20:23], v3 offset:52224
s_waitcnt lgkmcnt(2)
v_mfma_f32_16x16x32_bf16 v[40:43], v[208:211], v[24:27], v[40:43]
v_mfma_f32_16x16x32_bf16 v[44:47], v[212:215], v[24:27], v[44:47]
ds_read_b128 v[24:27], v3 offset:53248
v_mfma_f32_16x16x32_bf16 v[40:43], v[216:219], v[28:31], v[40:43]
v_mfma_f32_16x16x32_bf16 v[44:47], v[220:223], v[28:31], v[44:47]
ds_read_b128 v[28:31], v3 offset:54272
ds_read_b128 v[76:79], v8 offset:8192
s_waitcnt lgkmcnt(3)
v_mfma_f32_16x16x32_bf16 v[40:43], v[224:227], v[16:19], v[40:43]
s_waitcnt lgkmcnt(0)
v_lshlrev_b32 v32, 16, v76
v_and_b32 v33, 0xffff0000, v76
v_lshlrev_b32 v34, 16, v77
v_mfma_f32_16x16x32_bf16 v[44:47], v[228:231], v[16:19], v[44:47]
v_and_b32 v35, 0xffff0000, v77
v_lshlrev_b32 v36, 16, v78
v_and_b32 v37, 0xffff0000, v78
v_mfma_f32_16x16x32_bf16 v[40:43], v[232:235], v[20:23], v[40:43]
v_lshlrev_b32 v38, 16, v79
v_and_b32 v39, 0xffff0000, v79
v_mfma_f32_16x16x32_bf16 v[44:47], v[236:239], v[20:23], v[44:47]
s_cmp_eq_u32 s10, 0
s_cbranch_scc1 Lg2_falate9
Lg2_faret9:
s_waitcnt vmcnt(2) lgkmcnt(0)
s_barrier
ds_read_b128 v[16:19], v2 offset:0
ds_read_b128 v[20:23], v2 offset:1024
v_mfma_f32_16x16x32_bf16 v[40:43], v[240:243], v[24:27], v[40:43]
v_mfma_f32_16x16x32_bf16 v[44:47], v[244:247], v[24:27], v[44:47]
ds_read_b128 v[24:27], v2 offset:2048
v_mfma_f32_16x16x32_bf16 v[40:43], v[248:251], v[28:31], v[40:43]
v_mfma_f32_16x16x32_bf16 v[44:47], v[252:255], v[28:31], v[44:47]
ds_read_b128 v[28:31], v2 offset:3072
s_waitcnt lgkmcnt(2)
v_mfma_f32_16x16x32_bf16 v[32:35], a[0:3], v[16:19], v[32:35]
s_waitcnt vmcnt(1)
v_cmp_ne_u32 vcc, s20, v59
s_cmp_eq_u64 vcc, 0
s_cselect_b32 s10, 0x10000000, 0
v_mfma_f32_16x16x32_bf16 v[36:39], a[4:7], v[16:19], v[36:39]
ds_read_b128 v[16:19], v2 offset:4096
s_add_u32 s26, s37, 327680
v_mfma_f32_16x16x32_bf16 v[32:35], a[8:11], v[20:23], v[32:35]
s_add_u32 s42, s30, 0x948000
s_add_u32 m0, s45, 55296
s_nop 0
buffer_load_dwordx4 v2, s[8:11], s42 offen offset:0 sc1 lds
v_mfma_f32_16x16x32_bf16 v[36:39], a[12:15], v[20:23], v[36:39]
ds_read_b128 v[20:23], v2 offset:5120
s_waitcnt lgkmcnt(2)
v_mfma_f32_16x16x32_bf16 v[32:35], a[16:19], v[24:27], v[32:35]
buffer_load_dwordx4 v2, s[8:11], s42 offen offset:1024 sc1 lds
v_mfma_f32_16x16x32_bf16 v[36:39], a[20:23], v[24:27], v[36:39]
ds_read_b128 v[24:27], v2 offset:6144
v_cvt_pk_bf16_f32 v76, v40, v41
v_mfma_f32_16x16x32_bf16 v[32:35], a[24:27], v[28:31], v[32:35]
buffer_load_dwordx4 v2, s[8:11], s42 offen offset:2048 sc1 lds
v_mfma_f32_16x16x32_bf16 v[36:39], a[28:31], v[28:31], v[36:39]
ds_read_b128 v[28:31], v2 offset:7168
s_waitcnt lgkmcnt(2)
v_mfma_f32_16x16x32_bf16 v[32:35], a[32:35], v[16:19], v[32:35]
buffer_load_dwordx4 v2, s[8:11], s42 offen offset:3072 sc1 lds
v_mfma_f32_16x16x32_bf16 v[36:39], a[36:39], v[16:19], v[36:39]
ds_read_b128 v[16:19], v2 offset:8192
v_cvt_pk_bf16_f32 v77, v42, v43
v_mfma_f32_16x16x32_bf16 v[32:35], a[40:43], v[20:23], v[32:35]
s_add_u32 s42, s42, 4096
s_add_u32 m0, s45, 59392
s_nop 0
buffer_load_dwordx4 v2, s[8:11], s42 offen offset:0 sc1 lds
v_mfma_f32_16x16x32_bf16 v[36:39], a[44:47], v[20:23], v[36:39]
ds_read_b128 v[20:23], v2 offset:9216
s_waitcnt lgkmcnt(2)
v_mfma_f32_16x16x32_bf16 v[32:35], a[48:51], v[24:27], v[32:35]
buffer_load_dwordx4 v2, s[8:11], s42 offen offset:1024 sc1 lds
v_mfma_f32_16x16x32_bf16 v[36:39], a[52:55], v[24:27], v[36:39]
ds_read_b128 v[24:27], v2 offset:10240
v_cvt_pk_bf16_f32 v78, v44, v45
v_mfma_f32_16x16x32_bf16 v[32:35], a[56:59], v[28:31], v[32:35]
v_cvt_pk_bf16_f32 v79, v46, v47
v_mfma_f32_16x16x32_bf16 v[36:39], a[60:63], v[28:31], v[36:39]
ds_read_b128 v[28:31], v2 offset:11264
s_waitcnt lgkmcnt(2)
v_mfma_f32_16x16x32_bf16 v[32:35], a[64:67], v[16:19], v[32:35]
v_mfma_f32_16x16x32_bf16 v[36:39], a[68:71], v[16:19], v[36:39]
ds_read_b128 v[16:19], v2 offset:12288
v_mfma_f32_16x16x32_bf16 v[32:35], a[72:75], v[20:23], v[32:35]
buffer_load_dwordx4 v2, s[8:11], s42 offen offset:2048 sc1 lds
v_mfma_f32_16x16x32_bf16 v[36:39], a[76:79], v[20:23], v[36:39]
ds_read_b128 v[20:23], v2 offset:13312
s_waitcnt lgkmcnt(2)
v_mfma_f32_16x16x32_bf16 v[32:35], a[80:83], v[24:27], v[32:35]
v_mfma_f32_16x16x32_bf16 v[36:39], a[84:87], v[24:27], v[36:39]
ds_read_b128 v[24:27], v2 offset:14336
v_mfma_f32_16x16x32_bf16 v[32:35], a[88:91], v[28:31], v[32:35]
buffer_load_dwordx4 v2, s[8:11], s42 offen offset:3072 sc1 lds
v_mfma_f32_16x16x32_bf16 v[36:39], a[92:95], v[28:31], v[36:39]
ds_read_b128 v[28:31], v2 offset:15360
s_waitcnt lgkmcnt(2)
v_mfma_f32_16x16x32_bf16 v[32:35], a[96:99], v[16:19], v[32:35]
v_mfma_f32_16x16x32_bf16 v[36:39], a[100:103], v[16:19], v[36:39]
ds_read_b128 v[16:19], v2 offset:16384
v_mfma_f32_16x16x32_bf16 v[32:35], a[104:107], v[20:23], v[32:35]
s_add_u32 s42, s42, 4096
s_add_u32 m0, s45, 63488
s_nop 0
buffer_load_dwordx4 v2, s[8:11], s42 offen offset:0 sc1 lds
v_mfma_f32_16x16x32_bf16 v[36:39], a[108:111], v[20:23], v[36:39]
ds_read_b128 v[20:23], v2 offset:17408
s_waitcnt lgkmcnt(2)
v_mfma_f32_16x16x32_bf16 v[32:35], a[112:115], v[24:27], v[32:35]
v_mfma_f32_16x16x32_bf16 v[36:39], a[116:119], v[24:27], v[36:39]
ds_read_b128 v[24:27], v2 offset:18432
v_mfma_f32_16x16x32_bf16 v[32:35], a[120:123], v[28:31], v[32:35]
buffer_load_dwordx4 v2, s[8:11], s42 offen offset:1024 sc1 lds
v_mfma_f32_16x16x32_bf16 v[36:39], a[124:127], v[28:31], v[36:39]
ds_read_b128 v[28:31], v2 offset:19456
s_waitcnt lgkmcnt(2)
v_mfma_f32_16x16x32_bf16 v[32:35], a[128:131], v[16:19], v[32:35]
v_mfma_f32_16x16x32_bf16 v[36:39], a[132:135], v[16:19], v[36:39]
ds_read_b128 v[16:19], v2 offset:20480
v_mfma_f32_16x16x32_bf16 v[32:35], a[136:139], v[20:23], v[32:35]
v_mfma_f32_16x16x32_bf16 v[36:39], a[140:143], v[20:23], v[36:39]
ds_read_b128 v[20:23], v2 offset:21504
s_waitcnt lgkmcnt(2)
v_mfma_f32_16x16x32_bf16 v[32:35], a[144:147], v[24:27], v[32:35]
buffer_load_dwordx4 v2, s[8:11], s42 offen offset:2048 sc1 lds
v_mfma_f32_16x16x32_bf16 v[36:39], a[148:151], v[24:27], v[36:39]
ds_read_b128 v[24:27], v2 offset:22528
v_mfma_f32_16x16x32_bf16 v[32:35], a[152:155], v[28:31], v[32:35]
v_mfma_f32_16x16x32_bf16 v[36:39], a[156:159], v[28:31], v[36:39]
ds_read_b128 v[28:31], v2 offset:23552
s_waitcnt lgkmcnt(2)
v_mfma_f32_16x16x32_bf16 v[32:35], a[160:163], v[16:19], v[32:35]
buffer_load_dwordx4 v2, s[8:11], s42 offen offset:3072 sc1 lds
v_mfma_f32_16x16x32_bf16 v[36:39], a[164:167], v[16:19], v[36:39]
ds_read_b128 v[16:19], v2 offset:24576
v_mfma_f32_16x16x32_bf16 v[32:35], a[168:171], v[20:23], v[32:35]
v_mfma_f32_16x16x32_bf16 v[36:39], a[172:175], v[20:23], v[36:39]
ds_read_b128 v[20:23], v2 offset:25600
s_waitcnt lgkmcnt(2)
v_mfma_f32_16x16x32_bf16 v[32:35], a[176:179], v[24:27], v[32:35]
s_add_u32 s42, s42, 4096
s_add_u32 m0, s45, 67584
s_nop 0
buffer_load_dwordx4 v2, s[8:11], s42 offen offset:0 sc1 lds
v_mfma_f32_16x16x32_bf16 v[36:39], a[180:183], v[24:27], v[36:39]
ds_read_b128 v[24:27], v2 offset:26624
v_mfma_f32_16x16x32_bf16 v[32:35], a[184:187], v[28:31], v[32:35]
v_mfma_f32_16x16x32_bf16 v[36:39], a[188:191], v[28:31], v[36:39]
ds_read_b128 v[28:31], v2 offset:27648
s_waitcnt lgkmcnt(2)
v_mfma_f32_16x16x32_bf16 v[32:35], a[192:195], v[16:19], v[32:35]
v_mfma_f32_16x16x32_bf16 v[36:39], a[196:199], v[16:19], v[36:39]
ds_read_b128 v[16:19], v2 offset:28672
buffer_store_dwordx2 v[76:77], v4, s[12:15], s26 offen
v_mfma_f32_16x16x32_bf16 v[32:35], a[200:203], v[20:23], v[32:35]
v_mfma_f32_16x16x32_bf16 v[36:39], a[204:207], v[20:23], v[36:39]
ds_read_b128 v[20:23], v2 offset:29696
s_waitcnt lgkmcnt(2)
v_mfma_f32_16x16x32_bf16 v[32:35], a[208:211], v[24:27], v[32:35]
v_mfma_f32_16x16x32_bf16 v[36:39], a[212:215], v[24:27], v[36:39]
ds_read_b128 v[24:27], v2 offset:30720
v_mfma_f32_16x16x32_bf16 v[32:35], a[216:219], v[28:31], v[32:35]
v_mfma_f32_16x16x32_bf16 v[36:39], a[220:223], v[28:31], v[36:39]
ds_read_b128 v[28:31], v2 offset:31744
s_waitcnt lgkmcnt(2)
v_mfma_f32_16x16x32_bf16 v[32:35], a[224:227], v[16:19], v[32:35]
v_mfma_f32_16x16x32_bf16 v[36:39], a[228:231], v[16:19], v[36:39]
ds_read_b128 v[16:19], v2 offset:32768
v_mfma_f32_16x16x32_bf16 v[32:35], a[232:235], v[20:23], v[32:35]
v_mfma_f32_16x16x32_bf16 v[36:39], a[236:239], v[20:23], v[36:39]
ds_read_b128 v[20:23], v2 offset:33792
s_waitcnt lgkmcnt(2)
v_mfma_f32_16x16x32_bf16 v[32:35], a[240:243], v[24:27], v[32:35]
v_mfma_f32_16x16x32_bf16 v[36:39], a[244:247], v[24:27], v[36:39]
ds_read_b128 v[24:27], v2 offset:34816
v_mfma_f32_16x16x32_bf16 v[32:35], a[248:251], v[28:31], v[32:35]
v_mfma_f32_16x16x32_bf16 v[36:39], a[252:255], v[28:31], v[36:39]
ds_read_b128 v[28:31], v2 offset:35840
s_waitcnt lgkmcnt(2)
v_mfma_f32_16x16x32_bf16 v[32:35], v[80:83], v[16:19], v[32:35]
buffer_load_dwordx4 v2, s[8:11], s42 offen offset:1024 sc1 lds
v_mfma_f32_16x16x32_bf16 v[36:39], v[84:87], v[16:19], v[36:39]
ds_read_b128 v[16:19], v2 offset:36864
v_mfma_f32_16x16x32_bf16 v[32:35], v[88:91], v[20:23], v[32:35]
v_mfma_f32_16x16x32_bf16 v[36:39], v[92:95], v[20:23], v[36:39]
ds_read_b128 v[20:23], v2 offset:37888
s_waitcnt lgkmcnt(2)
v_mfma_f32_16x16x32_bf16 v[32:35], v[96:99], v[24:27], v[32:35]
v_mfma_f32_16x16x32_bf16 v[36:39], v[100:103], v[24:27], v[36:39]
ds_read_b128 v[24:27], v2 offset:38912
v_mfma_f32_16x16x32_bf16 v[32:35], v[104:107], v[28:31], v[32:35]
s_add_u32 s43, s31, 196608
buffer_load_dword v59, v9, s[4:7], s43 offen sc1
v_mfma_f32_16x16x32_bf16 v[36:39], v[108:111], v[28:31], v[36:39]
ds_read_b128 v[28:31], v2 offset:39936
s_waitcnt lgkmcnt(2)
v_mfma_f32_16x16x32_bf16 v[32:35], v[112:115], v[16:19], v[32:35]
buffer_store_dwordx2 v[78:79], v4, s[12:15], s26 offen offset:32
v_mfma_f32_16x16x32_bf16 v[36:39], v[116:119], v[16:19], v[36:39]
ds_read_b128 v[16:19], v2 offset:40960
v_mfma_f32_16x16x32_bf16 v[32:35], v[120:123], v[20:23], v[32:35]
v_mfma_f32_16x16x32_bf16 v[36:39], v[124:127], v[20:23], v[36:39]
ds_read_b128 v[20:23], v2 offset:41984
s_waitcnt lgkmcnt(2)
v_mfma_f32_16x16x32_bf16 v[32:35], v[128:131], v[24:27], v[32:35]
v_mfma_f32_16x16x32_bf16 v[36:39], v[132:135], v[24:27], v[36:39]
ds_read_b128 v[24:27], v2 offset:43008
v_mfma_f32_16x16x32_bf16 v[32:35], v[136:139], v[28:31], v[32:35]
v_mfma_f32_16x16x32_bf16 v[36:39], v[140:143], v[28:31], v[36:39]
ds_read_b128 v[28:31], v2 offset:44032
s_waitcnt lgkmcnt(2)
v_mfma_f32_16x16x32_bf16 v[32:35], v[144:147], v[16:19], v[32:35]
v_mfma_f32_16x16x32_bf16 v[36:39], v[148:151], v[16:19], v[36:39]
ds_read_b128 v[16:19], v2 offset:45056
v_mfma_f32_16x16x32_bf16 v[32:35], v[152:155], v[20:23], v[32:35]
v_mfma_f32_16x16x32_bf16 v[36:39], v[156:159], v[20:23], v[36:39]
ds_read_b128 v[20:23], v2 offset:46080
s_waitcnt lgkmcnt(2)
v_mfma_f32_16x16x32_bf16 v[32:35], v[160:163], v[24:27], v[32:35]
v_mfma_f32_16x16x32_bf16 v[36:39], v[164:167], v[24:27], v[36:39]
ds_read_b128 v[24:27], v2 offset:47104
v_mfma_f32_16x16x32_bf16 v[32:35], v[168:171], v[28:31], v[32:35]
v_mfma_f32_16x16x32_bf16 v[36:39], v[172:175], v[28:31], v[36:39]
ds_read_b128 v[28:31], v2 offset:48128
s_waitcnt lgkmcnt(2)
v_mfma_f32_16x16x32_bf16 v[32:35], v[176:179], v[16:19], v[32:35]
v_mfma_f32_16x16x32_bf16 v[36:39], v[180:183], v[16:19], v[36:39]
ds_read_b128 v[16:19], v2 offset:49152
v_mfma_f32_16x16x32_bf16 v[32:35], v[184:187], v[20:23], v[32:35]
v_mfma_f32_16x16x32_bf16 v[36:39], v[188:191], v[20:23], v[36:39]
ds_read_b128 v[20:23], v2 offset:50176
s_waitcnt lgkmcnt(2)
v_mfma_f32_16x16x32_bf16 v[32:35], v[192:195], v[24:27], v[32:35]
v_mfma_f32_16x16x32_bf16 v[36:39], v[196:199], v[24:27], v[36:39]
ds_read_b128 v[24:27], v2 offset:51200
v_mfma_f32_16x16x32_bf16 v[32:35], v[200:203], v[28:31], v[32:35]
v_mfma_f32_16x16x32_bf16 v[36:39], v[204:207], v[28:31], v[36:39]
ds_read_b128 v[28:31], v2 offset:52224
s_waitcnt lgkmcnt(2)
v_mfma_f32_16x16x32_bf16 v[32:35], v[208:211], v[16:19], v[32:35]
v_mfma_f32_16x16x32_bf16 v[36:39], v[212:215], v[16:19], v[36:39]
ds_read_b128 v[16:19], v2 offset:53248
v_mfma_f32_16x16x32_bf16 v[32:35], v[216:219], v[20:23], v[32:35]
v_mfma_f32_16x16x32_bf16 v[36:39], v[220:223], v[20:23], v[36:39]
ds_read_b128 v[20:23], v2 offset:54272
ds_read_b128 v[76:79], v8 offset:12288
s_waitcnt lgkmcnt(3)
v_mfma_f32_16x16x32_bf16 v[32:35], v[224:227], v[24:27], v[32:35]
s_waitcnt lgkmcnt(0)
v_lshlrev_b32 v40, 16, v76
v_and_b32 v41, 0xffff0000, v76
v_lshlrev_b32 v42, 16, v77
v_mfma_f32_16x16x32_bf16 v[36:39], v[228:231], v[24:27], v[36:39]
v_and_b32 v43, 0xffff0000, v77
v_lshlrev_b32 v44, 16, v78
v_and_b32 v45, 0xffff0000, v78
v_mfma_f32_16x16x32_bf16 v[32:35], v[232:235], v[28:31], v[32:35]
v_lshlrev_b32 v46, 16, v79
v_and_b32 v47, 0xffff0000, v79
v_mfma_f32_16x16x32_bf16 v[36:39], v[236:239], v[28:31], v[36:39]
s_cmp_eq_u32 s10, 0
s_cbranch_scc1 Lg2_falate10
Lg2_faret10:
s_waitcnt vmcnt(2) lgkmcnt(0)
s_barrier
ds_read_b128 v[24:27], v3 offset:0
ds_read_b128 v[28:31], v3 offset:1024
v_mfma_f32_16x16x32_bf16 v[32:35], v[240:243], v[16:19], v[32:35]
v_mfma_f32_16x16x32_bf16 v[36:39], v[244:247], v[16:19], v[36:39]
ds_read_b128 v[16:19], v3 offset:2048
v_mfma_f32_16x16x32_bf16 v[32:35], v[248:251], v[20:23], v[32:35]
v_mfma_f32_16x16x32_bf16 v[36:39], v[252:255], v[20:23], v[36:39]
ds_read_b128 v[20:23], v3 offset:3072
s_waitcnt lgkmcnt(2)
v_mfma_f32_16x16x32_bf16 v[40:43], a[0:3], v[24:27], v[40:43]
s_waitcnt vmcnt(1)
v_cmp_ne_u32 vcc, s20, v59
s_cmp_eq_u64 vcc, 0
s_cselect_b32 s10, 0x10000000, 0
v_mfma_f32_16x16x32_bf16 v[44:47], a[4:7], v[24:27], v[44:47]
ds_read_b128 v[24:27], v3 offset:4096
s_add_u32 s26, s37, 655360
v_mfma_f32_16x16x32_bf16 v[40:43], a[8:11], v[28:31], v[40:43]
s_add_u32 s42, s30, 0xa20000
s_add_u32 m0, s45, 0
s_nop 0
buffer_load_dwordx4 v2, s[8:11], s42 offen offset:0 sc1 lds
v_mfma_f32_16x16x32_bf16 v[44:47], a[12:15], v[28:31], v[44:47]
ds_read_b128 v[28:31], v3 offset:5120
s_waitcnt lgkmcnt(2)
v_mfma_f32_16x16x32_bf16 v[40:43], a[16:19], v[16:19], v[40:43]
buffer_load_dwordx4 v2, s[8:11], s42 offen offset:1024 sc1 lds
v_mfma_f32_16x16x32_bf16 v[44:47], a[20:23], v[16:19], v[44:47]
ds_read_b128 v[16:19], v3 offset:6144
v_cvt_pk_bf16_f32 v76, v32, v33
v_mfma_f32_16x16x32_bf16 v[40:43], a[24:27], v[20:23], v[40:43]
buffer_load_dwordx4 v2, s[8:11], s42 offen offset:2048 sc1 lds
v_mfma_f32_16x16x32_bf16 v[44:47], a[28:31], v[20:23], v[44:47]
ds_read_b128 v[20:23], v3 offset:7168
s_waitcnt lgkmcnt(2)
v_mfma_f32_16x16x32_bf16 v[40:43], a[32:35], v[24:27], v[40:43]
buffer_load_dwordx4 v2, s[8:11], s42 offen offset:3072 sc1 lds
v_mfma_f32_16x16x32_bf16 v[44:47], a[36:39], v[24:27], v[44:47]
ds_read_b128 v[24:27], v3 offset:8192
v_cvt_pk_bf16_f32 v77, v34, v35
v_mfma_f32_16x16x32_bf16 v[40:43], a[40:43], v[28:31], v[40:43]
s_add_u32 s42, s42, 4096
s_add_u32 m0, s45, 4096
s_nop 0
buffer_load_dwordx4 v2, s[8:11], s42 offen offset:0 sc1 lds
v_mfma_f32_16x16x32_bf16 v[44:47], a[44:47], v[28:31], v[44:47]
ds_read_b128 v[28:31], v3 offset:9216
s_waitcnt lgkmcnt(2)
v_mfma_f32_16x16x32_bf16 v[40:43], a[48:51], v[16:19], v[40:43]
buffer_load_dwordx4 v2, s[8:11], s42 offen offset:1024 sc1 lds
v_mfma_f32_16x16x32_bf16 v[44:47], a[52:55], v[16:19], v[44:47]
ds_read_b128 v[16:19], v3 offset:10240
v_cvt_pk_bf16_f32 v78, v36, v37
v_mfma_f32_16x16x32_bf16 v[40:43], a[56:59], v[20:23], v[40:43]
v_cvt_pk_bf16_f32 v79, v38, v39
v_mfma_f32_16x16x32_bf16 v[44:47], a[60:63], v[20:23], v[44:47]
ds_read_b128 v[20:23], v3 offset:11264
s_waitcnt lgkmcnt(2)
v_mfma_f32_16x16x32_bf16 v[40:43], a[64:67], v[24:27], v[40:43]
v_mfma_f32_16x16x32_bf16 v[44:47], a[68:71], v[24:27], v[44:47]
ds_read_b128 v[24:27], v3 offset:12288
v_mfma_f32_16x16x32_bf16 v[40:43], a[72:75], v[28:31], v[40:43]
buffer_load_dwordx4 v2, s[8:11], s42 offen offset:2048 sc1 lds
v_mfma_f32_16x16x32_bf16 v[44:47], a[76:79], v[28:31], v[44:47]
ds_read_b128 v[28:31], v3 offset:13312
s_waitcnt lgkmcnt(2)
v_mfma_f32_16x16x32_bf16 v[40:43], a[80:83], v[16:19], v[40:43]
v_mfma_f32_16x16x32_bf16 v[44:47], a[84:87], v[16:19], v[44:47]
ds_read_b128 v[16:19], v3 offset:14336
v_mfma_f32_16x16x32_bf16 v[40:43], a[88:91], v[20:23], v[40:43]
buffer_load_dwordx4 v2, s[8:11], s42 offen offset:3072 sc1 lds
v_mfma_f32_16x16x32_bf16 v[44:47], a[92:95], v[20:23], v[44:47]
ds_read_b128 v[20:23], v3 offset:15360
s_waitcnt lgkmcnt(2)
v_mfma_f32_16x16x32_bf16 v[40:43], a[96:99], v[24:27], v[40:43]
v_mfma_f32_16x16x32_bf16 v[44:47], a[100:103], v[24:27], v[44:47]
ds_read_b128 v[24:27], v3 offset:16384
v_mfma_f32_16x16x32_bf16 v[40:43], a[104:107], v[28:31], v[40:43]
s_add_u32 s42, s42, 4096
s_add_u32 m0, s45, 8192
s_nop 0
buffer_load_dwordx4 v2, s[8:11], s42 offen offset:0 sc1 lds
v_mfma_f32_16x16x32_bf16 v[44:47], a[108:111], v[28:31], v[44:47]
ds_read_b128 v[28:31], v3 offset:17408
s_waitcnt lgkmcnt(2)
v_mfma_f32_16x16x32_bf16 v[40:43], a[112:115], v[16:19], v[40:43]
v_mfma_f32_16x16x32_bf16 v[44:47], a[116:119], v[16:19], v[44:47]
ds_read_b128 v[16:19], v3 offset:18432
v_mfma_f32_16x16x32_bf16 v[40:43], a[120:123], v[20:23], v[40:43]
buffer_load_dwordx4 v2, s[8:11], s42 offen offset:1024 sc1 lds
v_mfma_f32_16x16x32_bf16 v[44:47], a[124:127], v[20:23], v[44:47]
ds_read_b128 v[20:23], v3 offset:19456
s_waitcnt lgkmcnt(2)
v_mfma_f32_16x16x32_bf16 v[40:43], a[128:131], v[24:27], v[40:43]
v_mfma_f32_16x16x32_bf16 v[44:47], a[132:135], v[24:27], v[44:47]
ds_read_b128 v[24:27], v3 offset:20480
v_mfma_f32_16x16x32_bf16 v[40:43], a[136:139], v[28:31], v[40:43]
v_mfma_f32_16x16x32_bf16 v[44:47], a[140:143], v[28:31], v[44:47]
ds_read_b128 v[28:31], v3 offset:21504
s_waitcnt lgkmcnt(2)
v_mfma_f32_16x16x32_bf16 v[40:43], a[144:147], v[16:19], v[40:43]
buffer_load_dwordx4 v2, s[8:11], s42 offen offset:2048 sc1 lds
v_mfma_f32_16x16x32_bf16 v[44:47], a[148:151], v[16:19], v[44:47]
ds_read_b128 v[16:19], v3 offset:22528
v_mfma_f32_16x16x32_bf16 v[40:43], a[152:155], v[20:23], v[40:43]
v_mfma_f32_16x16x32_bf16 v[44:47], a[156:159], v[20:23], v[44:47]
ds_read_b128 v[20:23], v3 offset:23552
s_waitcnt lgkmcnt(2)
v_mfma_f32_16x16x32_bf16 v[40:43], a[160:163], v[24:27], v[40:43]
buffer_load_dwordx4 v2, s[8:11], s42 offen offset:3072 sc1 lds
v_mfma_f32_16x16x32_bf16 v[44:47], a[164:167], v[24:27], v[44:47]
ds_read_b128 v[24:27], v3 offset:24576
v_mfma_f32_16x16x32_bf16 v[40:43], a[168:171], v[28:31], v[40:43]
v_mfma_f32_16x16x32_bf16 v[44:47], a[172:175], v[28:31], v[44:47]
ds_read_b128 v[28:31], v3 offset:25600
s_waitcnt lgkmcnt(2)
v_mfma_f32_16x16x32_bf16 v[40:43], a[176:179], v[16:19], v[40:43]
s_add_u32 s42, s42, 4096
s_add_u32 m0, s45, 12288
s_nop 0
buffer_load_dwordx4 v2, s[8:11], s42 offen offset:0 sc1 lds
v_mfma_f32_16x16x32_bf16 v[44:47], a[180:183], v[16:19], v[44:47]
ds_read_b128 v[16:19], v3 offset:26624
v_mfma_f32_16x16x32_bf16 v[40:43], a[184:187], v[20:23], v[40:43]
v_mfma_f32_16x16x32_bf16 v[44:47], a[188:191], v[20:23], v[44:47]
ds_read_b128 v[20:23], v3 offset:27648
s_waitcnt lgkmcnt(2)
v_mfma_f32_16x16x32_bf16 v[40:43], a[192:195], v[24:27], v[40:43]
v_mfma_f32_16x16x32_bf16 v[44:47], a[196:199], v[24:27], v[44:47]
ds_read_b128 v[24:27], v3 offset:28672
buffer_store_dwordx2 v[76:77], v4, s[12:15], s26 offen
v_mfma_f32_16x16x32_bf16 v[40:43], a[200:203], v[28:31], v[40:43]
v_mfma_f32_16x16x32_bf16 v[44:47], a[204:207], v[28:31], v[44:47]
ds_read_b128 v[28:31], v3 offset:29696
s_waitcnt lgkmcnt(2)
v_mfma_f32_16x16x32_bf16 v[40:43], a[208:211], v[16:19], v[40:43]
v_mfma_f32_16x16x32_bf16 v[44:47], a[212:215], v[16:19], v[44:47]
ds_read_b128 v[16:19], v3 offset:30720
v_mfma_f32_16x16x32_bf16 v[40:43], a[216:219], v[20:23], v[40:43]
v_mfma_f32_16x16x32_bf16 v[44:47], a[220:223], v[20:23], v[44:47]
ds_read_b128 v[20:23], v3 offset:31744
s_waitcnt lgkmcnt(2)
v_mfma_f32_16x16x32_bf16 v[40:43], a[224:227], v[24:27], v[40:43]
v_mfma_f32_16x16x32_bf16 v[44:47], a[228:231], v[24:27], v[44:47]
ds_read_b128 v[24:27], v3 offset:32768
v_mfma_f32_16x16x32_bf16 v[40:43], a[232:235], v[28:31], v[40:43]
v_mfma_f32_16x16x32_bf16 v[44:47], a[236:239], v[28:31], v[44:47]
ds_read_b128 v[28:31], v3 offset:33792
s_waitcnt lgkmcnt(2)
v_mfma_f32_16x16x32_bf16 v[40:43], a[240:243], v[16:19], v[40:43]
v_mfma_f32_16x16x32_bf16 v[44:47], a[244:247], v[16:19], v[44:47]
ds_read_b128 v[16:19], v3 offset:34816
v_mfma_f32_16x16x32_bf16 v[40:43], a[248:251], v[20:23], v[40:43]
v_mfma_f32_16x16x32_bf16 v[44:47], a[252:255], v[20:23], v[44:47]
ds_read_b128 v[20:23], v3 offset:35840
s_waitcnt lgkmcnt(2)
v_mfma_f32_16x16x32_bf16 v[40:43], v[80:83], v[24:27], v[40:43]
buffer_load_dwordx4 v2, s[8:11], s42 offen offset:1024 sc1 lds
v_mfma_f32_16x16x32_bf16 v[44:47], v[84:87], v[24:27], v[44:47]
ds_read_b128 v[24:27], v3 offset:36864
v_mfma_f32_16x16x32_bf16 v[40:43], v[88:91], v[28:31], v[40:43]
v_mfma_f32_16x16x32_bf16 v[44:47], v[92:95], v[28:31], v[44:47]
ds_read_b128 v[28:31], v3 offset:37888
s_waitcnt lgkmcnt(2)
v_mfma_f32_16x16x32_bf16 v[40:43], v[96:99], v[16:19], v[40:43]
v_mfma_f32_16x16x32_bf16 v[44:47], v[100:103], v[16:19], v[44:47]
ds_read_b128 v[16:19], v3 offset:38912
v_mfma_f32_16x16x32_bf16 v[40:43], v[104:107], v[20:23], v[40:43]
s_add_u32 s43, s31, 212992
buffer_load_dword v59, v9, s[4:7], s43 offen sc1
v_mfma_f32_16x16x32_bf16 v[44:47], v[108:111], v[20:23], v[44:47]
ds_read_b128 v[20:23], v3 offset:39936
s_waitcnt lgkmcnt(2)
v_mfma_f32_16x16x32_bf16 v[40:43], v[112:115], v[24:27], v[40:43]
buffer_store_dwordx2 v[78:79], v4, s[12:15], s26 offen offset:32
v_mfma_f32_16x16x32_bf16 v[44:47], v[116:119], v[24:27], v[44:47]
ds_read_b128 v[24:27], v3 offset:40960
v_mfma_f32_16x16x32_bf16 v[40:43], v[120:123], v[28:31], v[40:43]
v_mfma_f32_16x16x32_bf16 v[44:47], v[124:127], v[28:31], v[44:47]
ds_read_b128 v[28:31], v3 offset:41984
s_waitcnt lgkmcnt(2)
v_mfma_f32_16x16x32_bf16 v[40:43], v[128:131], v[16:19], v[40:43]
v_mfma_f32_16x16x32_bf16 v[44:47], v[132:135], v[16:19], v[44:47]
ds_read_b128 v[16:19], v3 offset:43008
v_mfma_f32_16x16x32_bf16 v[40:43], v[136:139], v[20:23], v[40:43]
v_mfma_f32_16x16x32_bf16 v[44:47], v[140:143], v[20:23], v[44:47]
ds_read_b128 v[20:23], v3 offset:44032
s_waitcnt lgkmcnt(2)
v_mfma_f32_16x16x32_bf16 v[40:43], v[144:147], v[24:27], v[40:43]
v_mfma_f32_16x16x32_bf16 v[44:47], v[148:151], v[24:27], v[44:47]
ds_read_b128 v[24:27], v3 offset:45056
v_mfma_f32_16x16x32_bf16 v[40:43], v[152:155], v[28:31], v[40:43]
v_mfma_f32_16x16x32_bf16 v[44:47], v[156:159], v[28:31], v[44:47]
ds_read_b128 v[28:31], v3 offset:46080
s_waitcnt lgkmcnt(2)
v_mfma_f32_16x16x32_bf16 v[40:43], v[160:163], v[16:19], v[40:43]
v_mfma_f32_16x16x32_bf16 v[44:47], v[164:167], v[16:19], v[44:47]
ds_read_b128 v[16:19], v3 offset:47104
v_mfma_f32_16x16x32_bf16 v[40:43], v[168:171], v[20:23], v[40:43]
v_mfma_f32_16x16x32_bf16 v[44:47], v[172:175], v[20:23], v[44:47]
ds_read_b128 v[20:23], v3 offset:48128
s_waitcnt lgkmcnt(2)
v_mfma_f32_16x16x32_bf16 v[40:43], v[176:179], v[24:27], v[40:43]
v_mfma_f32_16x16x32_bf16 v[44:47], v[180:183], v[24:27], v[44:47]
ds_read_b128 v[24:27], v3 offset:49152
v_mfma_f32_16x16x32_bf16 v[40:43], v[184:187], v[28:31], v[40:43]
v_mfma_f32_16x16x32_bf16 v[44:47], v[188:191], v[28:31], v[44:47]
ds_read_b128 v[28:31], v3 offset:50176
s_waitcnt lgkmcnt(2)
v_mfma_f32_16x16x32_bf16 v[40:43], v[192:195], v[16:19], v[40:43]
v_mfma_f32_16x16x32_bf16 v[44:47], v[196:199], v[16:19], v[44:47]
ds_read_b128 v[16:19], v3 offset:51200
v_mfma_f32_16x16x32_bf16 v[40:43], v[200:203], v[20:23], v[40:43]
v_mfma_f32_16x16x32_bf16 v[44:47], v[204:207], v[20:23], v[44:47]
ds_read_b128 v[20:23], v3 offset:52224
s_waitcnt lgkmcnt(2)
v_mfma_f32_16x16x32_bf16 v[40:43], v[208:211], v[24:27], v[40:43]
v_mfma_f32_16x16x32_bf16 v[44:47], v[212:215], v[24:27], v[44:47]
ds_read_b128 v[24:27], v3 offset:53248
v_mfma_f32_16x16x32_bf16 v[40:43], v[216:219], v[28:31], v[40:43]
v_mfma_f32_16x16x32_bf16 v[44:47], v[220:223], v[28:31], v[44:47]
ds_read_b128 v[28:31], v3 offset:54272
ds_read_b128 v[76:79], v8 offset:16384
s_waitcnt lgkmcnt(3)
v_mfma_f32_16x16x32_bf16 v[40:43], v[224:227], v[16:19], v[40:43]
s_waitcnt lgkmcnt(0)
v_lshlrev_b32 v32, 16, v76
v_and_b32 v33, 0xffff0000, v76
v_lshlrev_b32 v34, 16, v77
v_mfma_f32_16x16x32_bf16 v[44:47], v[228:231], v[16:19], v[44:47]
v_and_b32 v35, 0xffff0000, v77
v_lshlrev_b32 v36, 16, v78
v_and_b32 v37, 0xffff0000, v78
v_mfma_f32_16x16x32_bf16 v[40:43], v[232:235], v[20:23], v[40:43]
v_lshlrev_b32 v38, 16, v79
v_and_b32 v39, 0xffff0000, v79
v_mfma_f32_16x16x32_bf16 v[44:47], v[236:239], v[20:23], v[44:47]
s_cmp_eq_u32 s10, 0
s_cbranch_scc1 Lg2_falate11
Lg2_faret11:
s_waitcnt vmcnt(2) lgkmcnt(0)
s_barrier
ds_read_b128 v[16:19], v2 offset:0
ds_read_b128 v[20:23], v2 offset:1024
v_mfma_f32_16x16x32_bf16 v[40:43], v[240:243], v[24:27], v[40:43]
v_mfma_f32_16x16x32_bf16 v[44:47], v[244:247], v[24:27], v[44:47]
ds_read_b128 v[24:27], v2 offset:2048
v_mfma_f32_16x16x32_bf16 v[40:43], v[248:251], v[28:31], v[40:43]
v_mfma_f32_16x16x32_bf16 v[44:47], v[252:255], v[28:31], v[44:47]
ds_read_b128 v[28:31], v2 offset:3072
s_waitcnt lgkmcnt(2)
v_mfma_f32_16x16x32_bf16 v[32:35], a[0:3], v[16:19], v[32:35]
s_waitcnt vmcnt(1)
v_cmp_ne_u32 vcc, s20, v59
s_cmp_eq_u64 vcc, 0
s_cselect_b32 s10, 0x10000000, 0
v_mfma_f32_16x16x32_bf16 v[36:39], a[4:7], v[16:19], v[36:39]
ds_read_b128 v[16:19], v2 offset:4096
s_add_u32 s26, s37, 983040
v_mfma_f32_16x16x32_bf16 v[32:35], a[8:11], v[20:23], v[32:35]
s_add_u32 s42, s30, 0xaf8000
s_add_u32 m0, s45, 55296
s_nop 0
buffer_load_dwordx4 v2, s[8:11], s42 offen offset:0 sc1 lds
v_mfma_f32_16x16x32_bf16 v[36:39], a[12:15], v[20:23], v[36:39]
ds_read_b128 v[20:23], v2 offset:5120
s_waitcnt lgkmcnt(2)
v_mfma_f32_16x16x32_bf16 v[32:35], a[16:19], v[24:27], v[32:35]
buffer_load_dwordx4 v2, s[8:11], s42 offen offset:1024 sc1 lds
v_mfma_f32_16x16x32_bf16 v[36:39], a[20:23], v[24:27], v[36:39]
ds_read_b128 v[24:27], v2 offset:6144
v_cvt_pk_bf16_f32 v76, v40, v41
v_mfma_f32_16x16x32_bf16 v[32:35], a[24:27], v[28:31], v[32:35]
buffer_load_dwordx4 v2, s[8:11], s42 offen offset:2048 sc1 lds
v_mfma_f32_16x16x32_bf16 v[36:39], a[28:31], v[28:31], v[36:39]
ds_read_b128 v[28:31], v2 offset:7168
s_waitcnt lgkmcnt(2)
v_mfma_f32_16x16x32_bf16 v[32:35], a[32:35], v[16:19], v[32:35]
buffer_load_dwordx4 v2, s[8:11], s42 offen offset:3072 sc1 lds
v_mfma_f32_16x16x32_bf16 v[36:39], a[36:39], v[16:19], v[36:39]
ds_read_b128 v[16:19], v2 offset:8192
v_cvt_pk_bf16_f32 v77, v42, v43
v_mfma_f32_16x16x32_bf16 v[32:35], a[40:43], v[20:23], v[32:35]
s_add_u32 s42, s42, 4096
s_add_u32 m0, s45, 59392
s_nop 0
buffer_load_dwordx4 v2, s[8:11], s42 offen offset:0 sc1 lds
v_mfma_f32_16x16x32_bf16 v[36:39], a[44:47], v[20:23], v[36:39]
ds_read_b128 v[20:23], v2 offset:9216
s_waitcnt lgkmcnt(2)
v_mfma_f32_16x16x32_bf16 v[32:35], a[48:51], v[24:27], v[32:35]
buffer_load_dwordx4 v2, s[8:11], s42 offen offset:1024 sc1 lds
v_mfma_f32_16x16x32_bf16 v[36:39], a[52:55], v[24:27], v[36:39]
ds_read_b128 v[24:27], v2 offset:10240
v_cvt_pk_bf16_f32 v78, v44, v45
v_mfma_f32_16x16x32_bf16 v[32:35], a[56:59], v[28:31], v[32:35]
v_cvt_pk_bf16_f32 v79, v46, v47
v_mfma_f32_16x16x32_bf16 v[36:39], a[60:63], v[28:31], v[36:39]
ds_read_b128 v[28:31], v2 offset:11264
s_waitcnt lgkmcnt(2)
v_mfma_f32_16x16x32_bf16 v[32:35], a[64:67], v[16:19], v[32:35]
v_mfma_f32_16x16x32_bf16 v[36:39], a[68:71], v[16:19], v[36:39]
ds_read_b128 v[16:19], v2 offset:12288
v_mfma_f32_16x16x32_bf16 v[32:35], a[72:75], v[20:23], v[32:35]
buffer_load_dwordx4 v2, s[8:11], s42 offen offset:2048 sc1 lds
v_mfma_f32_16x16x32_bf16 v[36:39], a[76:79], v[20:23], v[36:39]
ds_read_b128 v[20:23], v2 offset:13312
s_waitcnt lgkmcnt(2)
v_mfma_f32_16x16x32_bf16 v[32:35], a[80:83], v[24:27], v[32:35]
v_mfma_f32_16x16x32_bf16 v[36:39], a[84:87], v[24:27], v[36:39]
ds_read_b128 v[24:27], v2 offset:14336
v_mfma_f32_16x16x32_bf16 v[32:35], a[88:91], v[28:31], v[32:35]
buffer_load_dwordx4 v2, s[8:11], s42 offen offset:3072 sc1 lds
v_mfma_f32_16x16x32_bf16 v[36:39], a[92:95], v[28:31], v[36:39]
ds_read_b128 v[28:31], v2 offset:15360
s_waitcnt lgkmcnt(2)
v_mfma_f32_16x16x32_bf16 v[32:35], a[96:99], v[16:19], v[32:35]
v_mfma_f32_16x16x32_bf16 v[36:39], a[100:103], v[16:19], v[36:39]
ds_read_b128 v[16:19], v2 offset:16384
v_mfma_f32_16x16x32_bf16 v[32:35], a[104:107], v[20:23], v[32:35]
s_add_u32 s42, s42, 4096
s_add_u32 m0, s45, 63488
s_nop 0
buffer_load_dwordx4 v2, s[8:11], s42 offen offset:0 sc1 lds
v_mfma_f32_16x16x32_bf16 v[36:39], a[108:111], v[20:23], v[36:39]
ds_read_b128 v[20:23], v2 offset:17408
s_waitcnt lgkmcnt(2)
v_mfma_f32_16x16x32_bf16 v[32:35], a[112:115], v[24:27], v[32:35]
v_mfma_f32_16x16x32_bf16 v[36:39], a[116:119], v[24:27], v[36:39]
ds_read_b128 v[24:27], v2 offset:18432
v_mfma_f32_16x16x32_bf16 v[32:35], a[120:123], v[28:31], v[32:35]
buffer_load_dwordx4 v2, s[8:11], s42 offen offset:1024 sc1 lds
v_mfma_f32_16x16x32_bf16 v[36:39], a[124:127], v[28:31], v[36:39]
ds_read_b128 v[28:31], v2 offset:19456
s_waitcnt lgkmcnt(2)
v_mfma_f32_16x16x32_bf16 v[32:35], a[128:131], v[16:19], v[32:35]
v_mfma_f32_16x16x32_bf16 v[36:39], a[132:135], v[16:19], v[36:39]
ds_read_b128 v[16:19], v2 offset:20480
v_mfma_f32_16x16x32_bf16 v[32:35], a[136:139], v[20:23], v[32:35]
v_mfma_f32_16x16x32_bf16 v[36:39], a[140:143], v[20:23], v[36:39]
ds_read_b128 v[20:23], v2 offset:21504
s_waitcnt lgkmcnt(2)
v_mfma_f32_16x16x32_bf16 v[32:35], a[144:147], v[24:27], v[32:35]
buffer_load_dwordx4 v2, s[8:11], s42 offen offset:2048 sc1 lds
v_mfma_f32_16x16x32_bf16 v[36:39], a[148:151], v[24:27], v[36:39]
ds_read_b128 v[24:27], v2 offset:22528
v_mfma_f32_16x16x32_bf16 v[32:35], a[152:155], v[28:31], v[32:35]
v_mfma_f32_16x16x32_bf16 v[36:39], a[156:159], v[28:31], v[36:39]
ds_read_b128 v[28:31], v2 offset:23552
s_waitcnt lgkmcnt(2)
v_mfma_f32_16x16x32_bf16 v[32:35], a[160:163], v[16:19], v[32:35]
buffer_load_dwordx4 v2, s[8:11], s42 offen offset:3072 sc1 lds
v_mfma_f32_16x16x32_bf16 v[36:39], a[164:167], v[16:19], v[36:39]
ds_read_b128 v[16:19], v2 offset:24576
v_mfma_f32_16x16x32_bf16 v[32:35], a[168:171], v[20:23], v[32:35]
v_mfma_f32_16x16x32_bf16 v[36:39], a[172:175], v[20:23], v[36:39]
ds_read_b128 v[20:23], v2 offset:25600
s_waitcnt lgkmcnt(2)
v_mfma_f32_16x16x32_bf16 v[32:35], a[176:179], v[24:27], v[32:35]
s_add_u32 s42, s42, 4096
s_add_u32 m0, s45, 67584
s_nop 0
buffer_load_dwordx4 v2, s[8:11], s42 offen offset:0 sc1 lds
v_mfma_f32_16x16x32_bf16 v[36:39], a[180:183], v[24:27], v[36:39]
ds_read_b128 v[24:27], v2 offset:26624
v_mfma_f32_16x16x32_bf16 v[32:35], a[184:187], v[28:31], v[32:35]
v_mfma_f32_16x16x32_bf16 v[36:39], a[188:191], v[28:31], v[36:39]
ds_read_b128 v[28:31], v2 offset:27648
s_waitcnt lgkmcnt(2)
v_mfma_f32_16x16x32_bf16 v[32:35], a[192:195], v[16:19], v[32:35]
v_mfma_f32_16x16x32_bf16 v[36:39], a[196:199], v[16:19], v[36:39]
ds_read_b128 v[16:19], v2 offset:28672
buffer_store_dwordx2 v[76:77], v4, s[12:15], s26 offen
v_mfma_f32_16x16x32_bf16 v[32:35], a[200:203], v[20:23], v[32:35]
v_mfma_f32_16x16x32_bf16 v[36:39], a[204:207], v[20:23], v[36:39]
ds_read_b128 v[20:23], v2 offset:29696
s_waitcnt lgkmcnt(2)
v_mfma_f32_16x16x32_bf16 v[32:35], a[208:211], v[24:27], v[32:35]
v_mfma_f32_16x16x32_bf16 v[36:39], a[212:215], v[24:27], v[36:39]
ds_read_b128 v[24:27], v2 offset:30720
v_mfma_f32_16x16x32_bf16 v[32:35], a[216:219], v[28:31], v[32:35]
v_mfma_f32_16x16x32_bf16 v[36:39], a[220:223], v[28:31], v[36:39]
ds_read_b128 v[28:31], v2 offset:31744
s_waitcnt lgkmcnt(2)
v_mfma_f32_16x16x32_bf16 v[32:35], a[224:227], v[16:19], v[32:35]
v_mfma_f32_16x16x32_bf16 v[36:39], a[228:231], v[16:19], v[36:39]
ds_read_b128 v[16:19], v2 offset:32768
v_mfma_f32_16x16x32_bf16 v[32:35], a[232:235], v[20:23], v[32:35]
v_mfma_f32_16x16x32_bf16 v[36:39], a[236:239], v[20:23], v[36:39]
ds_read_b128 v[20:23], v2 offset:33792
s_waitcnt lgkmcnt(2)
v_mfma_f32_16x16x32_bf16 v[32:35], a[240:243], v[24:27], v[32:35]
v_mfma_f32_16x16x32_bf16 v[36:39], a[244:247], v[24:27], v[36:39]
ds_read_b128 v[24:27], v2 offset:34816
v_mfma_f32_16x16x32_bf16 v[32:35], a[248:251], v[28:31], v[32:35]
v_mfma_f32_16x16x32_bf16 v[36:39], a[252:255], v[28:31], v[36:39]
ds_read_b128 v[28:31], v2 offset:35840
s_waitcnt lgkmcnt(2)
v_mfma_f32_16x16x32_bf16 v[32:35], v[80:83], v[16:19], v[32:35]
buffer_load_dwordx4 v2, s[8:11], s42 offen offset:1024 sc1 lds
v_mfma_f32_16x16x32_bf16 v[36:39], v[84:87], v[16:19], v[36:39]
ds_read_b128 v[16:19], v2 offset:36864
v_mfma_f32_16x16x32_bf16 v[32:35], v[88:91], v[20:23], v[32:35]
v_mfma_f32_16x16x32_bf16 v[36:39], v[92:95], v[20:23], v[36:39]
ds_read_b128 v[20:23], v2 offset:37888
s_waitcnt lgkmcnt(2)
v_mfma_f32_16x16x32_bf16 v[32:35], v[96:99], v[24:27], v[32:35]
v_mfma_f32_16x16x32_bf16 v[36:39], v[100:103], v[24:27], v[36:39]
ds_read_b128 v[24:27], v2 offset:38912
v_mfma_f32_16x16x32_bf16 v[32:35], v[104:107], v[28:31], v[32:35]
s_add_u32 s43, s31, 229376
buffer_load_dword v59, v9, s[4:7], s43 offen sc1
v_mfma_f32_16x16x32_bf16 v[36:39], v[108:111], v[28:31], v[36:39]
ds_read_b128 v[28:31], v2 offset:39936
s_waitcnt lgkmcnt(2)
v_mfma_f32_16x16x32_bf16 v[32:35], v[112:115], v[16:19], v[32:35]
buffer_store_dwordx2 v[78:79], v4, s[12:15], s26 offen offset:32
v_mfma_f32_16x16x32_bf16 v[36:39], v[116:119], v[16:19], v[36:39]
ds_read_b128 v[16:19], v2 offset:40960
v_mfma_f32_16x16x32_bf16 v[32:35], v[120:123], v[20:23], v[32:35]
v_mfma_f32_16x16x32_bf16 v[36:39], v[124:127], v[20:23], v[36:39]
ds_read_b128 v[20:23], v2 offset:41984
s_waitcnt lgkmcnt(2)
v_mfma_f32_16x16x32_bf16 v[32:35], v[128:131], v[24:27], v[32:35]
v_mfma_f32_16x16x32_bf16 v[36:39], v[132:135], v[24:27], v[36:39]
ds_read_b128 v[24:27], v2 offset:43008
v_mfma_f32_16x16x32_bf16 v[32:35], v[136:139], v[28:31], v[32:35]
v_mfma_f32_16x16x32_bf16 v[36:39], v[140:143], v[28:31], v[36:39]
ds_read_b128 v[28:31], v2 offset:44032
s_waitcnt lgkmcnt(2)
v_mfma_f32_16x16x32_bf16 v[32:35], v[144:147], v[16:19], v[32:35]
v_mfma_f32_16x16x32_bf16 v[36:39], v[148:151], v[16:19], v[36:39]
ds_read_b128 v[16:19], v2 offset:45056
v_mfma_f32_16x16x32_bf16 v[32:35], v[152:155], v[20:23], v[32:35]
v_mfma_f32_16x16x32_bf16 v[36:39], v[156:159], v[20:23], v[36:39]
ds_read_b128 v[20:23], v2 offset:46080
s_waitcnt lgkmcnt(2)
v_mfma_f32_16x16x32_bf16 v[32:35], v[160:163], v[24:27], v[32:35]
v_mfma_f32_16x16x32_bf16 v[36:39], v[164:167], v[24:27], v[36:39]
ds_read_b128 v[24:27], v2 offset:47104
v_mfma_f32_16x16x32_bf16 v[32:35], v[168:171], v[28:31], v[32:35]
v_mfma_f32_16x16x32_bf16 v[36:39], v[172:175], v[28:31], v[36:39]
ds_read_b128 v[28:31], v2 offset:48128
s_waitcnt lgkmcnt(2)
v_mfma_f32_16x16x32_bf16 v[32:35], v[176:179], v[16:19], v[32:35]
v_mfma_f32_16x16x32_bf16 v[36:39], v[180:183], v[16:19], v[36:39]
ds_read_b128 v[16:19], v2 offset:49152
v_mfma_f32_16x16x32_bf16 v[32:35], v[184:187], v[20:23], v[32:35]
v_mfma_f32_16x16x32_bf16 v[36:39], v[188:191], v[20:23], v[36:39]
ds_read_b128 v[20:23], v2 offset:50176
s_waitcnt lgkmcnt(2)
v_mfma_f32_16x16x32_bf16 v[32:35], v[192:195], v[24:27], v[32:35]
v_mfma_f32_16x16x32_bf16 v[36:39], v[196:199], v[24:27], v[36:39]
ds_read_b128 v[24:27], v2 offset:51200
v_mfma_f32_16x16x32_bf16 v[32:35], v[200:203], v[28:31], v[32:35]
v_mfma_f32_16x16x32_bf16 v[36:39], v[204:207], v[28:31], v[36:39]
ds_read_b128 v[28:31], v2 offset:52224
s_waitcnt lgkmcnt(2)
v_mfma_f32_16x16x32_bf16 v[32:35], v[208:211], v[16:19], v[32:35]
v_mfma_f32_16x16x32_bf16 v[36:39], v[212:215], v[16:19], v[36:39]
ds_read_b128 v[16:19], v2 offset:53248
v_mfma_f32_16x16x32_bf16 v[32:35], v[216:219], v[20:23], v[32:35]
v_mfma_f32_16x16x32_bf16 v[36:39], v[220:223], v[20:23], v[36:39]
ds_read_b128 v[20:23], v2 offset:54272
ds_read_b128 v[76:79], v8 offset:20480
s_waitcnt lgkmcnt(3)
v_mfma_f32_16x16x32_bf16 v[32:35], v[224:227], v[24:27], v[32:35]
s_waitcnt lgkmcnt(0)
v_lshlrev_b32 v40, 16, v76
v_and_b32 v41, 0xffff0000, v76
v_lshlrev_b32 v42, 16, v77
v_mfma_f32_16x16x32_bf16 v[36:39], v[228:231], v[24:27], v[36:39]
v_and_b32 v43, 0xffff0000, v77
v_lshlrev_b32 v44, 16, v78
v_and_b32 v45, 0xffff0000, v78
v_mfma_f32_16x16x32_bf16 v[32:35], v[232:235], v[28:31], v[32:35]
v_lshlrev_b32 v46, 16, v79
v_and_b32 v47, 0xffff0000, v79
v_mfma_f32_16x16x32_bf16 v[36:39], v[236:239], v[28:31], v[36:39]
s_cmp_eq_u32 s10, 0
s_cbranch_scc1 Lg2_falate12
Lg2_faret12:
s_waitcnt vmcnt(2) lgkmcnt(0)
s_barrier
ds_read_b128 v[24:27], v3 offset:0
ds_read_b128 v[28:31], v3 offset:1024
v_mfma_f32_16x16x32_bf16 v[32:35], v[240:243], v[16:19], v[32:35]
v_mfma_f32_16x16x32_bf16 v[36:39], v[244:247], v[16:19], v[36:39]
ds_read_b128 v[16:19], v3 offset:2048
v_mfma_f32_16x16x32_bf16 v[32:35], v[248:251], v[20:23], v[32:35]
v_mfma_f32_16x16x32_bf16 v[36:39], v[252:255], v[20:23], v[36:39]
ds_read_b128 v[20:23], v3 offset:3072
s_waitcnt lgkmcnt(2)
v_mfma_f32_16x16x32_bf16 v[40:43], a[0:3], v[24:27], v[40:43]
s_waitcnt vmcnt(1)
v_cmp_ne_u32 vcc, s20, v59
s_cmp_eq_u64 vcc, 0
s_cselect_b32 s10, 0x10000000, 0
v_mfma_f32_16x16x32_bf16 v[44:47], a[4:7], v[24:27], v[44:47]
ds_read_b128 v[24:27], v3 offset:4096
s_add_u32 s26, s37, 1310720
v_mfma_f32_16x16x32_bf16 v[40:43], a[8:11], v[28:31], v[40:43]
s_add_u32 s42, s30, 0xbd0000
s_add_u32 m0, s45, 0
s_nop 0
buffer_load_dwordx4 v2, s[8:11], s42 offen offset:0 sc1 lds
v_mfma_f32_16x16x32_bf16 v[44:47], a[12:15], v[28:31], v[44:47]
ds_read_b128 v[28:31], v3 offset:5120
s_waitcnt lgkmcnt(2)
v_mfma_f32_16x16x32_bf16 v[40:43], a[16:19], v[16:19], v[40:43]
buffer_load_dwordx4 v2, s[8:11], s42 offen offset:1024 sc1 lds
v_mfma_f32_16x16x32_bf16 v[44:47], a[20:23], v[16:19], v[44:47]
ds_read_b128 v[16:19], v3 offset:6144
v_cvt_pk_bf16_f32 v76, v32, v33
v_mfma_f32_16x16x32_bf16 v[40:43], a[24:27], v[20:23], v[40:43]
buffer_load_dwordx4 v2, s[8:11], s42 offen offset:2048 sc1 lds
v_mfma_f32_16x16x32_bf16 v[44:47], a[28:31], v[20:23], v[44:47]
ds_read_b128 v[20:23], v3 offset:7168
s_waitcnt lgkmcnt(2)
v_mfma_f32_16x16x32_bf16 v[40:43], a[32:35], v[24:27], v[40:43]
buffer_load_dwordx4 v2, s[8:11], s42 offen offset:3072 sc1 lds
v_mfma_f32_16x16x32_bf16 v[44:47], a[36:39], v[24:27], v[44:47]
ds_read_b128 v[24:27], v3 offset:8192
v_cvt_pk_bf16_f32 v77, v34, v35
v_mfma_f32_16x16x32_bf16 v[40:43], a[40:43], v[28:31], v[40:43]
s_add_u32 s42, s42, 4096
s_add_u32 m0, s45, 4096
s_nop 0
buffer_load_dwordx4 v2, s[8:11], s42 offen offset:0 sc1 lds
v_mfma_f32_16x16x32_bf16 v[44:47], a[44:47], v[28:31], v[44:47]
ds_read_b128 v[28:31], v3 offset:9216
s_waitcnt lgkmcnt(2)
v_mfma_f32_16x16x32_bf16 v[40:43], a[48:51], v[16:19], v[40:43]
buffer_load_dwordx4 v2, s[8:11], s42 offen offset:1024 sc1 lds
v_mfma_f32_16x16x32_bf16 v[44:47], a[52:55], v[16:19], v[44:47]
ds_read_b128 v[16:19], v3 offset:10240
v_cvt_pk_bf16_f32 v78, v36, v37
v_mfma_f32_16x16x32_bf16 v[40:43], a[56:59], v[20:23], v[40:43]
v_cvt_pk_bf16_f32 v79, v38, v39
v_mfma_f32_16x16x32_bf16 v[44:47], a[60:63], v[20:23], v[44:47]
ds_read_b128 v[20:23], v3 offset:11264
s_waitcnt lgkmcnt(2)
v_mfma_f32_16x16x32_bf16 v[40:43], a[64:67], v[24:27], v[40:43]
v_mfma_f32_16x16x32_bf16 v[44:47], a[68:71], v[24:27], v[44:47]
ds_read_b128 v[24:27], v3 offset:12288
v_mfma_f32_16x16x32_bf16 v[40:43], a[72:75], v[28:31], v[40:43]
buffer_load_dwordx4 v2, s[8:11], s42 offen offset:2048 sc1 lds
v_mfma_f32_16x16x32_bf16 v[44:47], a[76:79], v[28:31], v[44:47]
ds_read_b128 v[28:31], v3 offset:13312
s_waitcnt lgkmcnt(2)
v_mfma_f32_16x16x32_bf16 v[40:43], a[80:83], v[16:19], v[40:43]
v_mfma_f32_16x16x32_bf16 v[44:47], a[84:87], v[16:19], v[44:47]
ds_read_b128 v[16:19], v3 offset:14336
v_mfma_f32_16x16x32_bf16 v[40:43], a[88:91], v[20:23], v[40:43]
buffer_load_dwordx4 v2, s[8:11], s42 offen offset:3072 sc1 lds
v_mfma_f32_16x16x32_bf16 v[44:47], a[92:95], v[20:23], v[44:47]
ds_read_b128 v[20:23], v3 offset:15360
s_waitcnt lgkmcnt(2)
v_mfma_f32_16x16x32_bf16 v[40:43], a[96:99], v[24:27], v[40:43]
v_mfma_f32_16x16x32_bf16 v[44:47], a[100:103], v[24:27], v[44:47]
ds_read_b128 v[24:27], v3 offset:16384
v_mfma_f32_16x16x32_bf16 v[40:43], a[104:107], v[28:31], v[40:43]
s_add_u32 s42, s42, 4096
s_add_u32 m0, s45, 8192
s_nop 0
buffer_load_dwordx4 v2, s[8:11], s42 offen offset:0 sc1 lds
v_mfma_f32_16x16x32_bf16 v[44:47], a[108:111], v[28:31], v[44:47]
ds_read_b128 v[28:31], v3 offset:17408
s_waitcnt lgkmcnt(2)
v_mfma_f32_16x16x32_bf16 v[40:43], a[112:115], v[16:19], v[40:43]
v_mfma_f32_16x16x32_bf16 v[44:47], a[116:119], v[16:19], v[44:47]
ds_read_b128 v[16:19], v3 offset:18432
v_mfma_f32_16x16x32_bf16 v[40:43], a[120:123], v[20:23], v[40:43]
buffer_load_dwordx4 v2, s[8:11], s42 offen offset:1024 sc1 lds
v_mfma_f32_16x16x32_bf16 v[44:47], a[124:127], v[20:23], v[44:47]
ds_read_b128 v[20:23], v3 offset:19456
s_waitcnt lgkmcnt(2)
v_mfma_f32_16x16x32_bf16 v[40:43], a[128:131], v[24:27], v[40:43]
v_mfma_f32_16x16x32_bf16 v[44:47], a[132:135], v[24:27], v[44:47]
ds_read_b128 v[24:27], v3 offset:20480
v_mfma_f32_16x16x32_bf16 v[40:43], a[136:139], v[28:31], v[40:43]
v_mfma_f32_16x16x32_bf16 v[44:47], a[140:143], v[28:31], v[44:47]
ds_read_b128 v[28:31], v3 offset:21504
s_waitcnt lgkmcnt(2)
v_mfma_f32_16x16x32_bf16 v[40:43], a[144:147], v[16:19], v[40:43]
buffer_load_dwordx4 v2, s[8:11], s42 offen offset:2048 sc1 lds
v_mfma_f32_16x16x32_bf16 v[44:47], a[148:151], v[16:19], v[44:47]
ds_read_b128 v[16:19], v3 offset:22528
v_mfma_f32_16x16x32_bf16 v[40:43], a[152:155], v[20:23], v[40:43]
v_mfma_f32_16x16x32_bf16 v[44:47], a[156:159], v[20:23], v[44:47]
ds_read_b128 v[20:23], v3 offset:23552
s_waitcnt lgkmcnt(2)
v_mfma_f32_16x16x32_bf16 v[40:43], a[160:163], v[24:27], v[40:43]
buffer_load_dwordx4 v2, s[8:11], s42 offen offset:3072 sc1 lds
v_mfma_f32_16x16x32_bf16 v[44:47], a[164:167], v[24:27], v[44:47]
ds_read_b128 v[24:27], v3 offset:24576
v_mfma_f32_16x16x32_bf16 v[40:43], a[168:171], v[28:31], v[40:43]
v_mfma_f32_16x16x32_bf16 v[44:47], a[172:175], v[28:31], v[44:47]
ds_read_b128 v[28:31], v3 offset:25600
s_waitcnt lgkmcnt(2)
v_mfma_f32_16x16x32_bf16 v[40:43], a[176:179], v[16:19], v[40:43]
s_add_u32 s42, s42, 4096
s_add_u32 m0, s45, 12288
s_nop 0
buffer_load_dwordx4 v2, s[8:11], s42 offen offset:0 sc1 lds
v_mfma_f32_16x16x32_bf16 v[44:47], a[180:183], v[16:19], v[44:47]
ds_read_b128 v[16:19], v3 offset:26624
v_mfma_f32_16x16x32_bf16 v[40:43], a[184:187], v[20:23], v[40:43]
v_mfma_f32_16x16x32_bf16 v[44:47], a[188:191], v[20:23], v[44:47]
ds_read_b128 v[20:23], v3 offset:27648
s_waitcnt lgkmcnt(2)
v_mfma_f32_16x16x32_bf16 v[40:43], a[192:195], v[24:27], v[40:43]
v_mfma_f32_16x16x32_bf16 v[44:47], a[196:199], v[24:27], v[44:47]
ds_read_b128 v[24:27], v3 offset:28672
buffer_store_dwordx2 v[76:77], v4, s[12:15], s26 offen
v_mfma_f32_16x16x32_bf16 v[40:43], a[200:203], v[28:31], v[40:43]
v_mfma_f32_16x16x32_bf16 v[44:47], a[204:207], v[28:31], v[44:47]
ds_read_b128 v[28:31], v3 offset:29696
s_waitcnt lgkmcnt(2)
v_mfma_f32_16x16x32_bf16 v[40:43], a[208:211], v[16:19], v[40:43]
v_mfma_f32_16x16x32_bf16 v[44:47], a[212:215], v[16:19], v[44:47]
ds_read_b128 v[16:19], v3 offset:30720
v_mfma_f32_16x16x32_bf16 v[40:43], a[216:219], v[20:23], v[40:43]
v_mfma_f32_16x16x32_bf16 v[44:47], a[220:223], v[20:23], v[44:47]
ds_read_b128 v[20:23], v3 offset:31744
s_waitcnt lgkmcnt(2)
v_mfma_f32_16x16x32_bf16 v[40:43], a[224:227], v[24:27], v[40:43]
v_mfma_f32_16x16x32_bf16 v[44:47], a[228:231], v[24:27], v[44:47]
ds_read_b128 v[24:27], v3 offset:32768
v_mfma_f32_16x16x32_bf16 v[40:43], a[232:235], v[28:31], v[40:43]
v_mfma_f32_16x16x32_bf16 v[44:47], a[236:239], v[28:31], v[44:47]
ds_read_b128 v[28:31], v3 offset:33792
s_waitcnt lgkmcnt(2)
v_mfma_f32_16x16x32_bf16 v[40:43], a[240:243], v[16:19], v[40:43]
v_mfma_f32_16x16x32_bf16 v[44:47], a[244:247], v[16:19], v[44:47]
ds_read_b128 v[16:19], v3 offset:34816
v_mfma_f32_16x16x32_bf16 v[40:43], a[248:251], v[20:23], v[40:43]
v_mfma_f32_16x16x32_bf16 v[44:47], a[252:255], v[20:23], v[44:47]
ds_read_b128 v[20:23], v3 offset:35840
s_waitcnt lgkmcnt(2)
v_mfma_f32_16x16x32_bf16 v[40:43], v[80:83], v[24:27], v[40:43]
buffer_load_dwordx4 v2, s[8:11], s42 offen offset:1024 sc1 lds
v_mfma_f32_16x16x32_bf16 v[44:47], v[84:87], v[24:27], v[44:47]
ds_read_b128 v[24:27], v3 offset:36864
v_mfma_f32_16x16x32_bf16 v[40:43], v[88:91], v[28:31], v[40:43]
v_mfma_f32_16x16x32_bf16 v[44:47], v[92:95], v[28:31], v[44:47]
ds_read_b128 v[28:31], v3 offset:37888
s_waitcnt lgkmcnt(2)
v_mfma_f32_16x16x32_bf16 v[40:43], v[96:99], v[16:19], v[40:43]
v_mfma_f32_16x16x32_bf16 v[44:47], v[100:103], v[16:19], v[44:47]
ds_read_b128 v[16:19], v3 offset:38912
v_mfma_f32_16x16x32_bf16 v[40:43], v[104:107], v[20:23], v[40:43]
s_add_u32 s43, s31, 245760
buffer_load_dword v59, v9, s[4:7], s43 offen sc1
v_mfma_f32_16x16x32_bf16 v[44:47], v[108:111], v[20:23], v[44:47]
ds_read_b128 v[20:23], v3 offset:39936
s_waitcnt lgkmcnt(2)
v_mfma_f32_16x16x32_bf16 v[40:43], v[112:115], v[24:27], v[40:43]
buffer_store_dwordx2 v[78:79], v4, s[12:15], s26 offen offset:32
v_mfma_f32_16x16x32_bf16 v[44:47], v[116:119], v[24:27], v[44:47]
ds_read_b128 v[24:27], v3 offset:40960
v_mfma_f32_16x16x32_bf16 v[40:43], v[120:123], v[28:31], v[40:43]
v_mfma_f32_16x16x32_bf16 v[44:47], v[124:127], v[28:31], v[44:47]
ds_read_b128 v[28:31], v3 offset:41984
s_waitcnt lgkmcnt(2)
v_mfma_f32_16x16x32_bf16 v[40:43], v[128:131], v[16:19], v[40:43]
v_mfma_f32_16x16x32_bf16 v[44:47], v[132:135], v[16:19], v[44:47]
ds_read_b128 v[16:19], v3 offset:43008
v_mfma_f32_16x16x32_bf16 v[40:43], v[136:139], v[20:23], v[40:43]
v_mfma_f32_16x16x32_bf16 v[44:47], v[140:143], v[20:23], v[44:47]
ds_read_b128 v[20:23], v3 offset:44032
s_waitcnt lgkmcnt(2)
v_mfma_f32_16x16x32_bf16 v[40:43], v[144:147], v[24:27], v[40:43]
v_mfma_f32_16x16x32_bf16 v[44:47], v[148:151], v[24:27], v[44:47]
ds_read_b128 v[24:27], v3 offset:45056
v_mfma_f32_16x16x32_bf16 v[40:43], v[152:155], v[28:31], v[40:43]
v_mfma_f32_16x16x32_bf16 v[44:47], v[156:159], v[28:31], v[44:47]
ds_read_b128 v[28:31], v3 offset:46080
s_waitcnt lgkmcnt(2)
v_mfma_f32_16x16x32_bf16 v[40:43], v[160:163], v[16:19], v[40:43]
v_mfma_f32_16x16x32_bf16 v[44:47], v[164:167], v[16:19], v[44:47]
ds_read_b128 v[16:19], v3 offset:47104
v_mfma_f32_16x16x32_bf16 v[40:43], v[168:171], v[20:23], v[40:43]
v_mfma_f32_16x16x32_bf16 v[44:47], v[172:175], v[20:23], v[44:47]
ds_read_b128 v[20:23], v3 offset:48128
s_waitcnt lgkmcnt(2)
v_mfma_f32_16x16x32_bf16 v[40:43], v[176:179], v[24:27], v[40:43]
v_mfma_f32_16x16x32_bf16 v[44:47], v[180:183], v[24:27], v[44:47]
ds_read_b128 v[24:27], v3 offset:49152
v_mfma_f32_16x16x32_bf16 v[40:43], v[184:187], v[28:31], v[40:43]
v_mfma_f32_16x16x32_bf16 v[44:47], v[188:191], v[28:31], v[44:47]
ds_read_b128 v[28:31], v3 offset:50176
s_waitcnt lgkmcnt(2)
v_mfma_f32_16x16x32_bf16 v[40:43], v[192:195], v[16:19], v[40:43]
v_mfma_f32_16x16x32_bf16 v[44:47], v[196:199], v[16:19], v[44:47]
ds_read_b128 v[16:19], v3 offset:51200
v_mfma_f32_16x16x32_bf16 v[40:43], v[200:203], v[20:23], v[40:43]
v_mfma_f32_16x16x32_bf16 v[44:47], v[204:207], v[20:23], v[44:47]
ds_read_b128 v[20:23], v3 offset:52224
s_waitcnt lgkmcnt(2)
v_mfma_f32_16x16x32_bf16 v[40:43], v[208:211], v[24:27], v[40:43]
v_mfma_f32_16x16x32_bf16 v[44:47], v[212:215], v[24:27], v[44:47]
ds_read_b128 v[24:27], v3 offset:53248
v_mfma_f32_16x16x32_bf16 v[40:43], v[216:219], v[28:31], v[40:43]
v_mfma_f32_16x16x32_bf16 v[44:47], v[220:223], v[28:31], v[44:47]
ds_read_b128 v[28:31], v3 offset:54272
ds_read_b128 v[76:79], v8 offset:24576
s_waitcnt lgkmcnt(3)
v_mfma_f32_16x16x32_bf16 v[40:43], v[224:227], v[16:19], v[40:43]
s_waitcnt lgkmcnt(0)
v_lshlrev_b32 v32, 16, v76
v_and_b32 v33, 0xffff0000, v76
v_lshlrev_b32 v34, 16, v77
v_mfma_f32_16x16x32_bf16 v[44:47], v[228:231], v[16:19], v[44:47]
v_and_b32 v35, 0xffff0000, v77
v_lshlrev_b32 v36, 16, v78
v_and_b32 v37, 0xffff0000, v78
v_mfma_f32_16x16x32_bf16 v[40:43], v[232:235], v[20:23], v[40:43]
v_lshlrev_b32 v38, 16, v79
v_and_b32 v39, 0xffff0000, v79
v_mfma_f32_16x16x32_bf16 v[44:47], v[236:239], v[20:23], v[44:47]
s_cmp_eq_u32 s10, 0
s_cbranch_scc1 Lg2_falate13
Lg2_faret13:
s_waitcnt vmcnt(2) lgkmcnt(0)
s_barrier
ds_read_b128 v[16:19], v2 offset:0
ds_read_b128 v[20:23], v2 offset:1024
v_mfma_f32_16x16x32_bf16 v[40:43], v[240:243], v[24:27], v[40:43]
v_mfma_f32_16x16x32_bf16 v[44:47], v[244:247], v[24:27], v[44:47]
ds_read_b128 v[24:27], v2 offset:2048
v_mfma_f32_16x16x32_bf16 v[40:43], v[248:251], v[28:31], v[40:43]
v_mfma_f32_16x16x32_bf16 v[44:47], v[252:255], v[28:31], v[44:47]
ds_read_b128 v[28:31], v2 offset:3072
s_waitcnt lgkmcnt(2)
v_mfma_f32_16x16x32_bf16 v[32:35], a[0:3], v[16:19], v[32:35]
s_waitcnt vmcnt(1)
v_cmp_ne_u32 vcc, s20, v59
s_cmp_eq_u64 vcc, 0
s_cselect_b32 s10, 0x10000000, 0
v_mfma_f32_16x16x32_bf16 v[36:39], a[4:7], v[16:19], v[36:39]
ds_read_b128 v[16:19], v2 offset:4096
s_add_u32 s26, s37, 1638400
v_mfma_f32_16x16x32_bf16 v[32:35], a[8:11], v[20:23], v[32:35]
s_add_u32 s42, s30, 0xca8000
s_add_u32 m0, s45, 55296
s_nop 0
buffer_load_dwordx4 v2, s[8:11], s42 offen offset:0 sc1 lds
v_mfma_f32_16x16x32_bf16 v[36:39], a[12:15], v[20:23], v[36:39]
ds_read_b128 v[20:23], v2 offset:5120
s_waitcnt lgkmcnt(2)
v_mfma_f32_16x16x32_bf16 v[32:35], a[16:19], v[24:27], v[32:35]
buffer_load_dwordx4 v2, s[8:11], s42 offen offset:1024 sc1 lds
v_mfma_f32_16x16x32_bf16 v[36:39], a[20:23], v[24:27], v[36:39]
ds_read_b128 v[24:27], v2 offset:6144
v_cvt_pk_bf16_f32 v76, v40, v41
v_mfma_f32_16x16x32_bf16 v[32:35], a[24:27], v[28:31], v[32:35]
buffer_load_dwordx4 v2, s[8:11], s42 offen offset:2048 sc1 lds
v_mfma_f32_16x16x32_bf16 v[36:39], a[28:31], v[28:31], v[36:39]
ds_read_b128 v[28:31], v2 offset:7168
s_waitcnt lgkmcnt(2)
v_mfma_f32_16x16x32_bf16 v[32:35], a[32:35], v[16:19], v[32:35]
buffer_load_dwordx4 v2, s[8:11], s42 offen offset:3072 sc1 lds
v_mfma_f32_16x16x32_bf16 v[36:39], a[36:39], v[16:19], v[36:39]
ds_read_b128 v[16:19], v2 offset:8192
v_cvt_pk_bf16_f32 v77, v42, v43
v_mfma_f32_16x16x32_bf16 v[32:35], a[40:43], v[20:23], v[32:35]
s_add_u32 s42, s42, 4096
s_add_u32 m0, s45, 59392
s_nop 0
buffer_load_dwordx4 v2, s[8:11], s42 offen offset:0 sc1 lds
v_mfma_f32_16x16x32_bf16 v[36:39], a[44:47], v[20:23], v[36:39]
ds_read_b128 v[20:23], v2 offset:9216
s_waitcnt lgkmcnt(2)
v_mfma_f32_16x16x32_bf16 v[32:35], a[48:51], v[24:27], v[32:35]
buffer_load_dwordx4 v2, s[8:11], s42 offen offset:1024 sc1 lds
v_mfma_f32_16x16x32_bf16 v[36:39], a[52:55], v[24:27], v[36:39]
ds_read_b128 v[24:27], v2 offset:10240
v_cvt_pk_bf16_f32 v78, v44, v45
v_mfma_f32_16x16x32_bf16 v[32:35], a[56:59], v[28:31], v[32:35]
v_cvt_pk_bf16_f32 v79, v46, v47
v_mfma_f32_16x16x32_bf16 v[36:39], a[60:63], v[28:31], v[36:39]
ds_read_b128 v[28:31], v2 offset:11264
s_waitcnt lgkmcnt(2)
v_mfma_f32_16x16x32_bf16 v[32:35], a[64:67], v[16:19], v[32:35]
v_mfma_f32_16x16x32_bf16 v[36:39], a[68:71], v[16:19], v[36:39]
ds_read_b128 v[16:19], v2 offset:12288
v_mfma_f32_16x16x32_bf16 v[32:35], a[72:75], v[20:23], v[32:35]
buffer_load_dwordx4 v2, s[8:11], s42 offen offset:2048 sc1 lds
v_mfma_f32_16x16x32_bf16 v[36:39], a[76:79], v[20:23], v[36:39]
ds_read_b128 v[20:23], v2 offset:13312
s_waitcnt lgkmcnt(2)
v_mfma_f32_16x16x32_bf16 v[32:35], a[80:83], v[24:27], v[32:35]
v_mfma_f32_16x16x32_bf16 v[36:39], a[84:87], v[24:27], v[36:39]
ds_read_b128 v[24:27], v2 offset:14336
v_mfma_f32_16x16x32_bf16 v[32:35], a[88:91], v[28:31], v[32:35]
buffer_load_dwordx4 v2, s[8:11], s42 offen offset:3072 sc1 lds
v_mfma_f32_16x16x32_bf16 v[36:39], a[92:95], v[28:31], v[36:39]
ds_read_b128 v[28:31], v2 offset:15360
s_waitcnt lgkmcnt(2)
v_mfma_f32_16x16x32_bf16 v[32:35], a[96:99], v[16:19], v[32:35]
v_mfma_f32_16x16x32_bf16 v[36:39], a[100:103], v[16:19], v[36:39]
ds_read_b128 v[16:19], v2 offset:16384
v_mfma_f32_16x16x32_bf16 v[32:35], a[104:107], v[20:23], v[32:35]
s_add_u32 s42, s42, 4096
s_add_u32 m0, s45, 63488
s_nop 0
buffer_load_dwordx4 v2, s[8:11], s42 offen offset:0 sc1 lds
v_mfma_f32_16x16x32_bf16 v[36:39], a[108:111], v[20:23], v[36:39]
ds_read_b128 v[20:23], v2 offset:17408
s_waitcnt lgkmcnt(2)
v_mfma_f32_16x16x32_bf16 v[32:35], a[112:115], v[24:27], v[32:35]
v_mfma_f32_16x16x32_bf16 v[36:39], a[116:119], v[24:27], v[36:39]
ds_read_b128 v[24:27], v2 offset:18432
v_mfma_f32_16x16x32_bf16 v[32:35], a[120:123], v[28:31], v[32:35]
buffer_load_dwordx4 v2, s[8:11], s42 offen offset:1024 sc1 lds
v_mfma_f32_16x16x32_bf16 v[36:39], a[124:127], v[28:31], v[36:39]
ds_read_b128 v[28:31], v2 offset:19456
s_waitcnt lgkmcnt(2)
v_mfma_f32_16x16x32_bf16 v[32:35], a[128:131], v[16:19], v[32:35]
v_mfma_f32_16x16x32_bf16 v[36:39], a[132:135], v[16:19], v[36:39]
ds_read_b128 v[16:19], v2 offset:20480
v_mfma_f32_16x16x32_bf16 v[32:35], a[136:139], v[20:23], v[32:35]
v_mfma_f32_16x16x32_bf16 v[36:39], a[140:143], v[20:23], v[36:39]
ds_read_b128 v[20:23], v2 offset:21504
s_waitcnt lgkmcnt(2)
v_mfma_f32_16x16x32_bf16 v[32:35], a[144:147], v[24:27], v[32:35]
buffer_load_dwordx4 v2, s[8:11], s42 offen offset:2048 sc1 lds
v_mfma_f32_16x16x32_bf16 v[36:39], a[148:151], v[24:27], v[36:39]
ds_read_b128 v[24:27], v2 offset:22528
v_mfma_f32_16x16x32_bf16 v[32:35], a[152:155], v[28:31], v[32:35]
v_mfma_f32_16x16x32_bf16 v[36:39], a[156:159], v[28:31], v[36:39]
ds_read_b128 v[28:31], v2 offset:23552
s_waitcnt lgkmcnt(2)
v_mfma_f32_16x16x32_bf16 v[32:35], a[160:163], v[16:19], v[32:35]
buffer_load_dwordx4 v2, s[8:11], s42 offen offset:3072 sc1 lds
v_mfma_f32_16x16x32_bf16 v[36:39], a[164:167], v[16:19], v[36:39]
ds_read_b128 v[16:19], v2 offset:24576
v_mfma_f32_16x16x32_bf16 v[32:35], a[168:171], v[20:23], v[32:35]
v_mfma_f32_16x16x32_bf16 v[36:39], a[172:175], v[20:23], v[36:39]
ds_read_b128 v[20:23], v2 offset:25600
s_waitcnt lgkmcnt(2)
v_mfma_f32_16x16x32_bf16 v[32:35], a[176:179], v[24:27], v[32:35]
s_add_u32 s42, s42, 4096
s_add_u32 m0, s45, 67584
s_nop 0
buffer_load_dwordx4 v2, s[8:11], s42 offen offset:0 sc1 lds
v_mfma_f32_16x16x32_bf16 v[36:39], a[180:183], v[24:27], v[36:39]
ds_read_b128 v[24:27], v2 offset:26624
v_mfma_f32_16x16x32_bf16 v[32:35], a[184:187], v[28:31], v[32:35]
v_mfma_f32_16x16x32_bf16 v[36:39], a[188:191], v[28:31], v[36:39]
ds_read_b128 v[28:31], v2 offset:27648
s_waitcnt lgkmcnt(2)
v_mfma_f32_16x16x32_bf16 v[32:35], a[192:195], v[16:19], v[32:35]
v_mfma_f32_16x16x32_bf16 v[36:39], a[196:199], v[16:19], v[36:39]
ds_read_b128 v[16:19], v2 offset:28672
buffer_store_dwordx2 v[76:77], v4, s[12:15], s26 offen
v_mfma_f32_16x16x32_bf16 v[32:35], a[200:203], v[20:23], v[32:35]
v_mfma_f32_16x16x32_bf16 v[36:39], a[204:207], v[20:23], v[36:39]
ds_read_b128 v[20:23], v2 offset:29696
s_waitcnt lgkmcnt(2)
v_mfma_f32_16x16x32_bf16 v[32:35], a[208:211], v[24:27], v[32:35]
v_mfma_f32_16x16x32_bf16 v[36:39], a[212:215], v[24:27], v[36:39]
ds_read_b128 v[24:27], v2 offset:30720
v_mfma_f32_16x16x32_bf16 v[32:35], a[216:219], v[28:31], v[32:35]
v_mfma_f32_16x16x32_bf16 v[36:39], a[220:223], v[28:31], v[36:39]
ds_read_b128 v[28:31], v2 offset:31744
s_waitcnt lgkmcnt(2)
v_mfma_f32_16x16x32_bf16 v[32:35], a[224:227], v[16:19], v[32:35]
v_mfma_f32_16x16x32_bf16 v[36:39], a[228:231], v[16:19], v[36:39]
ds_read_b128 v[16:19], v2 offset:32768
v_mfma_f32_16x16x32_bf16 v[32:35], a[232:235], v[20:23], v[32:35]
v_mfma_f32_16x16x32_bf16 v[36:39], a[236:239], v[20:23], v[36:39]
ds_read_b128 v[20:23], v2 offset:33792
s_waitcnt lgkmcnt(2)
v_mfma_f32_16x16x32_bf16 v[32:35], a[240:243], v[24:27], v[32:35]
v_mfma_f32_16x16x32_bf16 v[36:39], a[244:247], v[24:27], v[36:39]
ds_read_b128 v[24:27], v2 offset:34816
v_mfma_f32_16x16x32_bf16 v[32:35], a[248:251], v[28:31], v[32:35]
v_mfma_f32_16x16x32_bf16 v[36:39], a[252:255], v[28:31], v[36:39]
ds_read_b128 v[28:31], v2 offset:35840
s_waitcnt lgkmcnt(2)
v_mfma_f32_16x16x32_bf16 v[32:35], v[80:83], v[16:19], v[32:35]
buffer_load_dwordx4 v2, s[8:11], s42 offen offset:1024 sc1 lds
v_mfma_f32_16x16x32_bf16 v[36:39], v[84:87], v[16:19], v[36:39]
ds_read_b128 v[16:19], v2 offset:36864
v_mfma_f32_16x16x32_bf16 v[32:35], v[88:91], v[20:23], v[32:35]
v_mfma_f32_16x16x32_bf16 v[36:39], v[92:95], v[20:23], v[36:39]
ds_read_b128 v[20:23], v2 offset:37888
s_waitcnt lgkmcnt(2)
v_mfma_f32_16x16x32_bf16 v[32:35], v[96:99], v[24:27], v[32:35]
v_mfma_f32_16x16x32_bf16 v[36:39], v[100:103], v[24:27], v[36:39]
ds_read_b128 v[24:27], v2 offset:38912
v_mfma_f32_16x16x32_bf16 v[32:35], v[104:107], v[28:31], v[32:35]
buffer_store_dwordx2 v[78:79], v4, s[12:15], s26 offen offset:32
v_mfma_f32_16x16x32_bf16 v[36:39], v[108:111], v[28:31], v[36:39]
ds_read_b128 v[28:31], v2 offset:39936
s_waitcnt lgkmcnt(2)
v_mfma_f32_16x16x32_bf16 v[32:35], v[112:115], v[16:19], v[32:35]
v_mfma_f32_16x16x32_bf16 v[36:39], v[116:119], v[16:19], v[36:39]
ds_read_b128 v[16:19], v2 offset:40960
v_mfma_f32_16x16x32_bf16 v[32:35], v[120:123], v[20:23], v[32:35]
v_mfma_f32_16x16x32_bf16 v[36:39], v[124:127], v[20:23], v[36:39]
ds_read_b128 v[20:23], v2 offset:41984
s_waitcnt lgkmcnt(2)
v_mfma_f32_16x16x32_bf16 v[32:35], v[128:131], v[24:27], v[32:35]
v_mfma_f32_16x16x32_bf16 v[36:39], v[132:135], v[24:27], v[36:39]
ds_read_b128 v[24:27], v2 offset:43008
v_mfma_f32_16x16x32_bf16 v[32:35], v[136:139], v[28:31], v[32:35]
v_mfma_f32_16x16x32_bf16 v[36:39], v[140:143], v[28:31], v[36:39]
ds_read_b128 v[28:31], v2 offset:44032
s_waitcnt lgkmcnt(2)
v_mfma_f32_16x16x32_bf16 v[32:35], v[144:147], v[16:19], v[32:35]
v_mfma_f32_16x16x32_bf16 v[36:39], v[148:151], v[16:19], v[36:39]
ds_read_b128 v[16:19], v2 offset:45056
v_mfma_f32_16x16x32_bf16 v[32:35], v[152:155], v[20:23], v[32:35]
v_mfma_f32_16x16x32_bf16 v[36:39], v[156:159], v[20:23], v[36:39]
ds_read_b128 v[20:23], v2 offset:46080
s_waitcnt lgkmcnt(2)
v_mfma_f32_16x16x32_bf16 v[32:35], v[160:163], v[24:27], v[32:35]
v_mfma_f32_16x16x32_bf16 v[36:39], v[164:167], v[24:27], v[36:39]
ds_read_b128 v[24:27], v2 offset:47104
v_mfma_f32_16x16x32_bf16 v[32:35], v[168:171], v[28:31], v[32:35]
v_mfma_f32_16x16x32_bf16 v[36:39], v[172:175], v[28:31], v[36:39]
ds_read_b128 v[28:31], v2 offset:48128
s_waitcnt lgkmcnt(2)
v_mfma_f32_16x16x32_bf16 v[32:35], v[176:179], v[16:19], v[32:35]
v_mfma_f32_16x16x32_bf16 v[36:39], v[180:183], v[16:19], v[36:39]
ds_read_b128 v[16:19], v2 offset:49152
v_mfma_f32_16x16x32_bf16 v[32:35], v[184:187], v[20:23], v[32:35]
v_mfma_f32_16x16x32_bf16 v[36:39], v[188:191], v[20:23], v[36:39]
ds_read_b128 v[20:23], v2 offset:50176
s_waitcnt lgkmcnt(2)
v_mfma_f32_16x16x32_bf16 v[32:35], v[192:195], v[24:27], v[32:35]
v_mfma_f32_16x16x32_bf16 v[36:39], v[196:199], v[24:27], v[36:39]
ds_read_b128 v[24:27], v2 offset:51200
v_mfma_f32_16x16x32_bf16 v[32:35], v[200:203], v[28:31], v[32:35]
v_mfma_f32_16x16x32_bf16 v[36:39], v[204:207], v[28:31], v[36:39]
ds_read_b128 v[28:31], v2 offset:52224
s_waitcnt lgkmcnt(2)
v_mfma_f32_16x16x32_bf16 v[32:35], v[208:211], v[16:19], v[32:35]
v_mfma_f32_16x16x32_bf16 v[36:39], v[212:215], v[16:19], v[36:39]
ds_read_b128 v[16:19], v2 offset:53248
v_mfma_f32_16x16x32_bf16 v[32:35], v[216:219], v[20:23], v[32:35]
v_mfma_f32_16x16x32_bf16 v[36:39], v[220:223], v[20:23], v[36:39]
ds_read_b128 v[20:23], v2 offset:54272
ds_read_b128 v[76:79], v8 offset:28672
s_waitcnt lgkmcnt(3)
v_mfma_f32_16x16x32_bf16 v[32:35], v[224:227], v[24:27], v[32:35]
s_waitcnt lgkmcnt(0)
v_lshlrev_b32 v40, 16, v76
v_and_b32 v41, 0xffff0000, v76
v_lshlrev_b32 v42, 16, v77
v_mfma_f32_16x16x32_bf16 v[36:39], v[228:231], v[24:27], v[36:39]
v_and_b32 v43, 0xffff0000, v77
v_lshlrev_b32 v44, 16, v78
v_and_b32 v45, 0xffff0000, v78
v_mfma_f32_16x16x32_bf16 v[32:35], v[232:235], v[28:31], v[32:35]
v_lshlrev_b32 v46, 16, v79
v_and_b32 v47, 0xffff0000, v79
v_mfma_f32_16x16x32_bf16 v[36:39], v[236:239], v[28:31], v[36:39]
s_cmp_eq_u32 s10, 0
s_cbranch_scc1 Lg2_falate14
Lg2_faret14:
s_waitcnt vmcnt(1) lgkmcnt(0)
s_barrier
ds_read_b128 v[24:27], v3 offset:0
ds_read_b128 v[28:31], v3 offset:1024
v_mfma_f32_16x16x32_bf16 v[32:35], v[240:243], v[16:19], v[32:35]
v_mfma_f32_16x16x32_bf16 v[36:39], v[244:247], v[16:19], v[36:39]
ds_read_b128 v[16:19], v3 offset:2048
v_mfma_f32_16x16x32_bf16 v[32:35], v[248:251], v[20:23], v[32:35]
v_mfma_f32_16x16x32_bf16 v[36:39], v[252:255], v[20:23], v[36:39]
ds_read_b128 v[20:23], v3 offset:3072
s_waitcnt lgkmcnt(2)
v_mfma_f32_16x16x32_bf16 v[40:43], a[0:3], v[24:27], v[40:43]
s_add_u32 s26, s37, 1966080
s_nop 2
v_cvt_pk_bf16_f32 v76, v32, v33
v_mfma_f32_16x16x32_bf16 v[44:47], a[4:7], v[24:27], v[44:47]
ds_read_b128 v[24:27], v3 offset:4096
v_cvt_pk_bf16_f32 v77, v34, v35
v_mfma_f32_16x16x32_bf16 v[40:43], a[8:11], v[28:31], v[40:43]
v_cvt_pk_bf16_f32 v78, v36, v37
v_cvt_pk_bf16_f32 v79, v38, v39
v_mfma_f32_16x16x32_bf16 v[44:47], a[12:15], v[28:31], v[44:47]
ds_read_b128 v[28:31], v3 offset:5120
s_waitcnt lgkmcnt(2)
v_mfma_f32_16x16x32_bf16 v[40:43], a[16:19], v[16:19], v[40:43]
buffer_store_dwordx2 v[76:77], v4, s[12:15], s26 offen
v_mfma_f32_16x16x32_bf16 v[44:47], a[20:23], v[16:19], v[44:47]
ds_read_b128 v[16:19], v3 offset:6144
v_mfma_f32_16x16x32_bf16 v[40:43], a[24:27], v[20:23], v[40:43]
v_mfma_f32_16x16x32_bf16 v[44:47], a[28:31], v[20:23], v[44:47]
ds_read_b128 v[20:23], v3 offset:7168
s_waitcnt lgkmcnt(2)
v_mfma_f32_16x16x32_bf16 v[40:43], a[32:35], v[24:27], v[40:43]
buffer_store_dwordx2 v[78:79], v4, s[12:15], s26 offen offset:32
v_mfma_f32_16x16x32_bf16 v[44:47], a[36:39], v[24:27], v[44:47]
ds_read_b128 v[24:27], v3 offset:8192
v_mfma_f32_16x16x32_bf16 v[40:43], a[40:43], v[28:31], v[40:43]
v_mfma_f32_16x16x32_bf16 v[44:47], a[44:47], v[28:31], v[44:47]
ds_read_b128 v[28:31], v3 offset:9216
s_waitcnt lgkmcnt(2)
v_mfma_f32_16x16x32_bf16 v[40:43], a[48:51], v[16:19], v[40:43]
v_mfma_f32_16x16x32_bf16 v[44:47], a[52:55], v[16:19], v[44:47]
ds_read_b128 v[16:19], v3 offset:10240
v_mfma_f32_16x16x32_bf16 v[40:43], a[56:59], v[20:23], v[40:43]
v_mfma_f32_16x16x32_bf16 v[44:47], a[60:63], v[20:23], v[44:47]
ds_read_b128 v[20:23], v3 offset:11264
s_waitcnt lgkmcnt(2)
v_mfma_f32_16x16x32_bf16 v[40:43], a[64:67], v[24:27], v[40:43]
v_mfma_f32_16x16x32_bf16 v[44:47], a[68:71], v[24:27], v[44:47]
ds_read_b128 v[24:27], v3 offset:12288
v_mfma_f32_16x16x32_bf16 v[40:43], a[72:75], v[28:31], v[40:43]
v_mfma_f32_16x16x32_bf16 v[44:47], a[76:79], v[28:31], v[44:47]
ds_read_b128 v[28:31], v3 offset:13312
s_waitcnt lgkmcnt(2)
v_mfma_f32_16x16x32_bf16 v[40:43], a[80:83], v[16:19], v[40:43]
v_mfma_f32_16x16x32_bf16 v[44:47], a[84:87], v[16:19], v[44:47]
ds_read_b128 v[16:19], v3 offset:14336
v_mfma_f32_16x16x32_bf16 v[40:43], a[88:91], v[20:23], v[40:43]
v_mfma_f32_16x16x32_bf16 v[44:47], a[92:95], v[20:23], v[44:47]
ds_read_b128 v[20:23], v3 offset:15360
s_waitcnt lgkmcnt(2)
v_mfma_f32_16x16x32_bf16 v[40:43], a[96:99], v[24:27], v[40:43]
v_mfma_f32_16x16x32_bf16 v[44:47], a[100:103], v[24:27], v[44:47]
ds_read_b128 v[24:27], v3 offset:16384
v_mfma_f32_16x16x32_bf16 v[40:43], a[104:107], v[28:31], v[40:43]
v_mfma_f32_16x16x32_bf16 v[44:47], a[108:111], v[28:31], v[44:47]
ds_read_b128 v[28:31], v3 offset:17408
s_waitcnt lgkmcnt(2)
v_mfma_f32_16x16x32_bf16 v[40:43], a[112:115], v[16:19], v[40:43]
v_mfma_f32_16x16x32_bf16 v[44:47], a[116:119], v[16:19], v[44:47]
ds_read_b128 v[16:19], v3 offset:18432
v_mfma_f32_16x16x32_bf16 v[40:43], a[120:123], v[20:23], v[40:43]
v_mfma_f32_16x16x32_bf16 v[44:47], a[124:127], v[20:23], v[44:47]
ds_read_b128 v[20:23], v3 offset:19456
s_waitcnt lgkmcnt(2)
v_mfma_f32_16x16x32_bf16 v[40:43], a[128:131], v[24:27], v[40:43]
v_mfma_f32_16x16x32_bf16 v[44:47], a[132:135], v[24:27], v[44:47]
ds_read_b128 v[24:27], v3 offset:20480
v_mfma_f32_16x16x32_bf16 v[40:43], a[136:139], v[28:31], v[40:43]
v_mfma_f32_16x16x32_bf16 v[44:47], a[140:143], v[28:31], v[44:47]
ds_read_b128 v[28:31], v3 offset:21504
s_waitcnt lgkmcnt(2)
v_mfma_f32_16x16x32_bf16 v[40:43], a[144:147], v[16:19], v[40:43]
v_mfma_f32_16x16x32_bf16 v[44:47], a[148:151], v[16:19], v[44:47]
ds_read_b128 v[16:19], v3 offset:22528
v_mfma_f32_16x16x32_bf16 v[40:43], a[152:155], v[20:23], v[40:43]
v_mfma_f32_16x16x32_bf16 v[44:47], a[156:159], v[20:23], v[44:47]
ds_read_b128 v[20:23], v3 offset:23552
s_waitcnt lgkmcnt(2)
v_mfma_f32_16x16x32_bf16 v[40:43], a[160:163], v[24:27], v[40:43]
v_mfma_f32_16x16x32_bf16 v[44:47], a[164:167], v[24:27], v[44:47]
ds_read_b128 v[24:27], v3 offset:24576
v_mfma_f32_16x16x32_bf16 v[40:43], a[168:171], v[28:31], v[40:43]
v_mfma_f32_16x16x32_bf16 v[44:47], a[172:175], v[28:31], v[44:47]
ds_read_b128 v[28:31], v3 offset:25600
s_waitcnt lgkmcnt(2)
v_mfma_f32_16x16x32_bf16 v[40:43], a[176:179], v[16:19], v[40:43]
v_mfma_f32_16x16x32_bf16 v[44:47], a[180:183], v[16:19], v[44:47]
ds_read_b128 v[16:19], v3 offset:26624
v_mfma_f32_16x16x32_bf16 v[40:43], a[184:187], v[20:23], v[40:43]
v_mfma_f32_16x16x32_bf16 v[44:47], a[188:191], v[20:23], v[44:47]
ds_read_b128 v[20:23], v3 offset:27648
s_waitcnt lgkmcnt(2)
v_mfma_f32_16x16x32_bf16 v[40:43], a[192:195], v[24:27], v[40:43]
v_mfma_f32_16x16x32_bf16 v[44:47], a[196:199], v[24:27], v[44:47]
ds_read_b128 v[24:27], v3 offset:28672
v_mfma_f32_16x16x32_bf16 v[40:43], a[200:203], v[28:31], v[40:43]
v_mfma_f32_16x16x32_bf16 v[44:47], a[204:207], v[28:31], v[44:47]
ds_read_b128 v[28:31], v3 offset:29696
s_waitcnt lgkmcnt(2)
v_mfma_f32_16x16x32_bf16 v[40:43], a[208:211], v[16:19], v[40:43]
v_mfma_f32_16x16x32_bf16 v[44:47], a[212:215], v[16:19], v[44:47]
ds_read_b128 v[16:19], v3 offset:30720
v_mfma_f32_16x16x32_bf16 v[40:43], a[216:219], v[20:23], v[40:43]
v_mfma_f32_16x16x32_bf16 v[44:47], a[220:223], v[20:23], v[44:47]
ds_read_b128 v[20:23], v3 offset:31744
s_waitcnt lgkmcnt(2)
v_mfma_f32_16x16x32_bf16 v[40:43], a[224:227], v[24:27], v[40:43]
v_mfma_f32_16x16x32_bf16 v[44:47], a[228:231], v[24:27], v[44:47]
ds_read_b128 v[24:27], v3 offset:32768
v_mfma_f32_16x16x32_bf16 v[40:43], a[232:235], v[28:31], v[40:43]
v_mfma_f32_16x16x32_bf16 v[44:47], a[236:239], v[28:31], v[44:47]
ds_read_b128 v[28:31], v3 offset:33792
s_waitcnt lgkmcnt(2)
v_mfma_f32_16x16x32_bf16 v[40:43], a[240:243], v[16:19], v[40:43]
v_mfma_f32_16x16x32_bf16 v[44:47], a[244:247], v[16:19], v[44:47]
ds_read_b128 v[16:19], v3 offset:34816
v_mfma_f32_16x16x32_bf16 v[40:43], a[248:251], v[20:23], v[40:43]
v_mfma_f32_16x16x32_bf16 v[44:47], a[252:255], v[20:23], v[44:47]
ds_read_b128 v[20:23], v3 offset:35840
s_waitcnt lgkmcnt(2)
v_mfma_f32_16x16x32_bf16 v[40:43], v[80:83], v[24:27], v[40:43]
v_mfma_f32_16x16x32_bf16 v[44:47], v[84:87], v[24:27], v[44:47]
ds_read_b128 v[24:27], v3 offset:36864
v_mfma_f32_16x16x32_bf16 v[40:43], v[88:91], v[28:31], v[40:43]
v_mfma_f32_16x16x32_bf16 v[44:47], v[92:95], v[28:31], v[44:47]
ds_read_b128 v[28:31], v3 offset:37888
s_waitcnt lgkmcnt(2)
v_mfma_f32_16x16x32_bf16 v[40:43], v[96:99], v[16:19], v[40:43]
v_mfma_f32_16x16x32_bf16 v[44:47], v[100:103], v[16:19], v[44:47]
ds_read_b128 v[16:19], v3 offset:38912
v_mfma_f32_16x16x32_bf16 v[40:43], v[104:107], v[20:23], v[40:43]
v_mfma_f32_16x16x32_bf16 v[44:47], v[108:111], v[20:23], v[44:47]
ds_read_b128 v[20:23], v3 offset:39936
s_waitcnt lgkmcnt(2)
v_mfma_f32_16x16x32_bf16 v[40:43], v[112:115], v[24:27], v[40:43]
v_mfma_f32_16x16x32_bf16 v[44:47], v[116:119], v[24:27], v[44:47]
ds_read_b128 v[24:27], v3 offset:40960
v_mfma_f32_16x16x32_bf16 v[40:43], v[120:123], v[28:31], v[40:43]
v_mfma_f32_16x16x32_bf16 v[44:47], v[124:127], v[28:31], v[44:47]
ds_read_b128 v[28:31], v3 offset:41984
s_waitcnt lgkmcnt(2)
v_mfma_f32_16x16x32_bf16 v[40:43], v[128:131], v[16:19], v[40:43]
v_mfma_f32_16x16x32_bf16 v[44:47], v[132:135], v[16:19], v[44:47]
ds_read_b128 v[16:19], v3 offset:43008
v_mfma_f32_16x16x32_bf16 v[40:43], v[136:139], v[20:23], v[40:43]
v_mfma_f32_16x16x32_bf16 v[44:47], v[140:143], v[20:23], v[44:47]
ds_read_b128 v[20:23], v3 offset:44032
s_waitcnt lgkmcnt(2)
v_mfma_f32_16x16x32_bf16 v[40:43], v[144:147], v[24:27], v[40:43]
v_mfma_f32_16x16x32_bf16 v[44:47], v[148:151], v[24:27], v[44:47]
ds_read_b128 v[24:27], v3 offset:45056
v_mfma_f32_16x16x32_bf16 v[40:43], v[152:155], v[28:31], v[40:43]
v_mfma_f32_16x16x32_bf16 v[44:47], v[156:159], v[28:31], v[44:47]
ds_read_b128 v[28:31], v3 offset:46080
s_waitcnt lgkmcnt(2)
v_mfma_f32_16x16x32_bf16 v[40:43], v[160:163], v[16:19], v[40:43]
v_mfma_f32_16x16x32_bf16 v[44:47], v[164:167], v[16:19], v[44:47]
ds_read_b128 v[16:19], v3 offset:47104
v_mfma_f32_16x16x32_bf16 v[40:43], v[168:171], v[20:23], v[40:43]
v_mfma_f32_16x16x32_bf16 v[44:47], v[172:175], v[20:23], v[44:47]
ds_read_b128 v[20:23], v3 offset:48128
s_waitcnt lgkmcnt(2)
v_mfma_f32_16x16x32_bf16 v[40:43], v[176:179], v[24:27], v[40:43]
v_mfma_f32_16x16x32_bf16 v[44:47], v[180:183], v[24:27], v[44:47]
ds_read_b128 v[24:27], v3 offset:49152
v_mfma_f32_16x16x32_bf16 v[40:43], v[184:187], v[28:31], v[40:43]
v_mfma_f32_16x16x32_bf16 v[44:47], v[188:191], v[28:31], v[44:47]
ds_read_b128 v[28:31], v3 offset:50176
s_waitcnt lgkmcnt(2)
v_mfma_f32_16x16x32_bf16 v[40:43], v[192:195], v[16:19], v[40:43]
v_mfma_f32_16x16x32_bf16 v[44:47], v[196:199], v[16:19], v[44:47]
ds_read_b128 v[16:19], v3 offset:51200
v_mfma_f32_16x16x32_bf16 v[40:43], v[200:203], v[20:23], v[40:43]
v_mfma_f32_16x16x32_bf16 v[44:47], v[204:207], v[20:23], v[44:47]
ds_read_b128 v[20:23], v3 offset:52224
s_waitcnt lgkmcnt(2)
v_mfma_f32_16x16x32_bf16 v[40:43], v[208:211], v[24:27], v[40:43]
v_mfma_f32_16x16x32_bf16 v[44:47], v[212:215], v[24:27], v[44:47]
ds_read_b128 v[24:27], v3 offset:53248
v_mfma_f32_16x16x32_bf16 v[40:43], v[216:219], v[28:31], v[40:43]
v_mfma_f32_16x16x32_bf16 v[44:47], v[220:223], v[28:31], v[44:47]
ds_read_b128 v[28:31], v3 offset:54272
s_waitcnt lgkmcnt(2)
v_mfma_f32_16x16x32_bf16 v[40:43], v[224:227], v[16:19], v[40:43]
v_mfma_f32_16x16x32_bf16 v[44:47], v[228:231], v[16:19], v[44:47]
v_mfma_f32_16x16x32_bf16 v[40:43], v[232:235], v[20:23], v[40:43]
v_mfma_f32_16x16x32_bf16 v[44:47], v[236:239], v[20:23], v[44:47]
s_waitcnt lgkmcnt(0)
v_mfma_f32_16x16x32_bf16 v[40:43], v[240:243], v[24:27], v[40:43]
v_mfma_f32_16x16x32_bf16 v[44:47], v[244:247], v[24:27], v[44:47]
v_mfma_f32_16x16x32_bf16 v[40:43], v[248:251], v[28:31], v[40:43]
v_mfma_f32_16x16x32_bf16 v[44:47], v[252:255], v[28:31], v[44:47]
s_nop 7
s_add_u32 s26, s37, 2293760
v_cvt_pk_bf16_f32 v76, v40, v41
v_cvt_pk_bf16_f32 v77, v42, v43
v_cvt_pk_bf16_f32 v78, v44, v45
v_cvt_pk_bf16_f32 v79, v46, v47
buffer_store_dwordx2 v[76:77], v4, s[12:15], s26 offen
buffer_store_dwordx2 v[78:79], v4, s[12:15], s26 offen offset:32
s_waitcnt vmcnt(0)
s_branch Lg2_done
Lg2_falate0:
s_add_u32 s92, s31, 16384
s_mov_b32 s90, 40000
Lpoll_33:
buffer_load_dword v59, v9, s[4:7], s92 offen sc1
s_waitcnt vmcnt(0)
v_cmp_ne_u32 vcc, s20, v59
s_cmp_eq_u64 vcc, 0
s_cbranch_scc1 Lpok_34

s_sub_u32 s90, s90, 1
s_cmp_lg_u32 s90, 0
s_cbranch_scc1 Lpoll_33
s_mov_b32 s8, s86
s_mov_b32 s9, s87
s_mov_b32 s10, 0x100
s_mov_b32 s11, 0x20000
v_mov_b32 v2, 0x8
v_mov_b32 v3, 0x20
s_nop 1
buffer_store_dword v2, v3, s[8:11], 0 offen
s_waitcnt vmcnt(0)
s_endpgm
Lpok_34:
s_waitcnt vmcnt(0)
s_add_u32 s93, s30, 0xd8000
s_add_u32 m0, s45, 55296
s_nop 0
buffer_load_dwordx4 v2, s[4:7], s93 offen offset:0 sc1 lds
buffer_load_dwordx4 v2, s[4:7], s93 offen offset:1024 sc1 lds
buffer_load_dwordx4 v2, s[4:7], s93 offen offset:2048 sc1 lds
buffer_load_dwordx4 v2, s[4:7], s93 offen offset:3072 sc1 lds
s_add_u32 s93, s93, 4096
s_add_u32 m0, s45, 59392
s_nop 0
buffer_load_dwordx4 v2, s[4:7], s93 offen offset:0 sc1 lds
buffer_load_dwordx4 v2, s[4:7], s93 offen offset:1024 sc1 lds
buffer_load_dwordx4 v2, s[4:7], s93 offen offset:2048 sc1 lds
buffer_load_dwordx4 v2, s[4:7], s93 offen offset:3072 sc1 lds
s_add_u32 s93, s93, 4096
s_add_u32 m0, s45, 63488
s_nop 0
buffer_load_dwordx4 v2, s[4:7], s93 offen offset:0 sc1 lds
buffer_load_dwordx4 v2, s[4:7], s93 offen offset:1024 sc1 lds
buffer_load_dwordx4 v2, s[4:7], s93 offen offset:2048 sc1 lds
buffer_load_dwordx4 v2, s[4:7], s93 offen offset:3072 sc1 lds
s_add_u32 s93, s93, 4096
s_add_u32 m0, s45, 67584
s_nop 0
buffer_load_dwordx4 v2, s[4:7], s93 offen offset:0 sc1 lds
buffer_load_dwordx4 v2, s[4:7], s93 offen offset:1024 sc1 lds
s_add_u32 s92, s31, 32768
buffer_load_dword v59, v9, s[4:7], s92 offen sc1
s_waitcnt vmcnt(0)
s_branch Lg2_faret0
Lg2_falate1:
s_add_u32 s92, s31, 32768
s_mov_b32 s90, 40000
Lpoll_36:
buffer_load_dword v59, v9, s[4:7], s92 offen sc1
s_waitcnt vmcnt(0)
v_cmp_ne_u32 vcc, s20, v59
s_cmp_eq_u64 vcc, 0
s_cbranch_scc1 Lpok_37

s_sub_u32 s90, s90, 1
s_cmp_lg_u32 s90, 0
s_cbranch_scc1 Lpoll_36
s_mov_b32 s8, s86
s_mov_b32 s9, s87
s_mov_b32 s10, 0x100
s_mov_b32 s11, 0x20000
v_mov_b32 v2, 0x8
v_mov_b32 v3, 0x20
s_nop 1
buffer_store_dword v2, v3, s[8:11], 0 offen
s_waitcnt vmcnt(0)
s_endpgm
Lpok_37:
s_waitcnt vmcnt(0)
s_add_u32 s93, s30, 0x1b0000
s_add_u32 m0, s45, 0
s_nop 0
buffer_load_dwordx4 v2, s[4:7], s93 offen offset:0 sc1 lds
buffer_load_dwordx4 v2, s[4:7], s93 offen offset:1024 sc1 lds
buffer_load_dwordx4 v2, s[4:7], s93 offen offset:2048 sc1 lds
buffer_load_dwordx4 v2, s[4:7], s93 offen offset:3072 sc1 lds
s_add_u32 s93, s93, 4096
s_add_u32 m0, s45, 4096
s_nop 0
buffer_load_dwordx4 v2, s[4:7], s93 offen offset:0 sc1 lds
buffer_load_dwordx4 v2, s[4:7], s93 offen offset:1024 sc1 lds
buffer_load_dwordx4 v2, s[4:7], s93 offen offset:2048 sc1 lds
buffer_load_dwordx4 v2, s[4:7], s93 offen offset:3072 sc1 lds
s_add_u32 s93, s93, 4096
s_add_u32 m0, s45, 8192
s_nop 0
buffer_load_dwordx4 v2, s[4:7], s93 offen offset:0 sc1 lds
buffer_load_dwordx4 v2, s[4:7], s93 offen offset:1024 sc1 lds
buffer_load_dwordx4 v2, s[4:7], s93 offen offset:2048 sc1 lds
buffer_load_dwordx4 v2, s[4:7], s93 offen offset:3072 sc1 lds
s_add_u32 s93, s93, 4096
s_add_u32 m0, s45, 12288
s_nop 0
buffer_load_dwordx4 v2, s[4:7], s93 offen offset:0 sc1 lds
buffer_load_dwordx4 v2, s[4:7], s93 offen offset:1024 sc1 lds
s_add_u32 s92, s31, 49152
buffer_load_dword v59, v9, s[4:7], s92 offen sc1
s_waitcnt vmcnt(0)
s_branch Lg2_faret1
Lg2_e2late0:
s_add_u32 s92, s33, 0
s_mov_b32 s90, 40000
Lpg_39:
buffer_load_dwordx3 v[48:50], v64, s[4:7], s92 offen sc1
buffer_load_dwordx3 v[52:54], v65, s[4:7], s92 offen sc1
s_waitcnt vmcnt(0)
v_cmp_ne_u32 vcc, s20, v50
v_cmp_ne_u32 s[28:29], s20, v54
s_nop 0
s_or_b64 vcc, vcc, s[28:29]
s_cmp_eq_u64 vcc, 0
s_cbranch_scc1 Lpgok_40
s_sub_u32 s90, s90, 1
s_cmp_lg_u32 s90, 0
s_cbranch_scc1 Lpg_39
s_mov_b32 s8, s86
s_mov_b32 s9, s87
s_mov_b32 s10, 0x100
s_mov_b32 s11, 0x20000
v_mov_b32 v2, 0x7
v_mov_b32 v3, 0x1c
s_nop 1
buffer_store_dword v2, v3, s[8:11], 0 offen
s_waitcnt vmcnt(0)
s_endpgm
Lpgok_40:
s_waitcnt vmcnt(0)
s_branch Lg2_e2ret0
Lg2_falate2:
s_add_u32 s92, s31, 49152
s_mov_b32 s90, 40000
Lpoll_41:
buffer_load_dword v59, v9, s[4:7], s92 offen sc1
s_waitcnt vmcnt(0)
v_cmp_ne_u32 vcc, s20, v59
s_cmp_eq_u64 vcc, 0
s_cbranch_scc1 Lpok_42

s_sub_u32 s90, s90, 1
s_cmp_lg_u32 s90, 0
s_cbranch_scc1 Lpoll_41
s_mov_b32 s8, s86
s_mov_b32 s9, s87
s_mov_b32 s10, 0x100
s_mov_b32 s11, 0x20000
v_mov_b32 v2, 0x8
v_mov_b32 v3, 0x20
s_nop 1
buffer_store_dword v2, v3, s[8:11], 0 offen
s_waitcnt vmcnt(0)
s_endpgm
Lpok_42:
s_waitcnt vmcnt(0)
s_add_u32 s93, s30, 0x288000
s_add_u32 m0, s45, 55296
s_nop 0
buffer_load_dwordx4 v2, s[4:7], s93 offen offset:0 sc1 lds
buffer_load_dwordx4 v2, s[4:7], s93 offen offset:1024 sc1 lds
buffer_load_dwordx4 v2, s[4:7], s93 offen offset:2048 sc1 lds
buffer_load_dwordx4 v2, s[4:7], s93 offen offset:3072 sc1 lds
s_add_u32 s93, s93, 4096
s_add_u32 m0, s45, 59392
s_nop 0
buffer_load_dwordx4 v2, s[4:7], s93 offen offset:0 sc1 lds
buffer_load_dwordx4 v2, s[4:7], s93 offen offset:1024 sc1 lds
buffer_load_dwordx4 v2, s[4:7], s93 offen offset:2048 sc1 lds
buffer_load_dwordx4 v2, s[4:7], s93 offen offset:3072 sc1 lds
s_add_u32 s93, s93, 4096
s_add_u32 m0, s45, 63488
s_nop 0
buffer_load_dwordx4 v2, s[4:7], s93 offen offset:0 sc1 lds
buffer_load_dwordx4 v2, s[4:7], s93 offen offset:1024 sc1 lds
buffer_load_dwordx4 v2, s[4:7], s93 offen offset:2048 sc1 lds
buffer_load_dwordx4 v2, s[4:7], s93 offen offset:3072 sc1 lds
s_add_u32 s93, s93, 4096
s_add_u32 m0, s45, 67584
s_nop 0
buffer_load_dwordx4 v2, s[4:7], s93 offen offset:0 sc1 lds
buffer_load_dwordx4 v2, s[4:7], s93 offen offset:1024 sc1 lds
s_add_u32 s92, s31, 65536
buffer_load_dword v59, v9, s[4:7], s92 offen sc1
s_waitcnt vmcnt(0)
s_branch Lg2_faret2
Lg2_e2late1:
s_add_u32 s92, s33, 81920
s_mov_b32 s90, 40000
Lpg_44:
buffer_load_dwordx3 v[48:50], v64, s[4:7], s92 offen sc1
buffer_load_dwordx3 v[52:54], v65, s[4:7], s92 offen sc1
s_waitcnt vmcnt(0)
v_cmp_ne_u32 vcc, s20, v50
v_cmp_ne_u32 s[28:29], s20, v54
s_nop 0
s_or_b64 vcc, vcc, s[28:29]
s_cmp_eq_u64 vcc, 0
s_cbranch_scc1 Lpgok_45
s_sub_u32 s90, s90, 1
s_cmp_lg_u32 s90, 0
s_cbranch_scc1 Lpg_44
s_mov_b32 s8, s86
s_mov_b32 s9, s87
s_mov_b32 s10, 0x100
s_mov_b32 s11, 0x20000
v_mov_b32 v2, 0x7
v_mov_b32 v3, 0x1c
s_nop 1
buffer_store_dword v2, v3, s[8:11], 0 offen
s_waitcnt vmcnt(0)
s_endpgm
Lpgok_45:
s_waitcnt vmcnt(0)
s_branch Lg2_e2ret1
Lg2_falate3:
s_add_u32 s92, s31, 65536
s_mov_b32 s90, 40000
Lpoll_46:
buffer_load_dword v59, v9, s[4:7], s92 offen sc1
s_waitcnt vmcnt(0)
v_cmp_ne_u32 vcc, s20, v59
s_cmp_eq_u64 vcc, 0
s_cbranch_scc1 Lpok_47

s_sub_u32 s90, s90, 1
s_cmp_lg_u32 s90, 0
s_cbranch_scc1 Lpoll_46
s_mov_b32 s8, s86
s_mov_b32 s9, s87
s_mov_b32 s10, 0x100
s_mov_b32 s11, 0x20000
v_mov_b32 v2, 0x8
v_mov_b32 v3, 0x20
s_nop 1
buffer_store_dword v2, v3, s[8:11], 0 offen
s_waitcnt vmcnt(0)
s_endpgm
Lpok_47:
s_waitcnt vmcnt(0)
s_add_u32 s93, s30, 0x360000
s_add_u32 m0, s45, 0
s_nop 0
buffer_load_dwordx4 v2, s[4:7], s93 offen offset:0 sc1 lds
buffer_load_dwordx4 v2, s[4:7], s93 offen offset:1024 sc1 lds
buffer_load_dwordx4 v2, s[4:7], s93 offen offset:2048 sc1 lds
buffer_load_dwordx4 v2, s[4:7], s93 offen offset:3072 sc1 lds
s_add_u32 s93, s93, 4096
s_add_u32 m0, s45, 4096
s_nop 0
buffer_load_dwordx4 v2, s[4:7], s93 offen offset:0 sc1 lds
buffer_load_dwordx4 v2, s[4:7], s93 offen offset:1024 sc1 lds
buffer_load_dwordx4 v2, s[4:7], s93 offen offset:2048 sc1 lds
buffer_load_dwordx4 v2, s[4:7], s93 offen offset:3072 sc1 lds
s_add_u32 s93, s93, 4096
s_add_u32 m0, s45, 8192
s_nop 0
buffer_load_dwordx4 v2, s[4:7], s93 offen offset:0 sc1 lds
buffer_load_dwordx4 v2, s[4:7], s93 offen offset:1024 sc1 lds
buffer_load_dwordx4 v2, s[4:7], s93 offen offset:2048 sc1 lds
buffer_load_dwordx4 v2, s[4:7], s93 offen offset:3072 sc1 lds
s_add_u32 s93, s93, 4096
s_add_u32 m0, s45, 12288
s_nop 0
buffer_load_dwordx4 v2, s[4:7], s93 offen offset:0 sc1 lds
buffer_load_dwordx4 v2, s[4:7], s93 offen offset:1024 sc1 lds
s_add_u32 s92, s31, 81920
buffer_load_dword v59, v9, s[4:7], s92 offen sc1
s_waitcnt vmcnt(0)
s_branch Lg2_faret3
Lg2_e2late2:
s_add_u32 s92, s33, 163840
s_mov_b32 s90, 40000
Lpg_49:
buffer_load_dwordx3 v[48:50], v64, s[4:7], s92 offen sc1
buffer_load_dwordx3 v[52:54], v65, s[4:7], s92 offen sc1
s_waitcnt vmcnt(0)
v_cmp_ne_u32 vcc, s20, v50
v_cmp_ne_u32 s[28:29], s20, v54
s_nop 0
s_or_b64 vcc, vcc, s[28:29]
s_cmp_eq_u64 vcc, 0
s_cbranch_scc1 Lpgok_50
s_sub_u32 s90, s90, 1
s_cmp_lg_u32 s90, 0
s_cbranch_scc1 Lpg_49
s_mov_b32 s8, s86
s_mov_b32 s9, s87
s_mov_b32 s10, 0x100
s_mov_b32 s11, 0x20000
v_mov_b32 v2, 0x7
v_mov_b32 v3, 0x1c
s_nop 1
buffer_store_dword v2, v3, s[8:11], 0 offen
s_waitcnt vmcnt(0)
s_endpgm
Lpgok_50:
s_waitcnt vmcnt(0)
s_branch Lg2_e2ret2
Lg2_falate4:
s_add_u32 s92, s31, 81920
s_mov_b32 s90, 40000
Lpoll_51:
buffer_load_dword v59, v9, s[4:7], s92 offen sc1
s_waitcnt vmcnt(0)
v_cmp_ne_u32 vcc, s20, v59
s_cmp_eq_u64 vcc, 0
s_cbranch_scc1 Lpok_52

s_sub_u32 s90, s90, 1
s_cmp_lg_u32 s90, 0
s_cbranch_scc1 Lpoll_51
s_mov_b32 s8, s86
s_mov_b32 s9, s87
s_mov_b32 s10, 0x100
s_mov_b32 s11, 0x20000
v_mov_b32 v2, 0x8
v_mov_b32 v3, 0x20
s_nop 1
buffer_store_dword v2, v3, s[8:11], 0 offen
s_waitcnt vmcnt(0)
s_endpgm
Lpok_52:
s_waitcnt vmcnt(0)
s_add_u32 s93, s30, 0x438000
s_add_u32 m0, s45, 55296
s_nop 0
buffer_load_dwordx4 v2, s[4:7], s93 offen offset:0 sc1 lds
buffer_load_dwordx4 v2, s[4:7], s93 offen offset:1024 sc1 lds
buffer_load_dwordx4 v2, s[4:7], s93 offen offset:2048 sc1 lds
buffer_load_dwordx4 v2, s[4:7], s93 offen offset:3072 sc1 lds
s_add_u32 s93, s93, 4096
s_add_u32 m0, s45, 59392
s_nop 0
buffer_load_dwordx4 v2, s[4:7], s93 offen offset:0 sc1 lds
buffer_load_dwordx4 v2, s[4:7], s93 offen offset:1024 sc1 lds
buffer_load_dwordx4 v2, s[4:7], s93 offen offset:2048 sc1 lds
buffer_load_dwordx4 v2, s[4:7], s93 offen offset:3072 sc1 lds
s_add_u32 s93, s93, 4096
s_add_u32 m0, s45, 63488
s_nop 0
buffer_load_dwordx4 v2, s[4:7], s93 offen offset:0 sc1 lds
buffer_load_dwordx4 v2, s[4:7], s93 offen offset:1024 sc1 lds
buffer_load_dwordx4 v2, s[4:7], s93 offen offset:2048 sc1 lds
buffer_load_dwordx4 v2, s[4:7], s93 offen offset:3072 sc1 lds
s_add_u32 s93, s93, 4096
s_add_u32 m0, s45, 67584
s_nop 0
buffer_load_dwordx4 v2, s[4:7], s93 offen offset:0 sc1 lds
buffer_load_dwordx4 v2, s[4:7], s93 offen offset:1024 sc1 lds
s_add_u32 s92, s31, 98304
buffer_load_dword v59, v9, s[4:7], s92 offen sc1
s_waitcnt vmcnt(0)
s_branch Lg2_faret4
Lg2_e2late3:
s_add_u32 s92, s33, 245760
s_mov_b32 s90, 40000
Lpg_54:
buffer_load_dwordx3 v[48:50], v64, s[4:7], s92 offen sc1
buffer_load_dwordx3 v[52:54], v65, s[4:7], s92 offen sc1
s_waitcnt vmcnt(0)
v_cmp_ne_u32 vcc, s20, v50
v_cmp_ne_u32 s[28:29], s20, v54
s_nop 0
s_or_b64 vcc, vcc, s[28:29]
s_cmp_eq_u64 vcc, 0
s_cbranch_scc1 Lpgok_55
s_sub_u32 s90, s90, 1
s_cmp_lg_u32 s90, 0
s_cbranch_scc1 Lpg_54
s_mov_b32 s8, s86
s_mov_b32 s9, s87
s_mov_b32 s10, 0x100
s_mov_b32 s11, 0x20000
v_mov_b32 v2, 0x7
v_mov_b32 v3, 0x1c
s_nop 1
buffer_store_dword v2, v3, s[8:11], 0 offen
s_waitcnt vmcnt(0)
s_endpgm
Lpgok_55:
s_waitcnt vmcnt(0)
s_branch Lg2_e2ret3
Lg2_falate5:
s_add_u32 s92, s31, 98304
s_mov_b32 s90, 40000
Lpoll_56:
buffer_load_dword v59, v9, s[4:7], s92 offen sc1
s_waitcnt vmcnt(0)
v_cmp_ne_u32 vcc, s20, v59
s_cmp_eq_u64 vcc, 0
s_cbranch_scc1 Lpok_57

s_sub_u32 s90, s90, 1
s_cmp_lg_u32 s90, 0
s_cbranch_scc1 Lpoll_56
s_mov_b32 s8, s86
s_mov_b32 s9, s87
s_mov_b32 s10, 0x100
s_mov_b32 s11, 0x20000
v_mov_b32 v2, 0x8
v_mov_b32 v3, 0x20
s_nop 1
buffer_store_dword v2, v3, s[8:11], 0 offen
s_waitcnt vmcnt(0)
s_endpgm
Lpok_57:
s_waitcnt vmcnt(0)
s_add_u32 s93, s30, 0x510000
s_add_u32 m0, s45, 0
s_nop 0
buffer_load_dwordx4 v2, s[4:7], s93 offen offset:0 sc1 lds
buffer_load_dwordx4 v2, s[4:7], s93 offen offset:1024 sc1 lds
buffer_load_dwordx4 v2, s[4:7], s93 offen offset:2048 sc1 lds
buffer_load_dwordx4 v2, s[4:7], s93 offen offset:3072 sc1 lds
s_add_u32 s93, s93, 4096
s_add_u32 m0, s45, 4096
s_nop 0
buffer_load_dwordx4 v2, s[4:7], s93 offen offset:0 sc1 lds
buffer_load_dwordx4 v2, s[4:7], s93 offen offset:1024 sc1 lds
buffer_load_dwordx4 v2, s[4:7], s93 offen offset:2048 sc1 lds
buffer_load_dwordx4 v2, s[4:7], s93 offen offset:3072 sc1 lds
s_add_u32 s93, s93, 4096
s_add_u32 m0, s45, 8192
s_nop 0
buffer_load_dwordx4 v2, s[4:7], s93 offen offset:0 sc1 lds
buffer_load_dwordx4 v2, s[4:7], s93 offen offset:1024 sc1 lds
buffer_load_dwordx4 v2, s[4:7], s93 offen offset:2048 sc1 lds
buffer_load_dwordx4 v2, s[4:7], s93 offen offset:3072 sc1 lds
s_add_u32 s93, s93, 4096
s_add_u32 m0, s45, 12288
s_nop 0
buffer_load_dwordx4 v2, s[4:7], s93 offen offset:0 sc1 lds
buffer_load_dwordx4 v2, s[4:7], s93 offen offset:1024 sc1 lds
s_add_u32 s92, s31, 114688
buffer_load_dword v59, v9, s[4:7], s92 offen sc1
s_waitcnt vmcnt(0)
s_branch Lg2_faret5
Lg2_e2late4:
s_add_u32 s92, s33, 327680
s_mov_b32 s90, 40000
Lpg_59:
buffer_load_dwordx3 v[48:50], v64, s[4:7], s92 offen sc1
buffer_load_dwordx3 v[52:54], v65, s[4:7], s92 offen sc1
s_waitcnt vmcnt(0)
v_cmp_ne_u32 vcc, s20, v50
v_cmp_ne_u32 s[28:29], s20, v54
s_nop 0
s_or_b64 vcc, vcc, s[28:29]
s_cmp_eq_u64 vcc, 0
s_cbranch_scc1 Lpgok_60
s_sub_u32 s90, s90, 1
s_cmp_lg_u32 s90, 0
s_cbranch_scc1 Lpg_59
s_mov_b32 s8, s86
s_mov_b32 s9, s87
s_mov_b32 s10, 0x100
s_mov_b32 s11, 0x20000
v_mov_b32 v2, 0x7
v_mov_b32 v3, 0x1c
s_nop 1
buffer_store_dword v2, v3, s[8:11], 0 offen
s_waitcnt vmcnt(0)
s_endpgm
Lpgok_60:
s_waitcnt vmcnt(0)
s_branch Lg2_e2ret4
Lg2_falate6:
s_add_u32 s92, s31, 114688
s_mov_b32 s90, 40000
Lpoll_61:
buffer_load_dword v59, v9, s[4:7], s92 offen sc1
s_waitcnt vmcnt(0)
v_cmp_ne_u32 vcc, s20, v59
s_cmp_eq_u64 vcc, 0
s_cbranch_scc1 Lpok_62

s_sub_u32 s90, s90, 1
s_cmp_lg_u32 s90, 0
s_cbranch_scc1 Lpoll_61
s_mov_b32 s8, s86
s_mov_b32 s9, s87
s_mov_b32 s10, 0x100
s_mov_b32 s11, 0x20000
v_mov_b32 v2, 0x8
v_mov_b32 v3, 0x20
s_nop 1
buffer_store_dword v2, v3, s[8:11], 0 offen
s_waitcnt vmcnt(0)
s_endpgm
Lpok_62:
s_waitcnt vmcnt(0)
s_add_u32 s93, s30, 0x5e8000
s_add_u32 m0, s45, 55296
s_nop 0
buffer_load_dwordx4 v2, s[4:7], s93 offen offset:0 sc1 lds
buffer_load_dwordx4 v2, s[4:7], s93 offen offset:1024 sc1 lds
buffer_load_dwordx4 v2, s[4:7], s93 offen offset:2048 sc1 lds
buffer_load_dwordx4 v2, s[4:7], s93 offen offset:3072 sc1 lds
s_add_u32 s93, s93, 4096
s_add_u32 m0, s45, 59392
s_nop 0
buffer_load_dwordx4 v2, s[4:7], s93 offen offset:0 sc1 lds
buffer_load_dwordx4 v2, s[4:7], s93 offen offset:1024 sc1 lds
buffer_load_dwordx4 v2, s[4:7], s93 offen offset:2048 sc1 lds
buffer_load_dwordx4 v2, s[4:7], s93 offen offset:3072 sc1 lds
s_add_u32 s93, s93, 4096
s_add_u32 m0, s45, 63488
s_nop 0
buffer_load_dwordx4 v2, s[4:7], s93 offen offset:0 sc1 lds
buffer_load_dwordx4 v2, s[4:7], s93 offen offset:1024 sc1 lds
buffer_load_dwordx4 v2, s[4:7], s93 offen offset:2048 sc1 lds
buffer_load_dwordx4 v2, s[4:7], s93 offen offset:3072 sc1 lds
s_add_u32 s93, s93, 4096
s_add_u32 m0, s45, 67584
s_nop 0
buffer_load_dwordx4 v2, s[4:7], s93 offen offset:0 sc1 lds
buffer_load_dwordx4 v2, s[4:7], s93 offen offset:1024 sc1 lds
s_waitcnt vmcnt(0)
s_branch Lg2_faret6
Lg2_e2late5:
s_add_u32 s92, s33, 409600
s_mov_b32 s90, 40000
Lpg_64:
buffer_load_dwordx3 v[48:50], v64, s[4:7], s92 offen sc1
buffer_load_dwordx3 v[52:54], v65, s[4:7], s92 offen sc1
s_waitcnt vmcnt(0)
v_cmp_ne_u32 vcc, s20, v50
v_cmp_ne_u32 s[28:29], s20, v54
s_nop 0
s_or_b64 vcc, vcc, s[28:29]
s_cmp_eq_u64 vcc, 0
s_cbranch_scc1 Lpgok_65
s_sub_u32 s90, s90, 1
s_cmp_lg_u32 s90, 0
s_cbranch_scc1 Lpg_64
s_mov_b32 s8, s86
s_mov_b32 s9, s87
s_mov_b32 s10, 0x100
s_mov_b32 s11, 0x20000
v_mov_b32 v2, 0x7
v_mov_b32 v3, 0x1c
s_nop 1
buffer_store_dword v2, v3, s[8:11], 0 offen
s_waitcnt vmcnt(0)
s_endpgm
Lpgok_65:
s_waitcnt vmcnt(0)
s_branch Lg2_e2ret5
Lg2_falate7:
s_add_u32 s92, s31, 131072
s_mov_b32 s90, 40000
Lpoll_66:
buffer_load_dword v59, v9, s[4:7], s92 offen sc1
s_waitcnt vmcnt(0)
v_cmp_ne_u32 vcc, s20, v59
s_cmp_eq_u64 vcc, 0
s_cbranch_scc1 Lpok_67

s_sub_u32 s90, s90, 1
s_cmp_lg_u32 s90, 0
s_cbranch_scc1 Lpoll_66
s_mov_b32 s8, s86
s_mov_b32 s9, s87
s_mov_b32 s10, 0x100
s_mov_b32 s11, 0x20000
v_mov_b32 v2, 0x8
v_mov_b32 v3, 0x20
s_nop 1
buffer_store_dword v2, v3, s[8:11], 0 offen
s_waitcnt vmcnt(0)
s_endpgm
Lpok_67:
s_waitcnt vmcnt(0)
s_add_u32 s93, s30, 0x6c0000
s_add_u32 m0, s45, 0
s_nop 0
buffer_load_dwordx4 v2, s[4:7], s93 offen offset:0 sc1 lds
buffer_load_dwordx4 v2, s[4:7], s93 offen offset:1024 sc1 lds
buffer_load_dwordx4 v2, s[4:7], s93 offen offset:2048 sc1 lds
buffer_load_dwordx4 v2, s[4:7], s93 offen offset:3072 sc1 lds
s_add_u32 s93, s93, 4096
s_add_u32 m0, s45, 4096
s_nop 0
buffer_load_dwordx4 v2, s[4:7], s93 offen offset:0 sc1 lds
buffer_load_dwordx4 v2, s[4:7], s93 offen offset:1024 sc1 lds
buffer_load_dwordx4 v2, s[4:7], s93 offen offset:2048 sc1 lds
buffer_load_dwordx4 v2, s[4:7], s93 offen offset:3072 sc1 lds
s_add_u32 s93, s93, 4096
s_add_u32 m0, s45, 8192
s_nop 0
buffer_load_dwordx4 v2, s[4:7], s93 offen offset:0 sc1 lds
buffer_load_dwordx4 v2, s[4:7], s93 offen offset:1024 sc1 lds
buffer_load_dwordx4 v2, s[4:7], s93 offen offset:2048 sc1 lds
buffer_load_dwordx4 v2, s[4:7], s93 offen offset:3072 sc1 lds
s_add_u32 s93, s93, 4096
s_add_u32 m0, s45, 12288
s_nop 0
buffer_load_dwordx4 v2, s[4:7], s93 offen offset:0 sc1 lds
buffer_load_dwordx4 v2, s[4:7], s93 offen offset:1024 sc1 lds
s_add_u32 s92, s31, 147456
buffer_load_dword v59, v9, s[4:7], s92 offen sc1
s_waitcnt vmcnt(0)
s_branch Lg2_faret7
Lg2_e2late6:
s_add_u32 s92, s33, 491520
s_mov_b32 s90, 40000
Lpg_69:
buffer_load_dwordx3 v[48:50], v64, s[4:7], s92 offen sc1
buffer_load_dwordx3 v[52:54], v65, s[4:7], s92 offen sc1
s_waitcnt vmcnt(0)
v_cmp_ne_u32 vcc, s20, v50
v_cmp_ne_u32 s[28:29], s20, v54
s_nop 0
s_or_b64 vcc, vcc, s[28:29]
s_cmp_eq_u64 vcc, 0
s_cbranch_scc1 Lpgok_70
s_sub_u32 s90, s90, 1
s_cmp_lg_u32 s90, 0
s_cbranch_scc1 Lpg_69
s_mov_b32 s8, s86
s_mov_b32 s9, s87
s_mov_b32 s10, 0x100
s_mov_b32 s11, 0x20000
v_mov_b32 v2, 0x7
v_mov_b32 v3, 0x1c
s_nop 1
buffer_store_dword v2, v3, s[8:11], 0 offen
s_waitcnt vmcnt(0)
s_endpgm
Lpgok_70:
s_waitcnt vmcnt(0)
s_branch Lg2_e2ret6
Lg2_e2late7:
s_add_u32 s92, s33, 573440
s_mov_b32 s90, 40000
Lpg_71:
buffer_load_dwordx3 v[48:50], v64, s[4:7], s92 offen sc1
buffer_load_dwordx3 v[52:54], v65, s[4:7], s92 offen sc1
s_waitcnt vmcnt(0)
v_cmp_ne_u32 vcc, s20, v50
v_cmp_ne_u32 s[28:29], s20, v54
s_nop 0
s_or_b64 vcc, vcc, s[28:29]
s_cmp_eq_u64 vcc, 0
s_cbranch_scc1 Lpgok_72
s_sub_u32 s90, s90, 1
s_cmp_lg_u32 s90, 0
s_cbranch_scc1 Lpg_71
s_mov_b32 s8, s86
s_mov_b32 s9, s87
s_mov_b32 s10, 0x100
s_mov_b32 s11, 0x20000
v_mov_b32 v2, 0x7
v_mov_b32 v3, 0x1c
s_nop 1
buffer_store_dword v2, v3, s[8:11], 0 offen
s_waitcnt vmcnt(0)
s_endpgm
Lpgok_72:
s_waitcnt vmcnt(0)
s_branch Lg2_e2ret7
Lg2_falate8:
s_add_u32 s92, s31, 147456
s_mov_b32 s90, 40000
Lpoll_73:
buffer_load_dword v59, v9, s[4:7], s92 offen sc1
s_waitcnt vmcnt(0)
v_cmp_ne_u32 vcc, s20, v59
s_cmp_eq_u64 vcc, 0
s_cbranch_scc1 Lpok_74

s_sub_u32 s90, s90, 1
s_cmp_lg_u32 s90, 0
s_cbranch_scc1 Lpoll_73
s_mov_b32 s8, s86
s_mov_b32 s9, s87
s_mov_b32 s10, 0x100
s_mov_b32 s11, 0x20000
v_mov_b32 v2, 0x8
v_mov_b32 v3, 0x20
s_nop 1
buffer_store_dword v2, v3, s[8:11], 0 offen
s_waitcnt vmcnt(0)
s_endpgm
Lpok_74:
s_waitcnt vmcnt(0)
s_add_u32 s93, s30, 0x798000
s_add_u32 m0, s45, 55296
s_nop 0
buffer_load_dwordx4 v2, s[4:7], s93 offen offset:0 sc1 lds
buffer_load_dwordx4 v2, s[4:7], s93 offen offset:1024 sc1 lds
buffer_load_dwordx4 v2, s[4:7], s93 offen offset:2048 sc1 lds
buffer_load_dwordx4 v2, s[4:7], s93 offen offset:3072 sc1 lds
s_add_u32 s93, s93, 4096
s_add_u32 m0, s45, 59392
s_nop 0
buffer_load_dwordx4 v2, s[4:7], s93 offen offset:0 sc1 lds
buffer_load_dwordx4 v2, s[4:7], s93 offen offset:1024 sc1 lds
buffer_load_dwordx4 v2, s[4:7], s93 offen offset:2048 sc1 lds
buffer_load_dwordx4 v2, s[4:7], s93 offen offset:3072 sc1 lds
s_add_u32 s93, s93, 4096
s_add_u32 m0, s45, 63488
s_nop 0
buffer_load_dwordx4 v2, s[4:7], s93 offen offset:0 sc1 lds
buffer_load_dwordx4 v2, s[4:7], s93 offen offset:1024 sc1 lds
buffer_load_dwordx4 v2, s[4:7], s93 offen offset:2048 sc1 lds
buffer_load_dwordx4 v2, s[4:7], s93 offen offset:3072 sc1 lds
s_add_u32 s93, s93, 4096
s_add_u32 m0, s45, 67584
s_nop 0
buffer_load_dwordx4 v2, s[4:7], s93 offen offset:0 sc1 lds
buffer_load_dwordx4 v2, s[4:7], s93 offen offset:1024 sc1 lds
s_add_u32 s92, s31, 163840
buffer_load_dword v59, v9, s[4:7], s92 offen sc1
s_waitcnt vmcnt(0)
s_branch Lg2_faret8
Lg2_falate9:
s_add_u32 s92, s31, 163840
s_mov_b32 s90, 40000
Lpoll_76:
buffer_load_dword v59, v9, s[4:7], s92 offen sc1
s_waitcnt vmcnt(0)
v_cmp_ne_u32 vcc, s20, v59
s_cmp_eq_u64 vcc, 0
s_cbranch_scc1 Lpok_77

s_sub_u32 s90, s90, 1
s_cmp_lg_u32 s90, 0
s_cbranch_scc1 Lpoll_76
s_mov_b32 s8, s86
s_mov_b32 s9, s87
s_mov_b32 s10, 0x100
s_mov_b32 s11, 0x20000
v_mov_b32 v2, 0x8
v_mov_b32 v3, 0x20
s_nop 1
buffer_store_dword v2, v3, s[8:11], 0 offen
s_waitcnt vmcnt(0)
s_endpgm
Lpok_77:
s_waitcnt vmcnt(0)
s_add_u32 s93, s30, 0x870000
s_add_u32 m0, s45, 0
s_nop 0
buffer_load_dwordx4 v2, s[4:7], s93 offen offset:0 sc1 lds
buffer_load_dwordx4 v2, s[4:7], s93 offen offset:1024 sc1 lds
buffer_load_dwordx4 v2, s[4:7], s93 offen offset:2048 sc1 lds
buffer_load_dwordx4 v2, s[4:7], s93 offen offset:3072 sc1 lds
s_add_u32 s93, s93, 4096
s_add_u32 m0, s45, 4096
s_nop 0
buffer_load_dwordx4 v2, s[4:7], s93 offen offset:0 sc1 lds
buffer_load_dwordx4 v2, s[4:7], s93 offen offset:1024 sc1 lds
buffer_load_dwordx4 v2, s[4:7], s93 offen offset:2048 sc1 lds
buffer_load_dwordx4 v2, s[4:7], s93 offen offset:3072 sc1 lds
s_add_u32 s93, s93, 4096
s_add_u32 m0, s45, 8192
s_nop 0
buffer_load_dwordx4 v2, s[4:7], s93 offen offset:0 sc1 lds
buffer_load_dwordx4 v2, s[4:7], s93 offen offset:1024 sc1 lds
buffer_load_dwordx4 v2, s[4:7], s93 offen offset:2048 sc1 lds
buffer_load_dwordx4 v2, s[4:7], s93 offen offset:3072 sc1 lds
s_add_u32 s93, s93, 4096
s_add_u32 m0, s45, 12288
s_nop 0
buffer_load_dwordx4 v2, s[4:7], s93 offen offset:0 sc1 lds
buffer_load_dwordx4 v2, s[4:7], s93 offen offset:1024 sc1 lds
s_add_u32 s92, s31, 180224
buffer_load_dword v59, v9, s[4:7], s92 offen sc1
s_waitcnt vmcnt(0)
s_branch Lg2_faret9
Lg2_falate10:
s_add_u32 s92, s31, 180224
s_mov_b32 s90, 40000
Lpoll_79:
buffer_load_dword v59, v9, s[4:7], s92 offen sc1
s_waitcnt vmcnt(0)
v_cmp_ne_u32 vcc, s20, v59
s_cmp_eq_u64 vcc, 0
s_cbranch_scc1 Lpok_80

s_sub_u32 s90, s90, 1
s_cmp_lg_u32 s90, 0
s_cbranch_scc1 Lpoll_79
s_mov_b32 s8, s86
s_mov_b32 s9, s87
s_mov_b32 s10, 0x100
s_mov_b32 s11, 0x20000
v_mov_b32 v2, 0x8
v_mov_b32 v3, 0x20
s_nop 1
buffer_store_dword v2, v3, s[8:11], 0 offen
s_waitcnt vmcnt(0)
s_endpgm
Lpok_80:
s_waitcnt vmcnt(0)
s_add_u32 s93, s30, 0x948000
s_add_u32 m0, s45, 55296
s_nop 0
buffer_load_dwordx4 v2, s[4:7], s93 offen offset:0 sc1 lds
buffer_load_dwordx4 v2, s[4:7], s93 offen offset:1024 sc1 lds
buffer_load_dwordx4 v2, s[4:7], s93 offen offset:2048 sc1 lds
buffer_load_dwordx4 v2, s[4:7], s93 offen offset:3072 sc1 lds
s_add_u32 s93, s93, 4096
s_add_u32 m0, s45, 59392
s_nop 0
buffer_load_dwordx4 v2, s[4:7], s93 offen offset:0 sc1 lds
buffer_load_dwordx4 v2, s[4:7], s93 offen offset:1024 sc1 lds
buffer_load_dwordx4 v2, s[4:7], s93 offen offset:2048 sc1 lds
buffer_load_dwordx4 v2, s[4:7], s93 offen offset:3072 sc1 lds
s_add_u32 s93, s93, 4096
s_add_u32 m0, s45, 63488
s_nop 0
buffer_load_dwordx4 v2, s[4:7], s93 offen offset:0 sc1 lds
buffer_load_dwordx4 v2, s[4:7], s93 offen offset:1024 sc1 lds
buffer_load_dwordx4 v2, s[4:7], s93 offen offset:2048 sc1 lds
buffer_load_dwordx4 v2, s[4:7], s93 offen offset:3072 sc1 lds
s_add_u32 s93, s93, 4096
s_add_u32 m0, s45, 67584
s_nop 0
buffer_load_dwordx4 v2, s[4:7], s93 offen offset:0 sc1 lds
buffer_load_dwordx4 v2, s[4:7], s93 offen offset:1024 sc1 lds
s_add_u32 s92, s31, 196608
buffer_load_dword v59, v9, s[4:7], s92 offen sc1
s_waitcnt vmcnt(0)
s_branch Lg2_faret10
Lg2_falate11:
s_add_u32 s92, s31, 196608
s_mov_b32 s90, 40000
Lpoll_82:
buffer_load_dword v59, v9, s[4:7], s92 offen sc1
s_waitcnt vmcnt(0)
v_cmp_ne_u32 vcc, s20, v59
s_cmp_eq_u64 vcc, 0
s_cbranch_scc1 Lpok_83

s_sub_u32 s90, s90, 1
s_cmp_lg_u32 s90, 0
s_cbranch_scc1 Lpoll_82
s_mov_b32 s8, s86
s_mov_b32 s9, s87
s_mov_b32 s10, 0x100
s_mov_b32 s11, 0x20000
v_mov_b32 v2, 0x8
v_mov_b32 v3, 0x20
s_nop 1
buffer_store_dword v2, v3, s[8:11], 0 offen
s_waitcnt vmcnt(0)
s_endpgm
Lpok_83:
s_waitcnt vmcnt(0)
s_add_u32 s93, s30, 0xa20000
s_add_u32 m0, s45, 0
s_nop 0
buffer_load_dwordx4 v2, s[4:7], s93 offen offset:0 sc1 lds
buffer_load_dwordx4 v2, s[4:7], s93 offen offset:1024 sc1 lds
buffer_load_dwordx4 v2, s[4:7], s93 offen offset:2048 sc1 lds
buffer_load_dwordx4 v2, s[4:7], s93 offen offset:3072 sc1 lds
s_add_u32 s93, s93, 4096
s_add_u32 m0, s45, 4096
s_nop 0
buffer_load_dwordx4 v2, s[4:7], s93 offen offset:0 sc1 lds
buffer_load_dwordx4 v2, s[4:7], s93 offen offset:1024 sc1 lds
buffer_load_dwordx4 v2, s[4:7], s93 offen offset:2048 sc1 lds
buffer_load_dwordx4 v2, s[4:7], s93 offen offset:3072 sc1 lds
s_add_u32 s93, s93, 4096
s_add_u32 m0, s45, 8192
s_nop 0
buffer_load_dwordx4 v2, s[4:7], s93 offen offset:0 sc1 lds
buffer_load_dwordx4 v2, s[4:7], s93 offen offset:1024 sc1 lds
buffer_load_dwordx4 v2, s[4:7], s93 offen offset:2048 sc1 lds
buffer_load_dwordx4 v2, s[4:7], s93 offen offset:3072 sc1 lds
s_add_u32 s93, s93, 4096
s_add_u32 m0, s45, 12288
s_nop 0
buffer_load_dwordx4 v2, s[4:7], s93 offen offset:0 sc1 lds
buffer_load_dwordx4 v2, s[4:7], s93 offen offset:1024 sc1 lds
s_add_u32 s92, s31, 212992
buffer_load_dword v59, v9, s[4:7], s92 offen sc1
s_waitcnt vmcnt(0)
s_branch Lg2_faret11
Lg2_falate12:
s_add_u32 s92, s31, 212992
s_mov_b32 s90, 40000
Lpoll_85:
buffer_load_dword v59, v9, s[4:7], s92 offen sc1
s_waitcnt vmcnt(0)
v_cmp_ne_u32 vcc, s20, v59
s_cmp_eq_u64 vcc, 0
s_cbranch_scc1 Lpok_86

s_sub_u32 s90, s90, 1
s_cmp_lg_u32 s90, 0
s_cbranch_scc1 Lpoll_85
s_mov_b32 s8, s86
s_mov_b32 s9, s87
s_mov_b32 s10, 0x100
s_mov_b32 s11, 0x20000
v_mov_b32 v2, 0x8
v_mov_b32 v3, 0x20
s_nop 1
buffer_store_dword v2, v3, s[8:11], 0 offen
s_waitcnt vmcnt(0)
s_endpgm
Lpok_86:
s_waitcnt vmcnt(0)
s_add_u32 s93, s30, 0xaf8000
s_add_u32 m0, s45, 55296
s_nop 0
buffer_load_dwordx4 v2, s[4:7], s93 offen offset:0 sc1 lds
buffer_load_dwordx4 v2, s[4:7], s93 offen offset:1024 sc1 lds
buffer_load_dwordx4 v2, s[4:7], s93 offen offset:2048 sc1 lds
buffer_load_dwordx4 v2, s[4:7], s93 offen offset:3072 sc1 lds
s_add_u32 s93, s93, 4096
s_add_u32 m0, s45, 59392
s_nop 0
buffer_load_dwordx4 v2, s[4:7], s93 offen offset:0 sc1 lds
buffer_load_dwordx4 v2, s[4:7], s93 offen offset:1024 sc1 lds
buffer_load_dwordx4 v2, s[4:7], s93 offen offset:2048 sc1 lds
buffer_load_dwordx4 v2, s[4:7], s93 offen offset:3072 sc1 lds
s_add_u32 s93, s93, 4096
s_add_u32 m0, s45, 63488
s_nop 0
buffer_load_dwordx4 v2, s[4:7], s93 offen offset:0 sc1 lds
buffer_load_dwordx4 v2, s[4:7], s93 offen offset:1024 sc1 lds
buffer_load_dwordx4 v2, s[4:7], s93 offen offset:2048 sc1 lds
buffer_load_dwordx4 v2, s[4:7], s93 offen offset:3072 sc1 lds
s_add_u32 s93, s93, 4096
s_add_u32 m0, s45, 67584
s_nop 0
buffer_load_dwordx4 v2, s[4:7], s93 offen offset:0 sc1 lds
buffer_load_dwordx4 v2, s[4:7], s93 offen offset:1024 sc1 lds
s_add_u32 s92, s31, 229376
buffer_load_dword v59, v9, s[4:7], s92 offen sc1
s_waitcnt vmcnt(0)
s_branch Lg2_faret12
Lg2_falate13:
s_add_u32 s92, s31, 229376
s_mov_b32 s90, 40000
Lpoll_88:
buffer_load_dword v59, v9, s[4:7], s92 offen sc1
s_waitcnt vmcnt(0)
v_cmp_ne_u32 vcc, s20, v59
s_cmp_eq_u64 vcc, 0
s_cbranch_scc1 Lpok_89

s_sub_u32 s90, s90, 1
s_cmp_lg_u32 s90, 0
s_cbranch_scc1 Lpoll_88
s_mov_b32 s8, s86
s_mov_b32 s9, s87
s_mov_b32 s10, 0x100
s_mov_b32 s11, 0x20000
v_mov_b32 v2, 0x8
v_mov_b32 v3, 0x20
s_nop 1
buffer_store_dword v2, v3, s[8:11], 0 offen
s_waitcnt vmcnt(0)
s_endpgm
Lpok_89:
s_waitcnt vmcnt(0)
s_add_u32 s93, s30, 0xbd0000
s_add_u32 m0, s45, 0
s_nop 0
buffer_load_dwordx4 v2, s[4:7], s93 offen offset:0 sc1 lds
buffer_load_dwordx4 v2, s[4:7], s93 offen offset:1024 sc1 lds
buffer_load_dwordx4 v2, s[4:7], s93 offen offset:2048 sc1 lds
buffer_load_dwordx4 v2, s[4:7], s93 offen offset:3072 sc1 lds
s_add_u32 s93, s93, 4096
s_add_u32 m0, s45, 4096
s_nop 0
buffer_load_dwordx4 v2, s[4:7], s93 offen offset:0 sc1 lds
buffer_load_dwordx4 v2, s[4:7], s93 offen offset:1024 sc1 lds
buffer_load_dwordx4 v2, s[4:7], s93 offen offset:2048 sc1 lds
buffer_load_dwordx4 v2, s[4:7], s93 offen offset:3072 sc1 lds
s_add_u32 s93, s93, 4096
s_add_u32 m0, s45, 8192
s_nop 0
buffer_load_dwordx4 v2, s[4:7], s93 offen offset:0 sc1 lds
buffer_load_dwordx4 v2, s[4:7], s93 offen offset:1024 sc1 lds
buffer_load_dwordx4 v2, s[4:7], s93 offen offset:2048 sc1 lds
buffer_load_dwordx4 v2, s[4:7], s93 offen offset:3072 sc1 lds
s_add_u32 s93, s93, 4096
s_add_u32 m0, s45, 12288
s_nop 0
buffer_load_dwordx4 v2, s[4:7], s93 offen offset:0 sc1 lds
buffer_load_dwordx4 v2, s[4:7], s93 offen offset:1024 sc1 lds
s_add_u32 s92, s31, 245760
buffer_load_dword v59, v9, s[4:7], s92 offen sc1
s_waitcnt vmcnt(0)
s_branch Lg2_faret13
Lg2_falate14:
s_add_u32 s92, s31, 245760
s_mov_b32 s90, 40000
Lpoll_91:
buffer_load_dword v59, v9, s[4:7], s92 offen sc1
s_waitcnt vmcnt(0)
v_cmp_ne_u32 vcc, s20, v59
s_cmp_eq_u64 vcc, 0
s_cbranch_scc1 Lpok_92

s_sub_u32 s90, s90, 1
s_cmp_lg_u32 s90, 0
s_cbranch_scc1 Lpoll_91
s_mov_b32 s8, s86
s_mov_b32 s9, s87
s_mov_b32 s10, 0x100
s_mov_b32 s11, 0x20000
v_mov_b32 v2, 0x8
v_mov_b32 v3, 0x20
s_nop 1
buffer_store_dword v2, v3, s[8:11], 0 offen
s_waitcnt vmcnt(0)
s_endpgm
Lpok_92:
s_waitcnt vmcnt(0)
s_add_u32 s93, s30, 0xca8000
s_add_u32 m0, s45, 55296
s_nop 0
buffer_load_dwordx4 v2, s[4:7], s93 offen offset:0 sc1 lds
buffer_load_dwordx4 v2, s[4:7], s93 offen offset:1024 sc1 lds
buffer_load_dwordx4 v2, s[4:7], s93 offen offset:2048 sc1 lds
buffer_load_dwordx4 v2, s[4:7], s93 offen offset:3072 sc1 lds
s_add_u32 s93, s93, 4096
s_add_u32 m0, s45, 59392
s_nop 0
buffer_load_dwordx4 v2, s[4:7], s93 offen offset:0 sc1 lds
buffer_load_dwordx4 v2, s[4:7], s93 offen offset:1024 sc1 lds
buffer_load_dwordx4 v2, s[4:7], s93 offen offset:2048 sc1 lds
buffer_load_dwordx4 v2, s[4:7], s93 offen offset:3072 sc1 lds
s_add_u32 s93, s93, 4096
s_add_u32 m0, s45, 63488
s_nop 0
buffer_load_dwordx4 v2, s[4:7], s93 offen offset:0 sc1 lds
buffer_load_dwordx4 v2, s[4:7], s93 offen offset:1024 sc1 lds
buffer_load_dwordx4 v2, s[4:7], s93 offen offset:2048 sc1 lds
buffer_load_dwordx4 v2, s[4:7], s93 offen offset:3072 sc1 lds
s_add_u32 s93, s93, 4096
s_add_u32 m0, s45, 67584
s_nop 0
buffer_load_dwordx4 v2, s[4:7], s93 offen offset:0 sc1 lds
buffer_load_dwordx4 v2, s[4:7], s93 offen offset:1024 sc1 lds
s_waitcnt vmcnt(0)
s_branch Lg2_faret14
Lg2_done:
Lfin:
s_cmp_lg_u32 s2, 0
s_cbranch_scc1 Lend
s_cmp_lg_u32 s3, 0
s_cbranch_scc1 Lend
s_mov_b32 s26, 0x1f80000
v_mov_b32 v2, s20
v_mov_b32 v3, 0
s_mov_b64 exec, 1
buffer_store_dword v2, v3, s[4:7], s26 offen sc1
Lend:
s_endpgm
.section .rodata,"a"
.p2align 6
.amdhsa_kernel interleave_layers__ssm_conv_h3__swiglu_ffn__prompt_kernel
  .amdhsa_next_free_vgpr 512
  .amdhsa_next_free_sgpr 102
  .amdhsa_accum_offset 256
  .amdhsa_group_segment_fixed_size 0
  .amdhsa_kernarg_size 104
  .amdhsa_user_sgpr_count 2
  .amdhsa_user_sgpr_kernarg_segment_ptr 1
  .amdhsa_system_sgpr_workgroup_id_x 1
.end_amdhsa_kernel
```
